```python
import torch

def _softmax(x, axis=-1):
    return torch.softmax(x, dim=axis)

def _gelu(x):
    return torch.nn.functional.gelu(x, approximate='tanh')

def _silu(x):
    return torch.nn.functional.silu(x)

def _sigmoid(x):
    return torch.sigmoid(x)

def _layernorm(x, axis=-1, eps=1e-05):
    m = x.mean(dim=axis, keepdim=True)
    v = x.var(dim=axis, keepdim=True, unbiased=False)
    return (x - m) / torch.sqrt(v + eps)

def _scatter_add(tgt, idx, src, axis=0):
    return tgt.clone().index_add_(axis, idx, src)

def _segment_sum(src, seg, n):
    out = torch.zeros((n,) + src.shape[1:], dtype=src.dtype)
    return out.index_add_(0, seg, src)

def _pad(x, pw):
    flat = tuple((v for pair in reversed(pw) for v in pair))
    return torch.nn.functional.pad(x, flat)
kernel_name = 'adaLN_cond__mha_block_cached__mixer_s_mlp__prompt'

def setup_inputs():

    _w = lambda a: (lambda t: t.to(torch.bfloat16) if t.is_floating_point() else t)(torch.as_tensor(a))

    def _A_setup():
        B, Sq, D = (1, 2048, 640)
        H, Sk, Dh = (32, 2048, 192)
        return {'x': _w((lambda *s: torch.randn(*s, dtype=torch.bfloat16) * 0.1)(B, Sq, D)), 'k_cache': _w((lambda *s: torch.randn(*s, dtype=torch.bfloat16) * 0.8)(B, H, Sk, Dh)), 'v_cache': _w((lambda *s: torch.randn(*s, dtype=torch.bfloat16) * 0.8)(B, H, Sk, Dh)), 'wq': _w((lambda *s: torch.randn(*s, dtype=torch.bfloat16) * 0.8)(D, H * Dh) * D ** (-0.5)), 'wo': _w((lambda *s: torch.randn(*s, dtype=torch.bfloat16) * 0.8)(H * Dh, D) * (H * Dh) ** (-0.5))}
    _A_in = _A_setup()

    def _B_setup():
        B, S, D, F = (1, 2048, 640, 1536)
        return {'x': _w((lambda *s: torch.randn(*s, dtype=torch.bfloat16) * 0.1)(B, S, D)), 'w1': _w((lambda *s: torch.randn(*s, dtype=torch.bfloat16) * 3.2)(D, D) * D ** (-0.5)), 'w2': _w((lambda *s: torch.randn(*s, dtype=torch.bfloat16) * 3.2)(D, D) * D ** (-0.5)), 'w3': _w((lambda *s: torch.randn(*s, dtype=torch.bfloat16) * 3.2)(D, F) * D ** (-0.5)), 'w4': _w((lambda *s: torch.randn(*s, dtype=torch.bfloat16) * 3.2)(F, D) * F ** (-0.5))}
    _B_in = _B_setup()
    return {'A_x': _A_in['x'], 'A_k_cache': _A_in['k_cache'], 'A_v_cache': _A_in['v_cache'], 'A_wq': _A_in['wq'], 'A_wo': _A_in['wo'], 'B_x': _B_in['x'], 'B_w1': _B_in['w1'], 'B_w2': _B_in['w2'], 'B_w3': _B_in['w3'], 'B_w4': _B_in['w4'], 'c': _w((lambda *s: torch.randn(*s, dtype=torch.bfloat16) * 0.2)(1, 640) * 8.0), 'w_mod': _w((lambda *s: torch.randn(*s, dtype=torch.bfloat16) * 0.2)(640, 6 * 640) * 640 ** (-0.5) * 8.0)}

def reference(A_x, A_k_cache, A_v_cache, A_wq, A_wo, B_x, B_w1, B_w2, B_w3, B_w4, c, w_mod):

    def _A_ref(x, k_cache, v_cache, wq, wo):
        B, Sq, D = x.shape
        H, Dh = (32, 192)
        q = (lambda x, *d: x.permute(*d))((x @ wq).reshape(B, Sq, H, Dh), 0, 2, 1, 3)
        scores = torch.einsum('bhqd,bhkd->bhqk', q, k_cache) * Dh ** (-0.5)
        p = _softmax(scores, axis=-1)
        o = torch.einsum('bhqk,bhkd->bhqd', p, v_cache)
        return (lambda x, *d: x.permute(*d))(o, 0, 2, 1, 3).reshape(B, Sq, H * Dh) @ wo

    def _B_ref(x, w1, w2, w3, w4):
        B, S, D = x.shape
        h = _gelu(_layernorm(x, axis=-1) @ w1)
        c = D // 4
        g0 = _pad(h[:, :, 0 * c:1 * c], ((0, 0), (1, 0), (0, 0)))[:, :S, :]
        g1 = _pad(h[:, :, 1 * c:2 * c], ((0, 0), (0, 1), (0, 0)))[:, 1:, :]
        g2 = _pad(h[:, :, 2 * c:3 * c], ((0, 0), (2, 0), (0, 0)))[:, :S, :]
        g3 = _pad(h[:, :, 3 * c:], ((0, 0), (0, 2), (0, 0)))[:, 2:, :]
        hs = torch.concatenate([g0, g1, g2, g3], axis=-1) @ w2
        x1 = x + hs
        h2 = _gelu(_layernorm(x1, axis=-1) @ w3) @ w4
        return x1 + h2
    x = A_x
    mod = (_silu(c) @ w_mod).reshape(c.shape[0], 6, 1, -1)
    sa, ca, ga, sb, cb, gb = (mod[:, 0].clone(), mod[:, 1].clone(), mod[:, 2].clone(), mod[:, 3].clone(), mod[:, 4].clone(), mod[:, 5].clone())
    h = _layernorm(x, axis=-1) * (1 + ca) + sa
    x = x + ga * _A_ref(h, A_k_cache, A_v_cache, A_wq, A_wo)
    h = _layernorm(x, axis=-1) * (1 + cb) + sb
    x = x + gb * _B_ref(h, B_w1, B_w2, B_w3, B_w4)
    return x
```

```asm
; @launch kernel=mod_kernel grid=(256,1,1) block=(256,1,1) lds=1024
; @launch kernel=attn_kernel grid=(256,1,1) block=(256,1,1) lds=156416
.amdgcn_target "amdgcn-amd-amdhsa--gfx950"
.text
.globl mod_kernel
.p2align 8
.type mod_kernel,@function
mod_kernel:
    s_cmp_ge_u32 s2, 256
    s_cbranch_scc1 L_mod_end
    s_load_dwordx4 s[8:11], s[0:1], 80
    s_load_dwordx2 s[6:7], s[0:1], 64
    s_load_dwordx2 s[4:5], s[0:1], 24
    s_load_dwordx2 s[12:13], s[0:1], 112
    v_and_b32 v4, 7, v0
    v_lshrrev_b32 v5, 3, v0
    s_mul_i32 s15, s2, 171
    s_lshr_b32 s15, s15, 9
    s_mul_i32 s3, s15, 3
    s_sub_u32 s3, s2, s3
    s_mov_b32 s14, 7680
    s_mov_b32 s34, 214
    s_cmp_eq_u32 s3, 2
    s_cmov_b32 s34, 212
    s_cmp_ge_u32 s2, 252
    s_cmov_b32 s34, 0
    s_cmp_ge_u32 s15, 60
    s_cmov_b32 s14, 3072
    s_cselect_b32 s29, 60, 0
    s_cselect_b64 s[30:31], -1, 0
    s_sub_u32 s29, s15, s29
    s_lshl_b32 s29, s29, 7
    s_mul_i32 s35, s3, 214
    s_mul_i32 s28, s35, s14
    s_add_u32 s28, s28, s29
    v_mul_lo_u32 v6, v5, s14
    v_lshlrev_b32 v7, 1, v5
    v_lshl_add_u32 v6, v4, 4, v6
    s_mul_i32 s22, s34, s14
    s_sub_u32 s22, s22, s29
    s_max_i32 s22, s22, 0
    s_mov_b32 s23, 0x20000
    s_lshl_b32 s26, s34, 1
    s_mov_b32 s27, 0x20000
    s_lshl_b32 s35, s35, 1
    s_lshl_b32 s14, s14, 5
    s_mov_b32 s33, 0
    s_waitcnt lgkmcnt(0)
    s_cmp_ge_u32 s15, 60
    s_cselect_b32 s20, s6, s10
    s_cselect_b32 s21, s7, s11
    s_add_u32 s20, s20, s28
    s_addc_u32 s21, s21, 0
    s_add_u32 s24, s8, s35
    s_addc_u32 s25, s9, 0
    buffer_load_dwordx4 v[8:11], v6, s[20:23], s33 offen
    s_add_u32 s33, s33, s14
    buffer_load_ushort v36, v7, s[24:27], 0 offen offset:0
    buffer_load_ushort v37, v7, s[24:27], 0 offen offset:64
    buffer_load_ushort v38, v7, s[24:27], 0 offen offset:128
    buffer_load_ushort v39, v7, s[24:27], 0 offen offset:192
    buffer_load_ushort v40, v7, s[24:27], 0 offen offset:256
    buffer_load_ushort v41, v7, s[24:27], 0 offen offset:320
    buffer_load_ushort v42, v7, s[24:27], 0 offen offset:384
    buffer_load_dwordx4 v[12:15], v6, s[20:23], s33 offen
    s_add_u32 s33, s33, s14
    buffer_load_dwordx4 v[16:19], v6, s[20:23], s33 offen
    s_add_u32 s33, s33, s14
    buffer_load_dwordx4 v[20:23], v6, s[20:23], s33 offen
    s_add_u32 s33, s33, s14
    buffer_load_dwordx4 v[24:27], v6, s[20:23], s33 offen
    s_add_u32 s33, s33, s14
    buffer_load_dwordx4 v[28:31], v6, s[20:23], s33 offen
    s_add_u32 s33, s33, s14
    buffer_load_dwordx4 v[32:35], v6, s[20:23], s33 offen
    s_add_u32 s33, s33, s14
    s_getpc_b64 s[46:47]
L_mod_npc:
    s_add_u32 s46, s46, attn_kernel-L_mod_npc
    s_addc_u32 s47, s47, 0
    v_lshlrev_b32 v63, 6, v0
    global_load_dword v63, v63, s[46:47]
    s_mul_i32 s28, s3, 21504
    s_lshl_b32 s29, s15, 8
    s_add_u32 s28, s28, s29
    s_add_u32 s28, s28, 163840
    s_add_u32 s36, s12, s28
    s_addc_u32 s37, s13, 0
    s_mov_b32 s38, 256
    s_mov_b32 s39, 0x20000
    s_cmp_ge_u32 s2, 252
    s_cmov_b32 s38, 0
    s_lshl_b32 s28, s2, 7
    s_add_u32 s28, s28, 229376
    s_add_u32 s40, s12, s28
    s_addc_u32 s41, s13, 0
    s_mov_b32 s42, 128
    s_mov_b32 s43, 0x20000
    v_lshlrev_b32 v60, 2, v0
    v_mov_b32 v61, 0
    buffer_store_dword v61, v60, s[40:43], 0 offen
    s_lshl_b32 s28, s2, 11
    s_add_u32 s28, s28, 3145728
    s_add_u32 s48, s12, s28
    s_addc_u32 s49, s13, 0
    s_mov_b32 s50, 2048
    s_mov_b32 s51, 0x20000
    buffer_store_dword v61, v60, s[48:51], 0 offen
    buffer_store_dword v61, v60, s[48:51], 0 offen offset:1024
    s_waitcnt vmcnt(10)
    v_lshlrev_b32 v36, 16, v36
    v_lshlrev_b32 v37, 16, v37
    v_lshlrev_b32 v38, 16, v38
    v_lshlrev_b32 v39, 16, v39
    v_lshlrev_b32 v40, 16, v40
    v_lshlrev_b32 v41, 16, v41
    v_lshlrev_b32 v42, 16, v42
    v_mul_f32 v44, 0xbfb8aa3b, v36
    v_mul_f32 v45, 0xbfb8aa3b, v37
    v_mul_f32 v46, 0xbfb8aa3b, v38
    v_mul_f32 v47, 0xbfb8aa3b, v39
    v_mul_f32 v48, 0xbfb8aa3b, v40
    v_mul_f32 v49, 0xbfb8aa3b, v41
    v_mul_f32 v50, 0xbfb8aa3b, v42
    v_exp_f32 v44, v44
    v_exp_f32 v45, v45
    v_exp_f32 v46, v46
    v_exp_f32 v47, v47
    v_exp_f32 v48, v48
    v_exp_f32 v49, v49
    v_exp_f32 v50, v50
    v_add_f32 v44, 1.0, v44
    v_add_f32 v45, 1.0, v45
    v_add_f32 v46, 1.0, v46
    v_add_f32 v47, 1.0, v47
    v_add_f32 v48, 1.0, v48
    v_add_f32 v49, 1.0, v49
    v_add_f32 v50, 1.0, v50
    v_rcp_f32 v44, v44
    v_rcp_f32 v45, v45
    v_rcp_f32 v46, v46
    v_rcp_f32 v47, v47
    v_rcp_f32 v48, v48
    v_rcp_f32 v49, v49
    v_rcp_f32 v50, v50
    v_mul_f32 v36, v36, v44
    v_mul_f32 v37, v37, v45
    v_mul_f32 v38, v38, v46
    v_mul_f32 v39, v39, v47
    v_mul_f32 v40, v40, v48
    v_mul_f32 v41, v41, v49
    v_mul_f32 v42, v42, v50
    v_cndmask_b32 v36, v36, 1.0, s[30:31]
    v_cndmask_b32 v37, v37, 1.0, s[30:31]
    v_cndmask_b32 v38, v38, 1.0, s[30:31]
    v_cndmask_b32 v39, v39, 1.0, s[30:31]
    v_cndmask_b32 v40, v40, 1.0, s[30:31]
    v_cndmask_b32 v41, v41, 1.0, s[30:31]
    v_cndmask_b32 v42, v42, 1.0, s[30:31]
    v_cvt_pk_bf16_f32 v36, v36, 0
    v_cvt_pk_bf16_f32 v37, v37, 0
    v_cvt_pk_bf16_f32 v38, v38, 0
    v_cvt_pk_bf16_f32 v39, v39, 0
    v_cvt_pk_bf16_f32 v40, v40, 0
    v_cvt_pk_bf16_f32 v41, v41, 0
    v_cvt_pk_bf16_f32 v42, v42, 0
    v_lshlrev_b32 v44, 16, v36
    v_lshlrev_b32 v45, 16, v37
    v_lshlrev_b32 v46, 16, v38
    v_lshlrev_b32 v47, 16, v39
    v_lshlrev_b32 v48, 16, v40
    v_lshlrev_b32 v49, 16, v41
    v_lshlrev_b32 v50, 16, v42
    v_mov_b32 v52, 0
    v_mov_b32 v53, 0
    v_mov_b32 v54, 0
    v_mov_b32 v55, 0
    v_mov_b32 v56, 0
    v_mov_b32 v57, 0
    v_mov_b32 v58, 0
    v_mov_b32 v59, 0
    s_waitcnt vmcnt(17)
    v_dot2c_f32_bf16 v52, v8, v36
    v_dot2c_f32_bf16 v53, v8, v44
    v_dot2c_f32_bf16 v54, v9, v36
    v_dot2c_f32_bf16 v55, v9, v44
    v_dot2c_f32_bf16 v56, v10, v36
    v_dot2c_f32_bf16 v57, v10, v44
    v_dot2c_f32_bf16 v58, v11, v36
    v_dot2c_f32_bf16 v59, v11, v44
    s_waitcnt vmcnt(9)
    v_dot2c_f32_bf16 v52, v12, v37
    v_dot2c_f32_bf16 v53, v12, v45
    v_dot2c_f32_bf16 v54, v13, v37
    v_dot2c_f32_bf16 v55, v13, v45
    v_dot2c_f32_bf16 v56, v14, v37
    v_dot2c_f32_bf16 v57, v14, v45
    v_dot2c_f32_bf16 v58, v15, v37
    v_dot2c_f32_bf16 v59, v15, v45
    s_waitcnt vmcnt(8)
    v_dot2c_f32_bf16 v52, v16, v38
    v_dot2c_f32_bf16 v53, v16, v46
    v_dot2c_f32_bf16 v54, v17, v38
    v_dot2c_f32_bf16 v55, v17, v46
    v_dot2c_f32_bf16 v56, v18, v38
    v_dot2c_f32_bf16 v57, v18, v46
    v_dot2c_f32_bf16 v58, v19, v38
    v_dot2c_f32_bf16 v59, v19, v46
    s_waitcnt vmcnt(7)
    v_dot2c_f32_bf16 v52, v20, v39
    v_dot2c_f32_bf16 v53, v20, v47
    v_dot2c_f32_bf16 v54, v21, v39
    v_dot2c_f32_bf16 v55, v21, v47
    v_dot2c_f32_bf16 v56, v22, v39
    v_dot2c_f32_bf16 v57, v22, v47
    v_dot2c_f32_bf16 v58, v23, v39
    v_dot2c_f32_bf16 v59, v23, v47
    s_waitcnt vmcnt(6)
    v_dot2c_f32_bf16 v52, v24, v40
    v_dot2c_f32_bf16 v53, v24, v48
    v_dot2c_f32_bf16 v54, v25, v40
    v_dot2c_f32_bf16 v55, v25, v48
    v_dot2c_f32_bf16 v56, v26, v40
    v_dot2c_f32_bf16 v57, v26, v48
    v_dot2c_f32_bf16 v58, v27, v40
    v_dot2c_f32_bf16 v59, v27, v48
    s_waitcnt vmcnt(5)
    v_dot2c_f32_bf16 v52, v28, v41
    v_dot2c_f32_bf16 v53, v28, v49
    v_dot2c_f32_bf16 v54, v29, v41
    v_dot2c_f32_bf16 v55, v29, v49
    v_dot2c_f32_bf16 v56, v30, v41
    v_dot2c_f32_bf16 v57, v30, v49
    v_dot2c_f32_bf16 v58, v31, v41
    v_dot2c_f32_bf16 v59, v31, v49
    s_waitcnt vmcnt(4)
    v_dot2c_f32_bf16 v52, v32, v42
    v_dot2c_f32_bf16 v53, v32, v50
    v_dot2c_f32_bf16 v54, v33, v42
    v_dot2c_f32_bf16 v55, v33, v50
    v_dot2c_f32_bf16 v56, v34, v42
    v_dot2c_f32_bf16 v57, v34, v50
    v_dot2c_f32_bf16 v58, v35, v42
    v_dot2c_f32_bf16 v59, v35, v50
    v_pk_mul_f32 v[8:9], v[52:53], 1.0 op_sel_hi:[1,0]
    v_pk_mul_f32 v[10:11], v[54:55], 1.0 op_sel_hi:[1,0]
    v_pk_mul_f32 v[12:13], v[56:57], 1.0 op_sel_hi:[1,0]
    v_pk_mul_f32 v[14:15], v[58:59], 1.0 op_sel_hi:[1,0]
    v_permlane32_swap_b32 v52, v8
    v_permlane32_swap_b32 v53, v9
    v_permlane32_swap_b32 v54, v10
    v_permlane32_swap_b32 v55, v11
    v_permlane32_swap_b32 v56, v12
    v_permlane32_swap_b32 v57, v13
    v_permlane32_swap_b32 v58, v14
    v_permlane32_swap_b32 v59, v15
    v_pk_add_f32 v[52:53], v[52:53], v[8:9]
    v_pk_add_f32 v[54:55], v[54:55], v[10:11]
    v_pk_add_f32 v[56:57], v[56:57], v[12:13]
    v_pk_add_f32 v[58:59], v[58:59], v[14:15]
    v_pk_mul_f32 v[8:9], v[52:53], 1.0 op_sel_hi:[1,0]
    v_pk_mul_f32 v[10:11], v[54:55], 1.0 op_sel_hi:[1,0]
    v_pk_mul_f32 v[12:13], v[56:57], 1.0 op_sel_hi:[1,0]
    v_pk_mul_f32 v[14:15], v[58:59], 1.0 op_sel_hi:[1,0]
    v_permlane16_swap_b32 v52, v8
    v_permlane16_swap_b32 v53, v9
    v_permlane16_swap_b32 v54, v10
    v_permlane16_swap_b32 v55, v11
    v_permlane16_swap_b32 v56, v12
    v_permlane16_swap_b32 v57, v13
    v_permlane16_swap_b32 v58, v14
    v_permlane16_swap_b32 v59, v15
    v_pk_add_f32 v[52:53], v[52:53], v[8:9]
    v_pk_add_f32 v[54:55], v[54:55], v[10:11]
    v_pk_add_f32 v[56:57], v[56:57], v[12:13]
    v_pk_add_f32 v[58:59], v[58:59], v[14:15]
    v_add_f32_dpp v52, v52, v52 row_ror:8 row_mask:0xf bank_mask:0xf
    v_add_f32_dpp v53, v53, v53 row_ror:8 row_mask:0xf bank_mask:0xf
    v_add_f32_dpp v54, v54, v54 row_ror:8 row_mask:0xf bank_mask:0xf
    v_add_f32_dpp v55, v55, v55 row_ror:8 row_mask:0xf bank_mask:0xf
    v_add_f32_dpp v56, v56, v56 row_ror:8 row_mask:0xf bank_mask:0xf
    v_add_f32_dpp v57, v57, v57 row_ror:8 row_mask:0xf bank_mask:0xf
    v_add_f32_dpp v58, v58, v58 row_ror:8 row_mask:0xf bank_mask:0xf
    v_add_f32_dpp v59, v59, v59 row_ror:8 row_mask:0xf bank_mask:0xf
    v_lshrrev_b32 v2, 6, v0
    v_lshlrev_b32 v2, 8, v2
    v_lshl_add_u32 v2, v4, 5, v2
    ds_write_b128 v2, v[52:55]
    ds_write_b128 v2, v[56:59] offset:16
    v_and_b32 v3, 63, v0
    v_lshlrev_b32 v3, 2, v3
    s_waitcnt lgkmcnt(0)
    s_barrier
    ds_read_b32 v8, v3 offset:0
    ds_read_b32 v9, v3 offset:256
    ds_read_b32 v10, v3 offset:512
    ds_read_b32 v11, v3 offset:768
    v_lshlrev_b32 v3, 2, v0
    s_waitcnt lgkmcnt(0)
    v_add_f32 v8, v8, v9
    v_add_f32 v10, v10, v11
    v_add_f32 v8, v8, v10
    buffer_store_dword v8, v3, s[36:39], 0 offen
L_mod_end:
    s_endpgm
.globl attn_kernel
.p2align 8
.type attn_kernel,@function
attn_kernel:
    s_cmp_ge_u32 s2, 256
    s_cbranch_scc1 L_attn_end
    s_load_dwordx4 s[32:35], s[0:1], 8
    s_load_dwordx2 s[36:37], s[0:1], 24
    s_load_dwordx2 s[38:39], s[0:1], 112
    s_load_dwordx2 s[62:63], s[0:1], 0
    v_lshrrev_b32 v236, 6, v0
    v_and_b32 v237, 63, v0
    v_readfirstlane_b32 s24, v236
    v_lshlrev_b32 v234, 4, v237
    s_and_b32 s3, s2, 7
    s_lshl_b32 s3, s3, 2
    s_lshr_b32 s50, s2, 3
    s_and_b32 s51, s50, 3
    s_add_u32 s3, s3, s51
    s_lshr_b32 s50, s50, 2
    s_mul_i32 s25, s24, 3072
    s_lshl_b32 s52, s24, 3
    v_and_b32 v1, 7, v0
    v_bfe_u32 v2, v0, 3, 2
    v_lshrrev_b32 v3, 5, v0
    v_mul_u32_u24 v8, 1280, v1
    v_lshl_add_u32 v8, v3, 6, v8
    v_lshl_add_u32 v8, v2, 4, v8
    v_lshlrev_b32 v9, 4, v0
    v_min_u32 v10, 48, v9
    s_lshl_b32 s51, s50, 5
    s_add_u32 s51, s51, s3
    s_mul_i32 s51, s51, 10240
    s_cmp_lt_u32 s24, 2
    s_cselect_b32 s44, 0, 0x7fff0000
    s_cmp_eq_u32 s24, 0
    s_cselect_b32 s45, 0, 0x7fff0000
    s_add_u32 s46, s45, 21504
    s_add_u32 s47, s45, 43008
    s_lshl_b32 s53, s2, 6
    s_add_u32 s53, s53, 5120
    s_mov_b32 s55, 21504
    s_mov_b32 s54, 43008
    v_add_u32 v10, s53, v10
    v_add_u32 v11, 4096, v9
    s_waitcnt lgkmcnt(0)
    s_add_u32 s64, s62, s51
    s_addc_u32 s65, s63, 0
    s_mov_b32 s66, 10240
    s_mov_b32 s67, 0x20000
    s_add_u32 s68, s38, 163840
    s_addc_u32 s69, s39, 0
    s_mov_b32 s70, 64512
    s_mov_b32 s71, 0x20000
    buffer_load_dwordx4 v[144:147], v8, s[64:67], 0 offen offset:0
    buffer_load_dwordx4 v[148:151], v8, s[64:67], 0 offen offset:512
    buffer_load_dwordx4 v[152:155], v8, s[64:67], s44 offen offset:1024
    buffer_load_dwordx4 v[24:27], v9, s[68:71], 0 offen
    buffer_load_dwordx4 v[28:31], v9, s[68:71], s55 offen
    buffer_load_dwordx4 v[32:35], v9, s[68:71], s54 offen
    buffer_load_dwordx4 v[36:39], v11, s[68:71], s45 offen
    buffer_load_dwordx4 v[40:43], v11, s[68:71], s46 offen
    buffer_load_dwordx4 v[44:47], v11, s[68:71], s47 offen
    buffer_load_dwordx4 v[48:51], v10, s[68:71], 0 offen
    buffer_load_dwordx4 v[52:55], v10, s[68:71], s55 offen
    buffer_load_dwordx4 v[56:59], v10, s[68:71], s54 offen
    v_mov_b32 v230, 0xff800000
    v_mov_b32 v231, 0xff800000
    v_mov_b32 v232, 0xff800000
    v_mov_b32 v233, 0xff800000
    s_lshl_b32 s51, s50, 4
    s_lshr_b32 s53, s3, 1
    s_add_u32 s51, s51, s53
    s_mul_i32 s51, s51, 20480
    s_add_u32 s51, s51, 262144
    s_add_u32 s76, s38, s51
    s_addc_u32 s77, s39, 0
    s_mov_b32 s78, 20480
    s_mov_b32 s79, 0x20000
    s_lshl_b32 s53, s2, 6
    s_add_u32 s53, s53, 5120
    s_add_u32 s68, s38, s53
    s_addc_u32 s69, s39, 0
    s_mov_b32 s70, 64
    s_mov_b32 s71, 0x20000
    s_lshl_b32 s51, s50, 5
    s_add_u32 s51, s51, s3
    s_lshl_b32 s51, s51, 7
    s_add_u32 s51, s51, 3375104
    s_add_u32 s64, s38, s51
    s_addc_u32 s65, s39, 0
    s_mov_b32 s66, 128
    s_mov_b32 s67, 0x20000
    s_and_b32 s53, s3, 1
    s_lshl_b32 s53, s53, 7
    s_mov_b32 s54, 0x3dd53b95
    s_mov_b32 s44, 0
    s_mov_b32 s45, 8192
    s_mov_b32 s46, 16384
    v_lshlrev_b32 v5, 10, v3
    v_lshl_add_u32 v5, v2, 8, v5
    v_lshl_add_u32 v5, v1, 4, v5
    v_add_u32 v5, s53, v5
    v_mul_u32_u24 v4, 48, v1
    v_add_u32 v4, 32768, v4
    v_lshrrev_b32 v6, 1, v3
    v_lshl_add_u32 v6, v6, 3, v4
    v_lshlrev_b32 v8, 7, v3
    v_lshl_add_u32 v8, v2, 5, v8
    v_add_u32 v8, 24576, v8
    v_add_u32 v11, 24576, v9
    v_mov_b32 v60, s54
    v_cmp_le_u32 vcc, 2560, v9
    s_cmp_ge_u32 s2, 160
    s_cselect_b64 s[54:55], -1, 0
    v_cndmask_b32 v61, 0, v60, vcc
    s_waitcnt vmcnt(9)
    v_lshlrev_b32 v64, 16, v144
    v_and_b32 v65, 0xffff0000, v144
    v_lshlrev_b32 v66, 16, v145
    v_and_b32 v67, 0xffff0000, v145
    v_lshlrev_b32 v68, 16, v146
    v_and_b32 v69, 0xffff0000, v146
    v_lshlrev_b32 v70, 16, v147
    v_and_b32 v71, 0xffff0000, v147
    v_lshlrev_b32 v72, 16, v148
    v_and_b32 v73, 0xffff0000, v148
    v_lshlrev_b32 v74, 16, v149
    v_and_b32 v75, 0xffff0000, v149
    v_lshlrev_b32 v76, 16, v150
    v_and_b32 v77, 0xffff0000, v150
    v_lshlrev_b32 v78, 16, v151
    v_and_b32 v79, 0xffff0000, v151
    v_lshlrev_b32 v80, 16, v152
    v_and_b32 v81, 0xffff0000, v152
    v_lshlrev_b32 v82, 16, v153
    v_and_b32 v83, 0xffff0000, v153
    v_lshlrev_b32 v84, 16, v154
    v_and_b32 v85, 0xffff0000, v154
    v_lshlrev_b32 v86, 16, v155
    v_and_b32 v87, 0xffff0000, v155
    v_pk_add_f32 v[62:63], v[64:65], v[66:67]
    v_pk_mul_f32 v[20:21], v[64:65], v[64:65]
    v_pk_fma_f32 v[20:21], v[66:67], v[66:67], v[20:21]
    v_pk_add_f32 v[62:63], v[62:63], v[68:69]
    v_pk_fma_f32 v[20:21], v[68:69], v[68:69], v[20:21]
    v_pk_add_f32 v[62:63], v[62:63], v[70:71]
    v_pk_fma_f32 v[20:21], v[70:71], v[70:71], v[20:21]
    v_pk_add_f32 v[62:63], v[62:63], v[72:73]
    v_pk_fma_f32 v[20:21], v[72:73], v[72:73], v[20:21]
    v_pk_add_f32 v[62:63], v[62:63], v[74:75]
    v_pk_fma_f32 v[20:21], v[74:75], v[74:75], v[20:21]
    v_pk_add_f32 v[62:63], v[62:63], v[76:77]
    v_pk_fma_f32 v[20:21], v[76:77], v[76:77], v[20:21]
    v_pk_add_f32 v[62:63], v[62:63], v[78:79]
    v_pk_fma_f32 v[20:21], v[78:79], v[78:79], v[20:21]
    v_pk_add_f32 v[62:63], v[62:63], v[80:81]
    v_pk_fma_f32 v[20:21], v[80:81], v[80:81], v[20:21]
    v_pk_add_f32 v[62:63], v[62:63], v[82:83]
    v_pk_fma_f32 v[20:21], v[82:83], v[82:83], v[20:21]
    v_pk_add_f32 v[62:63], v[62:63], v[84:85]
    v_pk_fma_f32 v[20:21], v[84:85], v[84:85], v[20:21]
    v_pk_add_f32 v[62:63], v[62:63], v[86:87]
    v_pk_fma_f32 v[20:21], v[86:87], v[86:87], v[20:21]
    v_add_f32 v62, v62, v63
    v_add_f32 v63, v20, v21
    v_mov_b32 v20, v62
    v_mov_b32 v21, v63
    s_nop 0
    v_permlane32_swap_b32 v62, v20
    v_permlane32_swap_b32 v63, v21
    v_add_f32 v62, v62, v20
    v_add_f32 v63, v63, v21
    v_mov_b32 v20, v62
    v_mov_b32 v21, v63
    s_nop 0
    v_permlane16_swap_b32 v62, v20
    v_permlane16_swap_b32 v63, v21
    v_add_f32 v62, v62, v20
    v_add_f32 v63, v63, v21
    s_nop 0
    v_add_f32_dpp v62, v62, v62 row_ror:8 row_mask:0xf bank_mask:0xf
    v_add_f32_dpp v63, v63, v63 row_ror:8 row_mask:0xf bank_mask:0xf
    ds_write_b64 v6, v[62:63]
    s_waitcnt vmcnt(6)
    v_pk_add_f32 v[24:25], v[24:25], v[28:29]
    v_pk_add_f32 v[26:27], v[26:27], v[30:31]
    v_pk_add_f32 v[24:25], v[24:25], v[32:33]
    v_pk_add_f32 v[26:27], v[26:27], v[34:35]
    v_cvt_pk_bf16_f32 v32, v24, v25
    v_cvt_pk_bf16_f32 v33, v26, v27
    v_lshlrev_b32 v28, 16, v32
    v_and_b32 v29, 0xffff0000, v32
    v_lshlrev_b32 v30, 16, v33
    v_and_b32 v31, 0xffff0000, v33
    v_fma_f32 v28, v28, v60, v61
    v_fma_f32 v29, v29, v60, v61
    v_fma_f32 v30, v30, v60, v61
    v_fma_f32 v31, v31, v60, v61
    ds_write_b128 v11, v[28:31]
    s_waitcnt vmcnt(3)
    v_pk_add_f32 v[36:37], v[36:37], v[40:41]
    v_pk_add_f32 v[38:39], v[38:39], v[42:43]
    v_pk_add_f32 v[36:37], v[36:37], v[44:45]
    v_pk_add_f32 v[38:39], v[38:39], v[46:47]
    v_cvt_pk_bf16_f32 v44, v36, v37
    v_cvt_pk_bf16_f32 v45, v38, v39
    v_lshlrev_b32 v40, 16, v44
    v_and_b32 v41, 0xffff0000, v44
    v_lshlrev_b32 v42, 16, v45
    v_and_b32 v43, 0xffff0000, v45
    v_fma_f32 v40, v40, v60, v60
    v_fma_f32 v41, v41, v60, v60
    v_fma_f32 v42, v42, v60, v60
    v_fma_f32 v43, v43, v60, v60
    ds_write_b128 v11, v[40:43] offset:4096
    s_waitcnt lgkmcnt(0)
    s_barrier
    ds_read_b128 v[24:27], v4
    ds_read_b128 v[28:31], v4 offset:16
    ds_read_b128 v[96:99], v8 offset:0
    ds_read_b128 v[100:103], v8 offset:16
    ds_read_b128 v[104:107], v8 offset:2560
    ds_read_b128 v[108:111], v8 offset:2576
    ds_read_b128 v[112:115], v8 offset:1024
    ds_read_b128 v[116:119], v8 offset:1040
    ds_read_b128 v[120:123], v8 offset:3584
    ds_read_b128 v[124:127], v8 offset:3600
    ds_read_b128 v[128:131], v8 offset:2048
    ds_read_b128 v[132:135], v8 offset:2064
    ds_read_b128 v[136:139], v8 offset:4608
    ds_read_b128 v[140:143], v8 offset:4624
    s_waitcnt lgkmcnt(12)
    v_add_f32 v24, v24, v28
    v_add_f32 v25, v25, v29
    v_add_f32 v26, v26, v30
    v_add_f32 v27, v27, v31
    v_add_f32 v62, v24, v26
    v_add_f32 v63, v25, v27
    v_mul_f32 v62, 0x3acccccd, v62
    v_mul_f32 v63, 0x3acccccd, v63
    v_fma_f32 v63, -v62, v62, v63
    v_max_f32 v63, 0, v63
    v_add_f32 v63, 0x3727c5ac, v63
    v_rsq_f32 v63, v63
    s_nop 0
    v_mul_f32 v62, v62, v63
    v_pk_fma_f32 v[64:65], v[64:65], v[62:63], v[62:63] op_sel:[0,1,0] op_sel_hi:[1,1,0] neg_lo:[0,0,1] neg_hi:[0,0,1]
    v_pk_fma_f32 v[66:67], v[66:67], v[62:63], v[62:63] op_sel:[0,1,0] op_sel_hi:[1,1,0] neg_lo:[0,0,1] neg_hi:[0,0,1]
    v_pk_fma_f32 v[68:69], v[68:69], v[62:63], v[62:63] op_sel:[0,1,0] op_sel_hi:[1,1,0] neg_lo:[0,0,1] neg_hi:[0,0,1]
    v_pk_fma_f32 v[70:71], v[70:71], v[62:63], v[62:63] op_sel:[0,1,0] op_sel_hi:[1,1,0] neg_lo:[0,0,1] neg_hi:[0,0,1]
    s_waitcnt lgkmcnt(8)
    v_pk_fma_f32 v[64:65], v[64:65], v[104:105], v[96:97]
    v_pk_fma_f32 v[66:67], v[66:67], v[106:107], v[98:99]
    v_pk_fma_f32 v[68:69], v[68:69], v[108:109], v[100:101]
    v_pk_fma_f32 v[70:71], v[70:71], v[110:111], v[102:103]
    v_cvt_pk_bf16_f32 v144, v64, v65
    v_cvt_pk_bf16_f32 v145, v66, v67
    v_cvt_pk_bf16_f32 v146, v68, v69
    v_cvt_pk_bf16_f32 v147, v70, v71
    buffer_store_dwordx4 v[144:147], v5, s[76:79], s44 offen sc1
    v_pk_fma_f32 v[72:73], v[72:73], v[62:63], v[62:63] op_sel:[0,1,0] op_sel_hi:[1,1,0] neg_lo:[0,0,1] neg_hi:[0,0,1]
    v_pk_fma_f32 v[74:75], v[74:75], v[62:63], v[62:63] op_sel:[0,1,0] op_sel_hi:[1,1,0] neg_lo:[0,0,1] neg_hi:[0,0,1]
    v_pk_fma_f32 v[76:77], v[76:77], v[62:63], v[62:63] op_sel:[0,1,0] op_sel_hi:[1,1,0] neg_lo:[0,0,1] neg_hi:[0,0,1]
    v_pk_fma_f32 v[78:79], v[78:79], v[62:63], v[62:63] op_sel:[0,1,0] op_sel_hi:[1,1,0] neg_lo:[0,0,1] neg_hi:[0,0,1]
    s_waitcnt lgkmcnt(4)
    v_pk_fma_f32 v[72:73], v[72:73], v[120:121], v[112:113]
    v_pk_fma_f32 v[74:75], v[74:75], v[122:123], v[114:115]
    v_pk_fma_f32 v[76:77], v[76:77], v[124:125], v[116:117]
    v_pk_fma_f32 v[78:79], v[78:79], v[126:127], v[118:119]
    v_cvt_pk_bf16_f32 v148, v72, v73
    v_cvt_pk_bf16_f32 v149, v74, v75
    v_cvt_pk_bf16_f32 v150, v76, v77
    v_cvt_pk_bf16_f32 v151, v78, v79
    buffer_store_dwordx4 v[148:151], v5, s[76:79], s45 offen sc1
    v_pk_fma_f32 v[80:81], v[80:81], v[62:63], v[62:63] op_sel:[0,1,0] op_sel_hi:[1,1,0] neg_lo:[0,0,1] neg_hi:[0,0,1]
    v_pk_fma_f32 v[82:83], v[82:83], v[62:63], v[62:63] op_sel:[0,1,0] op_sel_hi:[1,1,0] neg_lo:[0,0,1] neg_hi:[0,0,1]
    v_pk_fma_f32 v[84:85], v[84:85], v[62:63], v[62:63] op_sel:[0,1,0] op_sel_hi:[1,1,0] neg_lo:[0,0,1] neg_hi:[0,0,1]
    v_pk_fma_f32 v[86:87], v[86:87], v[62:63], v[62:63] op_sel:[0,1,0] op_sel_hi:[1,1,0] neg_lo:[0,0,1] neg_hi:[0,0,1]
    s_waitcnt lgkmcnt(0)
    v_pk_fma_f32 v[80:81], v[80:81], v[136:137], v[128:129]
    v_pk_fma_f32 v[82:83], v[82:83], v[138:139], v[130:131]
    v_pk_fma_f32 v[84:85], v[84:85], v[140:141], v[132:133]
    v_pk_fma_f32 v[86:87], v[86:87], v[142:143], v[134:135]
    v_cvt_pk_bf16_f32 v152, v80, v81
    v_cvt_pk_bf16_f32 v153, v82, v83
    v_cvt_pk_bf16_f32 v154, v84, v85
    v_cvt_pk_bf16_f32 v155, v86, v87
    buffer_store_dwordx4 v[152:155], v5, s[76:79], s46 offen sc1
    s_waitcnt vmcnt(3)
    v_pk_add_f32 v[48:49], v[48:49], v[52:53]
    v_pk_add_f32 v[50:51], v[50:51], v[54:55]
    v_pk_add_f32 v[48:49], v[48:49], v[56:57]
    v_pk_add_f32 v[50:51], v[50:51], v[58:59]
    v_cvt_pk_bf16_f32 v56, v48, v49
    v_cvt_pk_bf16_f32 v57, v50, v51
    v_lshlrev_b32 v52, 16, v56
    v_and_b32 v53, 0xffff0000, v56
    v_lshlrev_b32 v54, 16, v57
    v_and_b32 v55, 0xffff0000, v57
    v_cndmask_b32 v52, v52, v48, s[54:55]
    v_cndmask_b32 v53, v53, v49, s[54:55]
    v_cndmask_b32 v54, v54, v50, s[54:55]
    v_cndmask_b32 v55, v55, v51, s[54:55]
    v_mov_b32 v24, 1
    v_lshlrev_b32 v25, 2, v0
    v_and_b32 v26, 31, v0
    v_lshlrev_b32 v26, 7, v26
    s_waitcnt vmcnt(0)
    s_barrier
    buffer_store_dword v24, v25, s[64:67], 0 offen sc1
    buffer_store_dwordx4 v[52:55], v9, s[68:71], 0 offen sc1
    v_add_u32 v238, 0, v237
    v_mul_u32_u24 v241, 2731, v238
    v_lshrrev_b32 v241, 16, v241
    v_mul_u32_u24 v240, 24, v241
    v_sub_u32 v240, v238, v240
    v_add_u32 v241, s52, v241
    v_bfe_u32 v239, v241, 1, 1
    v_lshlrev_b32 v239, 2, v239
    v_xor_b32 v239, v239, v240
    v_lshlrev_b32 v239, 4, v239
    v_subrev_u32 v239, 0, v239
    v_mul_u32_u24 v238, 12288, v241
    v_add_u32 v198, v238, v239
    v_add_u32 v238, 64, v237
    v_mul_u32_u24 v243, 2731, v238
    v_lshrrev_b32 v243, 16, v243
    v_mul_u32_u24 v242, 24, v243
    v_sub_u32 v242, v238, v242
    v_add_u32 v243, s52, v243
    v_bfe_u32 v239, v243, 1, 1
    v_lshlrev_b32 v239, 2, v239
    v_xor_b32 v239, v239, v242
    v_lshlrev_b32 v239, 4, v239
    v_subrev_u32 v239, 1024, v239
    v_mul_u32_u24 v238, 12288, v243
    v_add_u32 v199, v238, v239
    v_add_u32 v238, 128, v237
    v_mul_u32_u24 v245, 2731, v238
    v_lshrrev_b32 v245, 16, v245
    v_mul_u32_u24 v244, 24, v245
    v_sub_u32 v244, v238, v244
    v_add_u32 v245, s52, v245
    v_bfe_u32 v239, v245, 1, 1
    v_lshlrev_b32 v239, 2, v239
    v_xor_b32 v239, v239, v244
    v_lshlrev_b32 v239, 4, v239
    v_subrev_u32 v239, 2048, v239
    v_mul_u32_u24 v238, 12288, v245
    v_add_u32 v200, v238, v239
    v_add_u32 v201, 0, v234
    v_add_u32 v202, 20480, v234
    v_add_u32 v203, 40960, v234
    v_add_u32 v204, 61440, v234
    s_waitcnt lgkmcnt(0)
    s_mul_i32 s51, s3, 384
    s_add_u32 s12, s36, s51
    s_addc_u32 s13, s37, 0
    s_sub_u32 s14, 7864320, s51
    s_mov_b32 s15, 0x20000
    s_lshl_b32 s52, s50, 2
    s_add_u32 s52, s52, s24
    s_lshl_b32 s52, s52, 2
    s_mul_i32 s51, s52, 20480
    s_add_u32 s51, s51, 262144
    s_add_u32 s16, s38, s51
    s_addc_u32 s17, s39, 0
    s_mov_b32 s18, 81920
    s_mov_b32 s19, 0x20000
    s_mov_b32 s30, 0
    s_mov_b32 s26, 0
    s_mov_b32 s27, 0
    s_mov_b32 s29, 0
    s_mov_b32 s31, 0
    s_add_u32 m0, s25, 73728
    s_nop 0
    buffer_load_dwordx4 v198, s[12:15], s30 offen offset:0  lds
    buffer_load_dwordx4 v199, s[12:15], s30 offen offset:1024  lds
    buffer_load_dwordx4 v200, s[12:15], s30 offen offset:2048  lds
    s_add_u32 s30, s30, 393216
    s_add_u32 m0, s25, 86016
    s_nop 0
    buffer_load_dwordx4 v198, s[12:15], s30 offen offset:0  lds
    buffer_load_dwordx4 v199, s[12:15], s30 offen offset:1024  lds
    buffer_load_dwordx4 v200, s[12:15], s30 offen offset:2048  lds
    s_add_u32 s30, s30, 393216
    s_add_u32 m0, s25, 49152
    s_nop 0
    buffer_load_dwordx4 v198, s[12:15], s30 offen offset:0  lds
    buffer_load_dwordx4 v199, s[12:15], s30 offen offset:1024  lds
    buffer_load_dwordx4 v200, s[12:15], s30 offen offset:2048  lds
    s_add_u32 s30, s30, 393216
    s_add_u32 m0, s25, 61440
    s_nop 0
    buffer_load_dwordx4 v198, s[12:15], s30 offen offset:0  lds
    buffer_load_dwordx4 v199, s[12:15], s30 offen offset:1024  lds
    buffer_load_dwordx4 v200, s[12:15], s30 offen offset:2048  lds
    s_add_u32 s30, s30, 393216
    s_load_dwordx2 s[76:77], s[0:1], 32
    s_load_dwordx4 s[68:71], s[0:1], 48
    s_load_dwordx4 s[72:75], s[0:1], 64
    v_bfe_u32 v8, v237, 2, 2
    v_lshrrev_b32 v9, 4, v237
    v_lshl_add_u32 v9, v9, 3, v8
    v_mul_u32_u24 v9, 384, v9
    v_and_b32 v10, 3, v237
    v_lshl_add_u32 v9, v10, 4, v9
    v_lshrrev_b32 v8, 1, v8
    v_xor_b32 v10, 0, v8
    v_lshl_add_u32 v192, v10, 6, v9
    v_add_u32 v194, 49152, v192
    v_add_u32 v196, 98304, v192
    v_xor_b32 v10, 1, v8
    v_lshl_add_u32 v193, v10, 6, v9
    v_add_u32 v195, 49152, v193
    v_add_u32 v197, 98304, v193
    s_lshr_b32 s50, s2, 5
    s_lshl_b32 s50, s50, 12
    s_add_u32 s50, s50, 3375104
    s_add_u32 s64, s38, s50
    s_addc_u32 s65, s39, 0
    s_mov_b32 s66, 4096
    s_mov_b32 s67, 0x20000
    s_cmp_lg_u32 s24, 0
    s_cbranch_scc1 L_attn_got
    s_mov_b32 s50, 0x100000
L_attn_poll:
    buffer_load_dword v27, v26, s[64:67], 0 offen sc1
    s_waitcnt vmcnt(0)
    v_cmp_ne_u32 vcc, 1, v27
    s_sub_u32 s50, s50, 1
    s_nop 3
    s_cbranch_vccz L_attn_got
    s_cmp_eq_u32 s50, 0
    s_cbranch_scc1 L_attn_got
    s_branch L_attn_poll
L_attn_got:
    s_barrier
    buffer_load_dwordx4 a[0:3], v201, s[16:19], s31 offen offset:0 sc1
    buffer_load_dwordx4 a[4:7], v202, s[16:19], s31 offen offset:0 sc1
    buffer_load_dwordx4 a[8:11], v203, s[16:19], s31 offen offset:0 sc1
    buffer_load_dwordx4 a[12:15], v204, s[16:19], s31 offen offset:0 sc1
    buffer_load_dwordx4 a[16:19], v201, s[16:19], s31 offen offset:1024 sc1
    buffer_load_dwordx4 a[20:23], v202, s[16:19], s31 offen offset:1024 sc1
    buffer_load_dwordx4 a[24:27], v203, s[16:19], s31 offen offset:1024 sc1
    buffer_load_dwordx4 a[28:31], v204, s[16:19], s31 offen offset:1024 sc1
    s_getpc_b64 s[54:55]
L_attn_pc:
    v_lshlrev_b32 v238, 6, v0
    v_min_u32 v239, L_attn_fallback-L_attn_pc, v238
    global_load_dword v252, v239, s[54:55]
    v_add_u32 v238, 16384, v238
    v_min_u32 v239, L_attn_fallback-L_attn_pc, v238
    global_load_dword v253, v239, s[54:55]
    v_add_u32 v238, 16384, v238
    v_min_u32 v239, L_attn_fallback-L_attn_pc, v238
    global_load_dword v254, v239, s[54:55]
    s_waitcnt vmcnt(3) lgkmcnt(0)
    s_barrier
    ds_read_b64_tr_b16 a[192:193], v194 offset:24576
    ds_read_b64_tr_b16 a[194:195], v194 offset:26112
    ds_read_b64_tr_b16 a[196:197], v194 offset:36864
    ds_read_b64_tr_b16 a[198:199], v194 offset:38400
    ds_read_b64_tr_b16 a[200:201], v194 offset:24584
    ds_read_b64_tr_b16 a[202:203], v194 offset:26120
    ds_read_b64_tr_b16 a[204:205], v194 offset:36872
    ds_read_b64_tr_b16 a[206:207], v194 offset:38408
    ds_read_b64_tr_b16 a[208:209], v195 offset:24576
    ds_read_b64_tr_b16 a[210:211], v195 offset:26112
    ds_read_b64_tr_b16 a[212:213], v195 offset:36864
    ds_read_b64_tr_b16 a[214:215], v195 offset:38400
    s_waitcnt lgkmcnt(4)
    v_mfma_f32_16x16x32_bf16 v[0:3], a[192:195], a[0:3], 0
    ds_read_b64_tr_b16 a[216:217], v195 offset:24584
    v_mfma_f32_16x16x32_bf16 v[0:3], a[196:199], a[16:19], v[0:3]
    buffer_load_dwordx4 a[32:35], v201, s[16:19], s31 offen offset:2048 sc1
    v_mfma_f32_16x16x32_bf16 v[8:11], a[192:195], a[4:7], 0
    ds_read_b64_tr_b16 a[218:219], v195 offset:26120
    s_mul_i32 s51, s3, 786432
    v_mfma_f32_16x16x32_bf16 v[8:11], a[196:199], a[20:23], v[8:11]
    s_add_u32 s4, s32, s51
    s_addc_u32 s5, s33, 0
    s_mov_b32 s6, 786432
    s_mov_b32 s7, 0x20000
    v_mfma_f32_16x16x32_bf16 v[16:19], a[192:195], a[8:11], 0
    ds_read_b64_tr_b16 a[220:221], v195 offset:36872
    v_mfma_f32_16x16x32_bf16 v[16:19], a[196:199], a[24:27], v[16:19]
    buffer_load_dwordx4 a[36:39], v202, s[16:19], s31 offen offset:2048 sc1
    v_mfma_f32_16x16x32_bf16 v[24:27], a[192:195], a[12:15], 0
    ds_read_b64_tr_b16 a[222:223], v195 offset:38408
    v_mfma_f32_16x16x32_bf16 v[24:27], a[196:199], a[28:31], v[24:27]
    s_add_u32 s8, s34, s51
    s_addc_u32 s9, s35, 0
    s_mov_b32 s10, 786432
    s_mov_b32 s11, 0x20000
    v_mfma_f32_16x16x32_bf16 v[4:7], a[200:203], a[0:3], 0
    ds_read_b64_tr_b16 a[224:225], v194 offset:24704
    v_mfma_f32_16x16x32_bf16 v[4:7], a[204:207], a[16:19], v[4:7]
    buffer_load_dwordx4 a[40:43], v203, s[16:19], s31 offen offset:2048 sc1
    v_mfma_f32_16x16x32_bf16 v[12:15], a[200:203], a[4:7], 0
    ds_read_b64_tr_b16 a[226:227], v194 offset:26240
    v_mfma_f32_16x16x32_bf16 v[12:15], a[204:207], a[20:23], v[12:15]
    s_mul_i32 s51, s52, 196608
    s_mul_i32 s53, s3, 6144
    s_add_u32 s51, s51, s53
    s_add_u32 s51, s51, 4194304
    v_mfma_f32_16x16x32_bf16 v[20:23], a[200:203], a[8:11], 0
    ds_read_b64_tr_b16 a[228:229], v194 offset:36992
    v_mfma_f32_16x16x32_bf16 v[20:23], a[204:207], a[24:27], v[20:23]
    buffer_load_dwordx4 a[44:47], v204, s[16:19], s31 offen offset:2048 sc1
    v_mfma_f32_16x16x32_bf16 v[28:31], a[200:203], a[12:15], 0
    ds_read_b64_tr_b16 a[230:231], v194 offset:38528
    v_mfma_f32_16x16x32_bf16 v[28:31], a[204:207], a[28:31], v[28:31]
    s_waitcnt lgkmcnt(4)
    v_mfma_f32_16x16x32_bf16 v[32:35], a[208:211], a[0:3], 0
    ds_read_b64_tr_b16 a[232:233], v194 offset:24712
    v_mfma_f32_16x16x32_bf16 v[32:35], a[212:215], a[16:19], v[32:35]
    buffer_load_dwordx4 a[48:51], v201, s[16:19], s31 offen offset:3072 sc1
    v_mfma_f32_16x16x32_bf16 v[40:43], a[208:211], a[4:7], 0
    ds_read_b64_tr_b16 a[234:235], v194 offset:26248
    v_mfma_f32_16x16x32_bf16 v[40:43], a[212:215], a[20:23], v[40:43]
    s_add_u32 s20, s38, s51
    s_addc_u32 s21, s39, 0
    s_mov_b32 s22, 595968
    s_mov_b32 s23, 0x20000
    v_mfma_f32_16x16x32_bf16 v[48:51], a[208:211], a[8:11], 0
    ds_read_b64_tr_b16 a[236:237], v194 offset:37000
    v_mul_u32_u24 v238, 384, v241
    v_mfma_f32_16x16x32_bf16 v[48:51], a[212:215], a[24:27], v[48:51]
    v_subrev_u32 v238, 0, v238
    v_bfe_u32 v239, v241, 1, 2
    v_mfma_f32_16x16x32_bf16 v[56:59], a[208:211], a[12:15], 0
    ds_read_b64_tr_b16 a[238:239], v194 offset:38536
    v_lshlrev_b32 v239, 1, v239
    v_mfma_f32_16x16x32_bf16 v[56:59], a[212:215], a[28:31], v[56:59]
    buffer_load_dwordx4 a[52:55], v202, s[16:19], s31 offen offset:3072 sc1
    v_mfma_f32_16x16x32_bf16 v[36:39], a[216:219], a[0:3], 0
    ds_read_b64_tr_b16 a[192:193], v195 offset:24704
    v_xor_b32 v239, v239, v240
    v_mfma_f32_16x16x32_bf16 v[36:39], a[220:223], a[16:19], v[36:39]
    v_lshl_add_u32 v223, v239, 4, v238
    v_bfe_u32 v239, v241, 1, 3
    v_mfma_f32_16x16x32_bf16 v[44:47], a[216:219], a[4:7], 0
    ds_read_b64_tr_b16 a[194:195], v195 offset:26240
    v_xor_b32 v239, v239, v240
    v_mfma_f32_16x16x32_bf16 v[44:47], a[220:223], a[20:23], v[44:47]
    buffer_load_dwordx4 a[56:59], v203, s[16:19], s31 offen offset:3072 sc1
    v_mfma_f32_16x16x32_bf16 v[52:55], a[216:219], a[8:11], 0
    ds_read_b64_tr_b16 a[196:197], v195 offset:36992
    v_lshl_add_u32 v220, v239, 4, v238
    v_mfma_f32_16x16x32_bf16 v[52:55], a[220:223], a[24:27], v[52:55]
    v_mul_u32_u24 v238, 384, v243
    v_subrev_u32 v238, 1024, v238
    v_mfma_f32_16x16x32_bf16 v[60:63], a[216:219], a[12:15], 0
    ds_read_b64_tr_b16 a[198:199], v195 offset:38528
    v_bfe_u32 v239, v243, 1, 2
    v_mfma_f32_16x16x32_bf16 v[60:63], a[220:223], a[28:31], v[60:63]
    s_waitcnt lgkmcnt(4)
    v_lshlrev_b32 v239, 1, v239
    v_mfma_f32_16x16x32_bf16 v[64:67], a[224:227], a[0:3], 0
    ds_read_b64_tr_b16 a[200:201], v195 offset:24712
    v_xor_b32 v239, v239, v242
    v_mfma_f32_16x16x32_bf16 v[64:67], a[228:231], a[16:19], v[64:67]
    buffer_load_dwordx4 a[60:63], v204, s[16:19], s31 offen offset:3072 sc1
    v_mfma_f32_16x16x32_bf16 v[72:75], a[224:227], a[4:7], 0
    ds_read_b64_tr_b16 a[202:203], v195 offset:26248
    s_add_u32 s31, s31, 4096
    v_mfma_f32_16x16x32_bf16 v[72:75], a[228:231], a[20:23], v[72:75]
    buffer_load_dwordx4 a[64:67], v201, s[16:19], s31 offen offset:0 sc1
    v_mfma_f32_16x16x32_bf16 v[80:83], a[224:227], a[8:11], 0
    ds_read_b64_tr_b16 a[204:205], v195 offset:37000
    v_lshl_add_u32 v224, v239, 4, v238
    v_mfma_f32_16x16x32_bf16 v[80:83], a[228:231], a[24:27], v[80:83]
    v_bfe_u32 v239, v243, 1, 3
    v_xor_b32 v239, v239, v242
    v_mfma_f32_16x16x32_bf16 v[88:91], a[224:227], a[12:15], 0
    ds_read_b64_tr_b16 a[206:207], v195 offset:38536
    v_lshl_add_u32 v221, v239, 4, v238
    v_mfma_f32_16x16x32_bf16 v[88:91], a[228:231], a[28:31], v[88:91]
    buffer_load_dwordx4 a[68:71], v202, s[16:19], s31 offen offset:0 sc1
    v_mfma_f32_16x16x32_bf16 v[68:71], a[232:235], a[0:3], 0
    ds_read_b64_tr_b16 a[208:209], v194 offset:24832
    v_mul_u32_u24 v238, 384, v245
    v_mfma_f32_16x16x32_bf16 v[68:71], a[236:239], a[16:19], v[68:71]
    v_subrev_u32 v238, 2048, v238
    v_bfe_u32 v239, v245, 1, 2
    v_mfma_f32_16x16x32_bf16 v[76:79], a[232:235], a[4:7], 0
    ds_read_b64_tr_b16 a[210:211], v194 offset:26368
    v_lshlrev_b32 v239, 1, v239
    v_mfma_f32_16x16x32_bf16 v[76:79], a[236:239], a[20:23], v[76:79]
    v_xor_b32 v239, v239, v244
    v_lshl_add_u32 v225, v239, 4, v238
    v_mfma_f32_16x16x32_bf16 v[84:87], a[232:235], a[8:11], 0
    ds_read_b64_tr_b16 a[212:213], v194 offset:37120
    v_bfe_u32 v239, v245, 1, 3
    v_mfma_f32_16x16x32_bf16 v[84:87], a[236:239], a[24:27], v[84:87]
    buffer_load_dwordx4 a[72:75], v203, s[16:19], s31 offen offset:0 sc1
    v_mfma_f32_16x16x32_bf16 v[92:95], a[232:235], a[12:15], 0
    ds_read_b64_tr_b16 a[214:215], v194 offset:38656
    v_xor_b32 v239, v239, v244
    v_mfma_f32_16x16x32_bf16 v[92:95], a[236:239], a[28:31], v[92:95]
    s_waitcnt lgkmcnt(4)
    v_lshl_add_u32 v222, v239, 4, v238
    v_mfma_f32_16x16x32_bf16 v[96:99], a[192:195], a[0:3], 0
    ds_read_b64_tr_b16 a[216:217], v194 offset:24840
    v_add_u32 v235, 4096, v234
    v_mfma_f32_16x16x32_bf16 v[96:99], a[196:199], a[16:19], v[96:99]
    buffer_load_dwordx4 a[76:79], v204, s[16:19], s31 offen offset:0 sc1
    v_mfma_f32_16x16x32_bf16 v[104:107], a[192:195], a[4:7], 0
    ds_read_b64_tr_b16 a[218:219], v194 offset:26376
    v_and_b32 v238, 15, v237
    v_mfma_f32_16x16x32_bf16 v[104:107], a[196:199], a[20:23], v[104:107]
    v_lshrrev_b32 v239, 4, v237
    v_lshrrev_b32 v240, 1, v238
    v_mfma_f32_16x16x32_bf16 v[112:115], a[192:195], a[8:11], 0
    ds_read_b64_tr_b16 a[220:221], v194 offset:37128
    v_mul_u32_u24 v238, 384, v238
    v_mfma_f32_16x16x32_bf16 v[112:115], a[196:199], a[24:27], v[112:115]
    buffer_load_dwordx4 a[80:83], v201, s[16:19], s31 offen offset:1024 sc1
    v_mfma_f32_16x16x32_bf16 v[120:123], a[192:195], a[12:15], 0
    ds_read_b64_tr_b16 a[222:223], v194 offset:38664
    v_add_u32 v241, 0, v239
    v_mfma_f32_16x16x32_bf16 v[120:123], a[196:199], a[28:31], v[120:123]
    v_xor_b32 v241, v241, v240
    v_lshl_add_u32 v214, v241, 4, v238
    v_mfma_f32_16x16x32_bf16 v[100:103], a[200:203], a[0:3], 0
    ds_read_b64_tr_b16 a[224:225], v195 offset:24832
    v_add_u32 v241, 4, v239
    v_mfma_f32_16x16x32_bf16 v[100:103], a[204:207], a[16:19], v[100:103]
    buffer_load_dwordx4 a[84:87], v202, s[16:19], s31 offen offset:1024 sc1
    v_mfma_f32_16x16x32_bf16 v[108:111], a[200:203], a[4:7], 0
    ds_read_b64_tr_b16 a[226:227], v195 offset:26368
    v_xor_b32 v241, v241, v240
    v_mfma_f32_16x16x32_bf16 v[108:111], a[204:207], a[20:23], v[108:111]
    v_lshl_add_u32 v215, v241, 4, v238
    v_bfe_u32 v238, v237, 2, 2
    v_mfma_f32_16x16x32_bf16 v[116:119], a[200:203], a[8:11], 0
    ds_read_b64_tr_b16 a[228:229], v195 offset:37120
    v_lshl_add_u32 v240, v239, 2, v238
    v_mfma_f32_16x16x32_bf16 v[116:119], a[204:207], a[24:27], v[116:119]
    v_and_b32 v242, 3, v237
    v_bfe_u32 v241, v240, 1, 2
    v_mfma_f32_16x16x32_bf16 v[124:127], a[200:203], a[12:15], 0
    ds_read_b64_tr_b16 a[230:231], v195 offset:38656
    v_mul_u32_u24 v240, 384, v240
    v_mfma_f32_16x16x32_bf16 v[124:127], a[204:207], a[28:31], v[124:127]
    s_waitcnt lgkmcnt(4)
    v_lshl_add_u32 v238, v242, 3, v240
    v_mfma_f32_16x16x32_bf16 v[128:131], a[208:211], a[0:3], 0
    ds_read_b64_tr_b16 a[232:233], v195 offset:24840
    v_xor_b32 v243, 0, v241
    v_mfma_f32_16x16x32_bf16 v[128:131], a[212:215], a[16:19], v[128:131]
    buffer_load_dwordx4 a[88:91], v203, s[16:19], s31 offen offset:1024 sc1
    v_mfma_f32_16x16x32_bf16 v[136:139], a[208:211], a[4:7], 0
    ds_read_b64_tr_b16 a[234:235], v195 offset:26376
    v_lshl_add_u32 v216, v243, 5, v238
    v_mfma_f32_16x16x32_bf16 v[136:139], a[212:215], a[20:23], v[136:139]
    buffer_load_dwordx4 a[92:95], v204, s[16:19], s31 offen offset:1024 sc1
    v_mfma_f32_16x16x32_bf16 v[144:147], a[208:211], a[8:11], 0
    ds_read_b64_tr_b16 a[236:237], v195 offset:37128
    v_xor_b32 v243, 1, v241
    v_mfma_f32_16x16x32_bf16 v[144:147], a[212:215], a[24:27], v[144:147]
    v_lshl_add_u32 v217, v243, 5, v238
    v_xor_b32 v243, 2, v241
    v_mfma_f32_16x16x32_bf16 v[152:155], a[208:211], a[12:15], 0
    ds_read_b64_tr_b16 a[238:239], v195 offset:38664
    v_lshl_add_u32 v218, v243, 5, v238
    v_mfma_f32_16x16x32_bf16 v[152:155], a[212:215], a[28:31], v[152:155]
    v_xor_b32 v243, 3, v241
    v_lshl_add_u32 v219, v243, 5, v238
    v_mfma_f32_16x16x32_bf16 v[132:135], a[216:219], a[0:3], 0
    s_mov_b64 s[32:33], s[76:77]
    v_mfma_f32_16x16x32_bf16 v[132:135], a[220:223], a[16:19], v[132:135]
    s_lshl_b32 s50, s24, 8
    s_add_u32 s50, s50, s2
    v_mfma_f32_16x16x32_bf16 v[140:143], a[216:219], a[4:7], 0
    s_mov_b32 s34, 10
    s_mov_b32 s35, 1280
    s_mov_b32 s36, 192
    s_mov_b32 s37, 16
    s_mov_b32 s44, 83886080
    s_mov_b32 s45, 0
    s_mov_b32 s46, 6554
    v_mfma_f32_16x16x32_bf16 v[140:143], a[220:223], a[20:23], v[140:143]
    s_cmp_ge_u32 s50, 480
    s_cmov_b32 s34, 5
    s_cmov_b32 s35, 1280
    s_cmov_b32 s36, 48
    s_cmov_b32 s37, 16
    s_cmov_b32 s44, 92274688
    s_cmov_b32 s45, 480
    s_cmov_b32 s46, 13108
    s_cselect_b32 s32, s74, s32
    s_cselect_b32 s33, s75, s33
    v_mfma_f32_16x16x32_bf16 v[148:151], a[216:219], a[8:11], 0
    s_waitcnt vmcnt(8) lgkmcnt(0)
    s_barrier
    v_mfma_f32_16x16x32_bf16 v[148:151], a[220:223], a[24:27], v[148:151]
    ds_read_b64_tr_b16 a[192:193], v194 offset:0
    s_add_u32 m0, s25, 98304
    v_mfma_f32_16x16x32_bf16 v[156:159], a[216:219], a[12:15], 0
    ds_read_b64_tr_b16 a[194:195], v194 offset:1536
    v_mfma_f32_16x16x32_bf16 v[156:159], a[220:223], a[28:31], v[156:159]
    ds_read_b64_tr_b16 a[196:197], v194 offset:12288
    s_waitcnt lgkmcnt(3)
    v_mfma_f32_16x16x32_bf16 v[160:163], a[224:227], a[0:3], 0
    ds_read_b64_tr_b16 a[198:199], v194 offset:13824
    v_mfma_f32_16x16x32_bf16 v[160:163], a[228:231], a[16:19], v[160:163]
    ds_read_b64_tr_b16 a[200:201], v194 offset:8
    v_mfma_f32_16x16x32_bf16 v[168:171], a[224:227], a[4:7], 0
    ds_read_b64_tr_b16 a[202:203], v194 offset:1544
    v_mfma_f32_16x16x32_bf16 v[168:171], a[228:231], a[20:23], v[168:171]
    buffer_load_dwordx4 v198, s[12:15], s30 offen offset:0  lds
    v_mfma_f32_16x16x32_bf16 v[176:179], a[224:227], a[8:11], 0
    ds_read_b64_tr_b16 a[204:205], v194 offset:12296
    v_mfma_f32_16x16x32_bf16 v[176:179], a[228:231], a[24:27], v[176:179]
    buffer_load_dwordx4 v199, s[12:15], s30 offen offset:1024  lds
    v_mfma_f32_16x16x32_bf16 v[184:187], a[224:227], a[12:15], 0
    ds_read_b64_tr_b16 a[206:207], v194 offset:13832
    v_mfma_f32_16x16x32_bf16 v[184:187], a[228:231], a[28:31], v[184:187]
    buffer_load_dwordx4 v200, s[12:15], s30 offen offset:2048  lds
    v_mfma_f32_16x16x32_bf16 v[164:167], a[232:235], a[0:3], 0
    ds_read_b64_tr_b16 a[208:209], v195 offset:0
    s_add_u32 s30, s30, 393216
    v_mfma_f32_16x16x32_bf16 v[164:167], a[236:239], a[16:19], v[164:167]
    s_add_u32 m0, s25, 110592
    v_mfma_f32_16x16x32_bf16 v[172:175], a[232:235], a[4:7], 0
    ds_read_b64_tr_b16 a[210:211], v195 offset:1536
    v_mfma_f32_16x16x32_bf16 v[172:175], a[236:239], a[20:23], v[172:175]
    buffer_load_dwordx4 v198, s[12:15], s30 offen offset:0  lds
    v_mfma_f32_16x16x32_bf16 v[180:183], a[232:235], a[8:11], 0
    ds_read_b64_tr_b16 a[212:213], v195 offset:12288
    v_mfma_f32_16x16x32_bf16 v[180:183], a[236:239], a[24:27], v[180:183]
    s_cmp_ge_u32 s50, 600
    s_cmov_b32 s34, 5
    s_cmov_b32 s35, 1280
    s_cmov_b32 s36, 20
    s_cmov_b32 s37, 20
    s_cmov_b32 s44, 94371840
    s_cmov_b32 s45, 600
    s_cmov_b32 s46, 13108
    s_cselect_b32 s32, s68, s32
    s_cselect_b32 s33, s69, s33
    v_mfma_f32_16x16x32_bf16 v[188:191], a[232:235], a[12:15], 0
    ds_read_b64_tr_b16 a[214:215], v195 offset:13824
    v_mfma_f32_16x16x32_bf16 v[188:191], a[236:239], a[28:31], v[188:191]
    s_waitcnt lgkmcnt(4)
    v_mfma_f32_16x16x32_bf16 v[0:3], a[192:195], a[32:35], v[0:3]
    ds_read_b64_tr_b16 a[216:217], v195 offset:8
    v_mfma_f32_16x16x32_bf16 v[0:3], a[196:199], a[48:51], v[0:3]
    buffer_load_dwordx4 v199, s[12:15], s30 offen offset:1024  lds
    v_mfma_f32_16x16x32_bf16 v[8:11], a[192:195], a[36:39], v[8:11]
    ds_read_b64_tr_b16 a[218:219], v195 offset:1544
    v_mfma_f32_16x16x32_bf16 v[8:11], a[196:199], a[52:55], v[8:11]
    buffer_load_dwordx4 v200, s[12:15], s30 offen offset:2048  lds
    v_mfma_f32_16x16x32_bf16 v[16:19], a[192:195], a[40:43], v[16:19]
    ds_read_b64_tr_b16 a[220:221], v195 offset:12296
    s_add_u32 s30, s30, 393216
    v_mfma_f32_16x16x32_bf16 v[16:19], a[196:199], a[56:59], v[16:19]
    s_cmp_ge_u32 s50, 640
    s_cmov_b32 s34, 5
    s_cmov_b32 s35, 1280
    s_cmov_b32 s36, 20
    s_cmov_b32 s37, 20
    s_cmov_b32 s44, 95420416
    s_cmov_b32 s45, 640
    s_cmov_b32 s46, 13108
    s_cselect_b32 s32, s70, s32
    s_cselect_b32 s33, s71, s33
    v_mfma_f32_16x16x32_bf16 v[24:27], a[192:195], a[44:47], v[24:27]
    ds_read_b64_tr_b16 a[222:223], v195 offset:13832
    v_mfma_f32_16x16x32_bf16 v[24:27], a[196:199], a[60:63], v[24:27]
    s_cmp_ge_u32 s50, 680
    s_cmov_b32 s34, 6
    s_cmov_b32 s35, 3072
    s_cmov_b32 s36, 20
    s_cmov_b32 s37, 20
    s_cmov_b32 s44, 96468992
    s_cmov_b32 s45, 680
    s_cmov_b32 s46, 10923
    s_cselect_b32 s32, s72, s32
    s_cselect_b32 s33, s73, s33
    v_mfma_f32_16x16x32_bf16 v[4:7], a[200:203], a[32:35], v[4:7]
    ds_read_b64_tr_b16 a[224:225], v194 offset:128
    v_mfma_f32_16x16x32_bf16 v[4:7], a[204:207], a[48:51], v[4:7]
    buffer_load_dwordx4 a[96:99], v201, s[16:19], s31 offen offset:2048 sc1
    v_mfma_f32_16x16x32_bf16 v[12:15], a[200:203], a[36:39], v[12:15]
    ds_read_b64_tr_b16 a[226:227], v194 offset:1664
    v_mfma_f32_16x16x32_bf16 v[12:15], a[204:207], a[52:55], v[12:15]
    s_cmp_ge_u32 s50, 776
    s_cmov_b32 s34, 6
    s_cmov_b32 s35, 3072
    s_cmov_b32 s36, 20
    s_cmov_b32 s37, 0
    s_cmov_b32 s44, 96468992
    s_cmov_b32 s45, 776
    s_cmov_b32 s46, 10923
    s_cselect_b32 s32, s72, s32
    s_cselect_b32 s33, s73, s33
    v_mfma_f32_16x16x32_bf16 v[20:23], a[200:203], a[40:43], v[20:23]
    ds_read_b64_tr_b16 a[228:229], v194 offset:12416
    s_sub_u32 s50, s50, s45
    v_mfma_f32_16x16x32_bf16 v[20:23], a[204:207], a[56:59], v[20:23]
    buffer_load_dwordx4 a[100:103], v202, s[16:19], s31 offen offset:2048 sc1
    v_mfma_f32_16x16x32_bf16 v[28:31], a[200:203], a[44:47], v[28:31]
    ds_read_b64_tr_b16 a[230:231], v194 offset:13952
    v_mfma_f32_16x16x32_bf16 v[28:31], a[204:207], a[60:63], v[28:31]
    s_waitcnt lgkmcnt(4)
    v_mfma_f32_16x16x32_bf16 v[32:35], a[208:211], a[32:35], v[32:35]
    ds_read_b64_tr_b16 a[232:233], v194 offset:136
    v_mfma_f32_16x16x32_bf16 v[32:35], a[212:215], a[48:51], v[32:35]
    buffer_load_dwordx4 a[104:107], v203, s[16:19], s31 offen offset:2048 sc1
    v_mfma_f32_16x16x32_bf16 v[40:43], a[208:211], a[36:39], v[40:43]
    ds_read_b64_tr_b16 a[234:235], v194 offset:1672
    v_mfma_f32_16x16x32_bf16 v[40:43], a[212:215], a[52:55], v[40:43]
    s_mul_i32 s51, s50, s46
    s_lshr_b32 s51, s51, 16
    v_mfma_f32_16x16x32_bf16 v[48:51], a[208:211], a[40:43], v[48:51]
    ds_read_b64_tr_b16 a[236:237], v194 offset:12424
    v_mfma_f32_16x16x32_bf16 v[48:51], a[212:215], a[56:59], v[48:51]
    buffer_load_dwordx4 a[108:111], v204, s[16:19], s31 offen offset:2048 sc1
    v_mfma_f32_16x16x32_bf16 v[56:59], a[208:211], a[44:47], v[56:59]
    ds_read_b64_tr_b16 a[238:239], v194 offset:13960
    v_mfma_f32_16x16x32_bf16 v[56:59], a[212:215], a[60:63], v[56:59]
    s_mul_i32 s53, s51, s34
    s_sub_u32 s50, s50, s53
    v_mfma_f32_16x16x32_bf16 v[36:39], a[216:219], a[32:35], v[36:39]
    ds_read_b64_tr_b16 a[192:193], v195 offset:128
    v_mfma_f32_16x16x32_bf16 v[36:39], a[220:223], a[48:51], v[36:39]
    s_cmp_eq_u32 s34, 10
    s_cselect_b32 s52, 2, 3
    s_cmp_eq_u32 s34, 6
    s_cselect_b32 s52, 4, s52
    v_mfma_f32_16x16x32_bf16 v[44:47], a[216:219], a[36:39], v[44:47]
    ds_read_b64_tr_b16 a[194:195], v195 offset:1664
    v_mfma_f32_16x16x32_bf16 v[44:47], a[220:223], a[52:55], v[44:47]
    buffer_load_dwordx4 a[112:115], v201, s[16:19], s31 offen offset:3072 sc1
    v_mfma_f32_16x16x32_bf16 v[52:55], a[216:219], a[40:43], v[52:55]
    ds_read_b64_tr_b16 a[196:197], v195 offset:12416
    v_mfma_f32_16x16x32_bf16 v[52:55], a[220:223], a[56:59], v[52:55]
    s_lshr_b32 s53, s51, s52
    s_lshl_b32 s54, s53, s52
    s_sub_u32 s51, s51, s54
    v_mfma_f32_16x16x32_bf16 v[60:63], a[216:219], a[44:47], v[60:63]
    ds_read_b64_tr_b16 a[198:199], v195 offset:13952
    s_mul_i32 s53, s53, s37
    v_mfma_f32_16x16x32_bf16 v[60:63], a[220:223], a[60:63], v[60:63]
    s_waitcnt lgkmcnt(4)
    v_mfma_f32_16x16x32_bf16 v[64:67], a[224:227], a[32:35], v[64:67]
    ds_read_b64_tr_b16 a[200:201], v195 offset:136
    v_mfma_f32_16x16x32_bf16 v[64:67], a[228:231], a[48:51], v[64:67]
    buffer_load_dwordx4 a[116:119], v202, s[16:19], s31 offen offset:3072 sc1
    v_mfma_f32_16x16x32_bf16 v[72:75], a[224:227], a[36:39], v[72:75]
    ds_read_b64_tr_b16 a[202:203], v195 offset:1672
    v_mfma_f32_16x16x32_bf16 v[72:75], a[228:231], a[52:55], v[72:75]
    buffer_load_dwordx4 a[120:123], v203, s[16:19], s31 offen offset:3072 sc1
    v_mfma_f32_16x16x32_bf16 v[80:83], a[224:227], a[40:43], v[80:83]
    ds_read_b64_tr_b16 a[204:205], v195 offset:12424
    v_mfma_f32_16x16x32_bf16 v[80:83], a[228:231], a[56:59], v[80:83]
    s_mul_i32 s54, s51, s36
    s_add_u32 s54, s54, s53
    s_mul_i32 s54, s54, s34
    s_add_u32 s54, s54, s50
    s_lshl_b32 s54, s54, 10
    s_add_u32 s54, s54, s44
    v_mfma_f32_16x16x32_bf16 v[88:91], a[224:227], a[44:47], v[88:91]
    ds_read_b64_tr_b16 a[206:207], v195 offset:13960
    v_mfma_f32_16x16x32_bf16 v[88:91], a[228:231], a[60:63], v[88:91]
    buffer_load_dwordx4 a[124:127], v204, s[16:19], s31 offen offset:3072 sc1
    v_mfma_f32_16x16x32_bf16 v[68:71], a[232:235], a[32:35], v[68:71]
    ds_read_b64_tr_b16 a[208:209], v194 offset:256
    s_add_u32 s31, s31, 4096
    v_mfma_f32_16x16x32_bf16 v[68:71], a[236:239], a[48:51], v[68:71]
    s_add_u32 m0, s25, 122880
    v_mfma_f32_16x16x32_bf16 v[76:79], a[232:235], a[36:39], v[76:79]
    ds_read_b64_tr_b16 a[210:211], v194 offset:1792
    v_mfma_f32_16x16x32_bf16 v[76:79], a[236:239], a[52:55], v[76:79]
    s_lshl_b32 s48, s35, 5
    s_lshl_b32 s49, s34, 10
    v_mfma_f32_16x16x32_bf16 v[84:87], a[232:235], a[40:43], v[84:87]
    ds_read_b64_tr_b16 a[212:213], v194 offset:12544
    v_mfma_f32_16x16x32_bf16 v[84:87], a[236:239], a[56:59], v[84:87]
    buffer_load_dwordx4 v198, s[12:15], s30 offen offset:0  lds
    v_mfma_f32_16x16x32_bf16 v[92:95], a[232:235], a[44:47], v[92:95]
    ds_read_b64_tr_b16 a[214:215], v194 offset:14080
    v_mfma_f32_16x16x32_bf16 v[92:95], a[236:239], a[60:63], v[92:95]
    s_waitcnt lgkmcnt(4)
    v_mfma_f32_16x16x32_bf16 v[96:99], a[192:195], a[32:35], v[96:99]
    ds_read_b64_tr_b16 a[216:217], v194 offset:264
    v_mfma_f32_16x16x32_bf16 v[96:99], a[196:199], a[48:51], v[96:99]
    buffer_load_dwordx4 v199, s[12:15], s30 offen offset:1024  lds
    v_mfma_f32_16x16x32_bf16 v[104:107], a[192:195], a[36:39], v[104:107]
    ds_read_b64_tr_b16 a[218:219], v194 offset:1800
    v_mfma_f32_16x16x32_bf16 v[104:107], a[196:199], a[52:55], v[104:107]
    s_add_u32 s56, s38, s54
    s_addc_u32 s57, s39, 0
    s_mul_i32 s58, s37, s49
    s_mov_b32 s59, 0x20000
    v_mfma_f32_16x16x32_bf16 v[112:115], a[192:195], a[40:43], v[112:115]
    ds_read_b64_tr_b16 a[220:221], v194 offset:12552
    v_mfma_f32_16x16x32_bf16 v[112:115], a[196:199], a[56:59], v[112:115]
    buffer_load_dwordx4 v200, s[12:15], s30 offen offset:2048  lds
    v_mfma_f32_16x16x32_bf16 v[120:123], a[192:195], a[44:47], v[120:123]
    ds_read_b64_tr_b16 a[222:223], v194 offset:14088
    s_add_u32 s30, s30, 393216
    v_mfma_f32_16x16x32_bf16 v[120:123], a[196:199], a[60:63], v[120:123]
    s_add_u32 m0, s25, 135168
    v_mfma_f32_16x16x32_bf16 v[100:103], a[200:203], a[32:35], v[100:103]
    ds_read_b64_tr_b16 a[224:225], v195 offset:256
    v_mfma_f32_16x16x32_bf16 v[100:103], a[204:207], a[48:51], v[100:103]
    buffer_load_dwordx4 v198, s[12:15], s30 offen offset:0  lds
    v_mfma_f32_16x16x32_bf16 v[108:111], a[200:203], a[36:39], v[108:111]
    ds_read_b64_tr_b16 a[226:227], v195 offset:1792
    v_mfma_f32_16x16x32_bf16 v[108:111], a[204:207], a[52:55], v[108:111]
    s_lshl_b32 s55, s50, 10
    s_sub_u32 s58, s58, s55
    s_max_i32 s58, s58, 0
    v_mfma_f32_16x16x32_bf16 v[116:119], a[200:203], a[40:43], v[116:119]
    ds_read_b64_tr_b16 a[228:229], v195 offset:12544
    v_mfma_f32_16x16x32_bf16 v[116:119], a[204:207], a[56:59], v[116:119]
    s_mul_i32 s51, s51, s34
    s_lshl_b32 s51, s51, 5
    v_mfma_f32_16x16x32_bf16 v[124:127], a[200:203], a[44:47], v[124:127]
    ds_read_b64_tr_b16 a[230:231], v195 offset:14080
    v_mfma_f32_16x16x32_bf16 v[124:127], a[204:207], a[60:63], v[124:127]
    s_waitcnt lgkmcnt(4)
    v_mfma_f32_16x16x32_bf16 v[128:131], a[208:211], a[32:35], v[128:131]
    ds_read_b64_tr_b16 a[232:233], v195 offset:264
    v_mfma_f32_16x16x32_bf16 v[128:131], a[212:215], a[48:51], v[128:131]
    buffer_load_dwordx4 v199, s[12:15], s30 offen offset:1024  lds
    v_mfma_f32_16x16x32_bf16 v[136:139], a[208:211], a[36:39], v[136:139]
    ds_read_b64_tr_b16 a[234:235], v195 offset:1800
    v_mfma_f32_16x16x32_bf16 v[136:139], a[212:215], a[52:55], v[136:139]
    buffer_load_dwordx4 v200, s[12:15], s30 offen offset:2048  lds
    v_mfma_f32_16x16x32_bf16 v[144:147], a[208:211], a[40:43], v[144:147]
    ds_read_b64_tr_b16 a[236:237], v195 offset:12552
    s_add_u32 s30, s30, 393216
    v_mfma_f32_16x16x32_bf16 v[144:147], a[212:215], a[56:59], v[144:147]
    s_mul_i32 s53, s53, s48
    s_add_u32 s53, s53, s51
    v_mfma_f32_16x16x32_bf16 v[152:155], a[208:211], a[44:47], v[152:155]
    ds_read_b64_tr_b16 a[238:239], v195 offset:14088
    v_mfma_f32_16x16x32_bf16 v[152:155], a[212:215], a[60:63], v[152:155]
    s_add_u32 s40, s32, s53
    s_addc_u32 s41, s33, 0
    s_mul_i32 s42, s37, s48
    s_mov_b32 s43, 0x20000
    v_mfma_f32_16x16x32_bf16 v[132:135], a[216:219], a[32:35], v[132:135]
    s_sub_u32 s42, s42, s51
    s_max_i32 s42, s42, 0
    v_mfma_f32_16x16x32_bf16 v[132:135], a[220:223], a[48:51], v[132:135]
    s_mov_b32 s60, 0
    s_sub_u32 s61, 0, s49
    v_mfma_f32_16x16x32_bf16 v[140:143], a[216:219], a[36:39], v[140:143]
    s_lshl_b32 s50, s50, 6
    s_lshl_b32 s52, s34, 1
    s_and_b32 s55, s34, 1
    s_xor_b32 s55, s55, 1
    s_lshl_b32 s55, s55, 1
    v_mfma_f32_16x16x32_bf16 v[140:143], a[220:223], a[52:55], v[140:143]
    v_lshrrev_b32 v238, 4, v234
    v_add_u32 v238, s50, v238
    v_mfma_f32_16x16x32_bf16 v[148:151], a[216:219], a[40:43], v[148:151]
    s_waitcnt vmcnt(14) lgkmcnt(0)
    s_barrier
    v_mfma_f32_16x16x32_bf16 v[148:151], a[220:223], a[56:59], v[148:151]
    ds_read_b64_tr_b16 a[192:193], v196 offset:0
    v_mul_lo_u32 v239, v238, s46
    v_mfma_f32_16x16x32_bf16 v[156:159], a[216:219], a[44:47], v[156:159]
    ds_read_b64_tr_b16 a[194:195], v196 offset:1536
    v_lshrrev_b32 v239, 17, v239
    v_mfma_f32_16x16x32_bf16 v[156:159], a[220:223], a[60:63], v[156:159]
    ds_read_b64_tr_b16 a[196:197], v196 offset:12288
    s_waitcnt lgkmcnt(3)
    v_mfma_f32_16x16x32_bf16 v[160:163], a[224:227], a[32:35], v[160:163]
    ds_read_b64_tr_b16 a[198:199], v196 offset:13824
    v_mul_lo_u32 v240, v239, s52
    v_mfma_f32_16x16x32_bf16 v[160:163], a[228:231], a[48:51], v[160:163]
    ds_read_b64_tr_b16 a[200:201], v196 offset:8
    v_sub_u32 v238, v238, v240
    v_mfma_f32_16x16x32_bf16 v[168:171], a[224:227], a[36:39], v[168:171]
    ds_read_b64_tr_b16 a[202:203], v196 offset:1544
    v_lshrrev_b32 v240, 1, v239
    v_mfma_f32_16x16x32_bf16 v[168:171], a[228:231], a[52:55], v[168:171]
    buffer_load_dwordx4 a[128:131], v201, s[16:19], s31 offen offset:0 sc1
    v_mfma_f32_16x16x32_bf16 v[176:179], a[224:227], a[40:43], v[176:179]
    ds_read_b64_tr_b16 a[204:205], v196 offset:12296
    v_and_b32 v240, s55, v240
    v_mfma_f32_16x16x32_bf16 v[176:179], a[228:231], a[56:59], v[176:179]
    buffer_load_dwordx4 a[132:135], v202, s[16:19], s31 offen offset:0 sc1
    v_mfma_f32_16x16x32_bf16 v[184:187], a[224:227], a[44:47], v[184:187]
    ds_read_b64_tr_b16 a[206:207], v196 offset:13832
    v_xor_b32 v238, v238, v240
    v_mfma_f32_16x16x32_bf16 v[184:187], a[228:231], a[60:63], v[184:187]
    buffer_load_dwordx4 a[136:139], v203, s[16:19], s31 offen offset:0 sc1
    v_mfma_f32_16x16x32_bf16 v[164:167], a[232:235], a[32:35], v[164:167]
    ds_read_b64_tr_b16 a[208:209], v197 offset:0
    v_mul_lo_u32 v239, v239, s35
    v_mfma_f32_16x16x32_bf16 v[164:167], a[236:239], a[48:51], v[164:167]
    v_lshl_add_u32 v255, v238, 4, v239
    v_mfma_f32_16x16x32_bf16 v[172:175], a[232:235], a[36:39], v[172:175]
    ds_read_b64_tr_b16 a[210:211], v197 offset:1536
    v_mfma_f32_16x16x32_bf16 v[172:175], a[236:239], a[52:55], v[172:175]
    buffer_load_dwordx4 a[140:143], v204, s[16:19], s31 offen offset:0 sc1
    v_mfma_f32_16x16x32_bf16 v[180:183], a[232:235], a[40:43], v[180:183]
    ds_read_b64_tr_b16 a[212:213], v197 offset:12288
    v_mfma_f32_16x16x32_bf16 v[180:183], a[236:239], a[56:59], v[180:183]
    v_mfma_f32_16x16x32_bf16 v[188:191], a[232:235], a[44:47], v[188:191]
    ds_read_b64_tr_b16 a[214:215], v197 offset:13824
    v_mfma_f32_16x16x32_bf16 v[188:191], a[236:239], a[60:63], v[188:191]
    s_waitcnt lgkmcnt(4)
    v_mfma_f32_16x16x32_bf16 v[0:3], a[192:195], a[64:67], v[0:3]
    ds_read_b64_tr_b16 a[216:217], v197 offset:8
    v_mfma_f32_16x16x32_bf16 v[0:3], a[196:199], a[80:83], v[0:3]
    buffer_load_dwordx4 a[144:147], v201, s[16:19], s31 offen offset:1024 sc1
    v_mfma_f32_16x16x32_bf16 v[8:11], a[192:195], a[68:71], v[8:11]
    ds_read_b64_tr_b16 a[218:219], v197 offset:1544
    v_mfma_f32_16x16x32_bf16 v[8:11], a[196:199], a[84:87], v[8:11]
    buffer_load_dwordx4 a[148:151], v202, s[16:19], s31 offen offset:1024 sc1
    v_mfma_f32_16x16x32_bf16 v[16:19], a[192:195], a[72:75], v[16:19]
    ds_read_b64_tr_b16 a[220:221], v197 offset:12296
    v_mfma_f32_16x16x32_bf16 v[16:19], a[196:199], a[88:91], v[16:19]
    v_mfma_f32_16x16x32_bf16 v[24:27], a[192:195], a[76:79], v[24:27]
    ds_read_b64_tr_b16 a[222:223], v197 offset:13832
    v_mfma_f32_16x16x32_bf16 v[24:27], a[196:199], a[92:95], v[24:27]
    v_mfma_f32_16x16x32_bf16 v[4:7], a[200:203], a[64:67], v[4:7]
    ds_read_b64_tr_b16 a[224:225], v196 offset:128
    v_mfma_f32_16x16x32_bf16 v[4:7], a[204:207], a[80:83], v[4:7]
    buffer_load_dwordx4 a[152:155], v203, s[16:19], s31 offen offset:1024 sc1
    v_mfma_f32_16x16x32_bf16 v[12:15], a[200:203], a[68:71], v[12:15]
    ds_read_b64_tr_b16 a[226:227], v196 offset:1664
    v_mfma_f32_16x16x32_bf16 v[12:15], a[204:207], a[84:87], v[12:15]
    v_mfma_f32_16x16x32_bf16 v[20:23], a[200:203], a[72:75], v[20:23]
    ds_read_b64_tr_b16 a[228:229], v196 offset:12416
    v_mfma_f32_16x16x32_bf16 v[20:23], a[204:207], a[88:91], v[20:23]
    buffer_load_dwordx4 a[156:159], v204, s[16:19], s31 offen offset:1024 sc1
    v_mfma_f32_16x16x32_bf16 v[28:31], a[200:203], a[76:79], v[28:31]
    ds_read_b64_tr_b16 a[230:231], v196 offset:13952
    s_add_u32 m0, s25, 0
    v_mfma_f32_16x16x32_bf16 v[28:31], a[204:207], a[92:95], v[28:31]
    s_waitcnt lgkmcnt(4)
    v_mfma_f32_16x16x32_bf16 v[32:35], a[208:211], a[64:67], v[32:35]
    ds_read_b64_tr_b16 a[232:233], v196 offset:136
    v_mfma_f32_16x16x32_bf16 v[32:35], a[212:215], a[80:83], v[32:35]
    buffer_load_dwordx4 v198, s[12:15], s30 offen offset:0  lds
    v_mfma_f32_16x16x32_bf16 v[40:43], a[208:211], a[68:71], v[40:43]
    ds_read_b64_tr_b16 a[234:235], v196 offset:1672
    v_mfma_f32_16x16x32_bf16 v[40:43], a[212:215], a[84:87], v[40:43]
    v_mfma_f32_16x16x32_bf16 v[48:51], a[208:211], a[72:75], v[48:51]
    ds_read_b64_tr_b16 a[236:237], v196 offset:12424
    v_mfma_f32_16x16x32_bf16 v[48:51], a[212:215], a[88:91], v[48:51]
    buffer_load_dwordx4 v199, s[12:15], s30 offen offset:1024  lds
    v_mfma_f32_16x16x32_bf16 v[56:59], a[208:211], a[76:79], v[56:59]
    ds_read_b64_tr_b16 a[238:239], v196 offset:13960
    v_mfma_f32_16x16x32_bf16 v[56:59], a[212:215], a[92:95], v[56:59]
    v_mfma_f32_16x16x32_bf16 v[36:39], a[216:219], a[64:67], v[36:39]
    ds_read_b64_tr_b16 a[192:193], v197 offset:128
    v_mfma_f32_16x16x32_bf16 v[36:39], a[220:223], a[80:83], v[36:39]
    v_mfma_f32_16x16x32_bf16 v[44:47], a[216:219], a[68:71], v[44:47]
    ds_read_b64_tr_b16 a[194:195], v197 offset:1664
    v_mfma_f32_16x16x32_bf16 v[44:47], a[220:223], a[84:87], v[44:47]
    buffer_load_dwordx4 v200, s[12:15], s30 offen offset:2048  lds
    v_mfma_f32_16x16x32_bf16 v[52:55], a[216:219], a[72:75], v[52:55]
    ds_read_b64_tr_b16 a[196:197], v197 offset:12416
    s_add_u32 s30, s30, 393216
    v_mfma_f32_16x16x32_bf16 v[52:55], a[220:223], a[88:91], v[52:55]
    s_add_u32 m0, s25, 12288
    v_mfma_f32_16x16x32_bf16 v[60:63], a[216:219], a[76:79], v[60:63]
    ds_read_b64_tr_b16 a[198:199], v197 offset:13952
    v_mfma_f32_16x16x32_bf16 v[60:63], a[220:223], a[92:95], v[60:63]
    s_waitcnt lgkmcnt(4)
    v_mfma_f32_16x16x32_bf16 v[64:67], a[224:227], a[64:67], v[64:67]
    ds_read_b64_tr_b16 a[200:201], v197 offset:136
    v_mfma_f32_16x16x32_bf16 v[64:67], a[228:231], a[80:83], v[64:67]
    buffer_load_dwordx4 v198, s[12:15], s30 offen offset:0  lds
    v_mfma_f32_16x16x32_bf16 v[72:75], a[224:227], a[68:71], v[72:75]
    ds_read_b64_tr_b16 a[202:203], v197 offset:1672
    v_mfma_f32_16x16x32_bf16 v[72:75], a[228:231], a[84:87], v[72:75]
    buffer_load_dwordx4 v199, s[12:15], s30 offen offset:1024  lds
    v_mfma_f32_16x16x32_bf16 v[80:83], a[224:227], a[72:75], v[80:83]
    ds_read_b64_tr_b16 a[204:205], v197 offset:12424
    v_mfma_f32_16x16x32_bf16 v[80:83], a[228:231], a[88:91], v[80:83]
    v_mfma_f32_16x16x32_bf16 v[88:91], a[224:227], a[76:79], v[88:91]
    ds_read_b64_tr_b16 a[206:207], v197 offset:13960
    v_mfma_f32_16x16x32_bf16 v[88:91], a[228:231], a[92:95], v[88:91]
    buffer_load_dwordx4 v200, s[12:15], s30 offen offset:2048  lds
    v_mfma_f32_16x16x32_bf16 v[68:71], a[232:235], a[64:67], v[68:71]
    ds_read_b64_tr_b16 a[208:209], v196 offset:256
    s_add_u32 s30, s30, 393216
    v_mfma_f32_16x16x32_bf16 v[68:71], a[236:239], a[80:83], v[68:71]
    s_add_u32 m0, s25, 24576
    v_mfma_f32_16x16x32_bf16 v[76:79], a[232:235], a[68:71], v[76:79]
    ds_read_b64_tr_b16 a[210:211], v196 offset:1792
    v_mfma_f32_16x16x32_bf16 v[76:79], a[236:239], a[84:87], v[76:79]
    v_mfma_f32_16x16x32_bf16 v[84:87], a[232:235], a[72:75], v[84:87]
    ds_read_b64_tr_b16 a[212:213], v196 offset:12544
    v_mfma_f32_16x16x32_bf16 v[84:87], a[236:239], a[88:91], v[84:87]
    buffer_load_dwordx4 v198, s[12:15], s30 offen offset:0  lds
    v_mfma_f32_16x16x32_bf16 v[92:95], a[232:235], a[76:79], v[92:95]
    ds_read_b64_tr_b16 a[214:215], v196 offset:14080
    v_mfma_f32_16x16x32_bf16 v[92:95], a[236:239], a[92:95], v[92:95]
    s_waitcnt lgkmcnt(4)
    v_mfma_f32_16x16x32_bf16 v[96:99], a[192:195], a[64:67], v[96:99]
    ds_read_b64_tr_b16 a[216:217], v196 offset:264
    v_mfma_f32_16x16x32_bf16 v[96:99], a[196:199], a[80:83], v[96:99]
    buffer_load_dwordx4 v199, s[12:15], s30 offen offset:1024  lds
    v_mfma_f32_16x16x32_bf16 v[104:107], a[192:195], a[68:71], v[104:107]
    ds_read_b64_tr_b16 a[218:219], v196 offset:1800
    v_mfma_f32_16x16x32_bf16 v[104:107], a[196:199], a[84:87], v[104:107]
    v_mfma_f32_16x16x32_bf16 v[112:115], a[192:195], a[72:75], v[112:115]
    ds_read_b64_tr_b16 a[220:221], v196 offset:12552
    v_mfma_f32_16x16x32_bf16 v[112:115], a[196:199], a[88:91], v[112:115]
    buffer_load_dwordx4 v200, s[12:15], s30 offen offset:2048  lds
    v_mfma_f32_16x16x32_bf16 v[120:123], a[192:195], a[76:79], v[120:123]
    ds_read_b64_tr_b16 a[222:223], v196 offset:14088
    s_add_u32 s30, s30, 393216
    v_mfma_f32_16x16x32_bf16 v[120:123], a[196:199], a[92:95], v[120:123]
    s_add_u32 m0, s25, 36864
    v_mfma_f32_16x16x32_bf16 v[100:103], a[200:203], a[64:67], v[100:103]
    ds_read_b64_tr_b16 a[224:225], v197 offset:256
    v_mfma_f32_16x16x32_bf16 v[100:103], a[204:207], a[80:83], v[100:103]
    buffer_load_dwordx4 v198, s[12:15], s30 offen offset:0  lds
    v_mfma_f32_16x16x32_bf16 v[108:111], a[200:203], a[68:71], v[108:111]
    ds_read_b64_tr_b16 a[226:227], v197 offset:1792
    v_mfma_f32_16x16x32_bf16 v[108:111], a[204:207], a[84:87], v[108:111]
    v_mfma_f32_16x16x32_bf16 v[116:119], a[200:203], a[72:75], v[116:119]
    ds_read_b64_tr_b16 a[228:229], v197 offset:12544
    v_mfma_f32_16x16x32_bf16 v[116:119], a[204:207], a[88:91], v[116:119]
    v_mfma_f32_16x16x32_bf16 v[124:127], a[200:203], a[76:79], v[124:127]
    ds_read_b64_tr_b16 a[230:231], v197 offset:14080
    v_mfma_f32_16x16x32_bf16 v[124:127], a[204:207], a[92:95], v[124:127]
    s_waitcnt lgkmcnt(4)
    v_mfma_f32_16x16x32_bf16 v[128:131], a[208:211], a[64:67], v[128:131]
    ds_read_b64_tr_b16 a[232:233], v197 offset:264
    v_mfma_f32_16x16x32_bf16 v[128:131], a[212:215], a[80:83], v[128:131]
    buffer_load_dwordx4 v199, s[12:15], s30 offen offset:1024  lds
    v_mfma_f32_16x16x32_bf16 v[136:139], a[208:211], a[68:71], v[136:139]
    ds_read_b64_tr_b16 a[234:235], v197 offset:1800
    v_mfma_f32_16x16x32_bf16 v[136:139], a[212:215], a[84:87], v[136:139]
    buffer_load_dwordx4 v200, s[12:15], s30 offen offset:2048  lds
    v_mfma_f32_16x16x32_bf16 v[144:147], a[208:211], a[72:75], v[144:147]
    ds_read_b64_tr_b16 a[236:237], v197 offset:12552
    s_add_u32 s30, s30, 393216
    v_mfma_f32_16x16x32_bf16 v[144:147], a[212:215], a[88:91], v[144:147]
    v_mfma_f32_16x16x32_bf16 v[152:155], a[208:211], a[76:79], v[152:155]
    ds_read_b64_tr_b16 a[238:239], v197 offset:14088
    v_mfma_f32_16x16x32_bf16 v[152:155], a[212:215], a[92:95], v[152:155]
    v_mfma_f32_16x16x32_bf16 v[132:135], a[216:219], a[64:67], v[132:135]
    v_mfma_f32_16x16x32_bf16 v[132:135], a[220:223], a[80:83], v[132:135]
    v_mfma_f32_16x16x32_bf16 v[140:143], a[216:219], a[68:71], v[140:143]
    v_mfma_f32_16x16x32_bf16 v[140:143], a[220:223], a[84:87], v[140:143]
    v_mfma_f32_16x16x32_bf16 v[148:151], a[216:219], a[72:75], v[148:151]
    s_waitcnt vmcnt(20) lgkmcnt(0)
    s_barrier
    v_mfma_f32_16x16x32_bf16 v[148:151], a[220:223], a[88:91], v[148:151]
    ds_read_b64_tr_b16 a[192:193], v196 offset:24576
    v_mfma_f32_16x16x32_bf16 v[156:159], a[216:219], a[76:79], v[156:159]
    ds_read_b64_tr_b16 a[194:195], v196 offset:26112
    v_mfma_f32_16x16x32_bf16 v[156:159], a[220:223], a[92:95], v[156:159]
    ds_read_b64_tr_b16 a[196:197], v196 offset:36864
    s_waitcnt lgkmcnt(3)
    v_mfma_f32_16x16x32_bf16 v[160:163], a[224:227], a[64:67], v[160:163]
    ds_read_b64_tr_b16 a[198:199], v196 offset:38400
    v_mfma_f32_16x16x32_bf16 v[160:163], a[228:231], a[80:83], v[160:163]
    ds_read_b64_tr_b16 a[200:201], v196 offset:24584
    v_mfma_f32_16x16x32_bf16 v[168:171], a[224:227], a[68:71], v[168:171]
    ds_read_b64_tr_b16 a[202:203], v196 offset:26120
    v_mfma_f32_16x16x32_bf16 v[168:171], a[228:231], a[84:87], v[168:171]
    buffer_load_dwordx4 a[160:163], v201, s[16:19], s31 offen offset:2048 sc1
    v_mfma_f32_16x16x32_bf16 v[176:179], a[224:227], a[72:75], v[176:179]
    ds_read_b64_tr_b16 a[204:205], v196 offset:36872
    v_mfma_f32_16x16x32_bf16 v[176:179], a[228:231], a[88:91], v[176:179]
    buffer_load_dwordx4 a[164:167], v202, s[16:19], s31 offen offset:2048 sc1
    v_mfma_f32_16x16x32_bf16 v[184:187], a[224:227], a[76:79], v[184:187]
    ds_read_b64_tr_b16 a[206:207], v196 offset:38408
    v_mfma_f32_16x16x32_bf16 v[184:187], a[228:231], a[92:95], v[184:187]
    v_mfma_f32_16x16x32_bf16 v[164:167], a[232:235], a[64:67], v[164:167]
    ds_read_b64_tr_b16 a[208:209], v197 offset:24576
    v_mfma_f32_16x16x32_bf16 v[164:167], a[236:239], a[80:83], v[164:167]
    buffer_load_dwordx4 a[168:171], v203, s[16:19], s31 offen offset:2048 sc1
    v_mfma_f32_16x16x32_bf16 v[172:175], a[232:235], a[68:71], v[172:175]
    ds_read_b64_tr_b16 a[210:211], v197 offset:26112
    v_mfma_f32_16x16x32_bf16 v[172:175], a[236:239], a[84:87], v[172:175]
    v_mfma_f32_16x16x32_bf16 v[180:183], a[232:235], a[72:75], v[180:183]
    ds_read_b64_tr_b16 a[212:213], v197 offset:36864
    v_mfma_f32_16x16x32_bf16 v[180:183], a[236:239], a[88:91], v[180:183]
    buffer_load_dwordx4 a[172:175], v204, s[16:19], s31 offen offset:2048 sc1
    v_mfma_f32_16x16x32_bf16 v[188:191], a[232:235], a[76:79], v[188:191]
    ds_read_b64_tr_b16 a[214:215], v197 offset:38400
    v_mfma_f32_16x16x32_bf16 v[188:191], a[236:239], a[92:95], v[188:191]
    s_waitcnt lgkmcnt(4)
    v_mfma_f32_16x16x32_bf16 v[0:3], a[192:195], a[96:99], v[0:3]
    ds_read_b64_tr_b16 a[216:217], v197 offset:24584
    v_mfma_f32_16x16x32_bf16 v[0:3], a[196:199], a[112:115], v[0:3]
    v_mfma_f32_16x16x32_bf16 v[8:11], a[192:195], a[100:103], v[8:11]
    ds_read_b64_tr_b16 a[218:219], v197 offset:26120
    v_mfma_f32_16x16x32_bf16 v[8:11], a[196:199], a[116:119], v[8:11]
    buffer_load_dwordx4 a[176:179], v201, s[16:19], s31 offen offset:3072 sc1
    v_mfma_f32_16x16x32_bf16 v[16:19], a[192:195], a[104:107], v[16:19]
    ds_read_b64_tr_b16 a[220:221], v197 offset:36872
    v_mfma_f32_16x16x32_bf16 v[16:19], a[196:199], a[120:123], v[16:19]
    v_mfma_f32_16x16x32_bf16 v[24:27], a[192:195], a[108:111], v[24:27]
    ds_read_b64_tr_b16 a[222:223], v197 offset:38408
    v_mfma_f32_16x16x32_bf16 v[24:27], a[196:199], a[124:127], v[24:27]
    v_mfma_f32_16x16x32_bf16 v[4:7], a[200:203], a[96:99], v[4:7]
    ds_read_b64_tr_b16 a[224:225], v196 offset:24704
    v_mfma_f32_16x16x32_bf16 v[4:7], a[204:207], a[112:115], v[4:7]
    buffer_load_dwordx4 a[180:183], v202, s[16:19], s31 offen offset:3072 sc1
    v_mfma_f32_16x16x32_bf16 v[12:15], a[200:203], a[100:103], v[12:15]
    ds_read_b64_tr_b16 a[226:227], v196 offset:26240
    v_mfma_f32_16x16x32_bf16 v[12:15], a[204:207], a[116:119], v[12:15]
    v_mfma_f32_16x16x32_bf16 v[20:23], a[200:203], a[104:107], v[20:23]
    ds_read_b64_tr_b16 a[228:229], v196 offset:36992
    v_mfma_f32_16x16x32_bf16 v[20:23], a[204:207], a[120:123], v[20:23]
    v_mfma_f32_16x16x32_bf16 v[28:31], a[200:203], a[108:111], v[28:31]
    ds_read_b64_tr_b16 a[230:231], v196 offset:38528
    v_mfma_f32_16x16x32_bf16 v[28:31], a[204:207], a[124:127], v[28:31]
    s_waitcnt lgkmcnt(4)
    v_mfma_f32_16x16x32_bf16 v[32:35], a[208:211], a[96:99], v[32:35]
    ds_read_b64_tr_b16 a[232:233], v196 offset:24712
    v_mfma_f32_16x16x32_bf16 v[32:35], a[212:215], a[112:115], v[32:35]
    buffer_load_dwordx4 a[184:187], v203, s[16:19], s31 offen offset:3072 sc1
    v_mfma_f32_16x16x32_bf16 v[40:43], a[208:211], a[100:103], v[40:43]
    ds_read_b64_tr_b16 a[234:235], v196 offset:26248
    v_mfma_f32_16x16x32_bf16 v[40:43], a[212:215], a[116:119], v[40:43]
    v_mfma_f32_16x16x32_bf16 v[48:51], a[208:211], a[104:107], v[48:51]
    ds_read_b64_tr_b16 a[236:237], v196 offset:37000
    v_mfma_f32_16x16x32_bf16 v[48:51], a[212:215], a[120:123], v[48:51]
    buffer_load_dwordx4 a[188:191], v204, s[16:19], s31 offen offset:3072 sc1
    v_mfma_f32_16x16x32_bf16 v[56:59], a[208:211], a[108:111], v[56:59]
    ds_read_b64_tr_b16 a[238:239], v196 offset:38536
    s_add_u32 s31, s31, 4096
    v_mfma_f32_16x16x32_bf16 v[56:59], a[212:215], a[124:127], v[56:59]
    v_mfma_f32_16x16x32_bf16 v[36:39], a[216:219], a[96:99], v[36:39]
    ds_read_b64_tr_b16 a[192:193], v197 offset:24704
    v_mfma_f32_16x16x32_bf16 v[36:39], a[220:223], a[112:115], v[36:39]
    v_mfma_f32_16x16x32_bf16 v[44:47], a[216:219], a[100:103], v[44:47]
    ds_read_b64_tr_b16 a[194:195], v197 offset:26240
    v_mfma_f32_16x16x32_bf16 v[44:47], a[220:223], a[116:119], v[44:47]
    buffer_load_dwordx4 a[0:3], v201, s[16:19], s31 offen offset:0 sc1
    v_mfma_f32_16x16x32_bf16 v[52:55], a[216:219], a[104:107], v[52:55]
    ds_read_b64_tr_b16 a[196:197], v197 offset:36992
    v_mfma_f32_16x16x32_bf16 v[52:55], a[220:223], a[120:123], v[52:55]
    v_mfma_f32_16x16x32_bf16 v[60:63], a[216:219], a[108:111], v[60:63]
    ds_read_b64_tr_b16 a[198:199], v197 offset:38528
    v_mfma_f32_16x16x32_bf16 v[60:63], a[220:223], a[124:127], v[60:63]
    s_waitcnt lgkmcnt(4)
    v_mfma_f32_16x16x32_bf16 v[64:67], a[224:227], a[96:99], v[64:67]
    ds_read_b64_tr_b16 a[200:201], v197 offset:24712
    v_mfma_f32_16x16x32_bf16 v[64:67], a[228:231], a[112:115], v[64:67]
    buffer_load_dwordx4 a[4:7], v202, s[16:19], s31 offen offset:0 sc1
    v_mfma_f32_16x16x32_bf16 v[72:75], a[224:227], a[100:103], v[72:75]
    ds_read_b64_tr_b16 a[202:203], v197 offset:26248
    v_mfma_f32_16x16x32_bf16 v[72:75], a[228:231], a[116:119], v[72:75]
    v_mfma_f32_16x16x32_bf16 v[80:83], a[224:227], a[104:107], v[80:83]
    ds_read_b64_tr_b16 a[204:205], v197 offset:37000
    v_mfma_f32_16x16x32_bf16 v[80:83], a[228:231], a[120:123], v[80:83]
    buffer_load_dwordx4 a[8:11], v203, s[16:19], s31 offen offset:0 sc1
    v_mfma_f32_16x16x32_bf16 v[88:91], a[224:227], a[108:111], v[88:91]
    ds_read_b64_tr_b16 a[206:207], v197 offset:38536
    v_mfma_f32_16x16x32_bf16 v[88:91], a[228:231], a[124:127], v[88:91]
    v_mfma_f32_16x16x32_bf16 v[68:71], a[232:235], a[96:99], v[68:71]
    ds_read_b64_tr_b16 a[208:209], v196 offset:24832
    v_mfma_f32_16x16x32_bf16 v[68:71], a[236:239], a[112:115], v[68:71]
    v_mfma_f32_16x16x32_bf16 v[76:79], a[232:235], a[100:103], v[76:79]
    ds_read_b64_tr_b16 a[210:211], v196 offset:26368
    v_mfma_f32_16x16x32_bf16 v[76:79], a[236:239], a[116:119], v[76:79]
    buffer_load_dwordx4 a[12:15], v204, s[16:19], s31 offen offset:0 sc1
    v_mfma_f32_16x16x32_bf16 v[84:87], a[232:235], a[104:107], v[84:87]
    ds_read_b64_tr_b16 a[212:213], v196 offset:37120
    v_mfma_f32_16x16x32_bf16 v[84:87], a[236:239], a[120:123], v[84:87]
    v_mfma_f32_16x16x32_bf16 v[92:95], a[232:235], a[108:111], v[92:95]
    ds_read_b64_tr_b16 a[214:215], v196 offset:38656
    v_mfma_f32_16x16x32_bf16 v[92:95], a[236:239], a[124:127], v[92:95]
    s_waitcnt lgkmcnt(4)
    v_mfma_f32_16x16x32_bf16 v[96:99], a[192:195], a[96:99], v[96:99]
    ds_read_b64_tr_b16 a[216:217], v196 offset:24840
    v_mfma_f32_16x16x32_bf16 v[96:99], a[196:199], a[112:115], v[96:99]
    buffer_load_dwordx4 a[16:19], v201, s[16:19], s31 offen offset:1024 sc1
    v_mfma_f32_16x16x32_bf16 v[104:107], a[192:195], a[100:103], v[104:107]
    ds_read_b64_tr_b16 a[218:219], v196 offset:26376
    v_mfma_f32_16x16x32_bf16 v[104:107], a[196:199], a[116:119], v[104:107]
    v_mfma_f32_16x16x32_bf16 v[112:115], a[192:195], a[104:107], v[112:115]
    ds_read_b64_tr_b16 a[220:221], v196 offset:37128
    v_mfma_f32_16x16x32_bf16 v[112:115], a[196:199], a[120:123], v[112:115]
    v_mfma_f32_16x16x32_bf16 v[120:123], a[192:195], a[108:111], v[120:123]
    ds_read_b64_tr_b16 a[222:223], v196 offset:38664
    v_mfma_f32_16x16x32_bf16 v[120:123], a[196:199], a[124:127], v[120:123]
    buffer_load_dwordx4 a[20:23], v202, s[16:19], s31 offen offset:1024 sc1
    v_mfma_f32_16x16x32_bf16 v[100:103], a[200:203], a[96:99], v[100:103]
    ds_read_b64_tr_b16 a[224:225], v197 offset:24832
    v_mfma_f32_16x16x32_bf16 v[100:103], a[204:207], a[112:115], v[100:103]
    v_mfma_f32_16x16x32_bf16 v[108:111], a[200:203], a[100:103], v[108:111]
    ds_read_b64_tr_b16 a[226:227], v197 offset:26368
    v_mfma_f32_16x16x32_bf16 v[108:111], a[204:207], a[116:119], v[108:111]
    buffer_load_dwordx4 a[24:27], v203, s[16:19], s31 offen offset:1024 sc1
    v_mfma_f32_16x16x32_bf16 v[116:119], a[200:203], a[104:107], v[116:119]
    ds_read_b64_tr_b16 a[228:229], v197 offset:37120
    v_mfma_f32_16x16x32_bf16 v[116:119], a[204:207], a[120:123], v[116:119]
    v_mfma_f32_16x16x32_bf16 v[124:127], a[200:203], a[108:111], v[124:127]
    ds_read_b64_tr_b16 a[230:231], v197 offset:38656
    v_mfma_f32_16x16x32_bf16 v[124:127], a[204:207], a[124:127], v[124:127]
    s_waitcnt lgkmcnt(4)
    v_mfma_f32_16x16x32_bf16 v[128:131], a[208:211], a[96:99], v[128:131]
    ds_read_b64_tr_b16 a[232:233], v197 offset:24840
    v_mfma_f32_16x16x32_bf16 v[128:131], a[212:215], a[112:115], v[128:131]
    buffer_load_dwordx4 a[28:31], v204, s[16:19], s31 offen offset:1024 sc1
    v_mfma_f32_16x16x32_bf16 v[136:139], a[208:211], a[100:103], v[136:139]
    ds_read_b64_tr_b16 a[234:235], v197 offset:26376
    v_mfma_f32_16x16x32_bf16 v[136:139], a[212:215], a[116:119], v[136:139]
    v_mfma_f32_16x16x32_bf16 v[144:147], a[208:211], a[104:107], v[144:147]
    ds_read_b64_tr_b16 a[236:237], v197 offset:37128
    v_mfma_f32_16x16x32_bf16 v[144:147], a[212:215], a[120:123], v[144:147]
    v_mfma_f32_16x16x32_bf16 v[152:155], a[208:211], a[108:111], v[152:155]
    ds_read_b64_tr_b16 a[238:239], v197 offset:38664
    v_mfma_f32_16x16x32_bf16 v[152:155], a[212:215], a[124:127], v[152:155]
    v_mfma_f32_16x16x32_bf16 v[132:135], a[216:219], a[96:99], v[132:135]
    v_mfma_f32_16x16x32_bf16 v[132:135], a[220:223], a[112:115], v[132:135]
    v_mfma_f32_16x16x32_bf16 v[140:143], a[216:219], a[100:103], v[140:143]
    v_mfma_f32_16x16x32_bf16 v[140:143], a[220:223], a[116:119], v[140:143]
    v_mfma_f32_16x16x32_bf16 v[148:151], a[216:219], a[104:107], v[148:151]
    s_waitcnt vmcnt(22) lgkmcnt(0)
    s_barrier
    v_mfma_f32_16x16x32_bf16 v[148:151], a[220:223], a[120:123], v[148:151]
    ds_read_b64_tr_b16 a[192:193], v192 offset:0
    s_add_u32 m0, s25, 73728
    v_mfma_f32_16x16x32_bf16 v[156:159], a[216:219], a[108:111], v[156:159]
    ds_read_b64_tr_b16 a[194:195], v192 offset:1536
    v_mfma_f32_16x16x32_bf16 v[156:159], a[220:223], a[124:127], v[156:159]
    ds_read_b64_tr_b16 a[196:197], v192 offset:12288
    s_waitcnt lgkmcnt(3)
    v_mfma_f32_16x16x32_bf16 v[160:163], a[224:227], a[96:99], v[160:163]
    ds_read_b64_tr_b16 a[198:199], v192 offset:13824
    v_mfma_f32_16x16x32_bf16 v[160:163], a[228:231], a[112:115], v[160:163]
    ds_read_b64_tr_b16 a[200:201], v192 offset:8
    v_mfma_f32_16x16x32_bf16 v[168:171], a[224:227], a[100:103], v[168:171]
    ds_read_b64_tr_b16 a[202:203], v192 offset:1544
    v_mfma_f32_16x16x32_bf16 v[168:171], a[228:231], a[116:119], v[168:171]
    buffer_load_dwordx4 v198, s[12:15], s30 offen offset:0  lds
    v_mfma_f32_16x16x32_bf16 v[176:179], a[224:227], a[104:107], v[176:179]
    ds_read_b64_tr_b16 a[204:205], v192 offset:12296
    v_mfma_f32_16x16x32_bf16 v[176:179], a[228:231], a[120:123], v[176:179]
    buffer_load_dwordx4 v199, s[12:15], s30 offen offset:1024  lds
    v_mfma_f32_16x16x32_bf16 v[184:187], a[224:227], a[108:111], v[184:187]
    ds_read_b64_tr_b16 a[206:207], v192 offset:13832
    v_mfma_f32_16x16x32_bf16 v[184:187], a[228:231], a[124:127], v[184:187]
    buffer_load_dwordx4 v200, s[12:15], s30 offen offset:2048  lds
    v_mfma_f32_16x16x32_bf16 v[164:167], a[232:235], a[96:99], v[164:167]
    ds_read_b64_tr_b16 a[208:209], v193 offset:0
    s_add_u32 s30, s30, 393216
    v_mfma_f32_16x16x32_bf16 v[164:167], a[236:239], a[112:115], v[164:167]
    s_add_u32 m0, s25, 86016
    v_mfma_f32_16x16x32_bf16 v[172:175], a[232:235], a[100:103], v[172:175]
    ds_read_b64_tr_b16 a[210:211], v193 offset:1536
    v_mfma_f32_16x16x32_bf16 v[172:175], a[236:239], a[116:119], v[172:175]
    buffer_load_dwordx4 v198, s[12:15], s30 offen offset:0  lds
    v_mfma_f32_16x16x32_bf16 v[180:183], a[232:235], a[104:107], v[180:183]
    ds_read_b64_tr_b16 a[212:213], v193 offset:12288
    v_mfma_f32_16x16x32_bf16 v[180:183], a[236:239], a[120:123], v[180:183]
    v_mfma_f32_16x16x32_bf16 v[188:191], a[232:235], a[108:111], v[188:191]
    ds_read_b64_tr_b16 a[214:215], v193 offset:13824
    v_mfma_f32_16x16x32_bf16 v[188:191], a[236:239], a[124:127], v[188:191]
    s_waitcnt lgkmcnt(4)
    v_mfma_f32_16x16x32_bf16 v[0:3], a[192:195], a[128:131], v[0:3]
    ds_read_b64_tr_b16 a[216:217], v193 offset:8
    v_mfma_f32_16x16x32_bf16 v[0:3], a[196:199], a[144:147], v[0:3]
    buffer_load_dwordx4 v199, s[12:15], s30 offen offset:1024  lds
    v_mfma_f32_16x16x32_bf16 v[8:11], a[192:195], a[132:135], v[8:11]
    ds_read_b64_tr_b16 a[218:219], v193 offset:1544
    v_mfma_f32_16x16x32_bf16 v[8:11], a[196:199], a[148:151], v[8:11]
    buffer_load_dwordx4 v200, s[12:15], s30 offen offset:2048  lds
    v_mfma_f32_16x16x32_bf16 v[16:19], a[192:195], a[136:139], v[16:19]
    ds_read_b64_tr_b16 a[220:221], v193 offset:12296
    s_add_u32 s30, s30, 393216
    v_mfma_f32_16x16x32_bf16 v[16:19], a[196:199], a[152:155], v[16:19]
    v_mfma_f32_16x16x32_bf16 v[24:27], a[192:195], a[140:143], v[24:27]
    ds_read_b64_tr_b16 a[222:223], v193 offset:13832
    v_mfma_f32_16x16x32_bf16 v[24:27], a[196:199], a[156:159], v[24:27]
    v_mfma_f32_16x16x32_bf16 v[4:7], a[200:203], a[128:131], v[4:7]
    ds_read_b64_tr_b16 a[224:225], v192 offset:128
    v_mfma_f32_16x16x32_bf16 v[4:7], a[204:207], a[144:147], v[4:7]
    buffer_load_dwordx4 a[32:35], v201, s[16:19], s31 offen offset:2048 sc1
    v_mfma_f32_16x16x32_bf16 v[12:15], a[200:203], a[132:135], v[12:15]
    ds_read_b64_tr_b16 a[226:227], v192 offset:1664
    v_mfma_f32_16x16x32_bf16 v[12:15], a[204:207], a[148:151], v[12:15]
    v_mfma_f32_16x16x32_bf16 v[20:23], a[200:203], a[136:139], v[20:23]
    ds_read_b64_tr_b16 a[228:229], v192 offset:12416
    v_mfma_f32_16x16x32_bf16 v[20:23], a[204:207], a[152:155], v[20:23]
    buffer_load_dwordx4 a[36:39], v202, s[16:19], s31 offen offset:2048 sc1
    v_mfma_f32_16x16x32_bf16 v[28:31], a[200:203], a[140:143], v[28:31]
    ds_read_b64_tr_b16 a[230:231], v192 offset:13952
    v_mfma_f32_16x16x32_bf16 v[28:31], a[204:207], a[156:159], v[28:31]
    s_waitcnt lgkmcnt(4)
    v_mfma_f32_16x16x32_bf16 v[32:35], a[208:211], a[128:131], v[32:35]
    ds_read_b64_tr_b16 a[232:233], v192 offset:136
    v_mfma_f32_16x16x32_bf16 v[32:35], a[212:215], a[144:147], v[32:35]
    buffer_load_dwordx4 a[40:43], v203, s[16:19], s31 offen offset:2048 sc1
    v_mfma_f32_16x16x32_bf16 v[40:43], a[208:211], a[132:135], v[40:43]
    ds_read_b64_tr_b16 a[234:235], v192 offset:1672
    v_mfma_f32_16x16x32_bf16 v[40:43], a[212:215], a[148:151], v[40:43]
    v_mfma_f32_16x16x32_bf16 v[48:51], a[208:211], a[136:139], v[48:51]
    ds_read_b64_tr_b16 a[236:237], v192 offset:12424
    v_mfma_f32_16x16x32_bf16 v[48:51], a[212:215], a[152:155], v[48:51]
    buffer_load_dwordx4 a[44:47], v204, s[16:19], s31 offen offset:2048 sc1
    v_mfma_f32_16x16x32_bf16 v[56:59], a[208:211], a[140:143], v[56:59]
    ds_read_b64_tr_b16 a[238:239], v192 offset:13960
    v_mfma_f32_16x16x32_bf16 v[56:59], a[212:215], a[156:159], v[56:59]
    v_mfma_f32_16x16x32_bf16 v[36:39], a[216:219], a[128:131], v[36:39]
    ds_read_b64_tr_b16 a[192:193], v193 offset:128
    v_mfma_f32_16x16x32_bf16 v[36:39], a[220:223], a[144:147], v[36:39]
    v_mfma_f32_16x16x32_bf16 v[44:47], a[216:219], a[132:135], v[44:47]
    ds_read_b64_tr_b16 a[194:195], v193 offset:1664
    v_mfma_f32_16x16x32_bf16 v[44:47], a[220:223], a[148:151], v[44:47]
    buffer_load_dwordx4 a[48:51], v201, s[16:19], s31 offen offset:3072 sc1
    v_mfma_f32_16x16x32_bf16 v[52:55], a[216:219], a[136:139], v[52:55]
    ds_read_b64_tr_b16 a[196:197], v193 offset:12416
    v_mfma_f32_16x16x32_bf16 v[52:55], a[220:223], a[152:155], v[52:55]
    v_mfma_f32_16x16x32_bf16 v[60:63], a[216:219], a[140:143], v[60:63]
    ds_read_b64_tr_b16 a[198:199], v193 offset:13952
    v_mfma_f32_16x16x32_bf16 v[60:63], a[220:223], a[156:159], v[60:63]
    s_waitcnt lgkmcnt(4)
    v_mfma_f32_16x16x32_bf16 v[64:67], a[224:227], a[128:131], v[64:67]
    ds_read_b64_tr_b16 a[200:201], v193 offset:136
    v_mfma_f32_16x16x32_bf16 v[64:67], a[228:231], a[144:147], v[64:67]
    buffer_load_dwordx4 a[52:55], v202, s[16:19], s31 offen offset:3072 sc1
    v_mfma_f32_16x16x32_bf16 v[72:75], a[224:227], a[132:135], v[72:75]
    ds_read_b64_tr_b16 a[202:203], v193 offset:1672
    v_mfma_f32_16x16x32_bf16 v[72:75], a[228:231], a[148:151], v[72:75]
    buffer_load_dwordx4 a[56:59], v203, s[16:19], s31 offen offset:3072 sc1
    v_mfma_f32_16x16x32_bf16 v[80:83], a[224:227], a[136:139], v[80:83]
    ds_read_b64_tr_b16 a[204:205], v193 offset:12424
    v_mfma_f32_16x16x32_bf16 v[80:83], a[228:231], a[152:155], v[80:83]
    v_mfma_f32_16x16x32_bf16 v[88:91], a[224:227], a[140:143], v[88:91]
    ds_read_b64_tr_b16 a[206:207], v193 offset:13960
    v_mfma_f32_16x16x32_bf16 v[88:91], a[228:231], a[156:159], v[88:91]
    buffer_load_dwordx4 a[60:63], v204, s[16:19], s31 offen offset:3072 sc1
    v_mfma_f32_16x16x32_bf16 v[68:71], a[232:235], a[128:131], v[68:71]
    ds_read_b64_tr_b16 a[208:209], v192 offset:256
    s_add_u32 s31, s31, 4096
    v_mfma_f32_16x16x32_bf16 v[68:71], a[236:239], a[144:147], v[68:71]
    s_add_u32 m0, s25, 49152
    v_mfma_f32_16x16x32_bf16 v[76:79], a[232:235], a[132:135], v[76:79]
    ds_read_b64_tr_b16 a[210:211], v192 offset:1792
    v_mfma_f32_16x16x32_bf16 v[76:79], a[236:239], a[148:151], v[76:79]
    v_mfma_f32_16x16x32_bf16 v[84:87], a[232:235], a[136:139], v[84:87]
    ds_read_b64_tr_b16 a[212:213], v192 offset:12544
    v_mfma_f32_16x16x32_bf16 v[84:87], a[236:239], a[152:155], v[84:87]
    buffer_load_dwordx4 v198, s[12:15], s30 offen offset:0  lds
    v_mfma_f32_16x16x32_bf16 v[92:95], a[232:235], a[140:143], v[92:95]
    ds_read_b64_tr_b16 a[214:215], v192 offset:14080
    v_mfma_f32_16x16x32_bf16 v[92:95], a[236:239], a[156:159], v[92:95]
    s_waitcnt lgkmcnt(4)
    v_mfma_f32_16x16x32_bf16 v[96:99], a[192:195], a[128:131], v[96:99]
    ds_read_b64_tr_b16 a[216:217], v192 offset:264
    v_mfma_f32_16x16x32_bf16 v[96:99], a[196:199], a[144:147], v[96:99]
    buffer_load_dwordx4 v199, s[12:15], s30 offen offset:1024  lds
    v_mfma_f32_16x16x32_bf16 v[104:107], a[192:195], a[132:135], v[104:107]
    ds_read_b64_tr_b16 a[218:219], v192 offset:1800
    v_mfma_f32_16x16x32_bf16 v[104:107], a[196:199], a[148:151], v[104:107]
    v_mfma_f32_16x16x32_bf16 v[112:115], a[192:195], a[136:139], v[112:115]
    ds_read_b64_tr_b16 a[220:221], v192 offset:12552
    v_mfma_f32_16x16x32_bf16 v[112:115], a[196:199], a[152:155], v[112:115]
    buffer_load_dwordx4 v200, s[12:15], s30 offen offset:2048  lds
    v_mfma_f32_16x16x32_bf16 v[120:123], a[192:195], a[140:143], v[120:123]
    ds_read_b64_tr_b16 a[222:223], v192 offset:14088
    s_add_u32 s30, s30, 393216
    v_mfma_f32_16x16x32_bf16 v[120:123], a[196:199], a[156:159], v[120:123]
    s_add_u32 m0, s25, 61440
    v_mfma_f32_16x16x32_bf16 v[100:103], a[200:203], a[128:131], v[100:103]
    ds_read_b64_tr_b16 a[224:225], v193 offset:256
    v_mfma_f32_16x16x32_bf16 v[100:103], a[204:207], a[144:147], v[100:103]
    buffer_load_dwordx4 v198, s[12:15], s30 offen offset:0  lds
    v_mfma_f32_16x16x32_bf16 v[108:111], a[200:203], a[132:135], v[108:111]
    ds_read_b64_tr_b16 a[226:227], v193 offset:1792
    v_mfma_f32_16x16x32_bf16 v[108:111], a[204:207], a[148:151], v[108:111]
    v_mfma_f32_16x16x32_bf16 v[116:119], a[200:203], a[136:139], v[116:119]
    ds_read_b64_tr_b16 a[228:229], v193 offset:12544
    v_mfma_f32_16x16x32_bf16 v[116:119], a[204:207], a[152:155], v[116:119]
    v_mfma_f32_16x16x32_bf16 v[124:127], a[200:203], a[140:143], v[124:127]
    ds_read_b64_tr_b16 a[230:231], v193 offset:14080
    v_mfma_f32_16x16x32_bf16 v[124:127], a[204:207], a[156:159], v[124:127]
    s_waitcnt lgkmcnt(4)
    v_mfma_f32_16x16x32_bf16 v[128:131], a[208:211], a[128:131], v[128:131]
    ds_read_b64_tr_b16 a[232:233], v193 offset:264
    v_mfma_f32_16x16x32_bf16 v[128:131], a[212:215], a[144:147], v[128:131]
    buffer_load_dwordx4 v199, s[12:15], s30 offen offset:1024  lds
    v_mfma_f32_16x16x32_bf16 v[136:139], a[208:211], a[132:135], v[136:139]
    ds_read_b64_tr_b16 a[234:235], v193 offset:1800
    v_mfma_f32_16x16x32_bf16 v[136:139], a[212:215], a[148:151], v[136:139]
    buffer_load_dwordx4 v200, s[12:15], s30 offen offset:2048  lds
    v_mfma_f32_16x16x32_bf16 v[144:147], a[208:211], a[136:139], v[144:147]
    ds_read_b64_tr_b16 a[236:237], v193 offset:12552
    s_add_u32 s30, s30, 393216
    v_mfma_f32_16x16x32_bf16 v[144:147], a[212:215], a[152:155], v[144:147]
    v_mfma_f32_16x16x32_bf16 v[152:155], a[208:211], a[140:143], v[152:155]
    ds_read_b64_tr_b16 a[238:239], v193 offset:14088
    v_mfma_f32_16x16x32_bf16 v[152:155], a[212:215], a[156:159], v[152:155]
    v_mfma_f32_16x16x32_bf16 v[132:135], a[216:219], a[128:131], v[132:135]
    v_mfma_f32_16x16x32_bf16 v[132:135], a[220:223], a[144:147], v[132:135]
    v_mfma_f32_16x16x32_bf16 v[140:143], a[216:219], a[132:135], v[140:143]
    v_mfma_f32_16x16x32_bf16 v[140:143], a[220:223], a[148:151], v[140:143]
    v_mfma_f32_16x16x32_bf16 v[148:151], a[216:219], a[136:139], v[148:151]
    s_waitcnt vmcnt(28) lgkmcnt(0)
    s_barrier
    v_mfma_f32_16x16x32_bf16 v[148:151], a[220:223], a[152:155], v[148:151]
    ds_read_b64_tr_b16 a[192:193], v192 offset:24576
    v_mfma_f32_16x16x32_bf16 v[156:159], a[216:219], a[140:143], v[156:159]
    ds_read_b64_tr_b16 a[194:195], v192 offset:26112
    v_mfma_f32_16x16x32_bf16 v[156:159], a[220:223], a[156:159], v[156:159]
    ds_read_b64_tr_b16 a[196:197], v192 offset:36864
    s_waitcnt lgkmcnt(3)
    v_mfma_f32_16x16x32_bf16 v[160:163], a[224:227], a[128:131], v[160:163]
    ds_read_b64_tr_b16 a[198:199], v192 offset:38400
    v_mfma_f32_16x16x32_bf16 v[160:163], a[228:231], a[144:147], v[160:163]
    ds_read_b64_tr_b16 a[200:201], v192 offset:24584
    v_mfma_f32_16x16x32_bf16 v[168:171], a[224:227], a[132:135], v[168:171]
    ds_read_b64_tr_b16 a[202:203], v192 offset:26120
    v_mfma_f32_16x16x32_bf16 v[168:171], a[228:231], a[148:151], v[168:171]
    buffer_load_dwordx4 a[64:67], v201, s[16:19], s31 offen offset:0 sc1
    v_mfma_f32_16x16x32_bf16 v[176:179], a[224:227], a[136:139], v[176:179]
    ds_read_b64_tr_b16 a[204:205], v192 offset:36872
    v_mfma_f32_16x16x32_bf16 v[176:179], a[228:231], a[152:155], v[176:179]
    buffer_load_dwordx4 a[68:71], v202, s[16:19], s31 offen offset:0 sc1
    v_mfma_f32_16x16x32_bf16 v[184:187], a[224:227], a[140:143], v[184:187]
    ds_read_b64_tr_b16 a[206:207], v192 offset:38408
    v_mfma_f32_16x16x32_bf16 v[184:187], a[228:231], a[156:159], v[184:187]
    buffer_load_dwordx4 a[72:75], v203, s[16:19], s31 offen offset:0 sc1
    v_mfma_f32_16x16x32_bf16 v[164:167], a[232:235], a[128:131], v[164:167]
    ds_read_b64_tr_b16 a[208:209], v193 offset:24576
    v_mfma_f32_16x16x32_bf16 v[164:167], a[236:239], a[144:147], v[164:167]
    v_mfma_f32_16x16x32_bf16 v[172:175], a[232:235], a[132:135], v[172:175]
    ds_read_b64_tr_b16 a[210:211], v193 offset:26112
    v_mfma_f32_16x16x32_bf16 v[172:175], a[236:239], a[148:151], v[172:175]
    buffer_load_dwordx4 a[76:79], v204, s[16:19], s31 offen offset:0 sc1
    v_mfma_f32_16x16x32_bf16 v[180:183], a[232:235], a[136:139], v[180:183]
    ds_read_b64_tr_b16 a[212:213], v193 offset:36864
    v_mfma_f32_16x16x32_bf16 v[180:183], a[236:239], a[152:155], v[180:183]
    v_mfma_f32_16x16x32_bf16 v[188:191], a[232:235], a[140:143], v[188:191]
    ds_read_b64_tr_b16 a[214:215], v193 offset:38400
    v_mfma_f32_16x16x32_bf16 v[188:191], a[236:239], a[156:159], v[188:191]
    s_waitcnt lgkmcnt(4)
    v_mfma_f32_16x16x32_bf16 v[0:3], a[192:195], a[160:163], v[0:3]
    ds_read_b64_tr_b16 a[216:217], v193 offset:24584
    v_mfma_f32_16x16x32_bf16 v[0:3], a[196:199], a[176:179], v[0:3]
    buffer_load_dwordx4 a[80:83], v201, s[16:19], s31 offen offset:1024 sc1
    v_mfma_f32_16x16x32_bf16 v[8:11], a[192:195], a[164:167], v[8:11]
    ds_read_b64_tr_b16 a[218:219], v193 offset:26120
    v_mfma_f32_16x16x32_bf16 v[8:11], a[196:199], a[180:183], v[8:11]
    buffer_load_dwordx4 a[84:87], v202, s[16:19], s31 offen offset:1024 sc1
    v_mfma_f32_16x16x32_bf16 v[16:19], a[192:195], a[168:171], v[16:19]
    ds_read_b64_tr_b16 a[220:221], v193 offset:36872
    v_mfma_f32_16x16x32_bf16 v[16:19], a[196:199], a[184:187], v[16:19]
    v_mfma_f32_16x16x32_bf16 v[24:27], a[192:195], a[172:175], v[24:27]
    ds_read_b64_tr_b16 a[222:223], v193 offset:38408
    v_mfma_f32_16x16x32_bf16 v[24:27], a[196:199], a[188:191], v[24:27]
    v_mfma_f32_16x16x32_bf16 v[4:7], a[200:203], a[160:163], v[4:7]
    ds_read_b64_tr_b16 a[224:225], v192 offset:24704
    v_mfma_f32_16x16x32_bf16 v[4:7], a[204:207], a[176:179], v[4:7]
    buffer_load_dwordx4 a[88:91], v203, s[16:19], s31 offen offset:1024 sc1
    v_mfma_f32_16x16x32_bf16 v[12:15], a[200:203], a[164:167], v[12:15]
    ds_read_b64_tr_b16 a[226:227], v192 offset:26240
    v_mfma_f32_16x16x32_bf16 v[12:15], a[204:207], a[180:183], v[12:15]
    v_mfma_f32_16x16x32_bf16 v[20:23], a[200:203], a[168:171], v[20:23]
    ds_read_b64_tr_b16 a[228:229], v192 offset:36992
    v_mfma_f32_16x16x32_bf16 v[20:23], a[204:207], a[184:187], v[20:23]
    buffer_load_dwordx4 a[92:95], v204, s[16:19], s31 offen offset:1024 sc1
    v_mfma_f32_16x16x32_bf16 v[28:31], a[200:203], a[172:175], v[28:31]
    ds_read_b64_tr_b16 a[230:231], v192 offset:38528
    s_add_u32 m0, s25, 98304
    v_mfma_f32_16x16x32_bf16 v[28:31], a[204:207], a[188:191], v[28:31]
    s_waitcnt lgkmcnt(4)
    v_mfma_f32_16x16x32_bf16 v[32:35], a[208:211], a[160:163], v[32:35]
    ds_read_b64_tr_b16 a[232:233], v192 offset:24712
    v_mfma_f32_16x16x32_bf16 v[32:35], a[212:215], a[176:179], v[32:35]
    buffer_load_dwordx4 v198, s[12:15], s30 offen offset:0  lds
    v_mfma_f32_16x16x32_bf16 v[40:43], a[208:211], a[164:167], v[40:43]
    ds_read_b64_tr_b16 a[234:235], v192 offset:26248
    v_mfma_f32_16x16x32_bf16 v[40:43], a[212:215], a[180:183], v[40:43]
    v_mfma_f32_16x16x32_bf16 v[48:51], a[208:211], a[168:171], v[48:51]
    ds_read_b64_tr_b16 a[236:237], v192 offset:37000
    v_mfma_f32_16x16x32_bf16 v[48:51], a[212:215], a[184:187], v[48:51]
    buffer_load_dwordx4 v199, s[12:15], s30 offen offset:1024  lds
    v_mfma_f32_16x16x32_bf16 v[56:59], a[208:211], a[172:175], v[56:59]
    ds_read_b64_tr_b16 a[238:239], v192 offset:38536
    v_mfma_f32_16x16x32_bf16 v[56:59], a[212:215], a[188:191], v[56:59]
    v_mfma_f32_16x16x32_bf16 v[36:39], a[216:219], a[160:163], v[36:39]
    ds_read_b64_tr_b16 a[192:193], v193 offset:24704
    v_mfma_f32_16x16x32_bf16 v[36:39], a[220:223], a[176:179], v[36:39]
    v_mfma_f32_16x16x32_bf16 v[44:47], a[216:219], a[164:167], v[44:47]
    ds_read_b64_tr_b16 a[194:195], v193 offset:26240
    v_mfma_f32_16x16x32_bf16 v[44:47], a[220:223], a[180:183], v[44:47]
    buffer_load_dwordx4 v200, s[12:15], s30 offen offset:2048  lds
    v_mfma_f32_16x16x32_bf16 v[52:55], a[216:219], a[168:171], v[52:55]
    ds_read_b64_tr_b16 a[196:197], v193 offset:36992
    s_add_u32 s30, s30, 393216
    v_mfma_f32_16x16x32_bf16 v[52:55], a[220:223], a[184:187], v[52:55]
    s_add_u32 m0, s25, 110592
    v_mfma_f32_16x16x32_bf16 v[60:63], a[216:219], a[172:175], v[60:63]
    ds_read_b64_tr_b16 a[198:199], v193 offset:38528
    v_mfma_f32_16x16x32_bf16 v[60:63], a[220:223], a[188:191], v[60:63]
    s_waitcnt lgkmcnt(4)
    v_mfma_f32_16x16x32_bf16 v[64:67], a[224:227], a[160:163], v[64:67]
    ds_read_b64_tr_b16 a[200:201], v193 offset:24712
    v_mfma_f32_16x16x32_bf16 v[64:67], a[228:231], a[176:179], v[64:67]
    buffer_load_dwordx4 v198, s[12:15], s30 offen offset:0  lds
    v_mfma_f32_16x16x32_bf16 v[72:75], a[224:227], a[164:167], v[72:75]
    ds_read_b64_tr_b16 a[202:203], v193 offset:26248
    v_mfma_f32_16x16x32_bf16 v[72:75], a[228:231], a[180:183], v[72:75]
    buffer_load_dwordx4 v199, s[12:15], s30 offen offset:1024  lds
    v_mfma_f32_16x16x32_bf16 v[80:83], a[224:227], a[168:171], v[80:83]
    ds_read_b64_tr_b16 a[204:205], v193 offset:37000
    v_mfma_f32_16x16x32_bf16 v[80:83], a[228:231], a[184:187], v[80:83]
    v_mfma_f32_16x16x32_bf16 v[88:91], a[224:227], a[172:175], v[88:91]
    ds_read_b64_tr_b16 a[206:207], v193 offset:38536
    v_mfma_f32_16x16x32_bf16 v[88:91], a[228:231], a[188:191], v[88:91]
    buffer_load_dwordx4 v200, s[12:15], s30 offen offset:2048  lds
    v_mfma_f32_16x16x32_bf16 v[68:71], a[232:235], a[160:163], v[68:71]
    ds_read_b64_tr_b16 a[208:209], v192 offset:24832
    s_add_u32 s30, s30, 393216
    v_mfma_f32_16x16x32_bf16 v[68:71], a[236:239], a[176:179], v[68:71]
    s_add_u32 m0, s25, 122880
    v_mfma_f32_16x16x32_bf16 v[76:79], a[232:235], a[164:167], v[76:79]
    ds_read_b64_tr_b16 a[210:211], v192 offset:26368
    v_mfma_f32_16x16x32_bf16 v[76:79], a[236:239], a[180:183], v[76:79]
    v_mfma_f32_16x16x32_bf16 v[84:87], a[232:235], a[168:171], v[84:87]
    ds_read_b64_tr_b16 a[212:213], v192 offset:37120
    v_mfma_f32_16x16x32_bf16 v[84:87], a[236:239], a[184:187], v[84:87]
    buffer_load_dwordx4 v198, s[12:15], s30 offen offset:0  lds
    v_mfma_f32_16x16x32_bf16 v[92:95], a[232:235], a[172:175], v[92:95]
    ds_read_b64_tr_b16 a[214:215], v192 offset:38656
    v_mfma_f32_16x16x32_bf16 v[92:95], a[236:239], a[188:191], v[92:95]
    s_waitcnt lgkmcnt(4)
    v_mfma_f32_16x16x32_bf16 v[96:99], a[192:195], a[160:163], v[96:99]
    ds_read_b64_tr_b16 a[216:217], v192 offset:24840
    v_mfma_f32_16x16x32_bf16 v[96:99], a[196:199], a[176:179], v[96:99]
    buffer_load_dwordx4 v199, s[12:15], s30 offen offset:1024  lds
    v_mfma_f32_16x16x32_bf16 v[104:107], a[192:195], a[164:167], v[104:107]
    ds_read_b64_tr_b16 a[218:219], v192 offset:26376
    v_mfma_f32_16x16x32_bf16 v[104:107], a[196:199], a[180:183], v[104:107]
    v_mfma_f32_16x16x32_bf16 v[112:115], a[192:195], a[168:171], v[112:115]
    ds_read_b64_tr_b16 a[220:221], v192 offset:37128
    v_mfma_f32_16x16x32_bf16 v[112:115], a[196:199], a[184:187], v[112:115]
    buffer_load_dwordx4 v200, s[12:15], s30 offen offset:2048  lds
    v_mfma_f32_16x16x32_bf16 v[120:123], a[192:195], a[172:175], v[120:123]
    ds_read_b64_tr_b16 a[222:223], v192 offset:38664
    s_add_u32 s30, s30, 393216
    v_mfma_f32_16x16x32_bf16 v[120:123], a[196:199], a[188:191], v[120:123]
    s_add_u32 m0, s25, 135168
    v_mfma_f32_16x16x32_bf16 v[100:103], a[200:203], a[160:163], v[100:103]
    ds_read_b64_tr_b16 a[224:225], v193 offset:24832
    v_mfma_f32_16x16x32_bf16 v[100:103], a[204:207], a[176:179], v[100:103]
    buffer_load_dwordx4 v198, s[12:15], s30 offen offset:0  lds
    v_mfma_f32_16x16x32_bf16 v[108:111], a[200:203], a[164:167], v[108:111]
    ds_read_b64_tr_b16 a[226:227], v193 offset:26368
    v_mfma_f32_16x16x32_bf16 v[108:111], a[204:207], a[180:183], v[108:111]
    v_mfma_f32_16x16x32_bf16 v[116:119], a[200:203], a[168:171], v[116:119]
    ds_read_b64_tr_b16 a[228:229], v193 offset:37120
    v_mfma_f32_16x16x32_bf16 v[116:119], a[204:207], a[184:187], v[116:119]
    v_mfma_f32_16x16x32_bf16 v[124:127], a[200:203], a[172:175], v[124:127]
    ds_read_b64_tr_b16 a[230:231], v193 offset:38656
    v_mfma_f32_16x16x32_bf16 v[124:127], a[204:207], a[188:191], v[124:127]
    s_waitcnt lgkmcnt(4)
    v_mfma_f32_16x16x32_bf16 v[128:131], a[208:211], a[160:163], v[128:131]
    ds_read_b64_tr_b16 a[232:233], v193 offset:24840
    v_mfma_f32_16x16x32_bf16 v[128:131], a[212:215], a[176:179], v[128:131]
    buffer_load_dwordx4 v199, s[12:15], s30 offen offset:1024  lds
    v_mfma_f32_16x16x32_bf16 v[136:139], a[208:211], a[164:167], v[136:139]
    ds_read_b64_tr_b16 a[234:235], v193 offset:26376
    v_mfma_f32_16x16x32_bf16 v[136:139], a[212:215], a[180:183], v[136:139]
    buffer_load_dwordx4 v200, s[12:15], s30 offen offset:2048  lds
    v_mfma_f32_16x16x32_bf16 v[144:147], a[208:211], a[168:171], v[144:147]
    ds_read_b64_tr_b16 a[236:237], v193 offset:37128
    s_add_u32 s30, s30, 393216
    v_mfma_f32_16x16x32_bf16 v[144:147], a[212:215], a[184:187], v[144:147]
    v_mfma_f32_16x16x32_bf16 v[152:155], a[208:211], a[172:175], v[152:155]
    ds_read_b64_tr_b16 a[238:239], v193 offset:38664
    v_mfma_f32_16x16x32_bf16 v[152:155], a[212:215], a[188:191], v[152:155]
    v_mfma_f32_16x16x32_bf16 v[132:135], a[216:219], a[160:163], v[132:135]
    v_mfma_f32_16x16x32_bf16 v[132:135], a[220:223], a[176:179], v[132:135]
    v_mfma_f32_16x16x32_bf16 v[140:143], a[216:219], a[164:167], v[140:143]
    v_mfma_f32_16x16x32_bf16 v[140:143], a[220:223], a[180:183], v[140:143]
    v_mfma_f32_16x16x32_bf16 v[148:151], a[216:219], a[168:171], v[148:151]
    s_waitcnt vmcnt(34) lgkmcnt(0)
    s_barrier
    v_mfma_f32_16x16x32_bf16 v[148:151], a[220:223], a[184:187], v[148:151]
    ds_read_b64_tr_b16 a[192:193], v194 offset:24576
    v_mfma_f32_16x16x32_bf16 v[156:159], a[216:219], a[172:175], v[156:159]
    ds_read_b64_tr_b16 a[194:195], v194 offset:26112
    v_mfma_f32_16x16x32_bf16 v[156:159], a[220:223], a[188:191], v[156:159]
    ds_read_b64_tr_b16 a[196:197], v194 offset:36864
    s_waitcnt lgkmcnt(3)
    v_mfma_f32_16x16x32_bf16 v[160:163], a[224:227], a[160:163], v[160:163]
    ds_read_b64_tr_b16 a[198:199], v194 offset:38400
    v_mfma_f32_16x16x32_bf16 v[160:163], a[228:231], a[176:179], v[160:163]
    ds_read_b64_tr_b16 a[200:201], v194 offset:24584
    v_mfma_f32_16x16x32_bf16 v[168:171], a[224:227], a[164:167], v[168:171]
    ds_read_b64_tr_b16 a[202:203], v194 offset:26120
    v_mfma_f32_16x16x32_bf16 v[168:171], a[228:231], a[180:183], v[168:171]
    buffer_load_dwordx4 a[96:99], v201, s[16:19], s31 offen offset:2048 sc1
    v_mfma_f32_16x16x32_bf16 v[176:179], a[224:227], a[168:171], v[176:179]
    ds_read_b64_tr_b16 a[204:205], v194 offset:36872
    v_mfma_f32_16x16x32_bf16 v[176:179], a[228:231], a[184:187], v[176:179]
    buffer_load_dwordx4 a[100:103], v202, s[16:19], s31 offen offset:2048 sc1
    v_mfma_f32_16x16x32_bf16 v[184:187], a[224:227], a[172:175], v[184:187]
    ds_read_b64_tr_b16 a[206:207], v194 offset:38408
    v_mfma_f32_16x16x32_bf16 v[184:187], a[228:231], a[188:191], v[184:187]
    buffer_load_dwordx4 a[104:107], v203, s[16:19], s31 offen offset:2048 sc1
    v_mfma_f32_16x16x32_bf16 v[164:167], a[232:235], a[160:163], v[164:167]
    ds_read_b64_tr_b16 a[208:209], v195 offset:24576
    v_mfma_f32_16x16x32_bf16 v[164:167], a[236:239], a[176:179], v[164:167]
    v_mfma_f32_16x16x32_bf16 v[172:175], a[232:235], a[164:167], v[172:175]
    ds_read_b64_tr_b16 a[210:211], v195 offset:26112
    v_mfma_f32_16x16x32_bf16 v[172:175], a[236:239], a[180:183], v[172:175]
    buffer_load_dwordx4 a[108:111], v204, s[16:19], s31 offen offset:2048 sc1
    v_mfma_f32_16x16x32_bf16 v[180:183], a[232:235], a[168:171], v[180:183]
    ds_read_b64_tr_b16 a[212:213], v195 offset:36864
    v_mfma_f32_16x16x32_bf16 v[180:183], a[236:239], a[184:187], v[180:183]
    v_mfma_f32_16x16x32_bf16 v[188:191], a[232:235], a[172:175], v[188:191]
    ds_read_b64_tr_b16 a[214:215], v195 offset:38400
    v_mfma_f32_16x16x32_bf16 v[188:191], a[236:239], a[188:191], v[188:191]
    s_waitcnt lgkmcnt(4)
    v_mfma_f32_16x16x32_bf16 v[0:3], a[192:195], a[0:3], v[0:3]
    ds_read_b64_tr_b16 a[216:217], v195 offset:24584
    v_mfma_f32_16x16x32_bf16 v[0:3], a[196:199], a[16:19], v[0:3]
    buffer_load_dwordx4 a[112:115], v201, s[16:19], s31 offen offset:3072 sc1
    v_mfma_f32_16x16x32_bf16 v[8:11], a[192:195], a[4:7], v[8:11]
    ds_read_b64_tr_b16 a[218:219], v195 offset:26120
    v_mfma_f32_16x16x32_bf16 v[8:11], a[196:199], a[20:23], v[8:11]
    buffer_load_dwordx4 a[116:119], v202, s[16:19], s31 offen offset:3072 sc1
    v_mfma_f32_16x16x32_bf16 v[16:19], a[192:195], a[8:11], v[16:19]
    ds_read_b64_tr_b16 a[220:221], v195 offset:36872
    v_mfma_f32_16x16x32_bf16 v[16:19], a[196:199], a[24:27], v[16:19]
    v_mfma_f32_16x16x32_bf16 v[24:27], a[192:195], a[12:15], v[24:27]
    ds_read_b64_tr_b16 a[222:223], v195 offset:38408
    v_mfma_f32_16x16x32_bf16 v[24:27], a[196:199], a[28:31], v[24:27]
    v_mfma_f32_16x16x32_bf16 v[4:7], a[200:203], a[0:3], v[4:7]
    ds_read_b64_tr_b16 a[224:225], v194 offset:24704
    v_mfma_f32_16x16x32_bf16 v[4:7], a[204:207], a[16:19], v[4:7]
    buffer_load_dwordx4 a[120:123], v203, s[16:19], s31 offen offset:3072 sc1
    v_mfma_f32_16x16x32_bf16 v[12:15], a[200:203], a[4:7], v[12:15]
    ds_read_b64_tr_b16 a[226:227], v194 offset:26240
    v_mfma_f32_16x16x32_bf16 v[12:15], a[204:207], a[20:23], v[12:15]
    v_mfma_f32_16x16x32_bf16 v[20:23], a[200:203], a[8:11], v[20:23]
    ds_read_b64_tr_b16 a[228:229], v194 offset:36992
    v_mfma_f32_16x16x32_bf16 v[20:23], a[204:207], a[24:27], v[20:23]
    buffer_load_dwordx4 a[124:127], v204, s[16:19], s31 offen offset:3072 sc1
    v_mfma_f32_16x16x32_bf16 v[28:31], a[200:203], a[12:15], v[28:31]
    ds_read_b64_tr_b16 a[230:231], v194 offset:38528
    s_add_u32 s31, s31, 4096
    v_mfma_f32_16x16x32_bf16 v[28:31], a[204:207], a[28:31], v[28:31]
    s_waitcnt lgkmcnt(4)
    s_add_u32 m0, s25, 0
    v_mfma_f32_16x16x32_bf16 v[32:35], a[208:211], a[0:3], v[32:35]
    ds_read_b64_tr_b16 a[232:233], v194 offset:24712
    v_mfma_f32_16x16x32_bf16 v[32:35], a[212:215], a[16:19], v[32:35]
    buffer_load_dwordx4 v220, s[4:7], s26 offen offset:0  lds
    v_mfma_f32_16x16x32_bf16 v[40:43], a[208:211], a[4:7], v[40:43]
    ds_read_b64_tr_b16 a[234:235], v194 offset:26248
    v_mfma_f32_16x16x32_bf16 v[40:43], a[212:215], a[20:23], v[40:43]
    v_mfma_f32_16x16x32_bf16 v[48:51], a[208:211], a[8:11], v[48:51]
    ds_read_b64_tr_b16 a[236:237], v194 offset:37000
    v_mfma_f32_16x16x32_bf16 v[48:51], a[212:215], a[24:27], v[48:51]
    buffer_load_dwordx4 v221, s[4:7], s26 offen offset:1024  lds
    v_mfma_f32_16x16x32_bf16 v[56:59], a[208:211], a[12:15], v[56:59]
    ds_read_b64_tr_b16 a[238:239], v194 offset:38536
    v_mfma_f32_16x16x32_bf16 v[56:59], a[212:215], a[28:31], v[56:59]
    v_mfma_f32_16x16x32_bf16 v[36:39], a[216:219], a[0:3], v[36:39]
    ds_read_b64_tr_b16 a[192:193], v195 offset:24704
    v_mfma_f32_16x16x32_bf16 v[36:39], a[220:223], a[16:19], v[36:39]
    v_mfma_f32_16x16x32_bf16 v[44:47], a[216:219], a[4:7], v[44:47]
    ds_read_b64_tr_b16 a[194:195], v195 offset:26240
    v_mfma_f32_16x16x32_bf16 v[44:47], a[220:223], a[20:23], v[44:47]
    buffer_load_dwordx4 v222, s[4:7], s26 offen offset:2048  lds
    v_mfma_f32_16x16x32_bf16 v[52:55], a[216:219], a[8:11], v[52:55]
    ds_read_b64_tr_b16 a[196:197], v195 offset:36992
    s_add_u32 s26, s26, 12288
    v_mfma_f32_16x16x32_bf16 v[52:55], a[220:223], a[24:27], v[52:55]
    s_add_u32 m0, s25, 12288
    v_mfma_f32_16x16x32_bf16 v[60:63], a[216:219], a[12:15], v[60:63]
    ds_read_b64_tr_b16 a[198:199], v195 offset:38528
    v_mfma_f32_16x16x32_bf16 v[60:63], a[220:223], a[28:31], v[60:63]
    s_waitcnt lgkmcnt(4)
    v_mfma_f32_16x16x32_bf16 v[64:67], a[224:227], a[0:3], v[64:67]
    ds_read_b64_tr_b16 a[200:201], v195 offset:24712
    v_mfma_f32_16x16x32_bf16 v[64:67], a[228:231], a[16:19], v[64:67]
    buffer_load_dwordx4 v220, s[4:7], s26 offen offset:0  lds
    v_mfma_f32_16x16x32_bf16 v[72:75], a[224:227], a[4:7], v[72:75]
    ds_read_b64_tr_b16 a[202:203], v195 offset:26248
    v_mfma_f32_16x16x32_bf16 v[72:75], a[228:231], a[20:23], v[72:75]
    buffer_load_dwordx4 v221, s[4:7], s26 offen offset:1024  lds
    v_mfma_f32_16x16x32_bf16 v[80:83], a[224:227], a[8:11], v[80:83]
    ds_read_b64_tr_b16 a[204:205], v195 offset:37000
    v_mfma_f32_16x16x32_bf16 v[80:83], a[228:231], a[24:27], v[80:83]
    v_mfma_f32_16x16x32_bf16 v[88:91], a[224:227], a[12:15], v[88:91]
    ds_read_b64_tr_b16 a[206:207], v195 offset:38536
    v_mfma_f32_16x16x32_bf16 v[88:91], a[228:231], a[28:31], v[88:91]
    buffer_load_dwordx4 v222, s[4:7], s26 offen offset:2048  lds
    v_mfma_f32_16x16x32_bf16 v[68:71], a[232:235], a[0:3], v[68:71]
    ds_read_b64_tr_b16 a[208:209], v194 offset:24832
    s_add_u32 s26, s26, 12288
    v_mfma_f32_16x16x32_bf16 v[68:71], a[236:239], a[16:19], v[68:71]
    s_add_u32 m0, s25, 24576
    v_mfma_f32_16x16x32_bf16 v[76:79], a[232:235], a[4:7], v[76:79]
    ds_read_b64_tr_b16 a[210:211], v194 offset:26368
    v_mfma_f32_16x16x32_bf16 v[76:79], a[236:239], a[20:23], v[76:79]
    v_mfma_f32_16x16x32_bf16 v[84:87], a[232:235], a[8:11], v[84:87]
    ds_read_b64_tr_b16 a[212:213], v194 offset:37120
    v_mfma_f32_16x16x32_bf16 v[84:87], a[236:239], a[24:27], v[84:87]
    buffer_load_dwordx4 v220, s[4:7], s26 offen offset:0  lds
    v_mfma_f32_16x16x32_bf16 v[92:95], a[232:235], a[12:15], v[92:95]
    ds_read_b64_tr_b16 a[214:215], v194 offset:38656
    v_mfma_f32_16x16x32_bf16 v[92:95], a[236:239], a[28:31], v[92:95]
    s_waitcnt lgkmcnt(4)
    v_mfma_f32_16x16x32_bf16 v[96:99], a[192:195], a[0:3], v[96:99]
    ds_read_b64_tr_b16 a[216:217], v194 offset:24840
    v_mfma_f32_16x16x32_bf16 v[96:99], a[196:199], a[16:19], v[96:99]
    buffer_load_dwordx4 v221, s[4:7], s26 offen offset:1024  lds
    v_mfma_f32_16x16x32_bf16 v[104:107], a[192:195], a[4:7], v[104:107]
    ds_read_b64_tr_b16 a[218:219], v194 offset:26376
    v_mfma_f32_16x16x32_bf16 v[104:107], a[196:199], a[20:23], v[104:107]
    v_mfma_f32_16x16x32_bf16 v[112:115], a[192:195], a[8:11], v[112:115]
    ds_read_b64_tr_b16 a[220:221], v194 offset:37128
    v_mfma_f32_16x16x32_bf16 v[112:115], a[196:199], a[24:27], v[112:115]
    buffer_load_dwordx4 v222, s[4:7], s26 offen offset:2048  lds
    v_mfma_f32_16x16x32_bf16 v[120:123], a[192:195], a[12:15], v[120:123]
    ds_read_b64_tr_b16 a[222:223], v194 offset:38664
    s_add_u32 s26, s26, 12288
    v_mfma_f32_16x16x32_bf16 v[120:123], a[196:199], a[28:31], v[120:123]
    s_add_u32 m0, s25, 36864
    v_mfma_f32_16x16x32_bf16 v[100:103], a[200:203], a[0:3], v[100:103]
    ds_read_b64_tr_b16 a[224:225], v195 offset:24832
    v_mfma_f32_16x16x32_bf16 v[100:103], a[204:207], a[16:19], v[100:103]
    buffer_load_dwordx4 v220, s[4:7], s26 offen offset:0  lds
    v_mfma_f32_16x16x32_bf16 v[108:111], a[200:203], a[4:7], v[108:111]
    ds_read_b64_tr_b16 a[226:227], v195 offset:26368
    v_mfma_f32_16x16x32_bf16 v[108:111], a[204:207], a[20:23], v[108:111]
    v_mfma_f32_16x16x32_bf16 v[116:119], a[200:203], a[8:11], v[116:119]
    ds_read_b64_tr_b16 a[228:229], v195 offset:37120
    v_mfma_f32_16x16x32_bf16 v[116:119], a[204:207], a[24:27], v[116:119]
    v_mfma_f32_16x16x32_bf16 v[124:127], a[200:203], a[12:15], v[124:127]
    ds_read_b64_tr_b16 a[230:231], v195 offset:38656
    v_mfma_f32_16x16x32_bf16 v[124:127], a[204:207], a[28:31], v[124:127]
    s_waitcnt lgkmcnt(4)
    v_mfma_f32_16x16x32_bf16 v[128:131], a[208:211], a[0:3], v[128:131]
    ds_read_b64_tr_b16 a[232:233], v195 offset:24840
    v_mfma_f32_16x16x32_bf16 v[128:131], a[212:215], a[16:19], v[128:131]
    buffer_load_dwordx4 v221, s[4:7], s26 offen offset:1024  lds
    v_mfma_f32_16x16x32_bf16 v[136:139], a[208:211], a[4:7], v[136:139]
    ds_read_b64_tr_b16 a[234:235], v195 offset:26376
    v_mfma_f32_16x16x32_bf16 v[136:139], a[212:215], a[20:23], v[136:139]
    buffer_load_dwordx4 v222, s[4:7], s26 offen offset:2048  lds
    v_mfma_f32_16x16x32_bf16 v[144:147], a[208:211], a[8:11], v[144:147]
    ds_read_b64_tr_b16 a[236:237], v195 offset:37128
    s_add_u32 s26, s26, 12288
    v_mfma_f32_16x16x32_bf16 v[144:147], a[212:215], a[24:27], v[144:147]
    v_mfma_f32_16x16x32_bf16 v[152:155], a[208:211], a[12:15], v[152:155]
    ds_read_b64_tr_b16 a[238:239], v195 offset:38664
    v_mfma_f32_16x16x32_bf16 v[152:155], a[212:215], a[28:31], v[152:155]
    v_mfma_f32_16x16x32_bf16 v[132:135], a[216:219], a[0:3], v[132:135]
    v_mfma_f32_16x16x32_bf16 v[132:135], a[220:223], a[16:19], v[132:135]
    v_mfma_f32_16x16x32_bf16 v[140:143], a[216:219], a[4:7], v[140:143]
    v_mfma_f32_16x16x32_bf16 v[140:143], a[220:223], a[20:23], v[140:143]
    v_mfma_f32_16x16x32_bf16 v[148:151], a[216:219], a[8:11], v[148:151]
    s_waitcnt vmcnt(40) lgkmcnt(0)
    s_barrier
    v_mfma_f32_16x16x32_bf16 v[148:151], a[220:223], a[24:27], v[148:151]
    ds_read_b64_tr_b16 a[192:193], v194 offset:0
    s_add_u32 m0, s25, 73728
    v_mfma_f32_16x16x32_bf16 v[156:159], a[216:219], a[12:15], v[156:159]
    ds_read_b64_tr_b16 a[194:195], v194 offset:1536
    v_mfma_f32_16x16x32_bf16 v[156:159], a[220:223], a[28:31], v[156:159]
    ds_read_b64_tr_b16 a[196:197], v194 offset:12288
    s_waitcnt lgkmcnt(3)
    v_mfma_f32_16x16x32_bf16 v[160:163], a[224:227], a[0:3], v[160:163]
    ds_read_b64_tr_b16 a[198:199], v194 offset:13824
    v_mfma_f32_16x16x32_bf16 v[160:163], a[228:231], a[16:19], v[160:163]
    ds_read_b64_tr_b16 a[200:201], v194 offset:8
    v_mfma_f32_16x16x32_bf16 v[168:171], a[224:227], a[4:7], v[168:171]
    ds_read_b64_tr_b16 a[202:203], v194 offset:1544
    v_mfma_f32_16x16x32_bf16 v[168:171], a[228:231], a[20:23], v[168:171]
    buffer_load_dwordx4 v223, s[8:11], s27 offen offset:0  lds
    v_mfma_f32_16x16x32_bf16 v[176:179], a[224:227], a[8:11], v[176:179]
    ds_read_b64_tr_b16 a[204:205], v194 offset:12296
    v_mfma_f32_16x16x32_bf16 v[176:179], a[228:231], a[24:27], v[176:179]
    v_mfma_f32_16x16x32_bf16 v[184:187], a[224:227], a[12:15], v[184:187]
    ds_read_b64_tr_b16 a[206:207], v194 offset:13832
    v_mfma_f32_16x16x32_bf16 v[184:187], a[228:231], a[28:31], v[184:187]
    v_mfma_f32_16x16x32_bf16 v[164:167], a[232:235], a[0:3], v[164:167]
    ds_read_b64_tr_b16 a[208:209], v195 offset:0
    v_mfma_f32_16x16x32_bf16 v[164:167], a[236:239], a[16:19], v[164:167]
    v_mfma_f32_16x16x32_bf16 v[172:175], a[232:235], a[4:7], v[172:175]
    ds_read_b64_tr_b16 a[210:211], v195 offset:1536
    v_mfma_f32_16x16x32_bf16 v[172:175], a[236:239], a[20:23], v[172:175]
    v_mfma_f32_16x16x32_bf16 v[180:183], a[232:235], a[8:11], v[180:183]
    ds_read_b64_tr_b16 a[212:213], v195 offset:12288
    v_mfma_f32_16x16x32_bf16 v[180:183], a[236:239], a[24:27], v[180:183]
    buffer_load_dwordx4 v224, s[8:11], s27 offen offset:1024  lds
    v_mfma_f32_16x16x32_bf16 v[188:191], a[232:235], a[12:15], v[188:191]
    ds_read_b64_tr_b16 a[214:215], v195 offset:13824
    v_mfma_f32_16x16x32_bf16 v[188:191], a[236:239], a[28:31], v[188:191]
    s_waitcnt lgkmcnt(4)
    v_mfma_f32_16x16x32_bf16 v[0:3], a[192:195], a[32:35], v[0:3]
    ds_read_b64_tr_b16 a[216:217], v195 offset:8
    v_mfma_f32_16x16x32_bf16 v[0:3], a[196:199], a[48:51], v[0:3]
    v_mfma_f32_16x16x32_bf16 v[8:11], a[192:195], a[36:39], v[8:11]
    ds_read_b64_tr_b16 a[218:219], v195 offset:1544
    v_mfma_f32_16x16x32_bf16 v[8:11], a[196:199], a[52:55], v[8:11]
    v_mfma_f32_16x16x32_bf16 v[16:19], a[192:195], a[40:43], v[16:19]
    ds_read_b64_tr_b16 a[220:221], v195 offset:12296
    v_mfma_f32_16x16x32_bf16 v[16:19], a[196:199], a[56:59], v[16:19]
    v_mfma_f32_16x16x32_bf16 v[24:27], a[192:195], a[44:47], v[24:27]
    ds_read_b64_tr_b16 a[222:223], v195 offset:13832
    v_mfma_f32_16x16x32_bf16 v[24:27], a[196:199], a[60:63], v[24:27]
    v_mfma_f32_16x16x32_bf16 v[4:7], a[200:203], a[32:35], v[4:7]
    ds_read_b64_tr_b16 a[224:225], v194 offset:128
    v_mfma_f32_16x16x32_bf16 v[4:7], a[204:207], a[48:51], v[4:7]
    v_mfma_f32_16x16x32_bf16 v[12:15], a[200:203], a[36:39], v[12:15]
    ds_read_b64_tr_b16 a[226:227], v194 offset:1664
    v_mfma_f32_16x16x32_bf16 v[12:15], a[204:207], a[52:55], v[12:15]
    buffer_load_dwordx4 v225, s[8:11], s27 offen offset:2048  lds
    v_mfma_f32_16x16x32_bf16 v[20:23], a[200:203], a[40:43], v[20:23]
    ds_read_b64_tr_b16 a[228:229], v194 offset:12416
    s_add_u32 s27, s27, 12288
    v_mfma_f32_16x16x32_bf16 v[20:23], a[204:207], a[56:59], v[20:23]
    s_add_u32 m0, s25, 86016
    v_mfma_f32_16x16x32_bf16 v[28:31], a[200:203], a[44:47], v[28:31]
    ds_read_b64_tr_b16 a[230:231], v194 offset:13952
    v_mfma_f32_16x16x32_bf16 v[28:31], a[204:207], a[60:63], v[28:31]
    s_waitcnt lgkmcnt(4)
    v_mfma_f32_16x16x32_bf16 v[32:35], a[208:211], a[32:35], v[32:35]
    ds_read_b64_tr_b16 a[232:233], v194 offset:136
    v_mfma_f32_16x16x32_bf16 v[32:35], a[212:215], a[48:51], v[32:35]
    v_mfma_f32_16x16x32_bf16 v[40:43], a[208:211], a[36:39], v[40:43]
    ds_read_b64_tr_b16 a[234:235], v194 offset:1672
    v_mfma_f32_16x16x32_bf16 v[40:43], a[212:215], a[52:55], v[40:43]
    v_mfma_f32_16x16x32_bf16 v[48:51], a[208:211], a[40:43], v[48:51]
    ds_read_b64_tr_b16 a[236:237], v194 offset:12424
    v_mfma_f32_16x16x32_bf16 v[48:51], a[212:215], a[56:59], v[48:51]
    v_mfma_f32_16x16x32_bf16 v[56:59], a[208:211], a[44:47], v[56:59]
    ds_read_b64_tr_b16 a[238:239], v194 offset:13960
    v_mfma_f32_16x16x32_bf16 v[56:59], a[212:215], a[60:63], v[56:59]
    v_mfma_f32_16x16x32_bf16 v[36:39], a[216:219], a[32:35], v[36:39]
    ds_read_b64_tr_b16 a[192:193], v195 offset:128
    v_mfma_f32_16x16x32_bf16 v[36:39], a[220:223], a[48:51], v[36:39]
    v_mfma_f32_16x16x32_bf16 v[44:47], a[216:219], a[36:39], v[44:47]
    ds_read_b64_tr_b16 a[194:195], v195 offset:1664
    v_mfma_f32_16x16x32_bf16 v[44:47], a[220:223], a[52:55], v[44:47]
    buffer_load_dwordx4 v223, s[8:11], s27 offen offset:0  lds
    v_mfma_f32_16x16x32_bf16 v[52:55], a[216:219], a[40:43], v[52:55]
    ds_read_b64_tr_b16 a[196:197], v195 offset:12416
    v_mfma_f32_16x16x32_bf16 v[52:55], a[220:223], a[56:59], v[52:55]
    v_mfma_f32_16x16x32_bf16 v[60:63], a[216:219], a[44:47], v[60:63]
    ds_read_b64_tr_b16 a[198:199], v195 offset:13952
    v_mfma_f32_16x16x32_bf16 v[60:63], a[220:223], a[60:63], v[60:63]
    s_waitcnt lgkmcnt(4)
    v_mfma_f32_16x16x32_bf16 v[64:67], a[224:227], a[32:35], v[64:67]
    ds_read_b64_tr_b16 a[200:201], v195 offset:136
    v_mfma_f32_16x16x32_bf16 v[64:67], a[228:231], a[48:51], v[64:67]
    v_mfma_f32_16x16x32_bf16 v[72:75], a[224:227], a[36:39], v[72:75]
    ds_read_b64_tr_b16 a[202:203], v195 offset:1672
    v_mfma_f32_16x16x32_bf16 v[72:75], a[228:231], a[52:55], v[72:75]
    v_mfma_f32_16x16x32_bf16 v[80:83], a[224:227], a[40:43], v[80:83]
    ds_read_b64_tr_b16 a[204:205], v195 offset:12424
    v_mfma_f32_16x16x32_bf16 v[80:83], a[228:231], a[56:59], v[80:83]
    v_mfma_f32_16x16x32_bf16 v[88:91], a[224:227], a[44:47], v[88:91]
    ds_read_b64_tr_b16 a[206:207], v195 offset:13960
    v_mfma_f32_16x16x32_bf16 v[88:91], a[228:231], a[60:63], v[88:91]
    v_mfma_f32_16x16x32_bf16 v[68:71], a[232:235], a[32:35], v[68:71]
    ds_read_b64_tr_b16 a[208:209], v194 offset:256
    v_mfma_f32_16x16x32_bf16 v[68:71], a[236:239], a[48:51], v[68:71]
    buffer_load_dwordx4 v224, s[8:11], s27 offen offset:1024  lds
    v_mfma_f32_16x16x32_bf16 v[76:79], a[232:235], a[36:39], v[76:79]
    ds_read_b64_tr_b16 a[210:211], v194 offset:1792
    v_mfma_f32_16x16x32_bf16 v[76:79], a[236:239], a[52:55], v[76:79]
    v_mfma_f32_16x16x32_bf16 v[84:87], a[232:235], a[40:43], v[84:87]
    ds_read_b64_tr_b16 a[212:213], v194 offset:12544
    v_mfma_f32_16x16x32_bf16 v[84:87], a[236:239], a[56:59], v[84:87]
    v_mfma_f32_16x16x32_bf16 v[92:95], a[232:235], a[44:47], v[92:95]
    ds_read_b64_tr_b16 a[214:215], v194 offset:14080
    v_mfma_f32_16x16x32_bf16 v[92:95], a[236:239], a[60:63], v[92:95]
    s_waitcnt lgkmcnt(4)
    v_mfma_f32_16x16x32_bf16 v[96:99], a[192:195], a[32:35], v[96:99]
    ds_read_b64_tr_b16 a[216:217], v194 offset:264
    v_mfma_f32_16x16x32_bf16 v[96:99], a[196:199], a[48:51], v[96:99]
    v_mfma_f32_16x16x32_bf16 v[104:107], a[192:195], a[36:39], v[104:107]
    ds_read_b64_tr_b16 a[218:219], v194 offset:1800
    v_mfma_f32_16x16x32_bf16 v[104:107], a[196:199], a[52:55], v[104:107]
    v_mfma_f32_16x16x32_bf16 v[112:115], a[192:195], a[40:43], v[112:115]
    ds_read_b64_tr_b16 a[220:221], v194 offset:12552
    v_mfma_f32_16x16x32_bf16 v[112:115], a[196:199], a[56:59], v[112:115]
    v_mfma_f32_16x16x32_bf16 v[120:123], a[192:195], a[44:47], v[120:123]
    ds_read_b64_tr_b16 a[222:223], v194 offset:14088
    v_mfma_f32_16x16x32_bf16 v[120:123], a[196:199], a[60:63], v[120:123]
    v_mfma_f32_16x16x32_bf16 v[100:103], a[200:203], a[32:35], v[100:103]
    ds_read_b64_tr_b16 a[224:225], v195 offset:256
    v_mfma_f32_16x16x32_bf16 v[100:103], a[204:207], a[48:51], v[100:103]
    buffer_load_dwordx4 v225, s[8:11], s27 offen offset:2048  lds
    v_mfma_f32_16x16x32_bf16 v[108:111], a[200:203], a[36:39], v[108:111]
    ds_read_b64_tr_b16 a[226:227], v195 offset:1792
    s_add_u32 s27, s27, 12288
    v_mfma_f32_16x16x32_bf16 v[108:111], a[204:207], a[52:55], v[108:111]
    v_mfma_f32_16x16x32_bf16 v[116:119], a[200:203], a[40:43], v[116:119]
    ds_read_b64_tr_b16 a[228:229], v195 offset:12544
    v_mfma_f32_16x16x32_bf16 v[116:119], a[204:207], a[56:59], v[116:119]
    v_mfma_f32_16x16x32_bf16 v[124:127], a[200:203], a[44:47], v[124:127]
    ds_read_b64_tr_b16 a[230:231], v195 offset:14080
    v_mfma_f32_16x16x32_bf16 v[124:127], a[204:207], a[60:63], v[124:127]
    s_waitcnt lgkmcnt(4)
    v_mfma_f32_16x16x32_bf16 v[128:131], a[208:211], a[32:35], v[128:131]
    ds_read_b64_tr_b16 a[232:233], v195 offset:264
    v_mfma_f32_16x16x32_bf16 v[128:131], a[212:215], a[48:51], v[128:131]
    v_mfma_f32_16x16x32_bf16 v[136:139], a[208:211], a[36:39], v[136:139]
    ds_read_b64_tr_b16 a[234:235], v195 offset:1800
    v_mfma_f32_16x16x32_bf16 v[136:139], a[212:215], a[52:55], v[136:139]
    v_mfma_f32_16x16x32_bf16 v[144:147], a[208:211], a[40:43], v[144:147]
    ds_read_b64_tr_b16 a[236:237], v195 offset:12552
    v_mfma_f32_16x16x32_bf16 v[144:147], a[212:215], a[56:59], v[144:147]
    v_mfma_f32_16x16x32_bf16 v[152:155], a[208:211], a[44:47], v[152:155]
    ds_read_b64_tr_b16 a[238:239], v195 offset:14088
    v_mfma_f32_16x16x32_bf16 v[152:155], a[212:215], a[60:63], v[152:155]
    v_mfma_f32_16x16x32_bf16 v[132:135], a[216:219], a[32:35], v[132:135]
    v_mfma_f32_16x16x32_bf16 v[132:135], a[220:223], a[48:51], v[132:135]
    v_mfma_f32_16x16x32_bf16 v[140:143], a[216:219], a[36:39], v[140:143]
    v_mfma_f32_16x16x32_bf16 v[140:143], a[220:223], a[52:55], v[140:143]
    v_mfma_f32_16x16x32_bf16 v[148:151], a[216:219], a[40:43], v[148:151]
    s_waitcnt vmcnt(32) lgkmcnt(0)
    s_barrier
    v_mfma_f32_16x16x32_bf16 v[148:151], a[220:223], a[56:59], v[148:151]
    ds_read_b64_tr_b16 a[192:193], v196 offset:0
    s_add_u32 m0, s25, 49152
    v_mfma_f32_16x16x32_bf16 v[156:159], a[216:219], a[44:47], v[156:159]
    ds_read_b64_tr_b16 a[194:195], v196 offset:1536
    v_mfma_f32_16x16x32_bf16 v[156:159], a[220:223], a[60:63], v[156:159]
    ds_read_b64_tr_b16 a[196:197], v196 offset:12288
    s_waitcnt lgkmcnt(3)
    v_mfma_f32_16x16x32_bf16 v[160:163], a[224:227], a[32:35], v[160:163]
    ds_read_b64_tr_b16 a[198:199], v196 offset:13824
    v_mfma_f32_16x16x32_bf16 v[160:163], a[228:231], a[48:51], v[160:163]
    ds_read_b64_tr_b16 a[200:201], v196 offset:8
    v_mfma_f32_16x16x32_bf16 v[168:171], a[224:227], a[36:39], v[168:171]
    ds_read_b64_tr_b16 a[202:203], v196 offset:1544
    v_mfma_f32_16x16x32_bf16 v[168:171], a[228:231], a[52:55], v[168:171]
    buffer_load_dwordx4 v220, s[4:7], s26 offen offset:0  lds
    v_mfma_f32_16x16x32_bf16 v[176:179], a[224:227], a[40:43], v[176:179]
    ds_read_b64_tr_b16 a[204:205], v196 offset:12296
    v_mfma_f32_16x16x32_bf16 v[176:179], a[228:231], a[56:59], v[176:179]
    v_mfma_f32_16x16x32_bf16 v[184:187], a[224:227], a[44:47], v[184:187]
    ds_read_b64_tr_b16 a[206:207], v196 offset:13832
    v_mfma_f32_16x16x32_bf16 v[184:187], a[228:231], a[60:63], v[184:187]
    v_mfma_f32_16x16x32_bf16 v[164:167], a[232:235], a[32:35], v[164:167]
    ds_read_b64_tr_b16 a[208:209], v197 offset:0
    v_mfma_f32_16x16x32_bf16 v[164:167], a[236:239], a[48:51], v[164:167]
    v_mfma_f32_16x16x32_bf16 v[172:175], a[232:235], a[36:39], v[172:175]
    ds_read_b64_tr_b16 a[210:211], v197 offset:1536
    v_mfma_f32_16x16x32_bf16 v[172:175], a[236:239], a[52:55], v[172:175]
    v_mfma_f32_16x16x32_bf16 v[180:183], a[232:235], a[40:43], v[180:183]
    ds_read_b64_tr_b16 a[212:213], v197 offset:12288
    v_mfma_f32_16x16x32_bf16 v[180:183], a[236:239], a[56:59], v[180:183]
    buffer_load_dwordx4 v221, s[4:7], s26 offen offset:1024  lds
    v_mfma_f32_16x16x32_bf16 v[188:191], a[232:235], a[44:47], v[188:191]
    ds_read_b64_tr_b16 a[214:215], v197 offset:13824
    v_mfma_f32_16x16x32_bf16 v[188:191], a[236:239], a[60:63], v[188:191]
    s_waitcnt lgkmcnt(4)
    v_mfma_f32_16x16x32_bf16 v[0:3], a[192:195], a[64:67], v[0:3]
    ds_read_b64_tr_b16 a[216:217], v197 offset:8
    v_mfma_f32_16x16x32_bf16 v[0:3], a[196:199], a[80:83], v[0:3]
    v_mfma_f32_16x16x32_bf16 v[8:11], a[192:195], a[68:71], v[8:11]
    ds_read_b64_tr_b16 a[218:219], v197 offset:1544
    v_mfma_f32_16x16x32_bf16 v[8:11], a[196:199], a[84:87], v[8:11]
    v_mfma_f32_16x16x32_bf16 v[16:19], a[192:195], a[72:75], v[16:19]
    ds_read_b64_tr_b16 a[220:221], v197 offset:12296
    v_mfma_f32_16x16x32_bf16 v[16:19], a[196:199], a[88:91], v[16:19]
    v_mfma_f32_16x16x32_bf16 v[24:27], a[192:195], a[76:79], v[24:27]
    ds_read_b64_tr_b16 a[222:223], v197 offset:13832
    v_mfma_f32_16x16x32_bf16 v[24:27], a[196:199], a[92:95], v[24:27]
    v_mfma_f32_16x16x32_bf16 v[4:7], a[200:203], a[64:67], v[4:7]
    ds_read_b64_tr_b16 a[224:225], v196 offset:128
    v_mfma_f32_16x16x32_bf16 v[4:7], a[204:207], a[80:83], v[4:7]
    v_mfma_f32_16x16x32_bf16 v[12:15], a[200:203], a[68:71], v[12:15]
    ds_read_b64_tr_b16 a[226:227], v196 offset:1664
    v_mfma_f32_16x16x32_bf16 v[12:15], a[204:207], a[84:87], v[12:15]
    buffer_load_dwordx4 v222, s[4:7], s26 offen offset:2048  lds
    v_mfma_f32_16x16x32_bf16 v[20:23], a[200:203], a[72:75], v[20:23]
    ds_read_b64_tr_b16 a[228:229], v196 offset:12416
    s_add_u32 s26, s26, 12288
    v_mfma_f32_16x16x32_bf16 v[20:23], a[204:207], a[88:91], v[20:23]
    s_add_u32 m0, s25, 61440
    v_mfma_f32_16x16x32_bf16 v[28:31], a[200:203], a[76:79], v[28:31]
    ds_read_b64_tr_b16 a[230:231], v196 offset:13952
    v_mfma_f32_16x16x32_bf16 v[28:31], a[204:207], a[92:95], v[28:31]
    s_waitcnt lgkmcnt(4)
    v_mfma_f32_16x16x32_bf16 v[32:35], a[208:211], a[64:67], v[32:35]
    ds_read_b64_tr_b16 a[232:233], v196 offset:136
    v_mfma_f32_16x16x32_bf16 v[32:35], a[212:215], a[80:83], v[32:35]
    v_mfma_f32_16x16x32_bf16 v[40:43], a[208:211], a[68:71], v[40:43]
    ds_read_b64_tr_b16 a[234:235], v196 offset:1672
    v_mfma_f32_16x16x32_bf16 v[40:43], a[212:215], a[84:87], v[40:43]
    v_mfma_f32_16x16x32_bf16 v[48:51], a[208:211], a[72:75], v[48:51]
    ds_read_b64_tr_b16 a[236:237], v196 offset:12424
    v_mfma_f32_16x16x32_bf16 v[48:51], a[212:215], a[88:91], v[48:51]
    v_mfma_f32_16x16x32_bf16 v[56:59], a[208:211], a[76:79], v[56:59]
    ds_read_b64_tr_b16 a[238:239], v196 offset:13960
    v_mfma_f32_16x16x32_bf16 v[56:59], a[212:215], a[92:95], v[56:59]
    v_mfma_f32_16x16x32_bf16 v[36:39], a[216:219], a[64:67], v[36:39]
    ds_read_b64_tr_b16 a[192:193], v197 offset:128
    v_mfma_f32_16x16x32_bf16 v[36:39], a[220:223], a[80:83], v[36:39]
    v_mfma_f32_16x16x32_bf16 v[44:47], a[216:219], a[68:71], v[44:47]
    ds_read_b64_tr_b16 a[194:195], v197 offset:1664
    v_mfma_f32_16x16x32_bf16 v[44:47], a[220:223], a[84:87], v[44:47]
    buffer_load_dwordx4 v220, s[4:7], s26 offen offset:0  lds
    v_mfma_f32_16x16x32_bf16 v[52:55], a[216:219], a[72:75], v[52:55]
    ds_read_b64_tr_b16 a[196:197], v197 offset:12416
    v_mfma_f32_16x16x32_bf16 v[52:55], a[220:223], a[88:91], v[52:55]
    v_mfma_f32_16x16x32_bf16 v[60:63], a[216:219], a[76:79], v[60:63]
    ds_read_b64_tr_b16 a[198:199], v197 offset:13952
    v_mfma_f32_16x16x32_bf16 v[60:63], a[220:223], a[92:95], v[60:63]
    s_waitcnt lgkmcnt(4)
    v_mfma_f32_16x16x32_bf16 v[64:67], a[224:227], a[64:67], v[64:67]
    ds_read_b64_tr_b16 a[200:201], v197 offset:136
    v_mfma_f32_16x16x32_bf16 v[64:67], a[228:231], a[80:83], v[64:67]
    v_mfma_f32_16x16x32_bf16 v[72:75], a[224:227], a[68:71], v[72:75]
    ds_read_b64_tr_b16 a[202:203], v197 offset:1672
    v_mfma_f32_16x16x32_bf16 v[72:75], a[228:231], a[84:87], v[72:75]
    v_mfma_f32_16x16x32_bf16 v[80:83], a[224:227], a[72:75], v[80:83]
    ds_read_b64_tr_b16 a[204:205], v197 offset:12424
    v_mfma_f32_16x16x32_bf16 v[80:83], a[228:231], a[88:91], v[80:83]
    v_mfma_f32_16x16x32_bf16 v[88:91], a[224:227], a[76:79], v[88:91]
    ds_read_b64_tr_b16 a[206:207], v197 offset:13960
    v_mfma_f32_16x16x32_bf16 v[88:91], a[228:231], a[92:95], v[88:91]
    v_mfma_f32_16x16x32_bf16 v[68:71], a[232:235], a[64:67], v[68:71]
    ds_read_b64_tr_b16 a[208:209], v196 offset:256
    v_mfma_f32_16x16x32_bf16 v[68:71], a[236:239], a[80:83], v[68:71]
    buffer_load_dwordx4 v221, s[4:7], s26 offen offset:1024  lds
    v_mfma_f32_16x16x32_bf16 v[76:79], a[232:235], a[68:71], v[76:79]
    ds_read_b64_tr_b16 a[210:211], v196 offset:1792
    v_mfma_f32_16x16x32_bf16 v[76:79], a[236:239], a[84:87], v[76:79]
    v_mfma_f32_16x16x32_bf16 v[84:87], a[232:235], a[72:75], v[84:87]
    ds_read_b64_tr_b16 a[212:213], v196 offset:12544
    v_mfma_f32_16x16x32_bf16 v[84:87], a[236:239], a[88:91], v[84:87]
    v_mfma_f32_16x16x32_bf16 v[92:95], a[232:235], a[76:79], v[92:95]
    ds_read_b64_tr_b16 a[214:215], v196 offset:14080
    v_mfma_f32_16x16x32_bf16 v[92:95], a[236:239], a[92:95], v[92:95]
    s_waitcnt lgkmcnt(4)
    v_mfma_f32_16x16x32_bf16 v[96:99], a[192:195], a[64:67], v[96:99]
    ds_read_b64_tr_b16 a[216:217], v196 offset:264
    v_mfma_f32_16x16x32_bf16 v[96:99], a[196:199], a[80:83], v[96:99]
    v_mfma_f32_16x16x32_bf16 v[104:107], a[192:195], a[68:71], v[104:107]
    ds_read_b64_tr_b16 a[218:219], v196 offset:1800
    v_mfma_f32_16x16x32_bf16 v[104:107], a[196:199], a[84:87], v[104:107]
    v_mfma_f32_16x16x32_bf16 v[112:115], a[192:195], a[72:75], v[112:115]
    ds_read_b64_tr_b16 a[220:221], v196 offset:12552
    v_mfma_f32_16x16x32_bf16 v[112:115], a[196:199], a[88:91], v[112:115]
    v_mfma_f32_16x16x32_bf16 v[120:123], a[192:195], a[76:79], v[120:123]
    ds_read_b64_tr_b16 a[222:223], v196 offset:14088
    v_mfma_f32_16x16x32_bf16 v[120:123], a[196:199], a[92:95], v[120:123]
    v_mfma_f32_16x16x32_bf16 v[100:103], a[200:203], a[64:67], v[100:103]
    ds_read_b64_tr_b16 a[224:225], v197 offset:256
    v_mfma_f32_16x16x32_bf16 v[100:103], a[204:207], a[80:83], v[100:103]
    buffer_load_dwordx4 v222, s[4:7], s26 offen offset:2048  lds
    v_mfma_f32_16x16x32_bf16 v[108:111], a[200:203], a[68:71], v[108:111]
    ds_read_b64_tr_b16 a[226:227], v197 offset:1792
    s_add_u32 s26, s26, 12288
    v_mfma_f32_16x16x32_bf16 v[108:111], a[204:207], a[84:87], v[108:111]
    v_mfma_f32_16x16x32_bf16 v[116:119], a[200:203], a[72:75], v[116:119]
    ds_read_b64_tr_b16 a[228:229], v197 offset:12544
    v_mfma_f32_16x16x32_bf16 v[116:119], a[204:207], a[88:91], v[116:119]
    v_mfma_f32_16x16x32_bf16 v[124:127], a[200:203], a[76:79], v[124:127]
    ds_read_b64_tr_b16 a[230:231], v197 offset:14080
    v_mfma_f32_16x16x32_bf16 v[124:127], a[204:207], a[92:95], v[124:127]
    s_waitcnt lgkmcnt(4)
    v_mfma_f32_16x16x32_bf16 v[128:131], a[208:211], a[64:67], v[128:131]
    ds_read_b64_tr_b16 a[232:233], v197 offset:264
    v_mfma_f32_16x16x32_bf16 v[128:131], a[212:215], a[80:83], v[128:131]
    v_mfma_f32_16x16x32_bf16 v[136:139], a[208:211], a[68:71], v[136:139]
    ds_read_b64_tr_b16 a[234:235], v197 offset:1800
    v_mfma_f32_16x16x32_bf16 v[136:139], a[212:215], a[84:87], v[136:139]
    v_mfma_f32_16x16x32_bf16 v[144:147], a[208:211], a[72:75], v[144:147]
    ds_read_b64_tr_b16 a[236:237], v197 offset:12552
    v_mfma_f32_16x16x32_bf16 v[144:147], a[212:215], a[88:91], v[144:147]
    v_mfma_f32_16x16x32_bf16 v[152:155], a[208:211], a[76:79], v[152:155]
    ds_read_b64_tr_b16 a[238:239], v197 offset:14088
    v_mfma_f32_16x16x32_bf16 v[152:155], a[212:215], a[92:95], v[152:155]
    v_mfma_f32_16x16x32_bf16 v[132:135], a[216:219], a[64:67], v[132:135]
    v_mfma_f32_16x16x32_bf16 v[132:135], a[220:223], a[80:83], v[132:135]
    v_mfma_f32_16x16x32_bf16 v[140:143], a[216:219], a[68:71], v[140:143]
    v_mfma_f32_16x16x32_bf16 v[140:143], a[220:223], a[84:87], v[140:143]
    v_mfma_f32_16x16x32_bf16 v[148:151], a[216:219], a[72:75], v[148:151]
    s_waitcnt vmcnt(24) lgkmcnt(0)
    s_barrier
    v_mfma_f32_16x16x32_bf16 v[148:151], a[220:223], a[88:91], v[148:151]
    ds_read_b64_tr_b16 a[192:193], v196 offset:24576
    s_add_u32 m0, s25, 98304
    v_mfma_f32_16x16x32_bf16 v[156:159], a[216:219], a[76:79], v[156:159]
    ds_read_b64_tr_b16 a[194:195], v196 offset:26112
    v_mfma_f32_16x16x32_bf16 v[156:159], a[220:223], a[92:95], v[156:159]
    ds_read_b64_tr_b16 a[196:197], v196 offset:36864
    s_waitcnt lgkmcnt(3)
    v_mfma_f32_16x16x32_bf16 v[160:163], a[224:227], a[64:67], v[160:163]
    ds_read_b64_tr_b16 a[198:199], v196 offset:38400
    v_mfma_f32_16x16x32_bf16 v[160:163], a[228:231], a[80:83], v[160:163]
    ds_read_b64_tr_b16 a[200:201], v196 offset:24584
    v_mfma_f32_16x16x32_bf16 v[168:171], a[224:227], a[68:71], v[168:171]
    ds_read_b64_tr_b16 a[202:203], v196 offset:26120
    v_mfma_f32_16x16x32_bf16 v[168:171], a[228:231], a[84:87], v[168:171]
    buffer_load_dwordx4 v223, s[8:11], s27 offen offset:0  lds
    v_mfma_f32_16x16x32_bf16 v[176:179], a[224:227], a[72:75], v[176:179]
    ds_read_b64_tr_b16 a[204:205], v196 offset:36872
    v_mfma_f32_16x16x32_bf16 v[176:179], a[228:231], a[88:91], v[176:179]
    v_mfma_f32_16x16x32_bf16 v[184:187], a[224:227], a[76:79], v[184:187]
    ds_read_b64_tr_b16 a[206:207], v196 offset:38408
    v_mfma_f32_16x16x32_bf16 v[184:187], a[228:231], a[92:95], v[184:187]
    v_mfma_f32_16x16x32_bf16 v[164:167], a[232:235], a[64:67], v[164:167]
    ds_read_b64_tr_b16 a[208:209], v197 offset:24576
    v_mfma_f32_16x16x32_bf16 v[164:167], a[236:239], a[80:83], v[164:167]
    v_mfma_f32_16x16x32_bf16 v[172:175], a[232:235], a[68:71], v[172:175]
    ds_read_b64_tr_b16 a[210:211], v197 offset:26112
    v_mfma_f32_16x16x32_bf16 v[172:175], a[236:239], a[84:87], v[172:175]
    v_mfma_f32_16x16x32_bf16 v[180:183], a[232:235], a[72:75], v[180:183]
    ds_read_b64_tr_b16 a[212:213], v197 offset:36864
    v_mfma_f32_16x16x32_bf16 v[180:183], a[236:239], a[88:91], v[180:183]
    buffer_load_dwordx4 v224, s[8:11], s27 offen offset:1024  lds
    v_mfma_f32_16x16x32_bf16 v[188:191], a[232:235], a[76:79], v[188:191]
    ds_read_b64_tr_b16 a[214:215], v197 offset:38400
    v_mfma_f32_16x16x32_bf16 v[188:191], a[236:239], a[92:95], v[188:191]
    s_waitcnt lgkmcnt(4)
    v_mfma_f32_16x16x32_bf16 v[0:3], a[192:195], a[96:99], v[0:3]
    ds_read_b64_tr_b16 a[216:217], v197 offset:24584
    v_mfma_f32_16x16x32_bf16 v[0:3], a[196:199], a[112:115], v[0:3]
    v_mfma_f32_16x16x32_bf16 v[8:11], a[192:195], a[100:103], v[8:11]
    ds_read_b64_tr_b16 a[218:219], v197 offset:26120
    v_mfma_f32_16x16x32_bf16 v[8:11], a[196:199], a[116:119], v[8:11]
    v_mfma_f32_16x16x32_bf16 v[16:19], a[192:195], a[104:107], v[16:19]
    ds_read_b64_tr_b16 a[220:221], v197 offset:36872
    v_mfma_f32_16x16x32_bf16 v[16:19], a[196:199], a[120:123], v[16:19]
    v_mfma_f32_16x16x32_bf16 v[24:27], a[192:195], a[108:111], v[24:27]
    ds_read_b64_tr_b16 a[222:223], v197 offset:38408
    v_mfma_f32_16x16x32_bf16 v[24:27], a[196:199], a[124:127], v[24:27]
    v_mfma_f32_16x16x32_bf16 v[4:7], a[200:203], a[96:99], v[4:7]
    ds_read_b64_tr_b16 a[224:225], v196 offset:24704
    v_mfma_f32_16x16x32_bf16 v[4:7], a[204:207], a[112:115], v[4:7]
    v_mfma_f32_16x16x32_bf16 v[12:15], a[200:203], a[100:103], v[12:15]
    ds_read_b64_tr_b16 a[226:227], v196 offset:26240
    v_mfma_f32_16x16x32_bf16 v[12:15], a[204:207], a[116:119], v[12:15]
    buffer_load_dwordx4 v225, s[8:11], s27 offen offset:2048  lds
    v_mfma_f32_16x16x32_bf16 v[20:23], a[200:203], a[104:107], v[20:23]
    ds_read_b64_tr_b16 a[228:229], v196 offset:36992
    s_add_u32 s27, s27, 12288
    v_mfma_f32_16x16x32_bf16 v[20:23], a[204:207], a[120:123], v[20:23]
    s_add_u32 m0, s25, 110592
    v_mfma_f32_16x16x32_bf16 v[28:31], a[200:203], a[108:111], v[28:31]
    ds_read_b64_tr_b16 a[230:231], v196 offset:38528
    v_mfma_f32_16x16x32_bf16 v[28:31], a[204:207], a[124:127], v[28:31]
    s_waitcnt lgkmcnt(4)
    v_mfma_f32_16x16x32_bf16 v[32:35], a[208:211], a[96:99], v[32:35]
    ds_read_b64_tr_b16 a[232:233], v196 offset:24712
    v_cvt_pk_bf16_f32 v0, v0, v1
    v_mfma_f32_16x16x32_bf16 v[32:35], a[212:215], a[112:115], v[32:35]
    v_cvt_pk_bf16_f32 v1, v2, v3
    v_cvt_pk_bf16_f32 v2, v4, v5
    v_mfma_f32_16x16x32_bf16 v[40:43], a[208:211], a[100:103], v[40:43]
    ds_read_b64_tr_b16 a[234:235], v196 offset:26248
    v_cvt_pk_bf16_f32 v3, v6, v7
    v_mfma_f32_16x16x32_bf16 v[40:43], a[212:215], a[116:119], v[40:43]
    v_cvt_pk_bf16_f32 v4, v8, v9
    v_cvt_pk_bf16_f32 v5, v10, v11
    v_mfma_f32_16x16x32_bf16 v[48:51], a[208:211], a[104:107], v[48:51]
    ds_read_b64_tr_b16 a[236:237], v196 offset:37000
    v_cvt_pk_bf16_f32 v6, v12, v13
    v_mfma_f32_16x16x32_bf16 v[48:51], a[212:215], a[120:123], v[48:51]
    v_cvt_pk_bf16_f32 v7, v14, v15
    v_cvt_pk_bf16_f32 v8, v16, v17
    v_mfma_f32_16x16x32_bf16 v[56:59], a[208:211], a[108:111], v[56:59]
    ds_read_b64_tr_b16 a[238:239], v196 offset:38536
    v_cvt_pk_bf16_f32 v9, v18, v19
    v_mfma_f32_16x16x32_bf16 v[56:59], a[212:215], a[124:127], v[56:59]
    v_cvt_pk_bf16_f32 v10, v20, v21
    v_cvt_pk_bf16_f32 v11, v22, v23
    v_mfma_f32_16x16x32_bf16 v[36:39], a[216:219], a[96:99], v[36:39]
    ds_read_b64_tr_b16 a[192:193], v197 offset:24704
    v_cvt_pk_bf16_f32 v12, v24, v25
    v_mfma_f32_16x16x32_bf16 v[36:39], a[220:223], a[112:115], v[36:39]
    v_cvt_pk_bf16_f32 v13, v26, v27
    v_cvt_pk_bf16_f32 v14, v28, v29
    v_mfma_f32_16x16x32_bf16 v[44:47], a[216:219], a[100:103], v[44:47]
    ds_read_b64_tr_b16 a[194:195], v197 offset:26240
    v_cvt_pk_bf16_f32 v15, v30, v31
    v_mfma_f32_16x16x32_bf16 v[44:47], a[220:223], a[116:119], v[44:47]
    buffer_load_dwordx4 v223, s[8:11], s27 offen offset:0  lds
    v_mfma_f32_16x16x32_bf16 v[52:55], a[216:219], a[104:107], v[52:55]
    ds_read_b64_tr_b16 a[196:197], v197 offset:36992
    v_mfma_f32_16x16x32_bf16 v[52:55], a[220:223], a[120:123], v[52:55]
    v_mfma_f32_16x16x32_bf16 v[60:63], a[216:219], a[108:111], v[60:63]
    ds_read_b64_tr_b16 a[198:199], v197 offset:38528
    v_mfma_f32_16x16x32_bf16 v[60:63], a[220:223], a[124:127], v[60:63]
    s_waitcnt lgkmcnt(4)
    v_mfma_f32_16x16x32_bf16 v[64:67], a[224:227], a[96:99], v[64:67]
    ds_read_b64_tr_b16 a[200:201], v197 offset:24712
    v_cvt_pk_bf16_f32 v16, v32, v33
    v_mfma_f32_16x16x32_bf16 v[64:67], a[228:231], a[112:115], v[64:67]
    v_cvt_pk_bf16_f32 v17, v34, v35
    v_cvt_pk_bf16_f32 v18, v36, v37
    v_mfma_f32_16x16x32_bf16 v[72:75], a[224:227], a[100:103], v[72:75]
    ds_read_b64_tr_b16 a[202:203], v197 offset:26248
    v_cvt_pk_bf16_f32 v19, v38, v39
    v_mfma_f32_16x16x32_bf16 v[72:75], a[228:231], a[116:119], v[72:75]
    v_cvt_pk_bf16_f32 v20, v40, v41
    v_cvt_pk_bf16_f32 v21, v42, v43
    v_mfma_f32_16x16x32_bf16 v[80:83], a[224:227], a[104:107], v[80:83]
    ds_read_b64_tr_b16 a[204:205], v197 offset:37000
    v_cvt_pk_bf16_f32 v22, v44, v45
    v_mfma_f32_16x16x32_bf16 v[80:83], a[228:231], a[120:123], v[80:83]
    v_cvt_pk_bf16_f32 v23, v46, v47
    v_cvt_pk_bf16_f32 v24, v48, v49
    v_mfma_f32_16x16x32_bf16 v[88:91], a[224:227], a[108:111], v[88:91]
    ds_read_b64_tr_b16 a[206:207], v197 offset:38536
    v_cvt_pk_bf16_f32 v25, v50, v51
    v_mfma_f32_16x16x32_bf16 v[88:91], a[228:231], a[124:127], v[88:91]
    v_cvt_pk_bf16_f32 v26, v52, v53
    v_cvt_pk_bf16_f32 v27, v54, v55
    v_mfma_f32_16x16x32_bf16 v[68:71], a[232:235], a[96:99], v[68:71]
    ds_read_b64_tr_b16 a[208:209], v196 offset:24832
    v_cvt_pk_bf16_f32 v28, v56, v57
    v_mfma_f32_16x16x32_bf16 v[68:71], a[236:239], a[112:115], v[68:71]
    buffer_load_dwordx4 v224, s[8:11], s27 offen offset:1024  lds
    v_mfma_f32_16x16x32_bf16 v[76:79], a[232:235], a[100:103], v[76:79]
    ds_read_b64_tr_b16 a[210:211], v196 offset:26368
    v_cvt_pk_bf16_f32 v29, v58, v59
    v_mfma_f32_16x16x32_bf16 v[76:79], a[236:239], a[116:119], v[76:79]
    v_cvt_pk_bf16_f32 v30, v60, v61
    v_cvt_pk_bf16_f32 v31, v62, v63
    v_mfma_f32_16x16x32_bf16 v[84:87], a[232:235], a[104:107], v[84:87]
    ds_read_b64_tr_b16 a[212:213], v196 offset:37120
    v_mfma_f32_16x16x32_bf16 v[84:87], a[236:239], a[120:123], v[84:87]
    v_mfma_f32_16x16x32_bf16 v[92:95], a[232:235], a[108:111], v[92:95]
    ds_read_b64_tr_b16 a[214:215], v196 offset:38656
    v_mfma_f32_16x16x32_bf16 v[92:95], a[236:239], a[124:127], v[92:95]
    s_waitcnt lgkmcnt(4)
    v_mfma_f32_16x16x32_bf16 v[96:99], a[192:195], a[96:99], v[96:99]
    ds_read_b64_tr_b16 a[216:217], v196 offset:24840
    v_cvt_pk_bf16_f32 v32, v64, v65
    v_mfma_f32_16x16x32_bf16 v[96:99], a[196:199], a[112:115], v[96:99]
    v_cvt_pk_bf16_f32 v33, v66, v67
    v_cvt_pk_bf16_f32 v34, v68, v69
    v_mfma_f32_16x16x32_bf16 v[104:107], a[192:195], a[100:103], v[104:107]
    ds_read_b64_tr_b16 a[218:219], v196 offset:26376
    v_cvt_pk_bf16_f32 v35, v70, v71
    v_mfma_f32_16x16x32_bf16 v[104:107], a[196:199], a[116:119], v[104:107]
    v_cvt_pk_bf16_f32 v36, v72, v73
    v_cvt_pk_bf16_f32 v37, v74, v75
    v_mfma_f32_16x16x32_bf16 v[112:115], a[192:195], a[104:107], v[112:115]
    ds_read_b64_tr_b16 a[220:221], v196 offset:37128
    v_cvt_pk_bf16_f32 v38, v76, v77
    v_mfma_f32_16x16x32_bf16 v[112:115], a[196:199], a[120:123], v[112:115]
    v_cvt_pk_bf16_f32 v39, v78, v79
    v_cvt_pk_bf16_f32 v40, v80, v81
    v_mfma_f32_16x16x32_bf16 v[120:123], a[192:195], a[108:111], v[120:123]
    ds_read_b64_tr_b16 a[222:223], v196 offset:38664
    v_cvt_pk_bf16_f32 v41, v82, v83
    v_mfma_f32_16x16x32_bf16 v[120:123], a[196:199], a[124:127], v[120:123]
    v_cvt_pk_bf16_f32 v42, v84, v85
    v_cvt_pk_bf16_f32 v43, v86, v87
    v_mfma_f32_16x16x32_bf16 v[100:103], a[200:203], a[96:99], v[100:103]
    ds_read_b64_tr_b16 a[224:225], v197 offset:24832
    v_cvt_pk_bf16_f32 v44, v88, v89
    v_mfma_f32_16x16x32_bf16 v[100:103], a[204:207], a[112:115], v[100:103]
    buffer_load_dwordx4 v225, s[8:11], s27 offen offset:2048  lds
    v_mfma_f32_16x16x32_bf16 v[108:111], a[200:203], a[100:103], v[108:111]
    ds_read_b64_tr_b16 a[226:227], v197 offset:26368
    s_add_u32 s27, s27, 12288
    v_mfma_f32_16x16x32_bf16 v[108:111], a[204:207], a[116:119], v[108:111]
    v_cvt_pk_bf16_f32 v45, v90, v91
    v_cvt_pk_bf16_f32 v46, v92, v93
    v_mfma_f32_16x16x32_bf16 v[116:119], a[200:203], a[104:107], v[116:119]
    ds_read_b64_tr_b16 a[228:229], v197 offset:37120
    v_cvt_pk_bf16_f32 v47, v94, v95
    v_mfma_f32_16x16x32_bf16 v[116:119], a[204:207], a[120:123], v[116:119]
    v_mfma_f32_16x16x32_bf16 v[124:127], a[200:203], a[108:111], v[124:127]
    ds_read_b64_tr_b16 a[230:231], v197 offset:38656
    v_mfma_f32_16x16x32_bf16 v[124:127], a[204:207], a[124:127], v[124:127]
    s_waitcnt lgkmcnt(4)
    v_mfma_f32_16x16x32_bf16 v[128:131], a[208:211], a[96:99], v[128:131]
    ds_read_b64_tr_b16 a[232:233], v197 offset:24840
    v_cvt_pk_bf16_f32 v48, v96, v97
    v_mfma_f32_16x16x32_bf16 v[128:131], a[212:215], a[112:115], v[128:131]
    v_cvt_pk_bf16_f32 v49, v98, v99
    v_cvt_pk_bf16_f32 v50, v100, v101
    v_mfma_f32_16x16x32_bf16 v[136:139], a[208:211], a[100:103], v[136:139]
    ds_read_b64_tr_b16 a[234:235], v197 offset:26376
    v_cvt_pk_bf16_f32 v51, v102, v103
    v_mfma_f32_16x16x32_bf16 v[136:139], a[212:215], a[116:119], v[136:139]
    v_cvt_pk_bf16_f32 v52, v104, v105
    v_cvt_pk_bf16_f32 v53, v106, v107
    v_mfma_f32_16x16x32_bf16 v[144:147], a[208:211], a[104:107], v[144:147]
    ds_read_b64_tr_b16 a[236:237], v197 offset:37128
    v_cvt_pk_bf16_f32 v54, v108, v109
    v_mfma_f32_16x16x32_bf16 v[144:147], a[212:215], a[120:123], v[144:147]
    v_cvt_pk_bf16_f32 v55, v110, v111
    v_cvt_pk_bf16_f32 v56, v112, v113
    v_mfma_f32_16x16x32_bf16 v[152:155], a[208:211], a[108:111], v[152:155]
    ds_read_b64_tr_b16 a[238:239], v197 offset:38664
    v_cvt_pk_bf16_f32 v57, v114, v115
    v_mfma_f32_16x16x32_bf16 v[152:155], a[212:215], a[124:127], v[152:155]
    v_cvt_pk_bf16_f32 v58, v116, v117
    v_cvt_pk_bf16_f32 v59, v118, v119
    v_mfma_f32_16x16x32_bf16 v[132:135], a[216:219], a[96:99], v[132:135]
    v_cvt_pk_bf16_f32 v60, v120, v121
    v_cvt_pk_bf16_f32 v61, v122, v123
    v_mfma_f32_16x16x32_bf16 v[132:135], a[220:223], a[112:115], v[132:135]
    v_cvt_pk_bf16_f32 v62, v124, v125
    v_cvt_pk_bf16_f32 v63, v126, v127
    v_mfma_f32_16x16x32_bf16 v[140:143], a[216:219], a[100:103], v[140:143]
    v_mfma_f32_16x16x32_bf16 v[140:143], a[220:223], a[116:119], v[140:143]
    v_mfma_f32_16x16x32_bf16 v[148:151], a[216:219], a[104:107], v[148:151]
    s_waitcnt vmcnt(24) lgkmcnt(0)
    s_barrier
    v_mfma_f32_16x16x32_bf16 v[148:151], a[220:223], a[120:123], v[148:151]
    v_mfma_f32_16x16x32_bf16 v[156:159], a[216:219], a[108:111], v[156:159]
    v_mfma_f32_16x16x32_bf16 v[156:159], a[220:223], a[124:127], v[156:159]
    s_waitcnt lgkmcnt(0)
    v_mfma_f32_16x16x32_bf16 v[160:163], a[224:227], a[96:99], v[160:163]
    v_cvt_pk_bf16_f32 v64, v128, v129
    v_cvt_pk_bf16_f32 v65, v130, v131
    v_mfma_f32_16x16x32_bf16 v[160:163], a[228:231], a[112:115], v[160:163]
    v_cvt_pk_bf16_f32 v66, v132, v133
    v_cvt_pk_bf16_f32 v67, v134, v135
    v_mfma_f32_16x16x32_bf16 v[168:171], a[224:227], a[100:103], v[168:171]
    v_cvt_pk_bf16_f32 v68, v136, v137
    v_cvt_pk_bf16_f32 v69, v138, v139
    v_mfma_f32_16x16x32_bf16 v[168:171], a[228:231], a[116:119], v[168:171]
    v_cvt_pk_bf16_f32 v70, v140, v141
    v_cvt_pk_bf16_f32 v71, v142, v143
    v_mfma_f32_16x16x32_bf16 v[176:179], a[224:227], a[104:107], v[176:179]
    v_cvt_pk_bf16_f32 v72, v144, v145
    v_cvt_pk_bf16_f32 v73, v146, v147
    v_mfma_f32_16x16x32_bf16 v[176:179], a[228:231], a[120:123], v[176:179]
    v_cvt_pk_bf16_f32 v74, v148, v149
    v_cvt_pk_bf16_f32 v75, v150, v151
    v_mfma_f32_16x16x32_bf16 v[184:187], a[224:227], a[108:111], v[184:187]
    v_cvt_pk_bf16_f32 v76, v152, v153
    v_cvt_pk_bf16_f32 v77, v154, v155
    v_mfma_f32_16x16x32_bf16 v[184:187], a[228:231], a[124:127], v[184:187]
    v_cvt_pk_bf16_f32 v78, v156, v157
    v_cvt_pk_bf16_f32 v79, v158, v159
    v_mfma_f32_16x16x32_bf16 v[164:167], a[232:235], a[96:99], v[164:167]
    v_mfma_f32_16x16x32_bf16 v[164:167], a[236:239], a[112:115], v[164:167]
    v_mfma_f32_16x16x32_bf16 v[172:175], a[232:235], a[100:103], v[172:175]
    v_mfma_f32_16x16x32_bf16 v[172:175], a[236:239], a[116:119], v[172:175]
    v_mfma_f32_16x16x32_bf16 v[180:183], a[232:235], a[104:107], v[180:183]
    v_mfma_f32_16x16x32_bf16 v[180:183], a[236:239], a[120:123], v[180:183]
    v_mfma_f32_16x16x32_bf16 v[188:191], a[232:235], a[108:111], v[188:191]
    v_mfma_f32_16x16x32_bf16 v[188:191], a[236:239], a[124:127], v[188:191]
    s_nop 7
    v_cvt_pk_bf16_f32 v80, v160, v161
    v_cvt_pk_bf16_f32 v81, v162, v163
    v_cvt_pk_bf16_f32 v82, v164, v165
    v_cvt_pk_bf16_f32 v83, v166, v167
    v_cvt_pk_bf16_f32 v84, v168, v169
    v_cvt_pk_bf16_f32 v85, v170, v171
    v_cvt_pk_bf16_f32 v86, v172, v173
    v_cvt_pk_bf16_f32 v87, v174, v175
    v_cvt_pk_bf16_f32 v88, v176, v177
    v_cvt_pk_bf16_f32 v89, v178, v179
    v_cvt_pk_bf16_f32 v90, v180, v181
    v_cvt_pk_bf16_f32 v91, v182, v183
    v_cvt_pk_bf16_f32 v92, v184, v185
    v_cvt_pk_bf16_f32 v93, v186, v187
    v_cvt_pk_bf16_f32 v94, v188, v189
    v_cvt_pk_bf16_f32 v95, v190, v191
    s_mov_b32 s62, 0
    s_mov_b64 s[78:79], s[38:39]
    s_bfe_u32 s63, s2, 0x20003
    s_mul_i32 s63, s63, 1966080
    s_bfe_u32 s50, s2, 0x20001
    s_mul_i32 s50, s50, 491520
    s_add_u32 s63, s63, s50
    s_add_u32 s63, s63, 83886080
    s_lshl_b32 s50, s2, 7
    s_add_u32 s50, s50, 3342336
    s_add_u32 s12, s38, s50
    s_addc_u32 s13, s39, 0
    s_mov_b32 s14, 128
    s_mov_b32 s15, 0x20000
    s_lshl_b32 s50, s24, 13
    s_add_u32 s50, s50, 3342336
    s_add_u32 s16, s38, s50
    s_addc_u32 s17, s39, 0
    s_mov_b32 s18, 8192
    s_mov_b32 s19, 0x20000
    v_lshrrev_b32 v254, 2, v234
    s_lshl_b32 s51, s24, 8
    v_add_u32 v254, s51, v254
    v_lshlrev_b32 v253, 3, v234
    v_mov_b32 v252, 0
L_attn_restart:
    s_mov_b32 s44, 0
    s_mov_b32 s46, 122880
    v_mov_b32 v208, v214
    v_mov_b32 v209, v215
    ds_read_b128 a[192:195], v208 offset:0
    ds_read_b128 a[196:199], v209 offset:0
    ds_read_b128 a[200:203], v208 offset:128
    ds_read_b128 a[204:207], v209 offset:128
    ds_read_b128 a[208:211], v208 offset:256
    ds_read_b128 a[212:215], v209 offset:256
    v_mov_b32 v226, 0
    v_mov_b32 v227, 0
    v_mov_b32 v228, 0
    v_mov_b32 v229, 0
    s_mov_b32 s28, 15
    s_waitcnt lgkmcnt(0)
    v_mfma_f32_16x16x32_bf16 v[112:115], a[192:195], v[0:3], 0
    ds_read_b128 a[216:219], v208 offset:6144
    v_mfma_f32_16x16x32_bf16 v[112:115], a[196:199], v[16:19], v[112:115]
    v_mfma_f32_16x16x32_bf16 v[112:115], a[200:203], v[32:35], v[112:115]
    v_mfma_f32_16x16x32_bf16 v[112:115], a[204:207], v[48:51], v[112:115]
    ds_read_b128 a[220:223], v209 offset:6144
    v_mfma_f32_16x16x32_bf16 v[112:115], a[208:211], v[64:67], v[112:115]
    v_mfma_f32_16x16x32_bf16 v[112:115], a[212:215], v[80:83], v[112:115]
    v_mfma_f32_16x16x32_bf16 v[116:119], a[192:195], v[4:7], 0
    ds_read_b128 a[224:227], v208 offset:6272
    v_mfma_f32_16x16x32_bf16 v[116:119], a[196:199], v[20:23], v[116:119]
    v_mfma_f32_16x16x32_bf16 v[116:119], a[200:203], v[36:39], v[116:119]
    v_mfma_f32_16x16x32_bf16 v[116:119], a[204:207], v[52:55], v[116:119]
    ds_read_b128 a[228:231], v209 offset:6272
    v_mfma_f32_16x16x32_bf16 v[116:119], a[208:211], v[68:71], v[116:119]
    s_nop 0
    v_max3_f32 v236, v112, v113, v230
    v_max3_f32 v236, v114, v115, v236
    v_mfma_f32_16x16x32_bf16 v[116:119], a[212:215], v[84:87], v[116:119]
    v_mfma_f32_16x16x32_bf16 v[120:123], a[192:195], v[8:11], 0
    ds_read_b128 a[232:235], v208 offset:6400
    v_mfma_f32_16x16x32_bf16 v[120:123], a[196:199], v[24:27], v[120:123]
    v_mfma_f32_16x16x32_bf16 v[120:123], a[200:203], v[40:43], v[120:123]
    v_mfma_f32_16x16x32_bf16 v[120:123], a[204:207], v[56:59], v[120:123]
    ds_read_b128 a[236:239], v209 offset:6400
    v_mfma_f32_16x16x32_bf16 v[120:123], a[208:211], v[72:75], v[120:123]
    s_nop 0
    v_max3_f32 v237, v116, v117, v231
    v_max3_f32 v237, v118, v119, v237
    v_mfma_f32_16x16x32_bf16 v[120:123], a[212:215], v[88:91], v[120:123]
    v_mfma_f32_16x16x32_bf16 v[124:127], a[192:195], v[12:15], 0
    v_mfma_f32_16x16x32_bf16 v[124:127], a[196:199], v[28:31], v[124:127]
    v_mfma_f32_16x16x32_bf16 v[124:127], a[200:203], v[44:47], v[124:127]
    v_mfma_f32_16x16x32_bf16 v[124:127], a[204:207], v[60:63], v[124:127]
    v_mfma_f32_16x16x32_bf16 v[124:127], a[208:211], v[76:79], v[124:127]
    s_nop 2
    v_max3_f32 v238, v120, v121, v232
    v_max3_f32 v238, v122, v123, v238
    v_mfma_f32_16x16x32_bf16 v[124:127], a[212:215], v[92:95], v[124:127]
    s_nop 7
    v_max3_f32 v239, v124, v125, v233
    v_max3_f32 v239, v126, v127, v239
    v_mov_b32 v240, v236
    v_mov_b32 v241, v237
    v_mov_b32 v242, v238
    v_mov_b32 v243, v239
    v_permlane32_swap_b32 v236, v240
    v_permlane32_swap_b32 v237, v241
    v_permlane32_swap_b32 v238, v242
    v_permlane32_swap_b32 v239, v243
    v_max_f32 v236, v236, v240
    v_max_f32 v237, v237, v241
    v_max_f32 v238, v238, v242
    v_max_f32 v239, v239, v243
    v_mov_b32 v240, v236
    v_mov_b32 v241, v237
    v_mov_b32 v242, v238
    v_mov_b32 v243, v239
    v_permlane16_swap_b32 v236, v240
    v_permlane16_swap_b32 v237, v241
    v_permlane16_swap_b32 v238, v242
    v_permlane16_swap_b32 v239, v243
    v_max_f32 v236, v236, v240
    v_max_f32 v237, v237, v241
    v_max_f32 v238, v238, v242
    v_max_f32 v239, v239, v243
    v_sub_f32 v192, 0, v236
    v_sub_f32 v193, 0, v236
    v_sub_f32 v194, 0, v236
    v_sub_f32 v195, 0, v236
    v_sub_f32 v196, 0, v237
    v_sub_f32 v197, 0, v237
    v_sub_f32 v198, 0, v237
    v_sub_f32 v199, 0, v237
    v_sub_f32 v200, 0, v238
    v_sub_f32 v201, 0, v238
    v_sub_f32 v202, 0, v238
    v_sub_f32 v203, 0, v238
    v_sub_f32 v204, 0, v239
    v_sub_f32 v205, 0, v239
    v_sub_f32 v206, 0, v239
    v_sub_f32 v207, 0, v239
    s_waitcnt lgkmcnt(0)
    v_mfma_f32_16x16x32_bf16 v[96:99], a[216:219], v[0:3], v[192:195]
    ds_read_b128 a[192:195], v208 offset:12288
    v_sub_f32 v112, v112, v236
    v_sub_f32 v113, v113, v236
    v_mfma_f32_16x16x32_bf16 v[96:99], a[220:223], v[16:19], v[96:99]
    v_sub_f32 v114, v114, v236
    v_sub_f32 v115, v115, v236
    v_mfma_f32_16x16x32_bf16 v[96:99], a[224:227], v[32:35], v[96:99]
    v_exp_f32 v112, v112
    v_mfma_f32_16x16x32_bf16 v[96:99], a[228:231], v[48:51], v[96:99]
    ds_read_b128 a[196:199], v209 offset:12288
    v_exp_f32 v113, v113
    v_mfma_f32_16x16x32_bf16 v[96:99], a[232:235], v[64:67], v[96:99]
    v_add_f32 v226, v226, v112
    v_exp_f32 v114, v114
    v_mfma_f32_16x16x32_bf16 v[96:99], a[236:239], v[80:83], v[96:99]
    v_add_f32 v226, v226, v113
    v_cvt_pk_bf16_f32 v128, v112, v113
    v_mfma_f32_16x16x32_bf16 v[100:103], a[216:219], v[4:7], v[196:199]
    ds_read_b128 a[200:203], v208 offset:12416
    v_exp_f32 v115, v115
    v_mfma_f32_16x16x32_bf16 v[100:103], a[220:223], v[20:23], v[100:103]
    v_add_f32 v226, v226, v114
    v_add_f32 v226, v226, v115
    v_mfma_f32_16x16x32_bf16 v[100:103], a[224:227], v[36:39], v[100:103]
    v_cvt_pk_bf16_f32 v129, v114, v115
    v_sub_f32 v116, v116, v237
    v_mfma_f32_16x16x32_bf16 v[100:103], a[228:231], v[52:55], v[100:103]
    ds_read_b128 a[204:207], v209 offset:12416
    v_sub_f32 v117, v117, v237
    v_sub_f32 v118, v118, v237
    v_mfma_f32_16x16x32_bf16 v[100:103], a[232:235], v[68:71], v[100:103]
    v_sub_f32 v119, v119, v237
    v_exp_f32 v116, v116
    v_mfma_f32_16x16x32_bf16 v[100:103], a[236:239], v[84:87], v[100:103]
    v_exp_f32 v117, v117
    v_mfma_f32_16x16x32_bf16 v[104:107], a[216:219], v[8:11], v[200:203]
    ds_read_b128 a[208:211], v208 offset:12544
    v_add_f32 v227, v227, v116
    v_exp_f32 v118, v118
    v_mfma_f32_16x16x32_bf16 v[104:107], a[220:223], v[24:27], v[104:107]
    v_add_f32 v227, v227, v117
    v_cvt_pk_bf16_f32 v132, v116, v117
    v_mfma_f32_16x16x32_bf16 v[104:107], a[224:227], v[40:43], v[104:107]
    v_exp_f32 v119, v119
    v_mfma_f32_16x16x32_bf16 v[104:107], a[228:231], v[56:59], v[104:107]
    ds_read_b128 a[212:215], v209 offset:12544
    v_add_f32 v227, v227, v118
    v_add_f32 v227, v227, v119
    v_mfma_f32_16x16x32_bf16 v[104:107], a[232:235], v[72:75], v[104:107]
    v_cvt_pk_bf16_f32 v133, v118, v119
    v_sub_f32 v120, v120, v238
    v_mfma_f32_16x16x32_bf16 v[104:107], a[236:239], v[88:91], v[104:107]
    v_sub_f32 v121, v121, v238
    v_sub_f32 v122, v122, v238
    v_mfma_f32_16x16x32_bf16 v[108:111], a[216:219], v[12:15], v[204:207]
    v_sub_f32 v123, v123, v238
    v_exp_f32 v120, v120
    v_mfma_f32_16x16x32_bf16 v[108:111], a[220:223], v[28:31], v[108:111]
    v_exp_f32 v121, v121
    v_mfma_f32_16x16x32_bf16 v[108:111], a[224:227], v[44:47], v[108:111]
    v_add_f32 v228, v228, v120
    v_exp_f32 v122, v122
    v_mfma_f32_16x16x32_bf16 v[108:111], a[228:231], v[60:63], v[108:111]
    v_add_f32 v228, v228, v121
    v_cvt_pk_bf16_f32 v136, v120, v121
    v_mfma_f32_16x16x32_bf16 v[108:111], a[232:235], v[76:79], v[108:111]
    v_exp_f32 v123, v123
    v_mfma_f32_16x16x32_bf16 v[108:111], a[236:239], v[92:95], v[108:111]
    v_add_f32 v228, v228, v122
    v_add_f32 v228, v228, v123
    v_cvt_pk_bf16_f32 v137, v122, v123
    v_sub_f32 v124, v124, v239
    v_sub_f32 v125, v125, v239
    v_sub_f32 v126, v126, v239
    v_sub_f32 v127, v127, v239
    v_exp_f32 v124, v124
    v_exp_f32 v125, v125
    v_add_f32 v229, v229, v124
    v_exp_f32 v126, v126
    v_add_f32 v229, v229, v125
    v_cvt_pk_bf16_f32 v140, v124, v125
    v_exp_f32 v127, v127
    v_add_f32 v229, v229, v126
    v_add_f32 v229, v229, v127
    v_cvt_pk_bf16_f32 v141, v126, v127
    s_waitcnt lgkmcnt(0)
    v_mfma_f32_16x16x32_bf16 v[112:115], a[192:195], v[0:3], v[192:195]
    ds_read_b128 a[216:219], v208 offset:18432
    v_exp_f32 v96, v96
    v_mfma_f32_16x16x32_bf16 v[112:115], a[196:199], v[16:19], v[112:115]
    v_exp_f32 v97, v97
    v_mfma_f32_16x16x32_bf16 v[112:115], a[200:203], v[32:35], v[112:115]
    v_add_f32 v226, v226, v96
    v_exp_f32 v98, v98
    v_mfma_f32_16x16x32_bf16 v[112:115], a[204:207], v[48:51], v[112:115]
    ds_read_b128 a[220:223], v209 offset:18432
    v_add_f32 v226, v226, v97
    v_cvt_pk_bf16_f32 v130, v96, v97
    v_mfma_f32_16x16x32_bf16 v[112:115], a[208:211], v[64:67], v[112:115]
    v_exp_f32 v99, v99
    v_mfma_f32_16x16x32_bf16 v[112:115], a[212:215], v[80:83], v[112:115]
    v_add_f32 v226, v226, v98
    v_add_f32 v226, v226, v99
    v_mfma_f32_16x16x32_bf16 v[116:119], a[192:195], v[4:7], v[196:199]
    ds_read_b128 a[224:227], v208 offset:18560
    v_cvt_pk_bf16_f32 v131, v98, v99
    v_exp_f32 v100, v100
    v_mfma_f32_16x16x32_bf16 v[116:119], a[196:199], v[20:23], v[116:119]
    v_exp_f32 v101, v101
    v_mfma_f32_16x16x32_bf16 v[116:119], a[200:203], v[36:39], v[116:119]
    v_add_f32 v227, v227, v100
    v_exp_f32 v102, v102
    v_mfma_f32_16x16x32_bf16 v[116:119], a[204:207], v[52:55], v[116:119]
    ds_read_b128 a[228:231], v209 offset:18560
    v_add_f32 v227, v227, v101
    v_cvt_pk_bf16_f32 v134, v100, v101
    v_mfma_f32_16x16x32_bf16 v[116:119], a[208:211], v[68:71], v[116:119]
    v_exp_f32 v103, v103
    v_mfma_f32_16x16x32_bf16 v[116:119], a[212:215], v[84:87], v[116:119]
    v_add_f32 v227, v227, v102
    v_add_f32 v227, v227, v103
    v_mfma_f32_16x16x32_bf16 v[120:123], a[192:195], v[8:11], v[200:203]
    ds_read_b128 a[232:235], v208 offset:18688
    v_cvt_pk_bf16_f32 v135, v102, v103
    v_exp_f32 v104, v104
    v_mfma_f32_16x16x32_bf16 v[120:123], a[196:199], v[24:27], v[120:123]
    v_exp_f32 v105, v105
    v_mfma_f32_16x16x32_bf16 v[120:123], a[200:203], v[40:43], v[120:123]
    v_add_f32 v228, v228, v104
    v_exp_f32 v106, v106
    v_mfma_f32_16x16x32_bf16 v[120:123], a[204:207], v[56:59], v[120:123]
    ds_read_b128 a[236:239], v209 offset:18688
    v_add_f32 v228, v228, v105
    v_cvt_pk_bf16_f32 v138, v104, v105
    v_mfma_f32_16x16x32_bf16 v[120:123], a[208:211], v[72:75], v[120:123]
    v_exp_f32 v107, v107
    v_mfma_f32_16x16x32_bf16 v[120:123], a[212:215], v[88:91], v[120:123]
    v_add_f32 v228, v228, v106
    v_add_f32 v228, v228, v107
    v_mfma_f32_16x16x32_bf16 v[124:127], a[192:195], v[12:15], v[204:207]
    v_cvt_pk_bf16_f32 v139, v106, v107
    v_exp_f32 v108, v108
    v_mfma_f32_16x16x32_bf16 v[124:127], a[196:199], v[28:31], v[124:127]
    v_exp_f32 v109, v109
    v_mfma_f32_16x16x32_bf16 v[124:127], a[200:203], v[44:47], v[124:127]
    v_add_f32 v229, v229, v108
    v_exp_f32 v110, v110
    v_mfma_f32_16x16x32_bf16 v[124:127], a[204:207], v[60:63], v[124:127]
    v_add_f32 v229, v229, v109
    v_cvt_pk_bf16_f32 v142, v108, v109
    v_mfma_f32_16x16x32_bf16 v[124:127], a[208:211], v[76:79], v[124:127]
    v_exp_f32 v111, v111
    v_mfma_f32_16x16x32_bf16 v[124:127], a[212:215], v[92:95], v[124:127]
    v_add_f32 v229, v229, v110
    v_add_f32 v229, v229, v111
    v_cvt_pk_bf16_f32 v143, v110, v111
    s_waitcnt lgkmcnt(0)
    s_add_u32 s45, s44, s25
    s_add_u32 s44, s44, 24576
    s_cmp_eq_u32 s44, 73728
    s_cmov_b32 s44, 0
    v_add_u32 v208, s44, v214
    v_add_u32 v209, s44, v215
    s_waitcnt vmcnt(12)
    s_barrier
    v_mfma_f32_16x16x32_bf16 v[96:99], a[216:219], v[0:3], v[192:195]
    ds_read_b128 a[192:195], v208 offset:0
    v_exp_f32 v112, v112
    v_mfma_f32_16x16x32_bf16 v[96:99], a[220:223], v[16:19], v[96:99]
    v_exp_f32 v113, v113
    v_mfma_f32_16x16x32_bf16 v[96:99], a[224:227], v[32:35], v[96:99]
    v_add_f32 v226, v226, v112
    v_exp_f32 v114, v114
    v_mfma_f32_16x16x32_bf16 v[96:99], a[228:231], v[48:51], v[96:99]
    ds_read_b128 a[196:199], v209 offset:0
    v_add_f32 v226, v226, v113
    v_cvt_pk_bf16_f32 v144, v112, v113
    v_mfma_f32_16x16x32_bf16 v[96:99], a[232:235], v[64:67], v[96:99]
    v_exp_f32 v115, v115
    v_mfma_f32_16x16x32_bf16 v[96:99], a[236:239], v[80:83], v[96:99]
    v_add_f32 v226, v226, v114
    v_add_f32 v226, v226, v115
    v_mfma_f32_16x16x32_bf16 v[100:103], a[216:219], v[4:7], v[196:199]
    ds_read_b128 a[200:203], v208 offset:128
    v_cvt_pk_bf16_f32 v145, v114, v115
    v_exp_f32 v116, v116
    v_mfma_f32_16x16x32_bf16 v[100:103], a[220:223], v[20:23], v[100:103]
    v_exp_f32 v117, v117
    v_mfma_f32_16x16x32_bf16 v[100:103], a[224:227], v[36:39], v[100:103]
    v_add_f32 v227, v227, v116
    v_exp_f32 v118, v118
    v_mfma_f32_16x16x32_bf16 v[100:103], a[228:231], v[52:55], v[100:103]
    ds_read_b128 a[204:207], v209 offset:128
    v_add_f32 v227, v227, v117
    v_cvt_pk_bf16_f32 v148, v116, v117
    v_mfma_f32_16x16x32_bf16 v[100:103], a[232:235], v[68:71], v[100:103]
    v_exp_f32 v119, v119
    v_mfma_f32_16x16x32_bf16 v[100:103], a[236:239], v[84:87], v[100:103]
    v_add_f32 v227, v227, v118
    v_add_f32 v227, v227, v119
    v_mfma_f32_16x16x32_bf16 v[104:107], a[216:219], v[8:11], v[200:203]
    ds_read_b128 a[208:211], v208 offset:256
    v_cvt_pk_bf16_f32 v149, v118, v119
    v_exp_f32 v120, v120
    v_mfma_f32_16x16x32_bf16 v[104:107], a[220:223], v[24:27], v[104:107]
    v_exp_f32 v121, v121
    v_mfma_f32_16x16x32_bf16 v[104:107], a[224:227], v[40:43], v[104:107]
    v_add_f32 v228, v228, v120
    v_exp_f32 v122, v122
    v_mfma_f32_16x16x32_bf16 v[104:107], a[228:231], v[56:59], v[104:107]
    ds_read_b128 a[212:215], v209 offset:256
    v_add_f32 v228, v228, v121
    v_cvt_pk_bf16_f32 v152, v120, v121
    v_mfma_f32_16x16x32_bf16 v[104:107], a[232:235], v[72:75], v[104:107]
    v_exp_f32 v123, v123
    v_mfma_f32_16x16x32_bf16 v[104:107], a[236:239], v[88:91], v[104:107]
    v_add_f32 v228, v228, v122
    v_add_f32 v228, v228, v123
    v_mfma_f32_16x16x32_bf16 v[108:111], a[216:219], v[12:15], v[204:207]
    v_cvt_pk_bf16_f32 v153, v122, v123
    v_exp_f32 v124, v124
    v_mfma_f32_16x16x32_bf16 v[108:111], a[220:223], v[28:31], v[108:111]
    v_exp_f32 v125, v125
    v_mfma_f32_16x16x32_bf16 v[108:111], a[224:227], v[44:47], v[108:111]
    v_add_f32 v229, v229, v124
    v_exp_f32 v126, v126
    v_mfma_f32_16x16x32_bf16 v[108:111], a[228:231], v[60:63], v[108:111]
    v_add_f32 v229, v229, v125
    v_cvt_pk_bf16_f32 v156, v124, v125
    v_mfma_f32_16x16x32_bf16 v[108:111], a[232:235], v[76:79], v[108:111]
    v_exp_f32 v127, v127
    v_mfma_f32_16x16x32_bf16 v[108:111], a[236:239], v[92:95], v[108:111]
    v_add_f32 v229, v229, v126
    v_add_f32 v229, v229, v127
    v_cvt_pk_bf16_f32 v157, v126, v127
    v_exp_f32 v96, v96
    v_exp_f32 v97, v97
    v_add_f32 v226, v226, v96
    v_exp_f32 v98, v98
    v_add_f32 v226, v226, v97
    v_cvt_pk_bf16_f32 v146, v96, v97
    v_exp_f32 v99, v99
    v_add_f32 v226, v226, v98
    v_add_f32 v226, v226, v99
    v_cvt_pk_bf16_f32 v147, v98, v99
    v_exp_f32 v100, v100
    v_exp_f32 v101, v101
    v_add_f32 v227, v227, v100
    v_exp_f32 v102, v102
    v_add_f32 v227, v227, v101
    v_cvt_pk_bf16_f32 v150, v100, v101
    v_exp_f32 v103, v103
    v_add_f32 v227, v227, v102
    v_add_f32 v227, v227, v103
    v_cvt_pk_bf16_f32 v151, v102, v103
    v_exp_f32 v104, v104
    v_exp_f32 v105, v105
    v_add_f32 v228, v228, v104
    v_exp_f32 v106, v106
    v_add_f32 v228, v228, v105
    v_cvt_pk_bf16_f32 v154, v104, v105
    v_exp_f32 v107, v107
    v_add_f32 v228, v228, v106
    v_add_f32 v228, v228, v107
    v_cvt_pk_bf16_f32 v155, v106, v107
    s_add_u32 s47, s46, s25
    s_add_u32 s46, s46, 24576
    s_cmp_eq_u32 s46, 147456
    s_cmov_b32 s46, 73728
    v_add_u32 v210, s46, v216
    v_add_u32 v211, s46, v217
    v_exp_f32 v108, v108
    s_waitcnt lgkmcnt(0)
    v_add_f32 v229, v229, v108
    v_mfma_f32_16x16x32_bf16 v[96:99], a[192:195], v[0:3], v[192:195]
    v_add_u32 v212, s46, v218
    v_add_u32 v213, s46, v219
    v_mfma_f32_16x16x32_bf16 v[96:99], a[196:199], v[16:19], v[96:99]
    v_exp_f32 v109, v109
    v_mfma_f32_16x16x32_bf16 v[96:99], a[200:203], v[32:35], v[96:99]
    ds_read_b64_tr_b16 a[216:217], v210 offset:0
    v_add_f32 v229, v229, v109
    v_mfma_f32_16x16x32_bf16 v[96:99], a[204:207], v[48:51], v[96:99]
    ds_read_b64_tr_b16 a[218:219], v210 offset:6144
    v_cvt_pk_bf16_f32 v158, v108, v109
    v_mfma_f32_16x16x32_bf16 v[96:99], a[208:211], v[64:67], v[96:99]
    v_exp_f32 v110, v110
    v_mfma_f32_16x16x32_bf16 v[96:99], a[212:215], v[80:83], v[96:99]
    ds_read_b64_tr_b16 a[220:221], v210 offset:12288
    v_add_f32 v229, v229, v110
    v_mfma_f32_16x16x32_bf16 v[100:103], a[192:195], v[4:7], v[196:199]
    s_add_u32 m0, s45, 0
    v_mfma_f32_16x16x32_bf16 v[100:103], a[196:199], v[20:23], v[100:103]
    v_exp_f32 v111, v111
    v_mfma_f32_16x16x32_bf16 v[100:103], a[200:203], v[36:39], v[100:103]
    ds_read_b64_tr_b16 a[222:223], v210 offset:18432
    v_add_f32 v229, v229, v111
    v_mfma_f32_16x16x32_bf16 v[100:103], a[204:207], v[52:55], v[100:103]
    ds_read_b64_tr_b16 a[224:225], v211 offset:0
    v_cvt_pk_bf16_f32 v159, v110, v111
    v_mfma_f32_16x16x32_bf16 v[100:103], a[208:211], v[68:71], v[100:103]
    v_exp_f32 v96, v96
    v_mfma_f32_16x16x32_bf16 v[100:103], a[212:215], v[84:87], v[100:103]
    ds_read_b64_tr_b16 a[226:227], v211 offset:6144
    v_add_f32 v226, v226, v96
    v_mfma_f32_16x16x32_bf16 v[104:107], a[192:195], v[8:11], v[200:203]
    buffer_load_dwordx4 v220, s[4:7], s26 offen offset:0  lds
    v_mfma_f32_16x16x32_bf16 v[104:107], a[196:199], v[24:27], v[104:107]
    v_exp_f32 v97, v97
    v_mfma_f32_16x16x32_bf16 v[104:107], a[200:203], v[40:43], v[104:107]
    ds_read_b64_tr_b16 a[228:229], v211 offset:12288
    v_add_f32 v226, v226, v97
    v_mfma_f32_16x16x32_bf16 v[104:107], a[204:207], v[56:59], v[104:107]
    ds_read_b64_tr_b16 a[230:231], v211 offset:18432
    v_cvt_pk_bf16_f32 v160, v96, v97
    v_mfma_f32_16x16x32_bf16 v[104:107], a[208:211], v[72:75], v[104:107]
    v_exp_f32 v98, v98
    v_mfma_f32_16x16x32_bf16 v[104:107], a[212:215], v[88:91], v[104:107]
    ds_read_b64_tr_b16 a[232:233], v212 offset:0
    v_add_f32 v226, v226, v98
    v_mfma_f32_16x16x32_bf16 v[108:111], a[192:195], v[12:15], v[204:207]
    s_waitcnt lgkmcnt(5)
    v_mfma_f32_16x16x32_bf16 v[108:111], a[196:199], v[28:31], v[108:111]
    v_exp_f32 v99, v99
    v_mfma_f32_16x16x32_bf16 v[108:111], a[200:203], v[44:47], v[108:111]
    ds_read_b64_tr_b16 a[234:235], v212 offset:6144
    v_add_f32 v226, v226, v99
    v_mfma_f32_16x16x32_bf16 v[108:111], a[204:207], v[60:63], v[108:111]
    ds_read_b64_tr_b16 a[236:237], v212 offset:12288
    v_cvt_pk_bf16_f32 v161, v98, v99
    v_mfma_f32_16x16x32_bf16 v[108:111], a[208:211], v[76:79], v[108:111]
    v_exp_f32 v100, v100
    v_mfma_f32_16x16x32_bf16 v[108:111], a[212:215], v[92:95], v[108:111]
    ds_read_b64_tr_b16 a[238:239], v212 offset:18432
    v_add_f32 v227, v227, v100
    v_mfma_f32_16x16x32_bf16 a[0:3], a[216:219], v[128:131], 0
    buffer_load_dwordx4 v221, s[4:7], s26 offen offset:1024  lds
    v_mfma_f32_16x16x32_bf16 a[0:3], a[220:223], v[144:147], a[0:3]
    v_exp_f32 v101, v101
    v_mfma_f32_16x16x32_bf16 a[4:7], a[216:219], v[132:135], 0
    v_add_f32 v227, v227, v101
    v_mfma_f32_16x16x32_bf16 a[4:7], a[220:223], v[148:151], a[4:7]
    v_cvt_pk_bf16_f32 v164, v100, v101
    v_mfma_f32_16x16x32_bf16 a[8:11], a[216:219], v[136:139], 0
    v_exp_f32 v102, v102
    v_mfma_f32_16x16x32_bf16 a[8:11], a[220:223], v[152:155], a[8:11]
    v_add_f32 v227, v227, v102
    v_mfma_f32_16x16x32_bf16 a[12:15], a[216:219], v[140:143], 0
    s_waitcnt lgkmcnt(0)
    v_mfma_f32_16x16x32_bf16 a[12:15], a[220:223], v[156:159], a[12:15]
    v_exp_f32 v103, v103
    v_mfma_f32_16x16x32_bf16 a[16:19], a[224:227], v[128:131], 0
    ds_read_b128 a[192:195], v208 offset:6144
    v_add_f32 v227, v227, v103
    v_mfma_f32_16x16x32_bf16 a[16:19], a[228:231], v[144:147], a[16:19]
    ds_read_b128 a[196:199], v209 offset:6144
    v_cvt_pk_bf16_f32 v165, v102, v103
    v_mfma_f32_16x16x32_bf16 a[20:23], a[224:227], v[132:135], 0
    v_exp_f32 v104, v104
    v_mfma_f32_16x16x32_bf16 a[20:23], a[228:231], v[148:151], a[20:23]
    ds_read_b128 a[200:203], v208 offset:6272
    v_add_f32 v228, v228, v104
    v_mfma_f32_16x16x32_bf16 a[24:27], a[224:227], v[136:139], 0
    buffer_load_dwordx4 v222, s[4:7], s26 offen offset:2048  lds
    v_mfma_f32_16x16x32_bf16 a[24:27], a[228:231], v[152:155], a[24:27]
    v_exp_f32 v105, v105
    v_mfma_f32_16x16x32_bf16 a[28:31], a[224:227], v[140:143], 0
    ds_read_b128 a[204:207], v209 offset:6272
    v_add_f32 v228, v228, v105
    v_mfma_f32_16x16x32_bf16 a[28:31], a[228:231], v[156:159], a[28:31]
    ds_read_b128 a[208:211], v208 offset:6400
    v_cvt_pk_bf16_f32 v168, v104, v105
    v_mfma_f32_16x16x32_bf16 a[32:35], a[232:235], v[128:131], 0
    v_exp_f32 v106, v106
    v_mfma_f32_16x16x32_bf16 a[32:35], a[236:239], v[144:147], a[32:35]
    ds_read_b128 a[212:215], v209 offset:6400
    v_add_f32 v228, v228, v106
    v_mfma_f32_16x16x32_bf16 a[36:39], a[232:235], v[132:135], 0
    buffer_load_dwordx4 a[240:243], v255, s[40:43], s60 offen
    v_mfma_f32_16x16x32_bf16 a[36:39], a[236:239], v[148:151], a[36:39]
    v_exp_f32 v107, v107
    v_mfma_f32_16x16x32_bf16 a[40:43], a[232:235], v[136:139], 0
    v_add_f32 v228, v228, v107
    s_add_u32 s26, s26, 12288
    v_mfma_f32_16x16x32_bf16 a[40:43], a[236:239], v[152:155], a[40:43]
    v_cvt_pk_bf16_f32 v169, v106, v107
    s_add_u32 m0, s45, 12288
    v_mfma_f32_16x16x32_bf16 a[44:47], a[232:235], v[140:143], 0
    v_exp_f32 v108, v108
    v_mfma_f32_16x16x32_bf16 a[44:47], a[236:239], v[156:159], a[44:47]
    v_add_f32 v229, v229, v108
    s_waitcnt lgkmcnt(0)
    v_mfma_f32_16x16x32_bf16 v[96:99], a[192:195], v[0:3], v[192:195]
    buffer_load_dwordx4 v220, s[4:7], s26 offen offset:0  lds
    v_mfma_f32_16x16x32_bf16 v[96:99], a[196:199], v[16:19], v[96:99]
    v_exp_f32 v109, v109
    v_mfma_f32_16x16x32_bf16 v[96:99], a[200:203], v[32:35], v[96:99]
    ds_read_b64_tr_b16 a[216:217], v213 offset:0
    v_add_f32 v229, v229, v109
    v_mfma_f32_16x16x32_bf16 v[96:99], a[204:207], v[48:51], v[96:99]
    ds_read_b64_tr_b16 a[218:219], v213 offset:6144
    v_cvt_pk_bf16_f32 v172, v108, v109
    v_mfma_f32_16x16x32_bf16 v[96:99], a[208:211], v[64:67], v[96:99]
    v_exp_f32 v110, v110
    v_mfma_f32_16x16x32_bf16 v[96:99], a[212:215], v[80:83], v[96:99]
    ds_read_b64_tr_b16 a[220:221], v213 offset:12288
    v_add_f32 v229, v229, v110
    v_mfma_f32_16x16x32_bf16 v[100:103], a[192:195], v[4:7], v[196:199]
    buffer_load_dwordx4 v221, s[4:7], s26 offen offset:1024  lds
    v_mfma_f32_16x16x32_bf16 v[100:103], a[196:199], v[20:23], v[100:103]
    v_exp_f32 v111, v111
    v_mfma_f32_16x16x32_bf16 v[100:103], a[200:203], v[36:39], v[100:103]
    ds_read_b64_tr_b16 a[222:223], v213 offset:18432
    v_add_f32 v229, v229, v111
    v_mfma_f32_16x16x32_bf16 v[100:103], a[204:207], v[52:55], v[100:103]
    ds_read_b64_tr_b16 a[224:225], v210 offset:128
    v_cvt_pk_bf16_f32 v173, v110, v111
    v_mfma_f32_16x16x32_bf16 v[100:103], a[208:211], v[68:71], v[100:103]
    v_exp_f32 v96, v96
    v_mfma_f32_16x16x32_bf16 v[100:103], a[212:215], v[84:87], v[100:103]
    ds_read_b64_tr_b16 a[226:227], v210 offset:6272
    v_add_f32 v226, v226, v96
    v_mfma_f32_16x16x32_bf16 v[104:107], a[192:195], v[8:11], v[200:203]
    buffer_load_dwordx4 v222, s[4:7], s26 offen offset:2048  lds
    v_mfma_f32_16x16x32_bf16 v[104:107], a[196:199], v[24:27], v[104:107]
    v_exp_f32 v97, v97
    v_mfma_f32_16x16x32_bf16 v[104:107], a[200:203], v[40:43], v[104:107]
    ds_read_b64_tr_b16 a[228:229], v210 offset:12416
    v_add_f32 v226, v226, v97
    v_mfma_f32_16x16x32_bf16 v[104:107], a[204:207], v[56:59], v[104:107]
    ds_read_b64_tr_b16 a[230:231], v210 offset:18560
    v_cvt_pk_bf16_f32 v162, v96, v97
    v_mfma_f32_16x16x32_bf16 v[104:107], a[208:211], v[72:75], v[104:107]
    v_exp_f32 v98, v98
    v_mfma_f32_16x16x32_bf16 v[104:107], a[212:215], v[88:91], v[104:107]
    ds_read_b64_tr_b16 a[232:233], v211 offset:128
    v_add_f32 v226, v226, v98
    v_mfma_f32_16x16x32_bf16 v[108:111], a[192:195], v[12:15], v[204:207]
    s_waitcnt lgkmcnt(5)
    s_add_u32 s26, s26, 12288
    v_mfma_f32_16x16x32_bf16 v[108:111], a[196:199], v[28:31], v[108:111]
    v_exp_f32 v99, v99
    v_mfma_f32_16x16x32_bf16 v[108:111], a[200:203], v[44:47], v[108:111]
    ds_read_b64_tr_b16 a[234:235], v211 offset:6272
    v_add_f32 v226, v226, v99
    v_mfma_f32_16x16x32_bf16 v[108:111], a[204:207], v[60:63], v[108:111]
    ds_read_b64_tr_b16 a[236:237], v211 offset:12416
    v_cvt_pk_bf16_f32 v163, v98, v99
    v_mfma_f32_16x16x32_bf16 v[108:111], a[208:211], v[76:79], v[108:111]
    v_exp_f32 v100, v100
    v_mfma_f32_16x16x32_bf16 v[108:111], a[212:215], v[92:95], v[108:111]
    ds_read_b64_tr_b16 a[238:239], v211 offset:18560
    v_add_f32 v227, v227, v100
    v_mfma_f32_16x16x32_bf16 a[48:51], a[216:219], v[128:131], 0
    v_mfma_f32_16x16x32_bf16 a[48:51], a[220:223], v[144:147], a[48:51]
    v_exp_f32 v101, v101
    v_mfma_f32_16x16x32_bf16 a[52:55], a[216:219], v[132:135], 0
    v_add_f32 v227, v227, v101
    s_add_u32 s60, s60, s48
    v_mfma_f32_16x16x32_bf16 a[52:55], a[220:223], v[148:151], a[52:55]
    v_cvt_pk_bf16_f32 v166, v100, v101
    s_add_u32 m0, s47, 0
    v_mfma_f32_16x16x32_bf16 a[56:59], a[216:219], v[136:139], 0
    v_exp_f32 v102, v102
    v_mfma_f32_16x16x32_bf16 a[56:59], a[220:223], v[152:155], a[56:59]
    v_add_f32 v227, v227, v102
    v_mfma_f32_16x16x32_bf16 a[60:63], a[216:219], v[140:143], 0
    s_waitcnt lgkmcnt(0)
    v_mfma_f32_16x16x32_bf16 a[60:63], a[220:223], v[156:159], a[60:63]
    v_exp_f32 v103, v103
    v_mfma_f32_16x16x32_bf16 a[64:67], a[224:227], v[128:131], 0
    ds_read_b128 a[192:195], v208 offset:12288
    v_add_f32 v227, v227, v103
    v_mfma_f32_16x16x32_bf16 a[64:67], a[228:231], v[144:147], a[64:67]
    ds_read_b128 a[196:199], v209 offset:12288
    v_cvt_pk_bf16_f32 v167, v102, v103
    v_mfma_f32_16x16x32_bf16 a[68:71], a[224:227], v[132:135], 0
    v_exp_f32 v104, v104
    v_mfma_f32_16x16x32_bf16 a[68:71], a[228:231], v[148:151], a[68:71]
    ds_read_b128 a[200:203], v208 offset:12416
    v_add_f32 v228, v228, v104
    v_mfma_f32_16x16x32_bf16 a[72:75], a[224:227], v[136:139], 0
    buffer_load_dwordx4 v223, s[8:11], s27 offen offset:0  lds
    v_mfma_f32_16x16x32_bf16 a[72:75], a[228:231], v[152:155], a[72:75]
    v_exp_f32 v105, v105
    v_mfma_f32_16x16x32_bf16 a[76:79], a[224:227], v[140:143], 0
    ds_read_b128 a[204:207], v209 offset:12416
    v_add_f32 v228, v228, v105
    v_mfma_f32_16x16x32_bf16 a[76:79], a[228:231], v[156:159], a[76:79]
    ds_read_b128 a[208:211], v208 offset:12544
    v_cvt_pk_bf16_f32 v170, v104, v105
    v_mfma_f32_16x16x32_bf16 a[80:83], a[232:235], v[128:131], 0
    v_exp_f32 v106, v106
    v_mfma_f32_16x16x32_bf16 a[80:83], a[236:239], v[144:147], a[80:83]
    ds_read_b128 a[212:215], v209 offset:12544
    v_add_f32 v228, v228, v106
    v_mfma_f32_16x16x32_bf16 a[84:87], a[232:235], v[132:135], 0
    buffer_load_dwordx4 v224, s[8:11], s27 offen offset:1024  lds
    v_mfma_f32_16x16x32_bf16 a[84:87], a[236:239], v[148:151], a[84:87]
    v_exp_f32 v107, v107
    v_mfma_f32_16x16x32_bf16 a[88:91], a[232:235], v[136:139], 0
    v_add_f32 v228, v228, v107
    v_mfma_f32_16x16x32_bf16 a[88:91], a[236:239], v[152:155], a[88:91]
    v_cvt_pk_bf16_f32 v171, v106, v107
    v_mfma_f32_16x16x32_bf16 a[92:95], a[232:235], v[140:143], 0
    v_exp_f32 v108, v108
    v_mfma_f32_16x16x32_bf16 a[92:95], a[236:239], v[156:159], a[92:95]
    v_add_f32 v229, v229, v108
    s_waitcnt lgkmcnt(0)
    v_mfma_f32_16x16x32_bf16 v[96:99], a[192:195], v[0:3], v[192:195]
    buffer_load_dwordx4 v225, s[8:11], s27 offen offset:2048  lds
    v_mfma_f32_16x16x32_bf16 v[96:99], a[196:199], v[16:19], v[96:99]
    v_exp_f32 v109, v109
    v_mfma_f32_16x16x32_bf16 v[96:99], a[200:203], v[32:35], v[96:99]
    ds_read_b64_tr_b16 a[216:217], v212 offset:128
    v_add_f32 v229, v229, v109
    v_mfma_f32_16x16x32_bf16 v[96:99], a[204:207], v[48:51], v[96:99]
    ds_read_b64_tr_b16 a[218:219], v212 offset:6272
    v_cvt_pk_bf16_f32 v174, v108, v109
    v_mfma_f32_16x16x32_bf16 v[96:99], a[208:211], v[64:67], v[96:99]
    v_exp_f32 v110, v110
    v_mfma_f32_16x16x32_bf16 v[96:99], a[212:215], v[80:83], v[96:99]
    ds_read_b64_tr_b16 a[220:221], v212 offset:12416
    v_add_f32 v229, v229, v110
    v_mfma_f32_16x16x32_bf16 v[100:103], a[192:195], v[4:7], v[196:199]
    s_add_u32 s27, s27, 12288
    s_add_u32 m0, s47, 12288
    v_mfma_f32_16x16x32_bf16 v[100:103], a[196:199], v[20:23], v[100:103]
    v_exp_f32 v111, v111
    v_mfma_f32_16x16x32_bf16 v[100:103], a[200:203], v[36:39], v[100:103]
    ds_read_b64_tr_b16 a[222:223], v212 offset:18560
    v_add_f32 v229, v229, v111
    v_mfma_f32_16x16x32_bf16 v[100:103], a[204:207], v[52:55], v[100:103]
    ds_read_b64_tr_b16 a[224:225], v213 offset:128
    v_cvt_pk_bf16_f32 v175, v110, v111
    v_mfma_f32_16x16x32_bf16 v[100:103], a[208:211], v[68:71], v[100:103]
    v_exp_f32 v96, v96
    v_mfma_f32_16x16x32_bf16 v[100:103], a[212:215], v[84:87], v[100:103]
    ds_read_b64_tr_b16 a[226:227], v213 offset:6272
    v_add_f32 v226, v226, v96
    v_mfma_f32_16x16x32_bf16 v[104:107], a[192:195], v[8:11], v[200:203]
    buffer_load_dwordx4 v223, s[8:11], s27 offen offset:0  lds
    v_mfma_f32_16x16x32_bf16 v[104:107], a[196:199], v[24:27], v[104:107]
    v_exp_f32 v97, v97
    v_mfma_f32_16x16x32_bf16 v[104:107], a[200:203], v[40:43], v[104:107]
    ds_read_b64_tr_b16 a[228:229], v213 offset:12416
    v_add_f32 v226, v226, v97
    v_mfma_f32_16x16x32_bf16 v[104:107], a[204:207], v[56:59], v[104:107]
    ds_read_b64_tr_b16 a[230:231], v213 offset:18560
    v_cvt_pk_bf16_f32 v176, v96, v97
    v_mfma_f32_16x16x32_bf16 v[104:107], a[208:211], v[72:75], v[104:107]
    v_exp_f32 v98, v98
    v_mfma_f32_16x16x32_bf16 v[104:107], a[212:215], v[88:91], v[104:107]
    ds_read_b64_tr_b16 a[232:233], v210 offset:256
    v_add_f32 v226, v226, v98
    v_mfma_f32_16x16x32_bf16 v[108:111], a[192:195], v[12:15], v[204:207]
    s_waitcnt lgkmcnt(5)
    v_mfma_f32_16x16x32_bf16 v[108:111], a[196:199], v[28:31], v[108:111]
    v_exp_f32 v99, v99
    v_mfma_f32_16x16x32_bf16 v[108:111], a[200:203], v[44:47], v[108:111]
    ds_read_b64_tr_b16 a[234:235], v210 offset:6400
    v_add_f32 v226, v226, v99
    v_mfma_f32_16x16x32_bf16 v[108:111], a[204:207], v[60:63], v[108:111]
    ds_read_b64_tr_b16 a[236:237], v210 offset:12544
    v_cvt_pk_bf16_f32 v177, v98, v99
    v_mfma_f32_16x16x32_bf16 v[108:111], a[208:211], v[76:79], v[108:111]
    v_exp_f32 v100, v100
    v_mfma_f32_16x16x32_bf16 v[108:111], a[212:215], v[92:95], v[108:111]
    ds_read_b64_tr_b16 a[238:239], v210 offset:18688
    v_add_f32 v227, v227, v100
    v_mfma_f32_16x16x32_bf16 a[96:99], a[216:219], v[128:131], 0
    buffer_load_dwordx4 v224, s[8:11], s27 offen offset:1024  lds
    v_mfma_f32_16x16x32_bf16 a[96:99], a[220:223], v[144:147], a[96:99]
    v_exp_f32 v101, v101
    v_mfma_f32_16x16x32_bf16 a[100:103], a[216:219], v[132:135], 0
    v_add_f32 v227, v227, v101
    v_mfma_f32_16x16x32_bf16 a[100:103], a[220:223], v[148:151], a[100:103]
    v_cvt_pk_bf16_f32 v180, v100, v101
    v_mfma_f32_16x16x32_bf16 a[104:107], a[216:219], v[136:139], 0
    v_exp_f32 v102, v102
    v_mfma_f32_16x16x32_bf16 a[104:107], a[220:223], v[152:155], a[104:107]
    v_add_f32 v227, v227, v102
    v_mfma_f32_16x16x32_bf16 a[108:111], a[216:219], v[140:143], 0
    s_waitcnt lgkmcnt(0)
    v_mfma_f32_16x16x32_bf16 a[108:111], a[220:223], v[156:159], a[108:111]
    v_exp_f32 v103, v103
    v_mfma_f32_16x16x32_bf16 a[112:115], a[224:227], v[128:131], 0
    ds_read_b128 a[192:195], v208 offset:18432
    v_add_f32 v227, v227, v103
    v_mfma_f32_16x16x32_bf16 a[112:115], a[228:231], v[144:147], a[112:115]
    ds_read_b128 a[196:199], v209 offset:18432
    v_cvt_pk_bf16_f32 v181, v102, v103
    v_mfma_f32_16x16x32_bf16 a[116:119], a[224:227], v[132:135], 0
    v_exp_f32 v104, v104
    v_mfma_f32_16x16x32_bf16 a[116:119], a[228:231], v[148:151], a[116:119]
    ds_read_b128 a[200:203], v208 offset:18560
    v_add_f32 v228, v228, v104
    v_mfma_f32_16x16x32_bf16 a[120:123], a[224:227], v[136:139], 0
    buffer_load_dwordx4 v225, s[8:11], s27 offen offset:2048  lds
    v_mfma_f32_16x16x32_bf16 a[120:123], a[228:231], v[152:155], a[120:123]
    v_exp_f32 v105, v105
    v_mfma_f32_16x16x32_bf16 a[124:127], a[224:227], v[140:143], 0
    ds_read_b128 a[204:207], v209 offset:18560
    v_add_f32 v228, v228, v105
    v_mfma_f32_16x16x32_bf16 a[124:127], a[228:231], v[156:159], a[124:127]
    ds_read_b128 a[208:211], v208 offset:18688
    v_cvt_pk_bf16_f32 v184, v104, v105
    v_mfma_f32_16x16x32_bf16 a[128:131], a[232:235], v[128:131], 0
    v_exp_f32 v106, v106
    v_mfma_f32_16x16x32_bf16 a[128:131], a[236:239], v[144:147], a[128:131]
    ds_read_b128 a[212:215], v209 offset:18688
    v_add_f32 v228, v228, v106
    v_mfma_f32_16x16x32_bf16 a[132:135], a[232:235], v[132:135], 0
    s_add_u32 s27, s27, 12288
    v_mfma_f32_16x16x32_bf16 a[132:135], a[236:239], v[148:151], a[132:135]
    v_exp_f32 v107, v107
    v_mfma_f32_16x16x32_bf16 a[136:139], a[232:235], v[136:139], 0
    v_add_f32 v228, v228, v107
    s_add_u32 s45, s44, s25
    v_mfma_f32_16x16x32_bf16 a[136:139], a[236:239], v[152:155], a[136:139]
    v_cvt_pk_bf16_f32 v185, v106, v107
    s_add_u32 s44, s44, 24576
    v_mfma_f32_16x16x32_bf16 a[140:143], a[232:235], v[140:143], 0
    v_exp_f32 v108, v108
    v_mfma_f32_16x16x32_bf16 a[140:143], a[236:239], v[156:159], a[140:143]
    v_add_f32 v229, v229, v108
    s_waitcnt lgkmcnt(0)
    v_mfma_f32_16x16x32_bf16 v[96:99], a[192:195], v[0:3], v[192:195]
    s_cmp_eq_u32 s44, 73728
    s_cmov_b32 s44, 0
    v_mfma_f32_16x16x32_bf16 v[96:99], a[196:199], v[16:19], v[96:99]
    v_exp_f32 v109, v109
    v_mfma_f32_16x16x32_bf16 v[96:99], a[200:203], v[32:35], v[96:99]
    ds_read_b64_tr_b16 a[216:217], v211 offset:256
    v_add_f32 v229, v229, v109
    v_mfma_f32_16x16x32_bf16 v[96:99], a[204:207], v[48:51], v[96:99]
    ds_read_b64_tr_b16 a[218:219], v211 offset:6400
    v_cvt_pk_bf16_f32 v188, v108, v109
    v_mfma_f32_16x16x32_bf16 v[96:99], a[208:211], v[64:67], v[96:99]
    v_exp_f32 v110, v110
    v_mfma_f32_16x16x32_bf16 v[96:99], a[212:215], v[80:83], v[96:99]
    ds_read_b64_tr_b16 a[220:221], v211 offset:12544
    v_add_f32 v229, v229, v110
    v_mfma_f32_16x16x32_bf16 v[100:103], a[192:195], v[4:7], v[196:199]
    v_mfma_f32_16x16x32_bf16 v[100:103], a[196:199], v[20:23], v[100:103]
    v_exp_f32 v111, v111
    v_mfma_f32_16x16x32_bf16 v[100:103], a[200:203], v[36:39], v[100:103]
    ds_read_b64_tr_b16 a[222:223], v211 offset:18688
    v_add_f32 v229, v229, v111
    v_mfma_f32_16x16x32_bf16 v[100:103], a[204:207], v[52:55], v[100:103]
    ds_read_b64_tr_b16 a[224:225], v212 offset:256
    v_cvt_pk_bf16_f32 v189, v110, v111
    v_mfma_f32_16x16x32_bf16 v[100:103], a[208:211], v[68:71], v[100:103]
    v_exp_f32 v96, v96
    v_mfma_f32_16x16x32_bf16 v[100:103], a[212:215], v[84:87], v[100:103]
    ds_read_b64_tr_b16 a[226:227], v212 offset:6400
    v_add_f32 v226, v226, v96
    v_mfma_f32_16x16x32_bf16 v[104:107], a[192:195], v[8:11], v[200:203]
    v_mfma_f32_16x16x32_bf16 v[104:107], a[196:199], v[24:27], v[104:107]
    v_exp_f32 v97, v97
    v_mfma_f32_16x16x32_bf16 v[104:107], a[200:203], v[40:43], v[104:107]
    ds_read_b64_tr_b16 a[228:229], v212 offset:12544
    v_add_f32 v226, v226, v97
    v_mfma_f32_16x16x32_bf16 v[104:107], a[204:207], v[56:59], v[104:107]
    ds_read_b64_tr_b16 a[230:231], v212 offset:18688
    v_cvt_pk_bf16_f32 v178, v96, v97
    v_mfma_f32_16x16x32_bf16 v[104:107], a[208:211], v[72:75], v[104:107]
    v_exp_f32 v98, v98
    v_mfma_f32_16x16x32_bf16 v[104:107], a[212:215], v[88:91], v[104:107]
    ds_read_b64_tr_b16 a[232:233], v213 offset:256
    v_add_f32 v226, v226, v98
    v_mfma_f32_16x16x32_bf16 v[108:111], a[192:195], v[12:15], v[204:207]
    s_waitcnt lgkmcnt(5)
    v_add_u32 v208, s44, v214
    v_mfma_f32_16x16x32_bf16 v[108:111], a[196:199], v[28:31], v[108:111]
    v_exp_f32 v99, v99
    v_mfma_f32_16x16x32_bf16 v[108:111], a[200:203], v[44:47], v[108:111]
    ds_read_b64_tr_b16 a[234:235], v213 offset:6400
    v_add_f32 v226, v226, v99
    v_mfma_f32_16x16x32_bf16 v[108:111], a[204:207], v[60:63], v[108:111]
    ds_read_b64_tr_b16 a[236:237], v213 offset:12544
    v_cvt_pk_bf16_f32 v179, v98, v99
    v_mfma_f32_16x16x32_bf16 v[108:111], a[208:211], v[76:79], v[108:111]
    v_exp_f32 v100, v100
    v_mfma_f32_16x16x32_bf16 v[108:111], a[212:215], v[92:95], v[108:111]
    ds_read_b64_tr_b16 a[238:239], v213 offset:18688
    v_add_f32 v227, v227, v100
    v_mfma_f32_16x16x32_bf16 a[144:147], a[216:219], v[128:131], 0
    v_mfma_f32_16x16x32_bf16 a[144:147], a[220:223], v[144:147], a[144:147]
    v_exp_f32 v101, v101
    v_mfma_f32_16x16x32_bf16 a[148:151], a[216:219], v[132:135], 0
    v_add_f32 v227, v227, v101
    v_add_u32 v209, s44, v215
    v_mfma_f32_16x16x32_bf16 a[148:151], a[220:223], v[148:151], a[148:151]
    v_cvt_pk_bf16_f32 v182, v100, v101
    s_add_u32 s47, s46, s25
    v_mfma_f32_16x16x32_bf16 a[152:155], a[216:219], v[136:139], 0
    v_exp_f32 v102, v102
    v_mfma_f32_16x16x32_bf16 a[152:155], a[220:223], v[152:155], a[152:155]
    v_add_f32 v227, v227, v102
    s_add_u32 s46, s46, 24576
    v_mfma_f32_16x16x32_bf16 a[156:159], a[216:219], v[140:143], 0
    s_waitcnt vmcnt(13) lgkmcnt(0)
    s_barrier
    v_mfma_f32_16x16x32_bf16 a[156:159], a[220:223], v[156:159], a[156:159]
    v_exp_f32 v103, v103
    v_mfma_f32_16x16x32_bf16 a[160:163], a[224:227], v[128:131], 0
    ds_read_b128 a[192:195], v208 offset:0
    v_add_f32 v227, v227, v103
    v_mfma_f32_16x16x32_bf16 a[160:163], a[228:231], v[144:147], a[160:163]
    ds_read_b128 a[196:199], v209 offset:0
    v_cvt_pk_bf16_f32 v183, v102, v103
    v_mfma_f32_16x16x32_bf16 a[164:167], a[224:227], v[132:135], 0
    v_exp_f32 v104, v104
    v_mfma_f32_16x16x32_bf16 a[164:167], a[228:231], v[148:151], a[164:167]
    ds_read_b128 a[200:203], v208 offset:128
    v_add_f32 v228, v228, v104
    v_mfma_f32_16x16x32_bf16 a[168:171], a[224:227], v[136:139], 0
    s_cmp_eq_u32 s46, 147456
    s_cmov_b32 s46, 73728
    v_mfma_f32_16x16x32_bf16 a[168:171], a[228:231], v[152:155], a[168:171]
    v_exp_f32 v105, v105
    v_mfma_f32_16x16x32_bf16 a[172:175], a[224:227], v[140:143], 0
    ds_read_b128 a[204:207], v209 offset:128
    v_add_f32 v228, v228, v105
    v_mfma_f32_16x16x32_bf16 a[172:175], a[228:231], v[156:159], a[172:175]
    ds_read_b128 a[208:211], v208 offset:256
    v_cvt_pk_bf16_f32 v186, v104, v105
    v_mfma_f32_16x16x32_bf16 a[176:179], a[232:235], v[128:131], 0
    v_exp_f32 v106, v106
    v_mfma_f32_16x16x32_bf16 a[176:179], a[236:239], v[144:147], a[176:179]
    ds_read_b128 a[212:215], v209 offset:256
    v_add_f32 v228, v228, v106
    v_mfma_f32_16x16x32_bf16 a[180:183], a[232:235], v[132:135], 0
    v_mfma_f32_16x16x32_bf16 a[180:183], a[236:239], v[148:151], a[180:183]
    v_exp_f32 v107, v107
    v_mfma_f32_16x16x32_bf16 a[184:187], a[232:235], v[136:139], 0
    v_add_f32 v228, v228, v107
    v_add_u32 v210, s46, v216
    v_mfma_f32_16x16x32_bf16 a[184:187], a[236:239], v[152:155], a[184:187]
    v_cvt_pk_bf16_f32 v187, v106, v107
    v_add_u32 v211, s46, v217
    v_mfma_f32_16x16x32_bf16 a[188:191], a[232:235], v[140:143], 0
    v_exp_f32 v108, v108
    v_mfma_f32_16x16x32_bf16 a[188:191], a[236:239], v[156:159], a[188:191]
    v_add_f32 v229, v229, v108
    s_waitcnt lgkmcnt(0)
L_attn_loop:
    v_mfma_f32_16x16x32_bf16 v[96:99], a[192:195], v[0:3], v[192:195]
    v_add_u32 v212, s46, v218
    v_add_u32 v213, s46, v219
    v_mfma_f32_16x16x32_bf16 v[96:99], a[196:199], v[16:19], v[96:99]
    v_exp_f32 v109, v109
    v_mfma_f32_16x16x32_bf16 v[96:99], a[200:203], v[32:35], v[96:99]
    ds_read_b64_tr_b16 a[216:217], v210 offset:0
    v_add_f32 v229, v229, v109
    v_mfma_f32_16x16x32_bf16 v[96:99], a[204:207], v[48:51], v[96:99]
    ds_read_b64_tr_b16 a[218:219], v210 offset:6144
    v_cvt_pk_bf16_f32 v190, v108, v109
    v_mfma_f32_16x16x32_bf16 v[96:99], a[208:211], v[64:67], v[96:99]
    v_exp_f32 v110, v110
    v_mfma_f32_16x16x32_bf16 v[96:99], a[212:215], v[80:83], v[96:99]
    ds_read_b64_tr_b16 a[220:221], v210 offset:12288
    v_add_f32 v229, v229, v110
    v_mfma_f32_16x16x32_bf16 v[100:103], a[192:195], v[4:7], v[196:199]
    s_add_u32 m0, s45, 0
    v_mfma_f32_16x16x32_bf16 v[100:103], a[196:199], v[20:23], v[100:103]
    v_exp_f32 v111, v111
    v_mfma_f32_16x16x32_bf16 v[100:103], a[200:203], v[36:39], v[100:103]
    ds_read_b64_tr_b16 a[222:223], v210 offset:18432
    v_add_f32 v229, v229, v111
    v_mfma_f32_16x16x32_bf16 v[100:103], a[204:207], v[52:55], v[100:103]
    ds_read_b64_tr_b16 a[224:225], v211 offset:0
    v_cvt_pk_bf16_f32 v191, v110, v111
    v_mfma_f32_16x16x32_bf16 v[100:103], a[208:211], v[68:71], v[100:103]
    v_exp_f32 v96, v96
    v_mfma_f32_16x16x32_bf16 v[100:103], a[212:215], v[84:87], v[100:103]
    ds_read_b64_tr_b16 a[226:227], v211 offset:6144
    v_add_f32 v226, v226, v96
    v_mfma_f32_16x16x32_bf16 v[104:107], a[192:195], v[8:11], v[200:203]
    buffer_load_dwordx4 v220, s[4:7], s26 offen offset:0  lds
    v_mfma_f32_16x16x32_bf16 v[104:107], a[196:199], v[24:27], v[104:107]
    v_exp_f32 v97, v97
    v_mfma_f32_16x16x32_bf16 v[104:107], a[200:203], v[40:43], v[104:107]
    ds_read_b64_tr_b16 a[228:229], v211 offset:12288
    v_add_f32 v226, v226, v97
    v_mfma_f32_16x16x32_bf16 v[104:107], a[204:207], v[56:59], v[104:107]
    ds_read_b64_tr_b16 a[230:231], v211 offset:18432
    v_cvt_pk_bf16_f32 v128, v96, v97
    v_mfma_f32_16x16x32_bf16 v[104:107], a[208:211], v[72:75], v[104:107]
    v_exp_f32 v98, v98
    v_mfma_f32_16x16x32_bf16 v[104:107], a[212:215], v[88:91], v[104:107]
    ds_read_b64_tr_b16 a[232:233], v212 offset:0
    v_add_f32 v226, v226, v98
    v_mfma_f32_16x16x32_bf16 v[108:111], a[192:195], v[12:15], v[204:207]
    s_waitcnt lgkmcnt(5)
    v_mfma_f32_16x16x32_bf16 v[108:111], a[196:199], v[28:31], v[108:111]
    v_exp_f32 v99, v99
    v_mfma_f32_16x16x32_bf16 v[108:111], a[200:203], v[44:47], v[108:111]
    ds_read_b64_tr_b16 a[234:235], v212 offset:6144
    v_add_f32 v226, v226, v99
    v_mfma_f32_16x16x32_bf16 v[108:111], a[204:207], v[60:63], v[108:111]
    ds_read_b64_tr_b16 a[236:237], v212 offset:12288
    v_cvt_pk_bf16_f32 v129, v98, v99
    v_mfma_f32_16x16x32_bf16 v[108:111], a[208:211], v[76:79], v[108:111]
    v_exp_f32 v100, v100
    v_mfma_f32_16x16x32_bf16 v[108:111], a[212:215], v[92:95], v[108:111]
    ds_read_b64_tr_b16 a[238:239], v212 offset:18432
    v_add_f32 v227, v227, v100
    v_mfma_f32_16x16x32_bf16 a[0:3], a[216:219], v[160:163], a[0:3]
    buffer_load_dwordx4 v221, s[4:7], s26 offen offset:1024  lds
    v_mfma_f32_16x16x32_bf16 a[0:3], a[220:223], v[176:179], a[0:3]
    v_exp_f32 v101, v101
    v_mfma_f32_16x16x32_bf16 a[4:7], a[216:219], v[164:167], a[4:7]
    v_add_f32 v227, v227, v101
    v_mfma_f32_16x16x32_bf16 a[4:7], a[220:223], v[180:183], a[4:7]
    v_cvt_pk_bf16_f32 v132, v100, v101
    v_mfma_f32_16x16x32_bf16 a[8:11], a[216:219], v[168:171], a[8:11]
    v_exp_f32 v102, v102
    v_mfma_f32_16x16x32_bf16 a[8:11], a[220:223], v[184:187], a[8:11]
    v_add_f32 v227, v227, v102
    v_mfma_f32_16x16x32_bf16 a[12:15], a[216:219], v[172:175], a[12:15]
    s_waitcnt lgkmcnt(0)
    v_mfma_f32_16x16x32_bf16 a[12:15], a[220:223], v[188:191], a[12:15]
    v_exp_f32 v103, v103
    v_mfma_f32_16x16x32_bf16 a[16:19], a[224:227], v[160:163], a[16:19]
    ds_read_b128 a[192:195], v208 offset:6144
    v_add_f32 v227, v227, v103
    v_mfma_f32_16x16x32_bf16 a[16:19], a[228:231], v[176:179], a[16:19]
    ds_read_b128 a[196:199], v209 offset:6144
    v_cvt_pk_bf16_f32 v133, v102, v103
    v_mfma_f32_16x16x32_bf16 a[20:23], a[224:227], v[164:167], a[20:23]
    v_exp_f32 v104, v104
    v_mfma_f32_16x16x32_bf16 a[20:23], a[228:231], v[180:183], a[20:23]
    ds_read_b128 a[200:203], v208 offset:6272
    v_add_f32 v228, v228, v104
    v_mfma_f32_16x16x32_bf16 a[24:27], a[224:227], v[168:171], a[24:27]
    buffer_load_dwordx4 v222, s[4:7], s26 offen offset:2048  lds
    v_mfma_f32_16x16x32_bf16 a[24:27], a[228:231], v[184:187], a[24:27]
    v_exp_f32 v105, v105
    v_mfma_f32_16x16x32_bf16 a[28:31], a[224:227], v[172:175], a[28:31]
    ds_read_b128 a[204:207], v209 offset:6272
    v_add_f32 v228, v228, v105
    v_mfma_f32_16x16x32_bf16 a[28:31], a[228:231], v[188:191], a[28:31]
    ds_read_b128 a[208:211], v208 offset:6400
    v_cvt_pk_bf16_f32 v136, v104, v105
    v_mfma_f32_16x16x32_bf16 a[32:35], a[232:235], v[160:163], a[32:35]
    v_exp_f32 v106, v106
    v_mfma_f32_16x16x32_bf16 a[32:35], a[236:239], v[176:179], a[32:35]
    ds_read_b128 a[212:215], v209 offset:6400
    v_add_f32 v228, v228, v106
    v_mfma_f32_16x16x32_bf16 a[36:39], a[232:235], v[164:167], a[36:39]
    buffer_load_dwordx4 a[244:247], v255, s[40:43], s60 offen
    v_mfma_f32_16x16x32_bf16 a[36:39], a[236:239], v[180:183], a[36:39]
    v_exp_f32 v107, v107
    v_mfma_f32_16x16x32_bf16 a[40:43], a[232:235], v[168:171], a[40:43]
    v_add_f32 v228, v228, v107
    s_add_u32 s26, s26, 12288
    v_mfma_f32_16x16x32_bf16 a[40:43], a[236:239], v[184:187], a[40:43]
    v_cvt_pk_bf16_f32 v137, v106, v107
    s_add_u32 m0, s45, 12288
    v_mfma_f32_16x16x32_bf16 a[44:47], a[232:235], v[172:175], a[44:47]
    v_exp_f32 v108, v108
    v_mfma_f32_16x16x32_bf16 a[44:47], a[236:239], v[188:191], a[44:47]
    v_add_f32 v229, v229, v108
    s_waitcnt lgkmcnt(0)
    v_mfma_f32_16x16x32_bf16 v[96:99], a[192:195], v[0:3], v[192:195]
    buffer_load_dwordx4 v220, s[4:7], s26 offen offset:0  lds
    v_mfma_f32_16x16x32_bf16 v[96:99], a[196:199], v[16:19], v[96:99]
    v_exp_f32 v109, v109
    v_mfma_f32_16x16x32_bf16 v[96:99], a[200:203], v[32:35], v[96:99]
    ds_read_b64_tr_b16 a[216:217], v213 offset:0
    v_add_f32 v229, v229, v109
    v_mfma_f32_16x16x32_bf16 v[96:99], a[204:207], v[48:51], v[96:99]
    ds_read_b64_tr_b16 a[218:219], v213 offset:6144
    v_cvt_pk_bf16_f32 v140, v108, v109
    v_mfma_f32_16x16x32_bf16 v[96:99], a[208:211], v[64:67], v[96:99]
    v_exp_f32 v110, v110
    v_mfma_f32_16x16x32_bf16 v[96:99], a[212:215], v[80:83], v[96:99]
    ds_read_b64_tr_b16 a[220:221], v213 offset:12288
    v_add_f32 v229, v229, v110
    v_mfma_f32_16x16x32_bf16 v[100:103], a[192:195], v[4:7], v[196:199]
    buffer_load_dwordx4 v221, s[4:7], s26 offen offset:1024  lds
    v_mfma_f32_16x16x32_bf16 v[100:103], a[196:199], v[20:23], v[100:103]
    v_exp_f32 v111, v111
    v_mfma_f32_16x16x32_bf16 v[100:103], a[200:203], v[36:39], v[100:103]
    ds_read_b64_tr_b16 a[222:223], v213 offset:18432
    v_add_f32 v229, v229, v111
    v_mfma_f32_16x16x32_bf16 v[100:103], a[204:207], v[52:55], v[100:103]
    ds_read_b64_tr_b16 a[224:225], v210 offset:128
    v_cvt_pk_bf16_f32 v141, v110, v111
    v_mfma_f32_16x16x32_bf16 v[100:103], a[208:211], v[68:71], v[100:103]
    v_exp_f32 v96, v96
    v_mfma_f32_16x16x32_bf16 v[100:103], a[212:215], v[84:87], v[100:103]
    ds_read_b64_tr_b16 a[226:227], v210 offset:6272
    v_add_f32 v226, v226, v96
    v_mfma_f32_16x16x32_bf16 v[104:107], a[192:195], v[8:11], v[200:203]
    buffer_load_dwordx4 v222, s[4:7], s26 offen offset:2048  lds
    v_mfma_f32_16x16x32_bf16 v[104:107], a[196:199], v[24:27], v[104:107]
    v_exp_f32 v97, v97
    v_mfma_f32_16x16x32_bf16 v[104:107], a[200:203], v[40:43], v[104:107]
    ds_read_b64_tr_b16 a[228:229], v210 offset:12416
    v_add_f32 v226, v226, v97
    v_mfma_f32_16x16x32_bf16 v[104:107], a[204:207], v[56:59], v[104:107]
    ds_read_b64_tr_b16 a[230:231], v210 offset:18560
    v_cvt_pk_bf16_f32 v130, v96, v97
    v_mfma_f32_16x16x32_bf16 v[104:107], a[208:211], v[72:75], v[104:107]
    v_exp_f32 v98, v98
    v_mfma_f32_16x16x32_bf16 v[104:107], a[212:215], v[88:91], v[104:107]
    ds_read_b64_tr_b16 a[232:233], v211 offset:128
    v_add_f32 v226, v226, v98
    v_mfma_f32_16x16x32_bf16 v[108:111], a[192:195], v[12:15], v[204:207]
    s_waitcnt lgkmcnt(5)
    s_add_u32 s26, s26, 12288
    v_mfma_f32_16x16x32_bf16 v[108:111], a[196:199], v[28:31], v[108:111]
    v_exp_f32 v99, v99
    v_mfma_f32_16x16x32_bf16 v[108:111], a[200:203], v[44:47], v[108:111]
    ds_read_b64_tr_b16 a[234:235], v211 offset:6272
    v_add_f32 v226, v226, v99
    v_mfma_f32_16x16x32_bf16 v[108:111], a[204:207], v[60:63], v[108:111]
    ds_read_b64_tr_b16 a[236:237], v211 offset:12416
    v_cvt_pk_bf16_f32 v131, v98, v99
    v_mfma_f32_16x16x32_bf16 v[108:111], a[208:211], v[76:79], v[108:111]
    v_exp_f32 v100, v100
    v_mfma_f32_16x16x32_bf16 v[108:111], a[212:215], v[92:95], v[108:111]
    ds_read_b64_tr_b16 a[238:239], v211 offset:18560
    v_add_f32 v227, v227, v100
    v_mfma_f32_16x16x32_bf16 a[48:51], a[216:219], v[160:163], a[48:51]
    v_mfma_f32_16x16x32_bf16 a[48:51], a[220:223], v[176:179], a[48:51]
    v_exp_f32 v101, v101
    v_mfma_f32_16x16x32_bf16 a[52:55], a[216:219], v[164:167], a[52:55]
    v_add_f32 v227, v227, v101
    s_add_u32 s60, s60, s48
    v_mfma_f32_16x16x32_bf16 a[52:55], a[220:223], v[180:183], a[52:55]
    v_cvt_pk_bf16_f32 v134, v100, v101
    s_add_u32 m0, s47, 0
    v_mfma_f32_16x16x32_bf16 a[56:59], a[216:219], v[168:171], a[56:59]
    v_exp_f32 v102, v102
    v_mfma_f32_16x16x32_bf16 a[56:59], a[220:223], v[184:187], a[56:59]
    v_add_f32 v227, v227, v102
    v_mfma_f32_16x16x32_bf16 a[60:63], a[216:219], v[172:175], a[60:63]
    s_waitcnt lgkmcnt(0)
    v_mfma_f32_16x16x32_bf16 a[60:63], a[220:223], v[188:191], a[60:63]
    v_exp_f32 v103, v103
    v_mfma_f32_16x16x32_bf16 a[64:67], a[224:227], v[160:163], a[64:67]
    ds_read_b128 a[192:195], v208 offset:12288
    v_add_f32 v227, v227, v103
    v_mfma_f32_16x16x32_bf16 a[64:67], a[228:231], v[176:179], a[64:67]
    ds_read_b128 a[196:199], v209 offset:12288
    v_cvt_pk_bf16_f32 v135, v102, v103
    v_mfma_f32_16x16x32_bf16 a[68:71], a[224:227], v[164:167], a[68:71]
    v_exp_f32 v104, v104
    v_mfma_f32_16x16x32_bf16 a[68:71], a[228:231], v[180:183], a[68:71]
    ds_read_b128 a[200:203], v208 offset:12416
    v_add_f32 v228, v228, v104
    v_mfma_f32_16x16x32_bf16 a[72:75], a[224:227], v[168:171], a[72:75]
    buffer_load_dwordx4 v223, s[8:11], s27 offen offset:0  lds
    v_mfma_f32_16x16x32_bf16 a[72:75], a[228:231], v[184:187], a[72:75]
    v_exp_f32 v105, v105
    v_mfma_f32_16x16x32_bf16 a[76:79], a[224:227], v[172:175], a[76:79]
    ds_read_b128 a[204:207], v209 offset:12416
    v_add_f32 v228, v228, v105
    v_mfma_f32_16x16x32_bf16 a[76:79], a[228:231], v[188:191], a[76:79]
    ds_read_b128 a[208:211], v208 offset:12544
    v_cvt_pk_bf16_f32 v138, v104, v105
    v_mfma_f32_16x16x32_bf16 a[80:83], a[232:235], v[160:163], a[80:83]
    v_exp_f32 v106, v106
    v_mfma_f32_16x16x32_bf16 a[80:83], a[236:239], v[176:179], a[80:83]
    ds_read_b128 a[212:215], v209 offset:12544
    v_add_f32 v228, v228, v106
    v_mfma_f32_16x16x32_bf16 a[84:87], a[232:235], v[164:167], a[84:87]
    buffer_load_dwordx4 v224, s[8:11], s27 offen offset:1024  lds
    v_mfma_f32_16x16x32_bf16 a[84:87], a[236:239], v[180:183], a[84:87]
    v_exp_f32 v107, v107
    v_mfma_f32_16x16x32_bf16 a[88:91], a[232:235], v[168:171], a[88:91]
    v_add_f32 v228, v228, v107
    v_mfma_f32_16x16x32_bf16 a[88:91], a[236:239], v[184:187], a[88:91]
    v_cvt_pk_bf16_f32 v139, v106, v107
    v_mfma_f32_16x16x32_bf16 a[92:95], a[232:235], v[172:175], a[92:95]
    v_exp_f32 v108, v108
    v_mfma_f32_16x16x32_bf16 a[92:95], a[236:239], v[188:191], a[92:95]
    v_add_f32 v229, v229, v108
    s_waitcnt lgkmcnt(0)
    v_mfma_f32_16x16x32_bf16 v[96:99], a[192:195], v[0:3], v[192:195]
    buffer_load_dwordx4 v225, s[8:11], s27 offen offset:2048  lds
    v_mfma_f32_16x16x32_bf16 v[96:99], a[196:199], v[16:19], v[96:99]
    v_exp_f32 v109, v109
    v_mfma_f32_16x16x32_bf16 v[96:99], a[200:203], v[32:35], v[96:99]
    ds_read_b64_tr_b16 a[216:217], v212 offset:128
    v_add_f32 v229, v229, v109
    v_mfma_f32_16x16x32_bf16 v[96:99], a[204:207], v[48:51], v[96:99]
    ds_read_b64_tr_b16 a[218:219], v212 offset:6272
    v_cvt_pk_bf16_f32 v142, v108, v109
    v_mfma_f32_16x16x32_bf16 v[96:99], a[208:211], v[64:67], v[96:99]
    v_exp_f32 v110, v110
    v_mfma_f32_16x16x32_bf16 v[96:99], a[212:215], v[80:83], v[96:99]
    ds_read_b64_tr_b16 a[220:221], v212 offset:12416
    v_add_f32 v229, v229, v110
    v_mfma_f32_16x16x32_bf16 v[100:103], a[192:195], v[4:7], v[196:199]
    s_add_u32 s27, s27, 12288
    s_add_u32 m0, s47, 12288
    v_mfma_f32_16x16x32_bf16 v[100:103], a[196:199], v[20:23], v[100:103]
    v_exp_f32 v111, v111
    v_mfma_f32_16x16x32_bf16 v[100:103], a[200:203], v[36:39], v[100:103]
    ds_read_b64_tr_b16 a[222:223], v212 offset:18560
    v_add_f32 v229, v229, v111
    v_mfma_f32_16x16x32_bf16 v[100:103], a[204:207], v[52:55], v[100:103]
    ds_read_b64_tr_b16 a[224:225], v213 offset:128
    v_cvt_pk_bf16_f32 v143, v110, v111
    v_mfma_f32_16x16x32_bf16 v[100:103], a[208:211], v[68:71], v[100:103]
    v_exp_f32 v96, v96
    v_mfma_f32_16x16x32_bf16 v[100:103], a[212:215], v[84:87], v[100:103]
    ds_read_b64_tr_b16 a[226:227], v213 offset:6272
    v_add_f32 v226, v226, v96
    v_mfma_f32_16x16x32_bf16 v[104:107], a[192:195], v[8:11], v[200:203]
    buffer_load_dwordx4 v223, s[8:11], s27 offen offset:0  lds
    v_mfma_f32_16x16x32_bf16 v[104:107], a[196:199], v[24:27], v[104:107]
    v_exp_f32 v97, v97
    v_mfma_f32_16x16x32_bf16 v[104:107], a[200:203], v[40:43], v[104:107]
    ds_read_b64_tr_b16 a[228:229], v213 offset:12416
    v_add_f32 v226, v226, v97
    v_mfma_f32_16x16x32_bf16 v[104:107], a[204:207], v[56:59], v[104:107]
    ds_read_b64_tr_b16 a[230:231], v213 offset:18560
    v_cvt_pk_bf16_f32 v144, v96, v97
    v_mfma_f32_16x16x32_bf16 v[104:107], a[208:211], v[72:75], v[104:107]
    v_exp_f32 v98, v98
    v_mfma_f32_16x16x32_bf16 v[104:107], a[212:215], v[88:91], v[104:107]
    ds_read_b64_tr_b16 a[232:233], v210 offset:256
    v_add_f32 v226, v226, v98
    v_mfma_f32_16x16x32_bf16 v[108:111], a[192:195], v[12:15], v[204:207]
    s_waitcnt lgkmcnt(5)
    v_mfma_f32_16x16x32_bf16 v[108:111], a[196:199], v[28:31], v[108:111]
    v_exp_f32 v99, v99
    v_mfma_f32_16x16x32_bf16 v[108:111], a[200:203], v[44:47], v[108:111]
    ds_read_b64_tr_b16 a[234:235], v210 offset:6400
    v_add_f32 v226, v226, v99
    v_mfma_f32_16x16x32_bf16 v[108:111], a[204:207], v[60:63], v[108:111]
    ds_read_b64_tr_b16 a[236:237], v210 offset:12544
    v_cvt_pk_bf16_f32 v145, v98, v99
    v_mfma_f32_16x16x32_bf16 v[108:111], a[208:211], v[76:79], v[108:111]
    v_exp_f32 v100, v100
    v_mfma_f32_16x16x32_bf16 v[108:111], a[212:215], v[92:95], v[108:111]
    ds_read_b64_tr_b16 a[238:239], v210 offset:18688
    v_add_f32 v227, v227, v100
    v_mfma_f32_16x16x32_bf16 a[96:99], a[216:219], v[160:163], a[96:99]
    buffer_load_dwordx4 v224, s[8:11], s27 offen offset:1024  lds
    v_mfma_f32_16x16x32_bf16 a[96:99], a[220:223], v[176:179], a[96:99]
    v_exp_f32 v101, v101
    v_mfma_f32_16x16x32_bf16 a[100:103], a[216:219], v[164:167], a[100:103]
    v_add_f32 v227, v227, v101
    s_add_u32 s61, s61, s49
    v_mfma_f32_16x16x32_bf16 a[100:103], a[220:223], v[180:183], a[100:103]
    v_cvt_pk_bf16_f32 v148, v100, v101
    v_mfma_f32_16x16x32_bf16 a[104:107], a[216:219], v[168:171], a[104:107]
    v_exp_f32 v102, v102
    v_mfma_f32_16x16x32_bf16 a[104:107], a[220:223], v[184:187], a[104:107]
    v_add_f32 v227, v227, v102
    v_mfma_f32_16x16x32_bf16 a[108:111], a[216:219], v[172:175], a[108:111]
    s_waitcnt lgkmcnt(0)
    v_mfma_f32_16x16x32_bf16 a[108:111], a[220:223], v[188:191], a[108:111]
    v_exp_f32 v103, v103
    v_mfma_f32_16x16x32_bf16 a[112:115], a[224:227], v[160:163], a[112:115]
    ds_read_b128 a[192:195], v208 offset:18432
    v_add_f32 v227, v227, v103
    v_mfma_f32_16x16x32_bf16 a[112:115], a[228:231], v[176:179], a[112:115]
    ds_read_b128 a[196:199], v209 offset:18432
    v_cvt_pk_bf16_f32 v149, v102, v103
    v_mfma_f32_16x16x32_bf16 a[116:119], a[224:227], v[164:167], a[116:119]
    v_exp_f32 v104, v104
    v_mfma_f32_16x16x32_bf16 a[116:119], a[228:231], v[180:183], a[116:119]
    ds_read_b128 a[200:203], v208 offset:18560
    v_add_f32 v228, v228, v104
    v_mfma_f32_16x16x32_bf16 a[120:123], a[224:227], v[168:171], a[120:123]
    buffer_load_dwordx4 v225, s[8:11], s27 offen offset:2048  lds
    v_mfma_f32_16x16x32_bf16 a[120:123], a[228:231], v[184:187], a[120:123]
    v_exp_f32 v105, v105
    v_mfma_f32_16x16x32_bf16 a[124:127], a[224:227], v[172:175], a[124:127]
    ds_read_b128 a[204:207], v209 offset:18560
    v_add_f32 v228, v228, v105
    v_mfma_f32_16x16x32_bf16 a[124:127], a[228:231], v[188:191], a[124:127]
    ds_read_b128 a[208:211], v208 offset:18688
    v_cvt_pk_bf16_f32 v152, v104, v105
    v_mfma_f32_16x16x32_bf16 a[128:131], a[232:235], v[160:163], a[128:131]
    v_exp_f32 v106, v106
    v_mfma_f32_16x16x32_bf16 a[128:131], a[236:239], v[176:179], a[128:131]
    ds_read_b128 a[212:215], v209 offset:18688
    v_add_f32 v228, v228, v106
    v_mfma_f32_16x16x32_bf16 a[132:135], a[232:235], v[164:167], a[132:135]
    s_cmp_eq_u32 s62, 1
    s_cbranch_scc1 L_attn_inv
L_attn_invback:
    v_mfma_f32_16x16x32_bf16 a[132:135], a[236:239], v[180:183], a[132:135]
    v_exp_f32 v107, v107
    v_mfma_f32_16x16x32_bf16 a[136:139], a[232:235], v[168:171], a[136:139]
    v_add_f32 v228, v228, v107
    s_add_u32 s45, s44, s25
    v_mfma_f32_16x16x32_bf16 a[136:139], a[236:239], v[184:187], a[136:139]
    v_cvt_pk_bf16_f32 v153, v106, v107
    s_add_u32 s44, s44, 24576
    v_mfma_f32_16x16x32_bf16 a[140:143], a[232:235], v[172:175], a[140:143]
    v_exp_f32 v108, v108
    v_mfma_f32_16x16x32_bf16 a[140:143], a[236:239], v[188:191], a[140:143]
    v_add_f32 v229, v229, v108
    s_waitcnt lgkmcnt(0)
    v_mfma_f32_16x16x32_bf16 v[96:99], a[192:195], v[0:3], v[192:195]
    s_cmp_eq_u32 s44, 73728
    s_cmov_b32 s44, 0
    v_mfma_f32_16x16x32_bf16 v[96:99], a[196:199], v[16:19], v[96:99]
    v_exp_f32 v109, v109
    v_mfma_f32_16x16x32_bf16 v[96:99], a[200:203], v[32:35], v[96:99]
    ds_read_b64_tr_b16 a[216:217], v211 offset:256
    v_add_f32 v229, v229, v109
    v_mfma_f32_16x16x32_bf16 v[96:99], a[204:207], v[48:51], v[96:99]
    ds_read_b64_tr_b16 a[218:219], v211 offset:6400
    v_cvt_pk_bf16_f32 v156, v108, v109
    v_mfma_f32_16x16x32_bf16 v[96:99], a[208:211], v[64:67], v[96:99]
    v_exp_f32 v110, v110
    v_mfma_f32_16x16x32_bf16 v[96:99], a[212:215], v[80:83], v[96:99]
    ds_read_b64_tr_b16 a[220:221], v211 offset:12544
    v_add_f32 v229, v229, v110
    v_mfma_f32_16x16x32_bf16 v[100:103], a[192:195], v[4:7], v[196:199]
    s_add_u32 s27, s27, 12288
    v_mfma_f32_16x16x32_bf16 v[100:103], a[196:199], v[20:23], v[100:103]
    v_exp_f32 v111, v111
    v_mfma_f32_16x16x32_bf16 v[100:103], a[200:203], v[36:39], v[100:103]
    ds_read_b64_tr_b16 a[222:223], v211 offset:18688
    v_add_f32 v229, v229, v111
    v_mfma_f32_16x16x32_bf16 v[100:103], a[204:207], v[52:55], v[100:103]
    ds_read_b64_tr_b16 a[224:225], v212 offset:256
    v_cvt_pk_bf16_f32 v157, v110, v111
    v_mfma_f32_16x16x32_bf16 v[100:103], a[208:211], v[68:71], v[100:103]
    v_exp_f32 v96, v96
    v_mfma_f32_16x16x32_bf16 v[100:103], a[212:215], v[84:87], v[100:103]
    ds_read_b64_tr_b16 a[226:227], v212 offset:6400
    v_add_f32 v226, v226, v96
    v_mfma_f32_16x16x32_bf16 v[104:107], a[192:195], v[8:11], v[200:203]
    v_mfma_f32_16x16x32_bf16 v[104:107], a[196:199], v[24:27], v[104:107]
    v_exp_f32 v97, v97
    v_mfma_f32_16x16x32_bf16 v[104:107], a[200:203], v[40:43], v[104:107]
    ds_read_b64_tr_b16 a[228:229], v212 offset:12544
    v_add_f32 v226, v226, v97
    v_mfma_f32_16x16x32_bf16 v[104:107], a[204:207], v[56:59], v[104:107]
    ds_read_b64_tr_b16 a[230:231], v212 offset:18688
    v_cvt_pk_bf16_f32 v146, v96, v97
    v_mfma_f32_16x16x32_bf16 v[104:107], a[208:211], v[72:75], v[104:107]
    v_exp_f32 v98, v98
    v_mfma_f32_16x16x32_bf16 v[104:107], a[212:215], v[88:91], v[104:107]
    ds_read_b64_tr_b16 a[232:233], v213 offset:256
    v_add_f32 v226, v226, v98
    v_mfma_f32_16x16x32_bf16 v[108:111], a[192:195], v[12:15], v[204:207]
    s_waitcnt lgkmcnt(5)
    v_add_u32 v208, s44, v214
    v_mfma_f32_16x16x32_bf16 v[108:111], a[196:199], v[28:31], v[108:111]
    v_exp_f32 v99, v99
    v_mfma_f32_16x16x32_bf16 v[108:111], a[200:203], v[44:47], v[108:111]
    ds_read_b64_tr_b16 a[234:235], v213 offset:6400
    v_add_f32 v226, v226, v99
    v_mfma_f32_16x16x32_bf16 v[108:111], a[204:207], v[60:63], v[108:111]
    ds_read_b64_tr_b16 a[236:237], v213 offset:12544
    v_cvt_pk_bf16_f32 v147, v98, v99
    v_mfma_f32_16x16x32_bf16 v[108:111], a[208:211], v[76:79], v[108:111]
    v_exp_f32 v100, v100
    v_mfma_f32_16x16x32_bf16 v[108:111], a[212:215], v[92:95], v[108:111]
    ds_read_b64_tr_b16 a[238:239], v213 offset:18688
    v_add_f32 v227, v227, v100
    v_mfma_f32_16x16x32_bf16 a[144:147], a[216:219], v[160:163], a[144:147]
    v_mfma_f32_16x16x32_bf16 a[144:147], a[220:223], v[176:179], a[144:147]
    v_exp_f32 v101, v101
    v_mfma_f32_16x16x32_bf16 a[148:151], a[216:219], v[164:167], a[148:151]
    v_add_f32 v227, v227, v101
    v_add_u32 v209, s44, v215
    v_mfma_f32_16x16x32_bf16 a[148:151], a[220:223], v[180:183], a[148:151]
    v_cvt_pk_bf16_f32 v150, v100, v101
    s_add_u32 s47, s46, s25
    v_mfma_f32_16x16x32_bf16 a[152:155], a[216:219], v[168:171], a[152:155]
    v_exp_f32 v102, v102
    v_mfma_f32_16x16x32_bf16 a[152:155], a[220:223], v[184:187], a[152:155]
    v_add_f32 v227, v227, v102
    s_add_u32 s46, s46, 24576
    v_mfma_f32_16x16x32_bf16 a[156:159], a[216:219], v[172:175], a[156:159]
    s_waitcnt vmcnt(13) lgkmcnt(0)
    s_barrier
    v_mfma_f32_16x16x32_bf16 a[156:159], a[220:223], v[188:191], a[156:159]
    v_exp_f32 v103, v103
    v_mfma_f32_16x16x32_bf16 a[160:163], a[224:227], v[160:163], a[160:163]
    ds_read_b128 a[192:195], v208 offset:0
    v_add_f32 v227, v227, v103
    v_mfma_f32_16x16x32_bf16 a[160:163], a[228:231], v[176:179], a[160:163]
    ds_read_b128 a[196:199], v209 offset:0
    v_cvt_pk_bf16_f32 v151, v102, v103
    v_mfma_f32_16x16x32_bf16 a[164:167], a[224:227], v[164:167], a[164:167]
    v_exp_f32 v104, v104
    v_mfma_f32_16x16x32_bf16 a[164:167], a[228:231], v[180:183], a[164:167]
    ds_read_b128 a[200:203], v208 offset:128
    v_add_f32 v228, v228, v104
    v_mfma_f32_16x16x32_bf16 a[168:171], a[224:227], v[168:171], a[168:171]
    s_cmp_eq_u32 s46, 147456
    s_cmov_b32 s46, 73728
    v_mfma_f32_16x16x32_bf16 a[168:171], a[228:231], v[184:187], a[168:171]
    v_exp_f32 v105, v105
    v_mfma_f32_16x16x32_bf16 a[172:175], a[224:227], v[172:175], a[172:175]
    ds_read_b128 a[204:207], v209 offset:128
    v_add_f32 v228, v228, v105
    v_mfma_f32_16x16x32_bf16 a[172:175], a[228:231], v[188:191], a[172:175]
    ds_read_b128 a[208:211], v208 offset:256
    v_cvt_pk_bf16_f32 v154, v104, v105
    v_mfma_f32_16x16x32_bf16 a[176:179], a[232:235], v[160:163], a[176:179]
    v_exp_f32 v106, v106
    v_mfma_f32_16x16x32_bf16 a[176:179], a[236:239], v[176:179], a[176:179]
    ds_read_b128 a[212:215], v209 offset:256
    v_add_f32 v228, v228, v106
    v_mfma_f32_16x16x32_bf16 a[180:183], a[232:235], v[164:167], a[180:183]
    buffer_store_dwordx4 a[240:243], v234, s[56:59], s61 offen sc1
    v_mfma_f32_16x16x32_bf16 a[180:183], a[236:239], v[180:183], a[180:183]
    v_exp_f32 v107, v107
    v_mfma_f32_16x16x32_bf16 a[184:187], a[232:235], v[168:171], a[184:187]
    v_add_f32 v228, v228, v107
    v_add_u32 v210, s46, v216
    v_mfma_f32_16x16x32_bf16 a[184:187], a[236:239], v[184:187], a[184:187]
    v_cvt_pk_bf16_f32 v155, v106, v107
    v_add_u32 v211, s46, v217
    v_mfma_f32_16x16x32_bf16 a[188:191], a[232:235], v[172:175], a[188:191]
    v_exp_f32 v108, v108
    v_mfma_f32_16x16x32_bf16 a[188:191], a[236:239], v[188:191], a[188:191]
    v_add_f32 v229, v229, v108
    s_waitcnt lgkmcnt(0)
    v_mfma_f32_16x16x32_bf16 v[96:99], a[192:195], v[0:3], v[192:195]
    v_add_u32 v212, s46, v218
    v_add_u32 v213, s46, v219
    v_mfma_f32_16x16x32_bf16 v[96:99], a[196:199], v[16:19], v[96:99]
    v_exp_f32 v109, v109
    v_mfma_f32_16x16x32_bf16 v[96:99], a[200:203], v[32:35], v[96:99]
    ds_read_b64_tr_b16 a[216:217], v210 offset:0
    v_add_f32 v229, v229, v109
    v_mfma_f32_16x16x32_bf16 v[96:99], a[204:207], v[48:51], v[96:99]
    ds_read_b64_tr_b16 a[218:219], v210 offset:6144
    v_cvt_pk_bf16_f32 v158, v108, v109
    v_mfma_f32_16x16x32_bf16 v[96:99], a[208:211], v[64:67], v[96:99]
    v_exp_f32 v110, v110
    v_mfma_f32_16x16x32_bf16 v[96:99], a[212:215], v[80:83], v[96:99]
    ds_read_b64_tr_b16 a[220:221], v210 offset:12288
    v_add_f32 v229, v229, v110
    v_mfma_f32_16x16x32_bf16 v[100:103], a[192:195], v[4:7], v[196:199]
    s_add_u32 m0, s45, 0
    v_mfma_f32_16x16x32_bf16 v[100:103], a[196:199], v[20:23], v[100:103]
    v_exp_f32 v111, v111
    v_mfma_f32_16x16x32_bf16 v[100:103], a[200:203], v[36:39], v[100:103]
    ds_read_b64_tr_b16 a[222:223], v210 offset:18432
    v_add_f32 v229, v229, v111
    v_mfma_f32_16x16x32_bf16 v[100:103], a[204:207], v[52:55], v[100:103]
    ds_read_b64_tr_b16 a[224:225], v211 offset:0
    v_cvt_pk_bf16_f32 v159, v110, v111
    v_mfma_f32_16x16x32_bf16 v[100:103], a[208:211], v[68:71], v[100:103]
    v_exp_f32 v96, v96
    v_mfma_f32_16x16x32_bf16 v[100:103], a[212:215], v[84:87], v[100:103]
    ds_read_b64_tr_b16 a[226:227], v211 offset:6144
    v_add_f32 v226, v226, v96
    v_mfma_f32_16x16x32_bf16 v[104:107], a[192:195], v[8:11], v[200:203]
    buffer_load_dwordx4 v220, s[4:7], s26 offen offset:0  lds
    v_mfma_f32_16x16x32_bf16 v[104:107], a[196:199], v[24:27], v[104:107]
    v_exp_f32 v97, v97
    v_mfma_f32_16x16x32_bf16 v[104:107], a[200:203], v[40:43], v[104:107]
    ds_read_b64_tr_b16 a[228:229], v211 offset:12288
    v_add_f32 v226, v226, v97
    v_mfma_f32_16x16x32_bf16 v[104:107], a[204:207], v[56:59], v[104:107]
    ds_read_b64_tr_b16 a[230:231], v211 offset:18432
    v_cvt_pk_bf16_f32 v160, v96, v97
    v_mfma_f32_16x16x32_bf16 v[104:107], a[208:211], v[72:75], v[104:107]
    v_exp_f32 v98, v98
    v_mfma_f32_16x16x32_bf16 v[104:107], a[212:215], v[88:91], v[104:107]
    ds_read_b64_tr_b16 a[232:233], v212 offset:0
    v_add_f32 v226, v226, v98
    v_mfma_f32_16x16x32_bf16 v[108:111], a[192:195], v[12:15], v[204:207]
    s_waitcnt lgkmcnt(5)
    v_mfma_f32_16x16x32_bf16 v[108:111], a[196:199], v[28:31], v[108:111]
    v_exp_f32 v99, v99
    v_mfma_f32_16x16x32_bf16 v[108:111], a[200:203], v[44:47], v[108:111]
    ds_read_b64_tr_b16 a[234:235], v212 offset:6144
    v_add_f32 v226, v226, v99
    v_mfma_f32_16x16x32_bf16 v[108:111], a[204:207], v[60:63], v[108:111]
    ds_read_b64_tr_b16 a[236:237], v212 offset:12288
    v_cvt_pk_bf16_f32 v161, v98, v99
    v_mfma_f32_16x16x32_bf16 v[108:111], a[208:211], v[76:79], v[108:111]
    v_exp_f32 v100, v100
    v_mfma_f32_16x16x32_bf16 v[108:111], a[212:215], v[92:95], v[108:111]
    ds_read_b64_tr_b16 a[238:239], v212 offset:18432
    v_add_f32 v227, v227, v100
    v_mfma_f32_16x16x32_bf16 a[0:3], a[216:219], v[128:131], a[0:3]
    buffer_load_dwordx4 v221, s[4:7], s26 offen offset:1024  lds
    v_mfma_f32_16x16x32_bf16 a[0:3], a[220:223], v[144:147], a[0:3]
    v_exp_f32 v101, v101
    v_mfma_f32_16x16x32_bf16 a[4:7], a[216:219], v[132:135], a[4:7]
    v_add_f32 v227, v227, v101
    v_mfma_f32_16x16x32_bf16 a[4:7], a[220:223], v[148:151], a[4:7]
    v_cvt_pk_bf16_f32 v164, v100, v101
    v_mfma_f32_16x16x32_bf16 a[8:11], a[216:219], v[136:139], a[8:11]
    v_exp_f32 v102, v102
    v_mfma_f32_16x16x32_bf16 a[8:11], a[220:223], v[152:155], a[8:11]
    v_add_f32 v227, v227, v102
    v_mfma_f32_16x16x32_bf16 a[12:15], a[216:219], v[140:143], a[12:15]
    s_waitcnt lgkmcnt(0)
    v_mfma_f32_16x16x32_bf16 a[12:15], a[220:223], v[156:159], a[12:15]
    v_exp_f32 v103, v103
    v_mfma_f32_16x16x32_bf16 a[16:19], a[224:227], v[128:131], a[16:19]
    ds_read_b128 a[192:195], v208 offset:6144
    v_add_f32 v227, v227, v103
    v_mfma_f32_16x16x32_bf16 a[16:19], a[228:231], v[144:147], a[16:19]
    ds_read_b128 a[196:199], v209 offset:6144
    v_cvt_pk_bf16_f32 v165, v102, v103
    v_mfma_f32_16x16x32_bf16 a[20:23], a[224:227], v[132:135], a[20:23]
    v_exp_f32 v104, v104
    v_mfma_f32_16x16x32_bf16 a[20:23], a[228:231], v[148:151], a[20:23]
    ds_read_b128 a[200:203], v208 offset:6272
    v_add_f32 v228, v228, v104
    v_mfma_f32_16x16x32_bf16 a[24:27], a[224:227], v[136:139], a[24:27]
    buffer_load_dwordx4 v222, s[4:7], s26 offen offset:2048  lds
    v_mfma_f32_16x16x32_bf16 a[24:27], a[228:231], v[152:155], a[24:27]
    v_exp_f32 v105, v105
    v_mfma_f32_16x16x32_bf16 a[28:31], a[224:227], v[140:143], a[28:31]
    ds_read_b128 a[204:207], v209 offset:6272
    v_add_f32 v228, v228, v105
    v_mfma_f32_16x16x32_bf16 a[28:31], a[228:231], v[156:159], a[28:31]
    ds_read_b128 a[208:211], v208 offset:6400
    v_cvt_pk_bf16_f32 v168, v104, v105
    v_mfma_f32_16x16x32_bf16 a[32:35], a[232:235], v[128:131], a[32:35]
    v_exp_f32 v106, v106
    v_mfma_f32_16x16x32_bf16 a[32:35], a[236:239], v[144:147], a[32:35]
    ds_read_b128 a[212:215], v209 offset:6400
    v_add_f32 v228, v228, v106
    v_mfma_f32_16x16x32_bf16 a[36:39], a[232:235], v[132:135], a[36:39]
    buffer_load_dwordx4 a[240:243], v255, s[40:43], s60 offen
    v_mfma_f32_16x16x32_bf16 a[36:39], a[236:239], v[148:151], a[36:39]
    v_exp_f32 v107, v107
    v_mfma_f32_16x16x32_bf16 a[40:43], a[232:235], v[136:139], a[40:43]
    v_add_f32 v228, v228, v107
    s_add_u32 s26, s26, 12288
    v_mfma_f32_16x16x32_bf16 a[40:43], a[236:239], v[152:155], a[40:43]
    v_cvt_pk_bf16_f32 v169, v106, v107
    s_add_u32 m0, s45, 12288
    v_mfma_f32_16x16x32_bf16 a[44:47], a[232:235], v[140:143], a[44:47]
    v_exp_f32 v108, v108
    v_mfma_f32_16x16x32_bf16 a[44:47], a[236:239], v[156:159], a[44:47]
    v_add_f32 v229, v229, v108
    s_waitcnt lgkmcnt(0)
    v_mfma_f32_16x16x32_bf16 v[96:99], a[192:195], v[0:3], v[192:195]
    buffer_load_dwordx4 v220, s[4:7], s26 offen offset:0  lds
    v_mfma_f32_16x16x32_bf16 v[96:99], a[196:199], v[16:19], v[96:99]
    v_exp_f32 v109, v109
    v_mfma_f32_16x16x32_bf16 v[96:99], a[200:203], v[32:35], v[96:99]
    ds_read_b64_tr_b16 a[216:217], v213 offset:0
    v_add_f32 v229, v229, v109
    v_mfma_f32_16x16x32_bf16 v[96:99], a[204:207], v[48:51], v[96:99]
    ds_read_b64_tr_b16 a[218:219], v213 offset:6144
    v_cvt_pk_bf16_f32 v172, v108, v109
    v_mfma_f32_16x16x32_bf16 v[96:99], a[208:211], v[64:67], v[96:99]
    v_exp_f32 v110, v110
    v_mfma_f32_16x16x32_bf16 v[96:99], a[212:215], v[80:83], v[96:99]
    ds_read_b64_tr_b16 a[220:221], v213 offset:12288
    v_add_f32 v229, v229, v110
    v_mfma_f32_16x16x32_bf16 v[100:103], a[192:195], v[4:7], v[196:199]
    buffer_load_dwordx4 v221, s[4:7], s26 offen offset:1024  lds
    v_mfma_f32_16x16x32_bf16 v[100:103], a[196:199], v[20:23], v[100:103]
    v_exp_f32 v111, v111
    v_mfma_f32_16x16x32_bf16 v[100:103], a[200:203], v[36:39], v[100:103]
    ds_read_b64_tr_b16 a[222:223], v213 offset:18432
    v_add_f32 v229, v229, v111
    v_mfma_f32_16x16x32_bf16 v[100:103], a[204:207], v[52:55], v[100:103]
    ds_read_b64_tr_b16 a[224:225], v210 offset:128
    v_cvt_pk_bf16_f32 v173, v110, v111
    v_mfma_f32_16x16x32_bf16 v[100:103], a[208:211], v[68:71], v[100:103]
    v_exp_f32 v96, v96
    v_mfma_f32_16x16x32_bf16 v[100:103], a[212:215], v[84:87], v[100:103]
    ds_read_b64_tr_b16 a[226:227], v210 offset:6272
    v_add_f32 v226, v226, v96
    v_mfma_f32_16x16x32_bf16 v[104:107], a[192:195], v[8:11], v[200:203]
    buffer_load_dwordx4 v222, s[4:7], s26 offen offset:2048  lds
    v_mfma_f32_16x16x32_bf16 v[104:107], a[196:199], v[24:27], v[104:107]
    v_exp_f32 v97, v97
    v_mfma_f32_16x16x32_bf16 v[104:107], a[200:203], v[40:43], v[104:107]
    ds_read_b64_tr_b16 a[228:229], v210 offset:12416
    v_add_f32 v226, v226, v97
    v_mfma_f32_16x16x32_bf16 v[104:107], a[204:207], v[56:59], v[104:107]
    ds_read_b64_tr_b16 a[230:231], v210 offset:18560
    v_cvt_pk_bf16_f32 v162, v96, v97
    v_mfma_f32_16x16x32_bf16 v[104:107], a[208:211], v[72:75], v[104:107]
    v_exp_f32 v98, v98
    v_mfma_f32_16x16x32_bf16 v[104:107], a[212:215], v[88:91], v[104:107]
    ds_read_b64_tr_b16 a[232:233], v211 offset:128
    v_add_f32 v226, v226, v98
    v_mfma_f32_16x16x32_bf16 v[108:111], a[192:195], v[12:15], v[204:207]
    s_waitcnt lgkmcnt(5)
    s_add_u32 s26, s26, 12288
    v_mfma_f32_16x16x32_bf16 v[108:111], a[196:199], v[28:31], v[108:111]
    v_exp_f32 v99, v99
    v_mfma_f32_16x16x32_bf16 v[108:111], a[200:203], v[44:47], v[108:111]
    ds_read_b64_tr_b16 a[234:235], v211 offset:6272
    v_add_f32 v226, v226, v99
    v_mfma_f32_16x16x32_bf16 v[108:111], a[204:207], v[60:63], v[108:111]
    ds_read_b64_tr_b16 a[236:237], v211 offset:12416
    v_cvt_pk_bf16_f32 v163, v98, v99
    v_mfma_f32_16x16x32_bf16 v[108:111], a[208:211], v[76:79], v[108:111]
    v_exp_f32 v100, v100
    v_mfma_f32_16x16x32_bf16 v[108:111], a[212:215], v[92:95], v[108:111]
    ds_read_b64_tr_b16 a[238:239], v211 offset:18560
    v_add_f32 v227, v227, v100
    v_mfma_f32_16x16x32_bf16 a[48:51], a[216:219], v[128:131], a[48:51]
    v_mfma_f32_16x16x32_bf16 a[48:51], a[220:223], v[144:147], a[48:51]
    v_exp_f32 v101, v101
    v_mfma_f32_16x16x32_bf16 a[52:55], a[216:219], v[132:135], a[52:55]
    v_add_f32 v227, v227, v101
    s_add_u32 s60, s60, s48
    v_mfma_f32_16x16x32_bf16 a[52:55], a[220:223], v[148:151], a[52:55]
    v_cvt_pk_bf16_f32 v166, v100, v101
    s_add_u32 m0, s47, 0
    v_mfma_f32_16x16x32_bf16 a[56:59], a[216:219], v[136:139], a[56:59]
    v_exp_f32 v102, v102
    v_mfma_f32_16x16x32_bf16 a[56:59], a[220:223], v[152:155], a[56:59]
    v_add_f32 v227, v227, v102
    v_mfma_f32_16x16x32_bf16 a[60:63], a[216:219], v[140:143], a[60:63]
    s_waitcnt lgkmcnt(0)
    v_mfma_f32_16x16x32_bf16 a[60:63], a[220:223], v[156:159], a[60:63]
    v_exp_f32 v103, v103
    v_mfma_f32_16x16x32_bf16 a[64:67], a[224:227], v[128:131], a[64:67]
    ds_read_b128 a[192:195], v208 offset:12288
    v_add_f32 v227, v227, v103
    v_mfma_f32_16x16x32_bf16 a[64:67], a[228:231], v[144:147], a[64:67]
    ds_read_b128 a[196:199], v209 offset:12288
    v_cvt_pk_bf16_f32 v167, v102, v103
    v_mfma_f32_16x16x32_bf16 a[68:71], a[224:227], v[132:135], a[68:71]
    v_exp_f32 v104, v104
    v_mfma_f32_16x16x32_bf16 a[68:71], a[228:231], v[148:151], a[68:71]
    ds_read_b128 a[200:203], v208 offset:12416
    v_add_f32 v228, v228, v104
    v_mfma_f32_16x16x32_bf16 a[72:75], a[224:227], v[136:139], a[72:75]
    buffer_load_dwordx4 v223, s[8:11], s27 offen offset:0  lds
    v_mfma_f32_16x16x32_bf16 a[72:75], a[228:231], v[152:155], a[72:75]
    v_exp_f32 v105, v105
    v_mfma_f32_16x16x32_bf16 a[76:79], a[224:227], v[140:143], a[76:79]
    ds_read_b128 a[204:207], v209 offset:12416
    v_add_f32 v228, v228, v105
    v_mfma_f32_16x16x32_bf16 a[76:79], a[228:231], v[156:159], a[76:79]
    ds_read_b128 a[208:211], v208 offset:12544
    v_cvt_pk_bf16_f32 v170, v104, v105
    v_mfma_f32_16x16x32_bf16 a[80:83], a[232:235], v[128:131], a[80:83]
    v_exp_f32 v106, v106
    v_mfma_f32_16x16x32_bf16 a[80:83], a[236:239], v[144:147], a[80:83]
    ds_read_b128 a[212:215], v209 offset:12544
    v_add_f32 v228, v228, v106
    v_mfma_f32_16x16x32_bf16 a[84:87], a[232:235], v[132:135], a[84:87]
    buffer_load_dwordx4 v224, s[8:11], s27 offen offset:1024  lds
    v_mfma_f32_16x16x32_bf16 a[84:87], a[236:239], v[148:151], a[84:87]
    v_exp_f32 v107, v107
    v_mfma_f32_16x16x32_bf16 a[88:91], a[232:235], v[136:139], a[88:91]
    v_add_f32 v228, v228, v107
    v_mfma_f32_16x16x32_bf16 a[88:91], a[236:239], v[152:155], a[88:91]
    v_cvt_pk_bf16_f32 v171, v106, v107
    v_mfma_f32_16x16x32_bf16 a[92:95], a[232:235], v[140:143], a[92:95]
    v_exp_f32 v108, v108
    v_mfma_f32_16x16x32_bf16 a[92:95], a[236:239], v[156:159], a[92:95]
    v_add_f32 v229, v229, v108
    s_waitcnt lgkmcnt(0)
    v_mfma_f32_16x16x32_bf16 v[96:99], a[192:195], v[0:3], v[192:195]
    buffer_load_dwordx4 v225, s[8:11], s27 offen offset:2048  lds
    v_mfma_f32_16x16x32_bf16 v[96:99], a[196:199], v[16:19], v[96:99]
    v_exp_f32 v109, v109
    v_mfma_f32_16x16x32_bf16 v[96:99], a[200:203], v[32:35], v[96:99]
    ds_read_b64_tr_b16 a[216:217], v212 offset:128
    v_add_f32 v229, v229, v109
    v_mfma_f32_16x16x32_bf16 v[96:99], a[204:207], v[48:51], v[96:99]
    ds_read_b64_tr_b16 a[218:219], v212 offset:6272
    v_cvt_pk_bf16_f32 v174, v108, v109
    v_mfma_f32_16x16x32_bf16 v[96:99], a[208:211], v[64:67], v[96:99]
    v_exp_f32 v110, v110
    v_mfma_f32_16x16x32_bf16 v[96:99], a[212:215], v[80:83], v[96:99]
    ds_read_b64_tr_b16 a[220:221], v212 offset:12416
    v_add_f32 v229, v229, v110
    v_mfma_f32_16x16x32_bf16 v[100:103], a[192:195], v[4:7], v[196:199]
    s_add_u32 s27, s27, 12288
    s_add_u32 m0, s47, 12288
    v_mfma_f32_16x16x32_bf16 v[100:103], a[196:199], v[20:23], v[100:103]
    v_exp_f32 v111, v111
    v_mfma_f32_16x16x32_bf16 v[100:103], a[200:203], v[36:39], v[100:103]
    ds_read_b64_tr_b16 a[222:223], v212 offset:18560
    v_add_f32 v229, v229, v111
    v_mfma_f32_16x16x32_bf16 v[100:103], a[204:207], v[52:55], v[100:103]
    ds_read_b64_tr_b16 a[224:225], v213 offset:128
    v_cvt_pk_bf16_f32 v175, v110, v111
    v_mfma_f32_16x16x32_bf16 v[100:103], a[208:211], v[68:71], v[100:103]
    v_exp_f32 v96, v96
    v_mfma_f32_16x16x32_bf16 v[100:103], a[212:215], v[84:87], v[100:103]
    ds_read_b64_tr_b16 a[226:227], v213 offset:6272
    v_add_f32 v226, v226, v96
    v_mfma_f32_16x16x32_bf16 v[104:107], a[192:195], v[8:11], v[200:203]
    buffer_load_dwordx4 v223, s[8:11], s27 offen offset:0  lds
    v_mfma_f32_16x16x32_bf16 v[104:107], a[196:199], v[24:27], v[104:107]
    v_exp_f32 v97, v97
    v_mfma_f32_16x16x32_bf16 v[104:107], a[200:203], v[40:43], v[104:107]
    ds_read_b64_tr_b16 a[228:229], v213 offset:12416
    v_add_f32 v226, v226, v97
    v_mfma_f32_16x16x32_bf16 v[104:107], a[204:207], v[56:59], v[104:107]
    ds_read_b64_tr_b16 a[230:231], v213 offset:18560
    v_cvt_pk_bf16_f32 v176, v96, v97
    v_mfma_f32_16x16x32_bf16 v[104:107], a[208:211], v[72:75], v[104:107]
    v_exp_f32 v98, v98
    v_mfma_f32_16x16x32_bf16 v[104:107], a[212:215], v[88:91], v[104:107]
    ds_read_b64_tr_b16 a[232:233], v210 offset:256
    v_add_f32 v226, v226, v98
    v_mfma_f32_16x16x32_bf16 v[108:111], a[192:195], v[12:15], v[204:207]
    s_waitcnt lgkmcnt(5)
    v_mfma_f32_16x16x32_bf16 v[108:111], a[196:199], v[28:31], v[108:111]
    v_exp_f32 v99, v99
    v_mfma_f32_16x16x32_bf16 v[108:111], a[200:203], v[44:47], v[108:111]
    ds_read_b64_tr_b16 a[234:235], v210 offset:6400
    v_add_f32 v226, v226, v99
    v_mfma_f32_16x16x32_bf16 v[108:111], a[204:207], v[60:63], v[108:111]
    ds_read_b64_tr_b16 a[236:237], v210 offset:12544
    v_cvt_pk_bf16_f32 v177, v98, v99
    v_mfma_f32_16x16x32_bf16 v[108:111], a[208:211], v[76:79], v[108:111]
    v_exp_f32 v100, v100
    v_mfma_f32_16x16x32_bf16 v[108:111], a[212:215], v[92:95], v[108:111]
    ds_read_b64_tr_b16 a[238:239], v210 offset:18688
    v_add_f32 v227, v227, v100
    v_mfma_f32_16x16x32_bf16 a[96:99], a[216:219], v[128:131], a[96:99]
    buffer_load_dwordx4 v224, s[8:11], s27 offen offset:1024  lds
    v_mfma_f32_16x16x32_bf16 a[96:99], a[220:223], v[144:147], a[96:99]
    v_exp_f32 v101, v101
    v_mfma_f32_16x16x32_bf16 a[100:103], a[216:219], v[132:135], a[100:103]
    v_add_f32 v227, v227, v101
    s_add_u32 s61, s61, s49
    v_mfma_f32_16x16x32_bf16 a[100:103], a[220:223], v[148:151], a[100:103]
    v_cvt_pk_bf16_f32 v180, v100, v101
    v_mfma_f32_16x16x32_bf16 a[104:107], a[216:219], v[136:139], a[104:107]
    v_exp_f32 v102, v102
    v_mfma_f32_16x16x32_bf16 a[104:107], a[220:223], v[152:155], a[104:107]
    v_add_f32 v227, v227, v102
    v_mfma_f32_16x16x32_bf16 a[108:111], a[216:219], v[140:143], a[108:111]
    s_waitcnt lgkmcnt(0)
    v_mfma_f32_16x16x32_bf16 a[108:111], a[220:223], v[156:159], a[108:111]
    v_exp_f32 v103, v103
    v_mfma_f32_16x16x32_bf16 a[112:115], a[224:227], v[128:131], a[112:115]
    ds_read_b128 a[192:195], v208 offset:18432
    v_add_f32 v227, v227, v103
    v_mfma_f32_16x16x32_bf16 a[112:115], a[228:231], v[144:147], a[112:115]
    ds_read_b128 a[196:199], v209 offset:18432
    v_cvt_pk_bf16_f32 v181, v102, v103
    v_mfma_f32_16x16x32_bf16 a[116:119], a[224:227], v[132:135], a[116:119]
    v_exp_f32 v104, v104
    v_mfma_f32_16x16x32_bf16 a[116:119], a[228:231], v[148:151], a[116:119]
    ds_read_b128 a[200:203], v208 offset:18560
    v_add_f32 v228, v228, v104
    v_mfma_f32_16x16x32_bf16 a[120:123], a[224:227], v[136:139], a[120:123]
    buffer_load_dwordx4 v225, s[8:11], s27 offen offset:2048  lds
    v_mfma_f32_16x16x32_bf16 a[120:123], a[228:231], v[152:155], a[120:123]
    v_exp_f32 v105, v105
    v_mfma_f32_16x16x32_bf16 a[124:127], a[224:227], v[140:143], a[124:127]
    ds_read_b128 a[204:207], v209 offset:18560
    v_add_f32 v228, v228, v105
    v_mfma_f32_16x16x32_bf16 a[124:127], a[228:231], v[156:159], a[124:127]
    ds_read_b128 a[208:211], v208 offset:18688
    v_cvt_pk_bf16_f32 v184, v104, v105
    v_mfma_f32_16x16x32_bf16 a[128:131], a[232:235], v[128:131], a[128:131]
    v_exp_f32 v106, v106
    v_mfma_f32_16x16x32_bf16 a[128:131], a[236:239], v[144:147], a[128:131]
    ds_read_b128 a[212:215], v209 offset:18688
    v_add_f32 v228, v228, v106
    v_mfma_f32_16x16x32_bf16 a[132:135], a[232:235], v[132:135], a[132:135]
    s_add_u32 s27, s27, 12288
    v_mfma_f32_16x16x32_bf16 a[132:135], a[236:239], v[148:151], a[132:135]
    v_exp_f32 v107, v107
    v_mfma_f32_16x16x32_bf16 a[136:139], a[232:235], v[136:139], a[136:139]
    v_add_f32 v228, v228, v107
    s_add_u32 s45, s44, s25
    v_mfma_f32_16x16x32_bf16 a[136:139], a[236:239], v[152:155], a[136:139]
    v_cvt_pk_bf16_f32 v185, v106, v107
    s_add_u32 s44, s44, 24576
    v_mfma_f32_16x16x32_bf16 a[140:143], a[232:235], v[140:143], a[140:143]
    v_exp_f32 v108, v108
    v_mfma_f32_16x16x32_bf16 a[140:143], a[236:239], v[156:159], a[140:143]
    v_add_f32 v229, v229, v108
    s_waitcnt lgkmcnt(0)
    v_mfma_f32_16x16x32_bf16 v[96:99], a[192:195], v[0:3], v[192:195]
    s_cmp_eq_u32 s44, 73728
    s_cmov_b32 s44, 0
    v_mfma_f32_16x16x32_bf16 v[96:99], a[196:199], v[16:19], v[96:99]
    v_exp_f32 v109, v109
    v_mfma_f32_16x16x32_bf16 v[96:99], a[200:203], v[32:35], v[96:99]
    ds_read_b64_tr_b16 a[216:217], v211 offset:256
    v_add_f32 v229, v229, v109
    v_mfma_f32_16x16x32_bf16 v[96:99], a[204:207], v[48:51], v[96:99]
    ds_read_b64_tr_b16 a[218:219], v211 offset:6400
    v_cvt_pk_bf16_f32 v188, v108, v109
    v_mfma_f32_16x16x32_bf16 v[96:99], a[208:211], v[64:67], v[96:99]
    v_exp_f32 v110, v110
    v_mfma_f32_16x16x32_bf16 v[96:99], a[212:215], v[80:83], v[96:99]
    ds_read_b64_tr_b16 a[220:221], v211 offset:12544
    v_add_f32 v229, v229, v110
    v_mfma_f32_16x16x32_bf16 v[100:103], a[192:195], v[4:7], v[196:199]
    s_sub_u32 s28, s28, 1
    v_add_u32 v208, s44, v214
    v_mfma_f32_16x16x32_bf16 v[100:103], a[196:199], v[20:23], v[100:103]
    v_exp_f32 v111, v111
    v_mfma_f32_16x16x32_bf16 v[100:103], a[200:203], v[36:39], v[100:103]
    ds_read_b64_tr_b16 a[222:223], v211 offset:18688
    v_add_f32 v229, v229, v111
    v_mfma_f32_16x16x32_bf16 v[100:103], a[204:207], v[52:55], v[100:103]
    ds_read_b64_tr_b16 a[224:225], v212 offset:256
    v_cvt_pk_bf16_f32 v189, v110, v111
    v_mfma_f32_16x16x32_bf16 v[100:103], a[208:211], v[68:71], v[100:103]
    v_exp_f32 v96, v96
    v_mfma_f32_16x16x32_bf16 v[100:103], a[212:215], v[84:87], v[100:103]
    ds_read_b64_tr_b16 a[226:227], v212 offset:6400
    v_add_f32 v226, v226, v96
    v_mfma_f32_16x16x32_bf16 v[104:107], a[192:195], v[8:11], v[200:203]
    s_bitcmp1_b32 0x7fe8, s28
    s_cselect_b64 vcc, -1, 0
    v_mfma_f32_16x16x32_bf16 v[104:107], a[196:199], v[24:27], v[104:107]
    v_exp_f32 v97, v97
    v_mfma_f32_16x16x32_bf16 v[104:107], a[200:203], v[40:43], v[104:107]
    ds_read_b64_tr_b16 a[228:229], v212 offset:12544
    v_add_f32 v226, v226, v97
    v_mfma_f32_16x16x32_bf16 v[104:107], a[204:207], v[56:59], v[104:107]
    ds_read_b64_tr_b16 a[230:231], v212 offset:18688
    v_cvt_pk_bf16_f32 v178, v96, v97
    v_mfma_f32_16x16x32_bf16 v[104:107], a[208:211], v[72:75], v[104:107]
    v_exp_f32 v98, v98
    v_mfma_f32_16x16x32_bf16 v[104:107], a[212:215], v[88:91], v[104:107]
    ds_read_b64_tr_b16 a[232:233], v213 offset:256
    v_add_f32 v226, v226, v98
    v_mfma_f32_16x16x32_bf16 v[108:111], a[192:195], v[12:15], v[204:207]
    s_waitcnt lgkmcnt(5)
    v_add_u32 v209, s44, v215
    v_mfma_f32_16x16x32_bf16 v[108:111], a[196:199], v[28:31], v[108:111]
    v_exp_f32 v99, v99
    v_mfma_f32_16x16x32_bf16 v[108:111], a[200:203], v[44:47], v[108:111]
    ds_read_b64_tr_b16 a[234:235], v213 offset:6400
    v_add_f32 v226, v226, v99
    v_mfma_f32_16x16x32_bf16 v[108:111], a[204:207], v[60:63], v[108:111]
    ds_read_b64_tr_b16 a[236:237], v213 offset:12544
    v_cvt_pk_bf16_f32 v179, v98, v99
    v_mfma_f32_16x16x32_bf16 v[108:111], a[208:211], v[76:79], v[108:111]
    v_exp_f32 v100, v100
    v_mfma_f32_16x16x32_bf16 v[108:111], a[212:215], v[92:95], v[108:111]
    ds_read_b64_tr_b16 a[238:239], v213 offset:18688
    v_add_f32 v227, v227, v100
    v_mfma_f32_16x16x32_bf16 a[144:147], a[216:219], v[128:131], a[144:147]
    v_mfma_f32_16x16x32_bf16 a[144:147], a[220:223], v[144:147], a[144:147]
    v_exp_f32 v101, v101
    v_mfma_f32_16x16x32_bf16 a[148:151], a[216:219], v[132:135], a[148:151]
    v_add_f32 v227, v227, v101
    s_add_u32 s47, s46, s25
    v_mfma_f32_16x16x32_bf16 a[148:151], a[220:223], v[148:151], a[148:151]
    v_cvt_pk_bf16_f32 v182, v100, v101
    s_add_u32 s46, s46, 24576
    v_mfma_f32_16x16x32_bf16 a[152:155], a[216:219], v[136:139], a[152:155]
    v_exp_f32 v102, v102
    v_mfma_f32_16x16x32_bf16 a[152:155], a[220:223], v[152:155], a[152:155]
    v_add_f32 v227, v227, v102
    v_mfma_f32_16x16x32_bf16 a[156:159], a[216:219], v[140:143], a[156:159]
    s_waitcnt vmcnt(14) lgkmcnt(0)
    s_barrier
    v_mfma_f32_16x16x32_bf16 a[156:159], a[220:223], v[156:159], a[156:159]
    v_exp_f32 v103, v103
    v_mfma_f32_16x16x32_bf16 a[160:163], a[224:227], v[128:131], a[160:163]
    ds_read_b128 a[192:195], v208 offset:0
    v_add_f32 v227, v227, v103
    v_mfma_f32_16x16x32_bf16 a[160:163], a[228:231], v[144:147], a[160:163]
    ds_read_b128 a[196:199], v209 offset:0
    v_cvt_pk_bf16_f32 v183, v102, v103
    v_mfma_f32_16x16x32_bf16 a[164:167], a[224:227], v[132:135], a[164:167]
    v_exp_f32 v104, v104
    v_mfma_f32_16x16x32_bf16 a[164:167], a[228:231], v[148:151], a[164:167]
    ds_read_b128 a[200:203], v208 offset:128
    v_add_f32 v228, v228, v104
    v_mfma_f32_16x16x32_bf16 a[168:171], a[224:227], v[136:139], a[168:171]
    s_cmp_eq_u32 s46, 147456
    s_cmov_b32 s46, 73728
    v_mfma_f32_16x16x32_bf16 a[168:171], a[228:231], v[152:155], a[168:171]
    v_exp_f32 v105, v105
    v_mfma_f32_16x16x32_bf16 a[172:175], a[224:227], v[140:143], a[172:175]
    ds_read_b128 a[204:207], v209 offset:128
    v_add_f32 v228, v228, v105
    v_mfma_f32_16x16x32_bf16 a[172:175], a[228:231], v[156:159], a[172:175]
    ds_read_b128 a[208:211], v208 offset:256
    v_cvt_pk_bf16_f32 v186, v104, v105
    v_mfma_f32_16x16x32_bf16 a[176:179], a[232:235], v[128:131], a[176:179]
    v_exp_f32 v106, v106
    v_mfma_f32_16x16x32_bf16 a[176:179], a[236:239], v[144:147], a[176:179]
    ds_read_b128 a[212:215], v209 offset:256
    v_add_f32 v228, v228, v106
    v_mfma_f32_16x16x32_bf16 a[180:183], a[232:235], v[132:135], a[180:183]
    buffer_store_dwordx4 a[244:247], v234, s[56:59], s61 offen sc1
    v_mfma_f32_16x16x32_bf16 a[180:183], a[236:239], v[148:151], a[180:183]
    v_exp_f32 v107, v107
    v_mfma_f32_16x16x32_bf16 a[184:187], a[232:235], v[136:139], a[184:187]
    v_add_f32 v228, v228, v107
    v_add_u32 v210, s46, v216
    v_mfma_f32_16x16x32_bf16 a[184:187], a[236:239], v[152:155], a[184:187]
    v_cvt_pk_bf16_f32 v187, v106, v107
    v_add_u32 v211, s46, v217
    v_mfma_f32_16x16x32_bf16 a[188:191], a[232:235], v[140:143], a[188:191]
    v_exp_f32 v108, v108
    v_mfma_f32_16x16x32_bf16 a[188:191], a[236:239], v[156:159], a[188:191]
    v_add_f32 v229, v229, v108
    s_waitcnt lgkmcnt(0)
    s_cbranch_vccnz L_attn_loop
    s_cmp_eq_u32 s28, 0
    s_cbranch_scc1 L_attn_p31
L_attn_rt:
    s_cmp_eq_u32 s28, 2
    s_cbranch_scc1 L_attn_rt3
    s_cmp_eq_u32 s28, 1
    s_cbranch_scc1 L_attn_rt2
    s_getreg_b32 s50, hwreg(HW_REG_XCC_ID, 0, 4)
    s_or_b32 s50, s50, 0x100
    v_mov_b32 v237, s50
    s_waitcnt vmcnt(0)
    s_barrier
    buffer_store_dword v237, v254, s[12:15], 0 offen sc1
    s_branch L_attn_loop
L_attn_rt3:
    buffer_load_dword v252, v253, s[16:19], 0 offen sc1
    s_getpc_b64 s[54:55]
L_attn_rtpc:
    s_add_u32 s54, s54, L_attn_tailcode-L_attn_rtpc
    s_addc_u32 s55, s55, 0
    s_lshr_b32 s51, s2, 3
    s_lshl_b32 s51, s51, 11
    v_and_b32 v238, 0xf0, v234
    v_lshl_add_u32 v238, v238, 3, s51
    v_min_u32 v238, L_attn_tailcode_end-L_attn_tailcode, v238
    global_load_dword v239, v238, s[54:55]
    s_branch L_attn_loop
L_attn_rt2:
    s_mov_b32 s50, 0x100000
    s_waitcnt vmcnt(14)
L_attn_rtchk:
    v_cmp_gt_u32 vcc, 0x100, v252
    s_sub_u32 s50, s50, 1
    s_nop 3
    s_cbranch_vccz L_attn_rtok
    s_cmp_eq_u32 s50, 0
    s_cbranch_scc1 L_attn_rtok
    buffer_load_dword v252, v253, s[16:19], 0 offen sc1
    s_waitcnt vmcnt(0)
    s_branch L_attn_rtchk
L_attn_rtok:
    s_barrier
    s_cmp_lg_u32 s24, 0
    s_cbranch_scc1 L_attn_loop
    s_mov_b32 s62, 1
    s_branch L_attn_loop
L_attn_inv:
    buffer_inv sc1
    s_mov_b32 s62, 0
    s_branch L_attn_invback
L_attn_p31:
    s_waitcnt lgkmcnt(0)
    v_add_u32 v212, s46, v218
    v_add_u32 v213, s46, v219
    ds_read_b64_tr_b16 a[192:193], v210 offset:0
    v_exp_f32 v109, v109
    ds_read_b64_tr_b16 a[194:195], v210 offset:6144
    v_add_f32 v229, v229, v109
    ds_read_b64_tr_b16 a[196:197], v210 offset:12288
    v_cvt_pk_bf16_f32 v190, v108, v109
    ds_read_b64_tr_b16 a[198:199], v210 offset:18432
    v_exp_f32 v110, v110
    ds_read_b64_tr_b16 a[200:201], v211 offset:0
    v_add_f32 v229, v229, v110
    ds_read_b64_tr_b16 a[202:203], v211 offset:6144
    v_exp_f32 v111, v111
    ds_read_b64_tr_b16 a[204:205], v211 offset:12288
    v_add_f32 v229, v229, v111
    ds_read_b64_tr_b16 a[206:207], v211 offset:18432
    v_cvt_pk_bf16_f32 v191, v110, v111
    ds_read_b64_tr_b16 a[208:209], v212 offset:0
    ds_read_b64_tr_b16 a[210:211], v212 offset:6144
    ds_read_b64_tr_b16 a[212:213], v212 offset:12288
    ds_read_b64_tr_b16 a[214:215], v212 offset:18432
    s_waitcnt vmcnt(1)
    s_barrier
    s_add_u32 s84, s78, s63
    s_addc_u32 s85, s79, 0
    s_mov_b32 s86, 491520
    s_mov_b32 s87, 0x20000
    s_mul_i32 s90, s24, 5120
    s_mov_b32 s91, 0
    s_and_b32 s91, s3, 7
    s_mul_i32 s91, s91, 61440
    s_add_u32 s80, s91, s90
    s_add_u32 s81, s80, 4096
    s_waitcnt lgkmcnt(8)
    v_mfma_f32_16x16x32_bf16 a[0:3], a[192:195], v[160:163], a[0:3]
    ds_read_b64_tr_b16 a[216:217], v213 offset:0
    s_lshr_b32 s50, s24, 1
    s_and_b32 s51, s2, 1
    s_cmp_eq_u32 s50, s51
    s_cselect_b64 vcc, -1, 0
    s_and_b32 s50, s24, 1
    s_mul_i32 s50, s50, 24576
    s_add_u32 s50, s50, 49152
    s_add_u32 m0, s90, 122880
    s_nop 0
    buffer_load_dwordx4 v234, s[84:87], s80 offen offset:0  lds
    v_mfma_f32_16x16x32_bf16 a[0:3], a[196:199], v[176:179], a[0:3]
    v_add_u32 v248, s50, v234
    v_mov_b32 v236, v226
    buffer_load_dwordx4 v234, s[84:87], s80 offen offset:1024  lds
    v_mfma_f32_16x16x32_bf16 a[4:7], a[192:195], v[164:167], a[4:7]
    ds_read_b64_tr_b16 a[218:219], v213 offset:6144
    v_mov_b32 v237, v227
    v_mov_b32 v238, v228
    buffer_load_dwordx4 v234, s[84:87], s80 offen offset:2048  lds
    v_mfma_f32_16x16x32_bf16 a[4:7], a[196:199], v[180:183], a[4:7]
    v_mov_b32 v239, v229
    v_permlane32_swap_b32 v226, v236
    buffer_load_dwordx4 v234, s[84:87], s80 offen offset:3072  lds
    v_mfma_f32_16x16x32_bf16 a[8:11], a[192:195], v[168:171], a[8:11]
    ds_read_b64_tr_b16 a[220:221], v213 offset:12288
    v_permlane32_swap_b32 v227, v237
    v_permlane32_swap_b32 v228, v238
    s_add_u32 m0, s90, 126976
    s_nop 0
    buffer_load_dwordx4 v234, s[84:87], s81 offen offset:0  lds
    v_mfma_f32_16x16x32_bf16 a[8:11], a[196:199], v[184:187], a[8:11]
    v_permlane32_swap_b32 v229, v239
    v_add_f32 v226, v226, v236
    s_add_u32 s91, s91, 20480
    v_mfma_f32_16x16x32_bf16 a[12:15], a[192:195], v[172:175], a[12:15]
    ds_read_b64_tr_b16 a[222:223], v213 offset:18432
    v_add_f32 v227, v227, v237
    v_add_f32 v228, v228, v238
    s_add_u32 s80, s91, s90
    s_add_u32 s81, s80, 4096
    v_mfma_f32_16x16x32_bf16 a[12:15], a[196:199], v[188:191], a[12:15]
    v_add_f32 v229, v229, v239
    v_mov_b32 v236, v226
    s_add_u32 m0, s90, 0
    s_nop 0
    buffer_load_dwordx4 v234, s[84:87], s80 offen offset:0  lds
    s_waitcnt lgkmcnt(8)
    v_mfma_f32_16x16x32_bf16 a[16:19], a[200:203], v[160:163], a[16:19]
    ds_read_b64_tr_b16 a[224:225], v210 offset:128
    v_mov_b32 v237, v227
    v_mov_b32 v238, v228
    buffer_load_dwordx4 v234, s[84:87], s80 offen offset:1024  lds
    v_mfma_f32_16x16x32_bf16 a[16:19], a[204:207], v[176:179], a[16:19]
    v_mov_b32 v239, v229
    v_permlane16_swap_b32 v226, v236
    buffer_load_dwordx4 v234, s[84:87], s80 offen offset:2048  lds
    v_mfma_f32_16x16x32_bf16 a[20:23], a[200:203], v[164:167], a[20:23]
    ds_read_b64_tr_b16 a[226:227], v210 offset:6272
    v_permlane16_swap_b32 v227, v237
    v_permlane16_swap_b32 v228, v238
    buffer_load_dwordx4 v234, s[84:87], s80 offen offset:3072  lds
    v_mfma_f32_16x16x32_bf16 a[20:23], a[204:207], v[180:183], a[20:23]
    v_permlane16_swap_b32 v229, v239
    v_add_f32 v226, v226, v236
    s_add_u32 m0, s90, 4096
    s_nop 0
    buffer_load_dwordx4 v234, s[84:87], s81 offen offset:0  lds
    v_mfma_f32_16x16x32_bf16 a[24:27], a[200:203], v[168:171], a[24:27]
    ds_read_b64_tr_b16 a[228:229], v210 offset:12416
    v_add_f32 v227, v227, v237
    v_add_f32 v228, v228, v238
    s_add_u32 s91, s91, 20480
    v_mfma_f32_16x16x32_bf16 a[24:27], a[204:207], v[184:187], a[24:27]
    v_add_f32 v229, v229, v239
    s_mov_b32 s51, 1400897536
    s_add_u32 s80, s91, s90
    s_add_u32 s81, s80, 4096
    v_mfma_f32_16x16x32_bf16 a[28:31], a[200:203], v[172:175], a[28:31]
    ds_read_b64_tr_b16 a[230:231], v210 offset:18560
    v_cmp_ngt_f32 s[32:33], s51, v226
    v_cmp_ngt_f32 s[34:35], s51, v227
    s_add_u32 m0, s90, 24576
    s_nop 0
    buffer_load_dwordx4 v234, s[84:87], s80 offen offset:0  lds
    v_mfma_f32_16x16x32_bf16 a[28:31], a[204:207], v[188:191], a[28:31]
    v_cmp_ngt_f32 s[36:37], s51, v228
    v_cmp_ngt_f32 s[38:39], s51, v229
    buffer_load_dwordx4 v234, s[84:87], s80 offen offset:1024  lds
    s_waitcnt lgkmcnt(8)
    v_mfma_f32_16x16x32_bf16 a[32:35], a[208:211], v[160:163], a[32:35]
    ds_read_b64_tr_b16 a[232:233], v211 offset:128
    v_rcp_f32 v226, v226
    v_rcp_f32 v227, v227
    buffer_load_dwordx4 v234, s[84:87], s80 offen offset:2048  lds
    v_mfma_f32_16x16x32_bf16 a[32:35], a[212:215], v[176:179], a[32:35]
    v_rcp_f32 v228, v228
    v_rcp_f32 v229, v229
    buffer_load_dwordx4 v234, s[84:87], s80 offen offset:3072  lds
    v_mfma_f32_16x16x32_bf16 a[36:39], a[208:211], v[164:167], a[36:39]
    ds_read_b64_tr_b16 a[234:235], v211 offset:6272
    s_lshl_b32 s50, s24, 2
    s_add_u32 s50, s50, 147456
    s_add_u32 m0, s90, 28672
    s_nop 0
    buffer_load_dwordx4 v234, s[84:87], s81 offen offset:0  lds
    v_mfma_f32_16x16x32_bf16 a[36:39], a[212:215], v[180:183], a[36:39]
    v_mov_b32 v241, s50
    s_or_b64 s[32:33], s[32:33], s[34:35]
    s_or_b64 s[36:37], s[36:37], s[38:39]
    s_or_b64 s[32:33], s[32:33], s[36:37]
    s_cselect_b32 s50, 1, 0
    s_add_u32 s91, s91, 20480
    s_cmp_eq_u32 s91, 491520
    s_cmov_b32 s91, 0
    v_mfma_f32_16x16x32_bf16 a[40:43], a[208:211], v[168:171], a[40:43]
    ds_read_b64_tr_b16 a[236:237], v211 offset:12416
    s_mov_b32 s44, 0
    s_mov_b32 s45, 196608
    s_mov_b32 s46, 393216
    s_mov_b32 s47, 589824
    v_mfma_f32_16x16x32_bf16 a[40:43], a[212:215], v[184:187], a[40:43]
    v_mov_b32 v240, s50
    v_accvgpr_read_b32 v128, a0
    v_accvgpr_read_b32 v129, a1
    v_accvgpr_read_b32 v130, a2
    v_accvgpr_read_b32 v131, a3
    v_accvgpr_read_b32 v132, a16
    v_accvgpr_read_b32 v133, a17
    v_accvgpr_read_b32 v134, a18
    v_mfma_f32_16x16x32_bf16 a[44:47], a[208:211], v[172:175], a[44:47]
    ds_read_b64_tr_b16 a[238:239], v211 offset:18560
    v_mov_b32 v242, 147456
    v_accvgpr_read_b32 v135, a19
    v_mul_f32 v128, v128, v226
    v_mul_f32 v129, v129, v226
    v_mul_f32 v130, v130, v226
    v_mul_f32 v131, v131, v226
    v_mul_f32 v132, v132, v226
    v_mul_f32 v133, v133, v226
    v_mfma_f32_16x16x32_bf16 a[44:47], a[212:215], v[188:191], a[44:47]
    ds_write_b32 v241, v240
    v_mul_f32 v134, v134, v226
    v_mul_f32 v135, v135, v226
    v_cvt_pk_bf16_f32 v96, v128, v129
    v_cvt_pk_bf16_f32 v97, v130, v131
    v_cvt_pk_bf16_f32 v98, v132, v133
    v_cvt_pk_bf16_f32 v99, v134, v135
    buffer_store_dwordx4 v[96:99], v234, s[20:23], s44 offen offset:0 sc1
    s_waitcnt lgkmcnt(9)
    v_mfma_f32_16x16x32_bf16 a[48:51], a[216:219], v[160:163], a[48:51]
    ds_read_b64_tr_b16 a[192:193], v212 offset:128
    s_waitcnt lgkmcnt(1)
    s_cbranch_vccz L_attn_ex1
    ds_write_b128 v248, v[96:99] offset:0
L_attn_ex1:
    v_accvgpr_read_b32 v136, a4
    v_accvgpr_read_b32 v137, a5
    v_accvgpr_read_b32 v138, a6
    v_accvgpr_read_b32 v139, a7
    v_accvgpr_read_b32 v140, a20
    v_accvgpr_read_b32 v141, a21
    v_mfma_f32_16x16x32_bf16 a[48:51], a[220:223], v[176:179], a[48:51]
    s_barrier
    v_accvgpr_read_b32 v142, a22
    v_accvgpr_read_b32 v143, a23
    v_mul_f32 v136, v136, v227
    v_mul_f32 v137, v137, v227
    v_mul_f32 v138, v138, v227
    v_mul_f32 v139, v139, v227
    v_mul_f32 v140, v140, v227
    v_mfma_f32_16x16x32_bf16 a[52:55], a[216:219], v[164:167], a[52:55]
    ds_read_b64_tr_b16 a[194:195], v212 offset:6272
    ds_read_b128 v[244:247], v242
    v_mul_f32 v141, v141, v227
    v_mul_f32 v142, v142, v227
    v_mul_f32 v143, v143, v227
    v_cvt_pk_bf16_f32 v100, v136, v137
    v_cvt_pk_bf16_f32 v101, v138, v139
    v_cvt_pk_bf16_f32 v102, v140, v141
    v_cvt_pk_bf16_f32 v103, v142, v143
    v_mfma_f32_16x16x32_bf16 a[52:55], a[220:223], v[180:183], a[52:55]
    buffer_store_dwordx4 v[100:103], v234, s[20:23], s45 offen offset:0 sc1
    s_cbranch_vccz L_attn_ex2
    ds_write_b128 v248, v[100:103] offset:6144
L_attn_ex2:
    v_accvgpr_read_b32 v144, a8
    v_accvgpr_read_b32 v145, a9
    v_accvgpr_read_b32 v146, a10
    v_accvgpr_read_b32 v147, a11
    v_accvgpr_read_b32 v148, a24
    v_mfma_f32_16x16x32_bf16 a[56:59], a[216:219], v[168:171], a[56:59]
    ds_read_b64_tr_b16 a[196:197], v212 offset:12416
    v_accvgpr_read_b32 v149, a25
    v_accvgpr_read_b32 v150, a26
    v_accvgpr_read_b32 v151, a27
    v_mul_f32 v144, v144, v228
    v_mul_f32 v145, v145, v228
    v_mul_f32 v146, v146, v228
    v_mul_f32 v147, v147, v228
    v_mfma_f32_16x16x32_bf16 a[56:59], a[220:223], v[184:187], a[56:59]
    v_mul_f32 v148, v148, v228
    v_mul_f32 v149, v149, v228
    v_mul_f32 v150, v150, v228
    v_mul_f32 v151, v151, v228
    v_cvt_pk_bf16_f32 v104, v144, v145
    v_cvt_pk_bf16_f32 v105, v146, v147
    v_cvt_pk_bf16_f32 v106, v148, v149
    v_mfma_f32_16x16x32_bf16 a[60:63], a[216:219], v[172:175], a[60:63]
    ds_read_b64_tr_b16 a[198:199], v212 offset:18560
    v_cvt_pk_bf16_f32 v107, v150, v151
    buffer_store_dwordx4 v[104:107], v234, s[20:23], s46 offen offset:0 sc1
    s_cbranch_vccz L_attn_ex3
    ds_write_b128 v248, v[104:107] offset:12288
L_attn_ex3:
    v_accvgpr_read_b32 v152, a12
    v_accvgpr_read_b32 v153, a13
    v_accvgpr_read_b32 v154, a14
    v_accvgpr_read_b32 v155, a15
    v_mfma_f32_16x16x32_bf16 a[60:63], a[220:223], v[188:191], a[60:63]
    v_accvgpr_read_b32 v156, a28
    v_accvgpr_read_b32 v157, a29
    v_accvgpr_read_b32 v158, a30
    v_accvgpr_read_b32 v159, a31
    v_mul_f32 v152, v152, v229
    v_mul_f32 v153, v153, v229
    v_mul_f32 v154, v154, v229
    s_waitcnt lgkmcnt(10)
    v_mfma_f32_16x16x32_bf16 a[64:67], a[224:227], v[160:163], a[64:67]
    ds_read_b64_tr_b16 a[200:201], v213 offset:128
    v_mul_f32 v155, v155, v229
    v_mul_f32 v156, v156, v229
    v_mul_f32 v157, v157, v229
    v_mul_f32 v158, v158, v229
    v_mul_f32 v159, v159, v229
    v_cvt_pk_bf16_f32 v108, v152, v153
    v_cvt_pk_bf16_f32 v109, v154, v155
    v_mfma_f32_16x16x32_bf16 a[64:67], a[228:231], v[176:179], a[64:67]
    s_waitcnt lgkmcnt(3)
    v_cvt_pk_bf16_f32 v110, v156, v157
    v_cvt_pk_bf16_f32 v111, v158, v159
    buffer_store_dwordx4 v[108:111], v234, s[20:23], s47 offen offset:0 sc1
    s_cbranch_vccz L_attn_ex4
    ds_write_b128 v248, v[108:111] offset:18432
L_attn_ex4:
    v_accvgpr_read_b32 v128, a32
    v_accvgpr_read_b32 v129, a33
    v_accvgpr_read_b32 v130, a34
    v_mfma_f32_16x16x32_bf16 a[68:71], a[224:227], v[164:167], a[68:71]
    ds_read_b64_tr_b16 a[202:203], v213 offset:6272
    v_or_b32 v244, v244, v245
    v_accvgpr_read_b32 v131, a35
    v_accvgpr_read_b32 v132, a48
    v_accvgpr_read_b32 v133, a49
    v_accvgpr_read_b32 v134, a50
    v_accvgpr_read_b32 v135, a51
    v_mul_f32 v128, v128, v226
    v_mul_f32 v129, v129, v226
    v_mfma_f32_16x16x32_bf16 a[68:71], a[228:231], v[180:183], a[68:71]
    v_or3_b32 v244, v244, v246, v247
    v_mul_f32 v130, v130, v226
    v_mul_f32 v131, v131, v226
    v_mul_f32 v132, v132, v226
    v_mul_f32 v133, v133, v226
    v_mul_f32 v134, v134, v226
    v_mul_f32 v135, v135, v226
    v_cvt_pk_bf16_f32 v112, v128, v129
    v_mfma_f32_16x16x32_bf16 a[72:75], a[224:227], v[168:171], a[72:75]
    ds_read_b64_tr_b16 a[204:205], v213 offset:12416
    v_cvt_pk_bf16_f32 v113, v130, v131
    v_cvt_pk_bf16_f32 v114, v132, v133
    v_cvt_pk_bf16_f32 v115, v134, v135
    buffer_store_dwordx4 v[112:115], v234, s[20:23], s44 offen offset:1024 sc1
    s_cbranch_vccz L_attn_ex5
    ds_write_b128 v248, v[112:115] offset:1024
L_attn_ex5:
    v_accvgpr_read_b32 v136, a36
    v_accvgpr_read_b32 v137, a37
    v_mfma_f32_16x16x32_bf16 a[72:75], a[228:231], v[184:187], a[72:75]
    v_readfirstlane_b32 s51, v244
    v_accvgpr_read_b32 v138, a38
    v_accvgpr_read_b32 v139, a39
    v_accvgpr_read_b32 v140, a52
    v_accvgpr_read_b32 v141, a53
    v_accvgpr_read_b32 v142, a54
    v_accvgpr_read_b32 v143, a55
    v_mul_f32 v136, v136, v227
    v_mfma_f32_16x16x32_bf16 a[76:79], a[224:227], v[172:175], a[76:79]
    ds_read_b64_tr_b16 a[206:207], v213 offset:18560
    v_mul_f32 v137, v137, v227
    v_mul_f32 v138, v138, v227
    v_mul_f32 v139, v139, v227
    v_mul_f32 v140, v140, v227
    v_mul_f32 v141, v141, v227
    v_mul_f32 v142, v142, v227
    v_mul_f32 v143, v143, v227
    v_mfma_f32_16x16x32_bf16 a[76:79], a[228:231], v[188:191], a[76:79]
    s_cmp_gt_u32 s51, s29
    s_cbranch_scc1 L_attn_fallback
    v_cvt_pk_bf16_f32 v116, v136, v137
    v_cvt_pk_bf16_f32 v117, v138, v139
    v_cvt_pk_bf16_f32 v118, v140, v141
    v_cvt_pk_bf16_f32 v119, v142, v143
    buffer_store_dwordx4 v[116:119], v234, s[20:23], s45 offen offset:1024 sc1
    s_cbranch_vccz L_attn_ex6
    ds_write_b128 v248, v[116:119] offset:7168
L_attn_ex6:
    v_accvgpr_read_b32 v144, a40
    s_waitcnt lgkmcnt(10)
    v_mfma_f32_16x16x32_bf16 a[80:83], a[232:235], v[160:163], a[80:83]
    ds_read_b64_tr_b16 a[208:209], v210 offset:256
    v_accvgpr_read_b32 v145, a41
    v_accvgpr_read_b32 v146, a42
    v_accvgpr_read_b32 v147, a43
    v_accvgpr_read_b32 v148, a56
    v_accvgpr_read_b32 v149, a57
    v_accvgpr_read_b32 v150, a58
    v_accvgpr_read_b32 v151, a59
    v_mul_f32 v144, v144, v228
    v_mfma_f32_16x16x32_bf16 a[80:83], a[236:239], v[176:179], a[80:83]
    v_mul_f32 v145, v145, v228
    v_mul_f32 v146, v146, v228
    v_mul_f32 v147, v147, v228
    v_mul_f32 v148, v148, v228
    v_mul_f32 v149, v149, v228
    v_mul_f32 v150, v150, v228
    v_mul_f32 v151, v151, v228
    v_cvt_pk_bf16_f32 v120, v144, v145
    v_mfma_f32_16x16x32_bf16 a[84:87], a[232:235], v[164:167], a[84:87]
    ds_read_b64_tr_b16 a[210:211], v210 offset:6400
    v_cvt_pk_bf16_f32 v121, v146, v147
    v_cvt_pk_bf16_f32 v122, v148, v149
    v_cvt_pk_bf16_f32 v123, v150, v151
    buffer_store_dwordx4 v[120:123], v234, s[20:23], s46 offen offset:1024 sc1
    s_cbranch_vccz L_attn_ex7
    ds_write_b128 v248, v[120:123] offset:13312
L_attn_ex7:
    v_accvgpr_read_b32 v152, a44
    v_accvgpr_read_b32 v153, a45
    v_accvgpr_read_b32 v154, a46
    v_mfma_f32_16x16x32_bf16 a[84:87], a[236:239], v[180:183], a[84:87]
    v_accvgpr_read_b32 v155, a47
    v_accvgpr_read_b32 v156, a60
    v_accvgpr_read_b32 v157, a61
    v_accvgpr_read_b32 v158, a62
    v_accvgpr_read_b32 v159, a63
    v_mul_f32 v152, v152, v229
    v_mul_f32 v153, v153, v229
    v_mul_f32 v154, v154, v229
    v_mfma_f32_16x16x32_bf16 a[88:91], a[232:235], v[168:171], a[88:91]
    ds_read_b64_tr_b16 a[212:213], v210 offset:12544
    v_mul_f32 v155, v155, v229
    v_mul_f32 v156, v156, v229
    v_mul_f32 v157, v157, v229
    v_mul_f32 v158, v158, v229
    v_mul_f32 v159, v159, v229
    v_cvt_pk_bf16_f32 v124, v152, v153
    v_cvt_pk_bf16_f32 v125, v154, v155
    v_cvt_pk_bf16_f32 v126, v156, v157
    v_mfma_f32_16x16x32_bf16 a[88:91], a[236:239], v[184:187], a[88:91]
    v_cvt_pk_bf16_f32 v127, v158, v159
    buffer_store_dwordx4 v[124:127], v234, s[20:23], s47 offen offset:1024 sc1
    s_cbranch_vccz L_attn_ex8
    ds_write_b128 v248, v[124:127] offset:19456
L_attn_ex8:
    v_accvgpr_read_b32 v128, a64
    v_accvgpr_read_b32 v129, a65
    v_accvgpr_read_b32 v130, a66
    v_accvgpr_read_b32 v131, a67
    v_accvgpr_read_b32 v132, a80
    v_mfma_f32_16x16x32_bf16 a[92:95], a[232:235], v[172:175], a[92:95]
    ds_read_b64_tr_b16 a[214:215], v210 offset:18688
    v_accvgpr_read_b32 v133, a81
    v_accvgpr_read_b32 v134, a82
    v_accvgpr_read_b32 v135, a83
    v_mul_f32 v128, v128, v226
    v_mul_f32 v129, v129, v226
    v_mul_f32 v130, v130, v226
    v_mul_f32 v131, v131, v226
    v_mul_f32 v132, v132, v226
    v_mfma_f32_16x16x32_bf16 a[92:95], a[236:239], v[188:191], a[92:95]
    v_mul_f32 v133, v133, v226
    v_mul_f32 v134, v134, v226
    v_mul_f32 v135, v135, v226
    v_cvt_pk_bf16_f32 v96, v128, v129
    v_cvt_pk_bf16_f32 v97, v130, v131
    v_cvt_pk_bf16_f32 v98, v132, v133
    v_cvt_pk_bf16_f32 v99, v134, v135
    buffer_store_dwordx4 v[96:99], v234, s[20:23], s44 offen offset:2048 sc1
    s_waitcnt lgkmcnt(8)
    v_mfma_f32_16x16x32_bf16 a[96:99], a[192:195], v[160:163], a[96:99]
    ds_read_b64_tr_b16 a[216:217], v211 offset:256
    s_cbranch_vccz L_attn_ex9
    ds_write_b128 v248, v[96:99] offset:2048
L_attn_ex9:
    v_accvgpr_read_b32 v136, a68
    v_accvgpr_read_b32 v137, a69
    v_accvgpr_read_b32 v138, a70
    v_accvgpr_read_b32 v139, a71
    v_accvgpr_read_b32 v140, a84
    v_accvgpr_read_b32 v141, a85
    v_accvgpr_read_b32 v142, a86
    v_mfma_f32_16x16x32_bf16 a[96:99], a[196:199], v[176:179], a[96:99]
    v_accvgpr_read_b32 v143, a87
    v_mul_f32 v136, v136, v227
    v_mul_f32 v137, v137, v227
    v_mul_f32 v138, v138, v227
    v_mul_f32 v139, v139, v227
    v_mul_f32 v140, v140, v227
    v_mul_f32 v141, v141, v227
    v_mul_f32 v142, v142, v227
    v_mfma_f32_16x16x32_bf16 a[100:103], a[192:195], v[164:167], a[100:103]
    ds_read_b64_tr_b16 a[218:219], v211 offset:6400
    v_mul_f32 v143, v143, v227
    v_cvt_pk_bf16_f32 v100, v136, v137
    v_cvt_pk_bf16_f32 v101, v138, v139
    v_cvt_pk_bf16_f32 v102, v140, v141
    v_cvt_pk_bf16_f32 v103, v142, v143
    buffer_store_dwordx4 v[100:103], v234, s[20:23], s45 offen offset:2048 sc1
    s_cbranch_vccz L_attn_ex10
    ds_write_b128 v248, v[100:103] offset:8192
L_attn_ex10:
    v_accvgpr_read_b32 v144, a72
    v_mfma_f32_16x16x32_bf16 a[100:103], a[196:199], v[180:183], a[100:103]
    v_accvgpr_read_b32 v145, a73
    v_accvgpr_read_b32 v146, a74
    v_accvgpr_read_b32 v147, a75
    v_accvgpr_read_b32 v148, a88
    v_accvgpr_read_b32 v149, a89
    v_accvgpr_read_b32 v150, a90
    v_accvgpr_read_b32 v151, a91
    v_mul_f32 v144, v144, v228
    v_mfma_f32_16x16x32_bf16 a[104:107], a[192:195], v[168:171], a[104:107]
    ds_read_b64_tr_b16 a[220:221], v211 offset:12544
    v_mul_f32 v145, v145, v228
    v_mul_f32 v146, v146, v228
    v_mul_f32 v147, v147, v228
    v_mul_f32 v148, v148, v228
    v_mul_f32 v149, v149, v228
    v_mul_f32 v150, v150, v228
    v_mul_f32 v151, v151, v228
    v_cvt_pk_bf16_f32 v104, v144, v145
    v_mfma_f32_16x16x32_bf16 a[104:107], a[196:199], v[184:187], a[104:107]
    v_cvt_pk_bf16_f32 v105, v146, v147
    v_cvt_pk_bf16_f32 v106, v148, v149
    v_cvt_pk_bf16_f32 v107, v150, v151
    buffer_store_dwordx4 v[104:107], v234, s[20:23], s46 offen offset:2048 sc1
    s_cbranch_vccz L_attn_ex11
    ds_write_b128 v248, v[104:107] offset:14336
L_attn_ex11:
    v_accvgpr_read_b32 v152, a76
    v_accvgpr_read_b32 v153, a77
    v_accvgpr_read_b32 v154, a78
    v_mfma_f32_16x16x32_bf16 a[108:111], a[192:195], v[172:175], a[108:111]
    ds_read_b64_tr_b16 a[222:223], v211 offset:18688
    v_accvgpr_read_b32 v155, a79
    v_accvgpr_read_b32 v156, a92
    v_accvgpr_read_b32 v157, a93
    v_accvgpr_read_b32 v158, a94
    v_accvgpr_read_b32 v159, a95
    v_mul_f32 v152, v152, v229
    v_mul_f32 v153, v153, v229
    v_mul_f32 v154, v154, v229
    v_mfma_f32_16x16x32_bf16 a[108:111], a[196:199], v[188:191], a[108:111]
    v_mul_f32 v155, v155, v229
    v_mul_f32 v156, v156, v229
    v_mul_f32 v157, v157, v229
    v_mul_f32 v158, v158, v229
    v_mul_f32 v159, v159, v229
    v_cvt_pk_bf16_f32 v108, v152, v153
    v_cvt_pk_bf16_f32 v109, v154, v155
    v_cvt_pk_bf16_f32 v110, v156, v157
    s_waitcnt lgkmcnt(8)
    v_mfma_f32_16x16x32_bf16 a[112:115], a[200:203], v[160:163], a[112:115]
    ds_read_b64_tr_b16 a[224:225], v212 offset:256
    v_cvt_pk_bf16_f32 v111, v158, v159
    buffer_store_dwordx4 v[108:111], v234, s[20:23], s47 offen offset:2048 sc1
    s_cbranch_vccz L_attn_ex12
    ds_write_b128 v248, v[108:111] offset:20480
L_attn_ex12:
    v_mfma_f32_16x16x32_bf16 a[112:115], a[204:207], v[176:179], a[112:115]
    v_mfma_f32_16x16x32_bf16 a[116:119], a[200:203], v[164:167], a[116:119]
    ds_read_b64_tr_b16 a[226:227], v212 offset:6400
    v_mfma_f32_16x16x32_bf16 a[116:119], a[204:207], v[180:183], a[116:119]
    v_mfma_f32_16x16x32_bf16 a[120:123], a[200:203], v[168:171], a[120:123]
    ds_read_b64_tr_b16 a[228:229], v212 offset:12544
    v_accvgpr_read_b32 v128, a96
    v_accvgpr_read_b32 v129, a97
    v_accvgpr_read_b32 v130, a98
    v_accvgpr_read_b32 v131, a99
    v_accvgpr_read_b32 v132, a112
    v_accvgpr_read_b32 v133, a113
    v_accvgpr_read_b32 v134, a114
    v_accvgpr_read_b32 v135, a115
    v_mfma_f32_16x16x32_bf16 a[120:123], a[204:207], v[184:187], a[120:123]
    v_mul_f32 v128, v128, v226
    v_mul_f32 v129, v129, v226
    v_mul_f32 v130, v130, v226
    v_mul_f32 v131, v131, v226
    v_mul_f32 v132, v132, v226
    v_mul_f32 v133, v133, v226
    v_mul_f32 v134, v134, v226
    v_mul_f32 v135, v135, v226
    v_mfma_f32_16x16x32_bf16 a[124:127], a[200:203], v[172:175], a[124:127]
    ds_read_b64_tr_b16 a[230:231], v212 offset:18688
    v_cvt_pk_bf16_f32 v112, v128, v129
    v_cvt_pk_bf16_f32 v113, v130, v131
    v_cvt_pk_bf16_f32 v114, v132, v133
    v_cvt_pk_bf16_f32 v115, v134, v135
    buffer_store_dwordx4 v[112:115], v234, s[20:23], s44 offen offset:3072 sc1
    s_cbranch_vccz L_attn_ex13
    ds_write_b128 v248, v[112:115] offset:3072
L_attn_ex13:
    v_accvgpr_read_b32 v136, a100
    v_accvgpr_read_b32 v137, a101
    v_mfma_f32_16x16x32_bf16 a[124:127], a[204:207], v[188:191], a[124:127]
    v_accvgpr_read_b32 v138, a102
    v_accvgpr_read_b32 v139, a103
    v_accvgpr_read_b32 v140, a116
    v_accvgpr_read_b32 v141, a117
    v_accvgpr_read_b32 v142, a118
    v_accvgpr_read_b32 v143, a119
    v_mul_f32 v136, v136, v227
    v_mul_f32 v137, v137, v227
    s_waitcnt lgkmcnt(8)
    v_mfma_f32_16x16x32_bf16 a[128:131], a[208:211], v[160:163], a[128:131]
    ds_read_b64_tr_b16 a[232:233], v213 offset:256
    v_mul_f32 v138, v138, v227
    v_mul_f32 v139, v139, v227
    v_mul_f32 v140, v140, v227
    v_mul_f32 v141, v141, v227
    v_mul_f32 v142, v142, v227
    v_mul_f32 v143, v143, v227
    v_cvt_pk_bf16_f32 v116, v136, v137
    v_cvt_pk_bf16_f32 v117, v138, v139
    v_mfma_f32_16x16x32_bf16 a[128:131], a[212:215], v[176:179], a[128:131]
    v_cvt_pk_bf16_f32 v118, v140, v141
    v_cvt_pk_bf16_f32 v119, v142, v143
    buffer_store_dwordx4 v[116:119], v234, s[20:23], s45 offen offset:3072 sc1
    s_cbranch_vccz L_attn_ex14
    ds_write_b128 v248, v[116:119] offset:9216
L_attn_ex14:
    v_accvgpr_read_b32 v144, a104
    v_accvgpr_read_b32 v145, a105
    v_accvgpr_read_b32 v146, a106
    v_accvgpr_read_b32 v147, a107
    v_mfma_f32_16x16x32_bf16 a[132:135], a[208:211], v[164:167], a[132:135]
    ds_read_b64_tr_b16 a[234:235], v213 offset:6400
    v_accvgpr_read_b32 v148, a120
    v_accvgpr_read_b32 v149, a121
    v_accvgpr_read_b32 v150, a122
    v_accvgpr_read_b32 v151, a123
    v_mul_f32 v144, v144, v228
    v_mul_f32 v145, v145, v228
    v_mul_f32 v146, v146, v228
    v_mul_f32 v147, v147, v228
    v_mfma_f32_16x16x32_bf16 a[132:135], a[212:215], v[180:183], a[132:135]
    v_mul_f32 v148, v148, v228
    v_mul_f32 v149, v149, v228
    v_mul_f32 v150, v150, v228
    v_mul_f32 v151, v151, v228
    v_cvt_pk_bf16_f32 v120, v144, v145
    v_cvt_pk_bf16_f32 v121, v146, v147
    v_cvt_pk_bf16_f32 v122, v148, v149
    v_cvt_pk_bf16_f32 v123, v150, v151
    v_mfma_f32_16x16x32_bf16 a[136:139], a[208:211], v[168:171], a[136:139]
    ds_read_b64_tr_b16 a[236:237], v213 offset:12544
    buffer_store_dwordx4 v[120:123], v234, s[20:23], s46 offen offset:3072 sc1
    s_cbranch_vccz L_attn_ex15
    ds_write_b128 v248, v[120:123] offset:15360
L_attn_ex15:
    v_accvgpr_read_b32 v152, a108
    v_accvgpr_read_b32 v153, a109
    v_accvgpr_read_b32 v154, a110
    v_accvgpr_read_b32 v155, a111
    v_accvgpr_read_b32 v156, a124
    v_accvgpr_read_b32 v157, a125
    v_mfma_f32_16x16x32_bf16 a[136:139], a[212:215], v[184:187], a[136:139]
    v_accvgpr_read_b32 v158, a126
    v_accvgpr_read_b32 v159, a127
    v_mul_f32 v152, v152, v229
    v_mul_f32 v153, v153, v229
    v_mul_f32 v154, v154, v229
    v_mul_f32 v155, v155, v229
    v_mul_f32 v156, v156, v229
    v_mul_f32 v157, v157, v229
    v_mfma_f32_16x16x32_bf16 a[140:143], a[208:211], v[172:175], a[140:143]
    ds_read_b64_tr_b16 a[238:239], v213 offset:18688
    v_mul_f32 v158, v158, v229
    v_mul_f32 v159, v159, v229
    v_cvt_pk_bf16_f32 v124, v152, v153
    v_cvt_pk_bf16_f32 v125, v154, v155
    v_cvt_pk_bf16_f32 v126, v156, v157
    v_cvt_pk_bf16_f32 v127, v158, v159
    buffer_store_dwordx4 v[124:127], v234, s[20:23], s47 offen offset:3072 sc1
    s_lshr_b32 s50, s2, 5
    s_lshl_b32 s50, s50, 5
    s_add_u32 s50, s50, s3
    s_lshl_b32 s50, s50, 7
    s_add_u32 s50, s50, 3407872
    v_mfma_f32_16x16x32_bf16 a[140:143], a[212:215], v[188:191], a[140:143]
    s_add_u32 s52, s78, s50
    s_addc_u32 s53, s79, 0
    s_mov_b32 s54, 128
    s_mov_b32 s55, 0x20000
    v_mov_b32 v249, 1
    s_waitcnt vmcnt(8)
    s_barrier
    buffer_store_dword v249, v254, s[52:55], 0 offen sc1
    s_cbranch_vccz L_attn_ex16
    ds_write_b128 v248, v[124:127] offset:21504
L_attn_ex16:
    s_waitcnt lgkmcnt(8)
    v_mfma_f32_16x16x32_bf16 a[144:147], a[216:219], v[160:163], a[144:147]
    v_mfma_f32_16x16x32_bf16 a[144:147], a[220:223], v[176:179], a[144:147]
    v_mfma_f32_16x16x32_bf16 a[148:151], a[216:219], v[164:167], a[148:151]
    v_mfma_f32_16x16x32_bf16 a[148:151], a[220:223], v[180:183], a[148:151]
    v_mfma_f32_16x16x32_bf16 a[152:155], a[216:219], v[168:171], a[152:155]
    v_accvgpr_read_b32 v128, a128
    v_accvgpr_read_b32 v129, a129
    v_accvgpr_read_b32 v130, a130
    v_accvgpr_read_b32 v131, a131
    s_nop 0
    v_accvgpr_read_b32 v132, a144
    v_accvgpr_read_b32 v133, a145
    v_accvgpr_read_b32 v134, a146
    v_accvgpr_read_b32 v135, a147
    v_mfma_f32_16x16x32_bf16 a[152:155], a[220:223], v[184:187], a[152:155]
    v_mul_f32 v128, v128, v226
    v_mul_f32 v129, v129, v226
    v_mul_f32 v130, v130, v226
    v_mul_f32 v131, v131, v226
    v_mul_f32 v132, v132, v226
    v_mul_f32 v133, v133, v226
    v_mul_f32 v134, v134, v226
    v_mul_f32 v135, v135, v226
    v_mfma_f32_16x16x32_bf16 a[156:159], a[216:219], v[172:175], a[156:159]
    v_cvt_pk_bf16_f32 v96, v128, v129
    v_cvt_pk_bf16_f32 v97, v130, v131
    v_cvt_pk_bf16_f32 v98, v132, v133
    v_cvt_pk_bf16_f32 v99, v134, v135
    buffer_store_dwordx4 v[96:99], v235, s[20:23], s44 offen offset:0 sc1
    s_cbranch_vccz L_attn_ex17
    ds_write_b128 v248, v[96:99] offset:4096
L_attn_ex17:
    v_accvgpr_read_b32 v136, a132
    v_accvgpr_read_b32 v137, a133
    v_mfma_f32_16x16x32_bf16 a[156:159], a[220:223], v[188:191], a[156:159]
    v_accvgpr_read_b32 v138, a134
    v_accvgpr_read_b32 v139, a135
    v_accvgpr_read_b32 v140, a148
    v_accvgpr_read_b32 v141, a149
    v_accvgpr_read_b32 v142, a150
    v_accvgpr_read_b32 v143, a151
    v_mul_f32 v136, v136, v227
    v_mul_f32 v137, v137, v227
    s_waitcnt lgkmcnt(4)
    v_mfma_f32_16x16x32_bf16 a[160:163], a[224:227], v[160:163], a[160:163]
    v_mul_f32 v138, v138, v227
    v_mul_f32 v139, v139, v227
    v_mul_f32 v140, v140, v227
    v_mul_f32 v141, v141, v227
    v_mul_f32 v142, v142, v227
    v_mul_f32 v143, v143, v227
    v_cvt_pk_bf16_f32 v100, v136, v137
    v_cvt_pk_bf16_f32 v101, v138, v139
    v_mfma_f32_16x16x32_bf16 a[160:163], a[228:231], v[176:179], a[160:163]
    v_cvt_pk_bf16_f32 v102, v140, v141
    v_cvt_pk_bf16_f32 v103, v142, v143
    buffer_store_dwordx4 v[100:103], v235, s[20:23], s45 offen offset:0 sc1
    s_cbranch_vccz L_attn_ex18
    ds_write_b128 v248, v[100:103] offset:10240
L_attn_ex18:
    v_accvgpr_read_b32 v144, a136
    v_accvgpr_read_b32 v145, a137
    v_accvgpr_read_b32 v146, a138
    v_accvgpr_read_b32 v147, a139
    v_mfma_f32_16x16x32_bf16 a[164:167], a[224:227], v[164:167], a[164:167]
    v_accvgpr_read_b32 v148, a152
    v_accvgpr_read_b32 v149, a153
    v_accvgpr_read_b32 v150, a154
    v_accvgpr_read_b32 v151, a155
    v_mul_f32 v144, v144, v228
    v_mul_f32 v145, v145, v228
    v_mul_f32 v146, v146, v228
    v_mul_f32 v147, v147, v228
    v_mfma_f32_16x16x32_bf16 a[164:167], a[228:231], v[180:183], a[164:167]
    v_mul_f32 v148, v148, v228
    v_mul_f32 v149, v149, v228
    v_mul_f32 v150, v150, v228
    v_mul_f32 v151, v151, v228
    v_cvt_pk_bf16_f32 v104, v144, v145
    v_cvt_pk_bf16_f32 v105, v146, v147
    v_cvt_pk_bf16_f32 v106, v148, v149
    v_cvt_pk_bf16_f32 v107, v150, v151
    v_mfma_f32_16x16x32_bf16 a[168:171], a[224:227], v[168:171], a[168:171]
    buffer_store_dwordx4 v[104:107], v235, s[20:23], s46 offen offset:0 sc1
    s_cbranch_vccz L_attn_ex19
    ds_write_b128 v248, v[104:107] offset:16384
L_attn_ex19:
    v_accvgpr_read_b32 v152, a140
    v_accvgpr_read_b32 v153, a141
    v_accvgpr_read_b32 v154, a142
    v_accvgpr_read_b32 v155, a143
    v_accvgpr_read_b32 v156, a156
    v_accvgpr_read_b32 v157, a157
    v_mfma_f32_16x16x32_bf16 a[168:171], a[228:231], v[184:187], a[168:171]
    v_accvgpr_read_b32 v158, a158
    v_accvgpr_read_b32 v159, a159
    v_mul_f32 v152, v152, v229
    v_mul_f32 v153, v153, v229
    v_mul_f32 v154, v154, v229
    v_mul_f32 v155, v155, v229
    v_mul_f32 v156, v156, v229
    v_mul_f32 v157, v157, v229
    v_mfma_f32_16x16x32_bf16 a[172:175], a[224:227], v[172:175], a[172:175]
    v_mul_f32 v158, v158, v229
    v_mul_f32 v159, v159, v229
    v_cvt_pk_bf16_f32 v108, v152, v153
    v_cvt_pk_bf16_f32 v109, v154, v155
    v_cvt_pk_bf16_f32 v110, v156, v157
    v_cvt_pk_bf16_f32 v111, v158, v159
    buffer_store_dwordx4 v[108:111], v235, s[20:23], s47 offen offset:0 sc1
    s_cbranch_vccz L_attn_ex20
    ds_write_b128 v248, v[108:111] offset:22528
L_attn_ex20:
    v_mfma_f32_16x16x32_bf16 a[172:175], a[228:231], v[188:191], a[172:175]
    s_waitcnt lgkmcnt(0)
    v_mfma_f32_16x16x32_bf16 a[176:179], a[232:235], v[160:163], a[176:179]
    v_mfma_f32_16x16x32_bf16 a[176:179], a[236:239], v[176:179], a[176:179]
    v_mfma_f32_16x16x32_bf16 a[180:183], a[232:235], v[164:167], a[180:183]
    v_mfma_f32_16x16x32_bf16 a[180:183], a[236:239], v[180:183], a[180:183]
    v_mfma_f32_16x16x32_bf16 a[184:187], a[232:235], v[168:171], a[184:187]
    v_accvgpr_read_b32 v128, a160
    v_accvgpr_read_b32 v129, a161
    v_accvgpr_read_b32 v130, a162
    v_accvgpr_read_b32 v131, a163
    s_nop 0
    v_accvgpr_read_b32 v132, a176
    v_accvgpr_read_b32 v133, a177
    v_accvgpr_read_b32 v134, a178
    v_accvgpr_read_b32 v135, a179
    v_mfma_f32_16x16x32_bf16 a[184:187], a[236:239], v[184:187], a[184:187]
    v_mul_f32 v128, v128, v226
    v_mul_f32 v129, v129, v226
    v_mul_f32 v130, v130, v226
    v_mul_f32 v131, v131, v226
    v_mul_f32 v132, v132, v226
    v_mul_f32 v133, v133, v226
    v_mul_f32 v134, v134, v226
    v_mul_f32 v135, v135, v226
    v_mfma_f32_16x16x32_bf16 a[188:191], a[232:235], v[172:175], a[188:191]
    v_cvt_pk_bf16_f32 v112, v128, v129
    v_cvt_pk_bf16_f32 v113, v130, v131
    v_cvt_pk_bf16_f32 v114, v132, v133
    v_cvt_pk_bf16_f32 v115, v134, v135
    buffer_store_dwordx4 v[112:115], v235, s[20:23], s44 offen offset:1024 sc1
    s_cbranch_vccz L_attn_ex21
    ds_write_b128 v248, v[112:115] offset:5120
L_attn_ex21:
    v_accvgpr_read_b32 v136, a164
    v_accvgpr_read_b32 v137, a165
    v_mfma_f32_16x16x32_bf16 a[188:191], a[236:239], v[188:191], a[188:191]
    v_accvgpr_read_b32 v138, a166
    v_accvgpr_read_b32 v139, a167
    v_accvgpr_read_b32 v140, a180
    v_accvgpr_read_b32 v141, a181
    v_accvgpr_read_b32 v142, a182
    v_accvgpr_read_b32 v143, a183
    v_mul_f32 v136, v136, v227
    v_mul_f32 v137, v137, v227
    v_mul_f32 v138, v138, v227
    v_mul_f32 v139, v139, v227
    v_mul_f32 v140, v140, v227
    v_mul_f32 v141, v141, v227
    v_mul_f32 v142, v142, v227
    v_mul_f32 v143, v143, v227
    v_cvt_pk_bf16_f32 v116, v136, v137
    v_cvt_pk_bf16_f32 v117, v138, v139
    v_cvt_pk_bf16_f32 v118, v140, v141
    v_cvt_pk_bf16_f32 v119, v142, v143
    buffer_store_dwordx4 v[116:119], v235, s[20:23], s45 offen offset:1024 sc1
    s_cbranch_vccz L_attn_ex22
    ds_write_b128 v248, v[116:119] offset:11264
L_attn_ex22:
    v_accvgpr_read_b32 v144, a168
    v_accvgpr_read_b32 v145, a169
    v_accvgpr_read_b32 v146, a170
    v_accvgpr_read_b32 v147, a171
    v_accvgpr_read_b32 v148, a184
    v_accvgpr_read_b32 v149, a185
    v_accvgpr_read_b32 v150, a186
    v_accvgpr_read_b32 v151, a187
    v_mul_f32 v144, v144, v228
    v_mul_f32 v145, v145, v228
    v_mul_f32 v146, v146, v228
    v_mul_f32 v147, v147, v228
    v_mul_f32 v148, v148, v228
    v_mul_f32 v149, v149, v228
    v_mul_f32 v150, v150, v228
    v_mul_f32 v151, v151, v228
    v_cvt_pk_bf16_f32 v120, v144, v145
    v_cvt_pk_bf16_f32 v121, v146, v147
    v_cvt_pk_bf16_f32 v122, v148, v149
    v_cvt_pk_bf16_f32 v123, v150, v151
    buffer_store_dwordx4 v[120:123], v235, s[20:23], s46 offen offset:1024 sc1
    s_cbranch_vccz L_attn_ex23
    ds_write_b128 v248, v[120:123] offset:17408
L_attn_ex23:
    v_accvgpr_read_b32 v152, a172
    v_accvgpr_read_b32 v153, a173
    v_accvgpr_read_b32 v154, a174
    v_accvgpr_read_b32 v155, a175
    v_accvgpr_read_b32 v156, a188
    v_accvgpr_read_b32 v157, a189
    v_accvgpr_read_b32 v158, a190
    v_accvgpr_read_b32 v159, a191
    v_mul_f32 v152, v152, v229
    v_mul_f32 v153, v153, v229
    v_mul_f32 v154, v154, v229
    v_mul_f32 v155, v155, v229
    v_mul_f32 v156, v156, v229
    v_mul_f32 v157, v157, v229
    v_mul_f32 v158, v158, v229
    v_mul_f32 v159, v159, v229
    v_cvt_pk_bf16_f32 v124, v152, v153
    v_cvt_pk_bf16_f32 v125, v154, v155
    v_cvt_pk_bf16_f32 v126, v156, v157
    v_cvt_pk_bf16_f32 v127, v158, v159
    buffer_store_dwordx4 v[124:127], v235, s[20:23], s47 offen offset:1024 sc1
    s_cbranch_vccz L_attn_ex24
    ds_write_b128 v248, v[124:127] offset:23552
L_attn_ex24:
    s_mov_b64 s[8:9], s[84:85]
    s_mov_b32 s10, s86
    s_mov_b32 s11, 0x20000
    s_mov_b32 s34, s91
    s_waitcnt vmcnt(25) lgkmcnt(0)
    s_barrier
L_attn_tailcode:
    s_load_dwordx2 s[4:5], s[0:1], 0
    s_load_dwordx2 s[6:7], s[0:1], 112
    s_load_dwordx2 s[80:81], s[0:1], 96
    s_lshr_b32 s23, s2, 5
    s_lshl_b32 s23, s23, 5
    s_add_u32 s23, s23, s3
    s_lshl_b32 s23, s23, 7
    v_mbcnt_lo_u32_b32 v161, -1, 0
    v_mbcnt_hi_u32_b32 v161, -1, v161
    s_lshl_b32 s26, s24, 6
    v_add_u32 v162, s26, v161
    v_lshlrev_b32 v140, 4, v161
    s_mul_i32 s38, s24, 5120
    s_mul_i32 s39, s24, 6144
    s_sub_u32 s36, s24, 1
    s_mul_i32 s90, s36, 7168
    s_mul_i32 s91, s36, 8192
    s_and_b32 s12, s2, 1
    s_lshr_b32 s13, s2, 5
    s_lshl_b32 s13, s13, 1
    s_add_u32 s12, s12, s13
    s_bfe_u32 s13, s2, 0x20001
    s_bfe_u32 s14, s2, 0x20003
    s_and_b32 s3, s2, 7
    s_lshl_b32 s3, s3, 2
    s_bfe_u32 s26, s2, 0x20003
    s_add_u32 s3, s3, s26
    s_lshr_b32 s25, s2, 5
    s_and_b32 s36, s3, 1
    s_lshl_b32 s36, s36, 3
    s_add_u32 s40, s36, s25
    s_mul_i32 s16, s14, 1966080
    s_mul_i32 s36, s13, 491520
    s_add_u32 s16, s16, s36
    s_add_u32 s16, s16, 83886080
    s_mul_i32 s17, s25, 102400
    s_add_u32 s17, s17, 94371840
    s_mul_i32 s18, s25, 102400
    s_add_u32 s18, s18, 95420416
    s_mul_i32 s19, s40, 122880
    s_add_u32 s19, s19, 96468992
    s_mul_i32 s20, s25, 245760
    s_add_u32 s20, s20, 92274688
    s_lshl_b32 s21, s12, 2
    s_add_u32 s21, s21, s14
    s_lshl_b32 s21, s21, 2
    s_add_u32 s21, s21, s13
    s_lshl_b32 s21, s21, 7
    s_lshl_b32 s22, s3, 3
    s_add_u32 s22, s22, s25
    s_lshl_b32 s22, s22, 7
    s_waitcnt lgkmcnt(0)
    s_add_u32 s52, s6, 3145728
    s_addc_u32 s53, s7, 0
    s_mov_b32 s54, 524288
    s_mov_b32 s55, 0x20000
    v_cmp_gt_u32 vcc, 16, v162
    v_mov_b32 v146, 2147418112
    v_mov_b32 v147, 1
    v_lshlrev_b32 v164, 2, v162
    v_cndmask_b32 v146, v146, v164, vcc
    v_and_b32 v164, 7, v161
    v_lshlrev_b32 v164, 7, v164
    v_lshrrev_b32 v165, 3, v161
    s_lshl_b32 s36, s3, 10
    v_add_u32 v143, s36, v164
    v_min_u32 v166, 2, v165
    v_add_u32 v166, s3, v166
    v_max_u32 v166, 1, v166
    v_min_u32 v166, 32, v166
    v_subrev_u32 v166, 1, v166
    v_lshl_add_u32 v144, v166, 10, v164
    s_and_b32 s36, s3, 30
    v_and_b32 v165, 1, v165
    v_add_u32 v165, s36, v165
    v_lshl_add_u32 v145, v165, 10, v164
    s_lshr_b32 s36, s3, 1
    s_lshl_b32 s36, s36, 11
    v_and_b32 v165, 15, v161
    v_lshlrev_b32 v165, 7, v165
    v_add_u32 v159, s36, v165
    s_lshr_b32 s36, s12, 1
    s_lshl_b32 s36, s36, 2
    s_add_u32 s36, s36, s13
    s_lshl_b32 s36, s36, 10
    v_add_u32 v160, s36, v164
    s_lshl_b32 s26, s12, 3
    s_lshl_b32 s27, s24, 1
    s_add_u32 s26, s26, s27
    s_mul_i32 s27, s26, 196608
    s_mul_i32 s36, s13, 49152
    s_add_u32 s27, s27, s36
    s_add_u32 s27, s27, 4194304
    s_add_u32 s44, s6, s27
    s_addc_u32 s45, s7, 0
    s_mov_b32 s46, 49152
    s_mov_b32 s47, 0x20000
    s_add_u32 s27, s27, 196608
    s_add_u32 s48, s6, s27
    s_addc_u32 s49, s7, 0
    s_mov_b32 s50, 49152
    s_mov_b32 s51, 0x20000
    s_mul_i32 s27, s13, 2621440
    s_mul_i32 s26, s26, 20480
    s_add_u32 s27, s27, s26
    s_mul_i32 s26, s14, 5120
    s_add_u32 s27, s27, s26
    s_add_u32 s27, s27, 33554432
    s_add_u32 s84, s6, s27
    s_addc_u32 s85, s7, 0
    s_mov_b32 s86, 25600
    s_mov_b32 s87, 0x20000
    v_lshrrev_b32 v164, 2, v161
    v_mul_u32_u24 v164, 320, v164
    v_and_b32 v165, 3, v161
    v_lshl_add_u32 v164, v165, 3, v164
    v_bfe_u32 v165, v161, 4, 1
    v_lshl_add_u32 v151, v165, 5, v164
    v_xor_b32 v165, 1, v165
    v_lshl_add_u32 v152, v165, 5, v164
    v_add_u32 v153, 49152, v151
    v_add_u32 v154, 49152, v152
    v_add_u32 v155, 98304, v151
    v_add_u32 v156, 98304, v152
    s_and_b32 s42, s2, 1
    s_lshl_b32 s42, s42, 2
    s_add_u32 s42, s42, s14
    s_mul_i32 s60, s42, 61440
    s_add_u32 s61, s60, 61440
    s_mul_i32 s62, s42, 6144
    s_add_u32 s63, s62, 6144
    s_cmp_eq_u32 s42, 0
    s_cselect_b32 s34, s61, 0
    s_cselect_b32 s42, s63, 0
    s_mov_b32 s36, 262144
    buffer_load_dword v173, v160, s[52:55], s36 offen sc1
    s_mul_i32 s26, s24, 12288
    s_add_u32 s26, s26, 49152
    v_add_u32 v167, s26, v140
    ds_read_b128 a[0:3], v167 offset:0
    ds_read_b128 a[4:7], v167 offset:6144
    ds_read_b128 a[8:11], v167 offset:1024
    ds_read_b128 a[12:15], v167 offset:7168
    ds_read_b128 a[16:19], v167 offset:2048
    ds_read_b128 a[20:23], v167 offset:8192
    ds_read_b128 a[24:27], v167 offset:3072
    ds_read_b128 a[28:31], v167 offset:9216
    ds_read_b128 a[32:35], v167 offset:4096
    ds_read_b128 a[36:39], v167 offset:10240
    ds_read_b128 a[40:43], v167 offset:5120
    ds_read_b128 a[44:47], v167 offset:11264
    s_waitcnt lgkmcnt(0)
    ds_read_b64_tr_b16 a[192:193], v155 offset:24576
    ds_read_b64_tr_b16 a[194:195], v155 offset:29696
    ds_read_b64_tr_b16 a[196:197], v155 offset:34816
    ds_read_b64_tr_b16 a[198:199], v155 offset:39936
    ds_read_b64_tr_b16 a[200:201], v156 offset:24576
    ds_read_b64_tr_b16 a[202:203], v156 offset:29696
    ds_read_b64_tr_b16 a[204:205], v156 offset:34816
    ds_read_b64_tr_b16 a[206:207], v156 offset:39936
    ds_read_b64_tr_b16 a[208:209], v155 offset:24640
    ds_read_b64_tr_b16 a[210:211], v155 offset:29760
    ds_read_b64_tr_b16 a[212:213], v155 offset:34880
    ds_read_b64_tr_b16 a[214:215], v155 offset:40000
    ds_read_b64_tr_b16 a[216:217], v156 offset:24640
    ds_read_b64_tr_b16 a[218:219], v156 offset:29760
    ds_read_b64_tr_b16 a[220:221], v156 offset:34880
    ds_read_b64_tr_b16 a[222:223], v156 offset:40000
    s_mov_b32 s28, 0
    s_mov_b32 s29, 4096
    s_mov_b32 s30, 20480
    s_mov_b32 s31, 24576
    s_waitcnt lgkmcnt(12)
    v_mfma_f32_16x16x32_bf16 v[0:3], a[192:195], a[0:3], 0
    ds_read_b64_tr_b16 a[224:225], v155 offset:24704
    v_mfma_f32_16x16x32_bf16 v[0:3], a[196:199], a[8:11], v[0:3]
    ds_read_b64_tr_b16 a[226:227], v155 offset:29824
    v_mfma_f32_16x16x32_bf16 v[40:43], a[192:195], a[4:7], 0
    ds_read_b64_tr_b16 a[228:229], v155 offset:34944
    v_mfma_f32_16x16x32_bf16 v[40:43], a[196:199], a[12:15], v[40:43]
    ds_read_b64_tr_b16 a[230:231], v155 offset:40064
    s_waitcnt lgkmcnt(12)
    v_mfma_f32_16x16x32_bf16 v[4:7], a[200:203], a[0:3], 0
    ds_read_b64_tr_b16 a[192:193], v156 offset:24704
    v_mfma_f32_16x16x32_bf16 v[4:7], a[204:207], a[8:11], v[4:7]
    ds_read_b64_tr_b16 a[194:195], v156 offset:29824
    v_mfma_f32_16x16x32_bf16 v[44:47], a[200:203], a[4:7], 0
    ds_read_b64_tr_b16 a[196:197], v156 offset:34944
    v_mfma_f32_16x16x32_bf16 v[44:47], a[204:207], a[12:15], v[44:47]
    ds_read_b64_tr_b16 a[198:199], v156 offset:40064
    s_waitcnt lgkmcnt(12)
    v_mfma_f32_16x16x32_bf16 v[8:11], a[208:211], a[0:3], 0
    ds_read_b64_tr_b16 a[200:201], v155 offset:24768
    v_mfma_f32_16x16x32_bf16 v[8:11], a[212:215], a[8:11], v[8:11]
    ds_read_b64_tr_b16 a[202:203], v155 offset:29888
    v_mfma_f32_16x16x32_bf16 v[48:51], a[208:211], a[4:7], 0
    ds_read_b64_tr_b16 a[204:205], v155 offset:35008
    v_mfma_f32_16x16x32_bf16 v[48:51], a[212:215], a[12:15], v[48:51]
    ds_read_b64_tr_b16 a[206:207], v155 offset:40128
    s_waitcnt lgkmcnt(12)
    v_mfma_f32_16x16x32_bf16 v[12:15], a[216:219], a[0:3], 0
    ds_read_b64_tr_b16 a[208:209], v156 offset:24768
    v_mfma_f32_16x16x32_bf16 v[12:15], a[220:223], a[8:11], v[12:15]
    ds_read_b64_tr_b16 a[210:211], v156 offset:29888
    v_mfma_f32_16x16x32_bf16 v[52:55], a[216:219], a[4:7], 0
    ds_read_b64_tr_b16 a[212:213], v156 offset:35008
    v_mfma_f32_16x16x32_bf16 v[52:55], a[220:223], a[12:15], v[52:55]
    ds_read_b64_tr_b16 a[214:215], v156 offset:40128
    s_waitcnt lgkmcnt(12)
    v_mfma_f32_16x16x32_bf16 v[16:19], a[224:227], a[0:3], 0
    ds_read_b64_tr_b16 a[216:217], v155 offset:24832
    v_mfma_f32_16x16x32_bf16 v[16:19], a[228:231], a[8:11], v[16:19]
    ds_read_b64_tr_b16 a[218:219], v155 offset:29952
    v_mfma_f32_16x16x32_bf16 v[56:59], a[224:227], a[4:7], 0
    ds_read_b64_tr_b16 a[220:221], v155 offset:35072
    v_mfma_f32_16x16x32_bf16 v[56:59], a[228:231], a[12:15], v[56:59]
    ds_read_b64_tr_b16 a[222:223], v155 offset:40192
    s_waitcnt lgkmcnt(12)
    v_mfma_f32_16x16x32_bf16 v[20:23], a[192:195], a[0:3], 0
    ds_read_b64_tr_b16 a[224:225], v156 offset:24832
    v_mfma_f32_16x16x32_bf16 v[20:23], a[196:199], a[8:11], v[20:23]
    ds_read_b64_tr_b16 a[226:227], v156 offset:29952
    v_mfma_f32_16x16x32_bf16 v[60:63], a[192:195], a[4:7], 0
    ds_read_b64_tr_b16 a[228:229], v156 offset:35072
    v_mfma_f32_16x16x32_bf16 v[60:63], a[196:199], a[12:15], v[60:63]
    ds_read_b64_tr_b16 a[230:231], v156 offset:40192
    s_waitcnt lgkmcnt(12)
    v_mfma_f32_16x16x32_bf16 v[24:27], a[200:203], a[0:3], 0
    ds_read_b64_tr_b16 a[192:193], v151 offset:0
    v_mfma_f32_16x16x32_bf16 v[24:27], a[204:207], a[8:11], v[24:27]
    ds_read_b64_tr_b16 a[194:195], v151 offset:5120
    v_mfma_f32_16x16x32_bf16 v[64:67], a[200:203], a[4:7], 0
    ds_read_b64_tr_b16 a[196:197], v151 offset:10240
    v_mfma_f32_16x16x32_bf16 v[64:67], a[204:207], a[12:15], v[64:67]
    ds_read_b64_tr_b16 a[198:199], v151 offset:15360
    s_waitcnt lgkmcnt(12)
    v_mfma_f32_16x16x32_bf16 v[28:31], a[208:211], a[0:3], 0
    ds_read_b64_tr_b16 a[200:201], v152 offset:0
    v_mfma_f32_16x16x32_bf16 v[28:31], a[212:215], a[8:11], v[28:31]
    ds_read_b64_tr_b16 a[202:203], v152 offset:5120
    v_mfma_f32_16x16x32_bf16 v[68:71], a[208:211], a[4:7], 0
    ds_read_b64_tr_b16 a[204:205], v152 offset:10240
    v_mfma_f32_16x16x32_bf16 v[68:71], a[212:215], a[12:15], v[68:71]
    ds_read_b64_tr_b16 a[206:207], v152 offset:15360
    s_waitcnt lgkmcnt(12)
    v_mfma_f32_16x16x32_bf16 v[32:35], a[216:219], a[0:3], 0
    ds_read_b64_tr_b16 a[208:209], v151 offset:64
    v_mfma_f32_16x16x32_bf16 v[32:35], a[220:223], a[8:11], v[32:35]
    ds_read_b64_tr_b16 a[210:211], v151 offset:5184
    v_mfma_f32_16x16x32_bf16 v[72:75], a[216:219], a[4:7], 0
    ds_read_b64_tr_b16 a[212:213], v151 offset:10304
    v_mfma_f32_16x16x32_bf16 v[72:75], a[220:223], a[12:15], v[72:75]
    ds_read_b64_tr_b16 a[214:215], v151 offset:15424
    s_waitcnt lgkmcnt(12)
    v_mfma_f32_16x16x32_bf16 v[36:39], a[224:227], a[0:3], 0
    ds_read_b64_tr_b16 a[216:217], v152 offset:64
    v_mfma_f32_16x16x32_bf16 v[36:39], a[228:231], a[8:11], v[36:39]
    ds_read_b64_tr_b16 a[218:219], v152 offset:5184
    v_mfma_f32_16x16x32_bf16 v[76:79], a[224:227], a[4:7], 0
    ds_read_b64_tr_b16 a[220:221], v152 offset:10304
    v_mfma_f32_16x16x32_bf16 v[76:79], a[228:231], a[12:15], v[76:79]
    ds_read_b64_tr_b16 a[222:223], v152 offset:15424
    s_waitcnt lgkmcnt(12)
    v_mfma_f32_16x16x32_bf16 v[0:3], a[192:195], a[16:19], v[0:3]
    ds_read_b64_tr_b16 a[224:225], v151 offset:128
    v_mfma_f32_16x16x32_bf16 v[0:3], a[196:199], a[24:27], v[0:3]
    ds_read_b64_tr_b16 a[226:227], v151 offset:5248
    v_mfma_f32_16x16x32_bf16 v[40:43], a[192:195], a[20:23], v[40:43]
    ds_read_b64_tr_b16 a[228:229], v151 offset:10368
    v_mfma_f32_16x16x32_bf16 v[40:43], a[196:199], a[28:31], v[40:43]
    ds_read_b64_tr_b16 a[230:231], v151 offset:15488
    s_add_u32 s36, s23, 163840
    s_waitcnt vmcnt(0)
    s_barrier
    buffer_store_dword v147, v146, s[52:55], s36 offen sc1
    s_mov_b32 s27, 196608
    v_lshrrev_b32 v164, 12, v143
    v_bfe_u32 v165, v143, 10, 2
    v_bfe_u32 v166, v143, 7, 3
    v_lshl_add_u32 v164, v165, 3, v164
    v_lshl_add_u32 v164, v166, 5, v164
    v_lshlrev_b32 v164, 7, v164
    buffer_load_dword v184, v164, s[52:55], s27 offen sc1
    v_lshrrev_b32 v164, 12, v144
    v_bfe_u32 v165, v144, 10, 2
    v_bfe_u32 v166, v144, 7, 3
    v_lshl_add_u32 v164, v165, 3, v164
    v_lshl_add_u32 v164, v166, 5, v164
    v_lshlrev_b32 v164, 7, v164
    buffer_load_dword v185, v164, s[52:55], s27 offen sc1
    v_lshrrev_b32 v164, 12, v145
    v_bfe_u32 v165, v145, 10, 2
    v_bfe_u32 v166, v145, 7, 3
    v_lshl_add_u32 v164, v165, 3, v164
    v_lshl_add_u32 v164, v166, 5, v164
    v_lshlrev_b32 v164, 7, v164
    buffer_load_dword v186, v164, s[52:55], s27 offen sc1
    s_waitcnt vmcnt(4)
    v_cmp_ne_u32 vcc, 1, v173
    s_mov_b32 s36, 262144
    s_mov_b32 s37, 0x100000
    s_nop 2
    s_cbranch_vccnz L_tail_aspin800
L_tail_aok800:
    s_waitcnt lgkmcnt(12)
    v_mfma_f32_16x16x32_bf16 v[4:7], a[200:203], a[16:19], v[4:7]
    s_add_u32 s35, s34, s38
    s_add_u32 s43, s35, 4096
    s_add_u32 m0, s38, 49152
    s_nop 0
    buffer_load_dwordx4 v140, s[8:11], s35 offen offset:0  lds
    v_mfma_f32_16x16x32_bf16 v[4:7], a[204:207], a[24:27], v[4:7]
    buffer_load_dwordx4 v140, s[8:11], s35 offen offset:1024  lds
    v_mfma_f32_16x16x32_bf16 v[44:47], a[200:203], a[20:23], v[44:47]
    buffer_load_dwordx4 v140, s[8:11], s35 offen offset:2048  lds
    v_mfma_f32_16x16x32_bf16 v[44:47], a[204:207], a[28:31], v[44:47]
    buffer_load_dwordx4 v140, s[8:11], s35 offen offset:3072  lds
    s_add_u32 m0, s38, 53248
    s_nop 0
    ds_read_b64_tr_b16 a[192:193], v152 offset:128
    ds_read_b64_tr_b16 a[194:195], v152 offset:5248
    ds_read_b64_tr_b16 a[196:197], v152 offset:10368
    ds_read_b64_tr_b16 a[198:199], v152 offset:15488
    s_waitcnt lgkmcnt(12)
    v_mfma_f32_16x16x32_bf16 v[8:11], a[208:211], a[16:19], v[8:11]
    buffer_load_dwordx4 v140, s[8:11], s43 offen offset:0  lds
    s_add_u32 s34, s34, 61440
    s_cmp_eq_u32 s34, s60
    s_cmov_b32 s34, s61
    v_mfma_f32_16x16x32_bf16 v[8:11], a[212:215], a[24:27], v[8:11]
    buffer_load_dwordx4 a[48:51], v140, s[44:47], s42 offen offset:0 sc1
    v_mfma_f32_16x16x32_bf16 v[48:51], a[208:211], a[20:23], v[48:51]
    buffer_load_dwordx4 a[52:55], v140, s[48:51], s42 offen offset:0 sc1
    v_mfma_f32_16x16x32_bf16 v[48:51], a[212:215], a[28:31], v[48:51]
    buffer_load_dwordx4 a[56:59], v140, s[44:47], s42 offen offset:1024 sc1
    ds_read_b64_tr_b16 a[200:201], v151 offset:192
    ds_read_b64_tr_b16 a[202:203], v151 offset:5312
    ds_read_b64_tr_b16 a[204:205], v151 offset:10432
    ds_read_b64_tr_b16 a[206:207], v151 offset:15552
    s_waitcnt lgkmcnt(12)
    v_mfma_f32_16x16x32_bf16 v[12:15], a[216:219], a[16:19], v[12:15]
    buffer_load_dwordx4 a[60:63], v140, s[48:51], s42 offen offset:1024 sc1
    s_add_u32 s42, s42, 6144
    s_cmp_eq_u32 s42, s62
    s_cmov_b32 s42, s63
    s_add_u32 s35, s34, s38
    s_add_u32 s43, s35, 4096
    s_add_u32 m0, s38, 73728
    s_nop 0
    v_mfma_f32_16x16x32_bf16 v[12:15], a[220:223], a[24:27], v[12:15]
    buffer_load_dwordx4 v140, s[8:11], s35 offen offset:0  lds
    v_mfma_f32_16x16x32_bf16 v[52:55], a[216:219], a[20:23], v[52:55]
    buffer_load_dwordx4 v140, s[8:11], s35 offen offset:1024  lds
    v_mfma_f32_16x16x32_bf16 v[52:55], a[220:223], a[28:31], v[52:55]
    buffer_load_dwordx4 v140, s[8:11], s35 offen offset:2048  lds
    ds_read_b64_tr_b16 a[208:209], v152 offset:192
    ds_read_b64_tr_b16 a[210:211], v152 offset:5312
    ds_read_b64_tr_b16 a[212:213], v152 offset:10432
    ds_read_b64_tr_b16 a[214:215], v152 offset:15552
    s_waitcnt lgkmcnt(12)
    v_mfma_f32_16x16x32_bf16 v[16:19], a[224:227], a[16:19], v[16:19]
    buffer_load_dwordx4 v140, s[8:11], s35 offen offset:3072  lds
    s_add_u32 m0, s38, 77824
    s_nop 0
    v_mfma_f32_16x16x32_bf16 v[16:19], a[228:231], a[24:27], v[16:19]
    buffer_load_dwordx4 v140, s[8:11], s43 offen offset:0  lds
    s_add_u32 s34, s34, 61440
    s_cmp_eq_u32 s34, s60
    s_cmov_b32 s34, s61
    v_mfma_f32_16x16x32_bf16 v[56:59], a[224:227], a[20:23], v[56:59]
    buffer_load_dwordx4 a[0:3], v140, s[44:47], s42 offen offset:0 sc1
    v_mfma_f32_16x16x32_bf16 v[56:59], a[228:231], a[28:31], v[56:59]
    buffer_load_dwordx4 a[4:7], v140, s[48:51], s42 offen offset:0 sc1
    ds_read_b64_tr_b16 a[216:217], v151 offset:256
    ds_read_b64_tr_b16 a[218:219], v151 offset:5376
    ds_read_b64_tr_b16 a[220:221], v151 offset:10496
    ds_read_b64_tr_b16 a[222:223], v151 offset:15616
    s_waitcnt lgkmcnt(12)
    v_mfma_f32_16x16x32_bf16 v[20:23], a[192:195], a[16:19], v[20:23]
    buffer_load_dwordx4 a[8:11], v140, s[44:47], s42 offen offset:1024 sc1
    v_mfma_f32_16x16x32_bf16 v[20:23], a[196:199], a[24:27], v[20:23]
    buffer_load_dwordx4 a[12:15], v140, s[48:51], s42 offen offset:1024 sc1
    s_add_u32 s42, s42, 6144
    s_cmp_eq_u32 s42, s62
    s_cmov_b32 s42, s63
    v_mfma_f32_16x16x32_bf16 v[60:63], a[192:195], a[20:23], v[60:63]
    ds_read_b64_tr_b16 a[224:225], v152 offset:256
    ds_read_b64_tr_b16 a[226:227], v152 offset:5376
    v_mfma_f32_16x16x32_bf16 v[60:63], a[196:199], a[28:31], v[60:63]
    ds_read_b64_tr_b16 a[228:229], v152 offset:10496
    ds_read_b64_tr_b16 a[230:231], v152 offset:15616
    s_waitcnt lgkmcnt(12)
    v_mfma_f32_16x16x32_bf16 v[24:27], a[200:203], a[16:19], v[24:27]
    ds_read_b64_tr_b16 a[192:193], v151 offset:24576
    v_mfma_f32_16x16x32_bf16 v[24:27], a[204:207], a[24:27], v[24:27]
    ds_read_b64_tr_b16 a[194:195], v151 offset:29696
    v_mfma_f32_16x16x32_bf16 v[64:67], a[200:203], a[20:23], v[64:67]
    ds_read_b64_tr_b16 a[196:197], v151 offset:34816
    v_mfma_f32_16x16x32_bf16 v[64:67], a[204:207], a[28:31], v[64:67]
    ds_read_b64_tr_b16 a[198:199], v151 offset:39936
    s_waitcnt lgkmcnt(12)
    v_mfma_f32_16x16x32_bf16 v[28:31], a[208:211], a[16:19], v[28:31]
    ds_read_b64_tr_b16 a[200:201], v152 offset:24576
    v_mfma_f32_16x16x32_bf16 v[28:31], a[212:215], a[24:27], v[28:31]
    ds_read_b64_tr_b16 a[202:203], v152 offset:29696
    v_mfma_f32_16x16x32_bf16 v[68:71], a[208:211], a[20:23], v[68:71]
    ds_read_b64_tr_b16 a[204:205], v152 offset:34816
    v_mfma_f32_16x16x32_bf16 v[68:71], a[212:215], a[28:31], v[68:71]
    ds_read_b64_tr_b16 a[206:207], v152 offset:39936
    s_waitcnt lgkmcnt(12)
    v_mfma_f32_16x16x32_bf16 v[32:35], a[216:219], a[16:19], v[32:35]
    ds_read_b64_tr_b16 a[208:209], v151 offset:24640
    v_mfma_f32_16x16x32_bf16 v[32:35], a[220:223], a[24:27], v[32:35]
    ds_read_b64_tr_b16 a[210:211], v151 offset:29760
    v_mfma_f32_16x16x32_bf16 v[72:75], a[216:219], a[20:23], v[72:75]
    ds_read_b64_tr_b16 a[212:213], v151 offset:34880
    v_mfma_f32_16x16x32_bf16 v[72:75], a[220:223], a[28:31], v[72:75]
    ds_read_b64_tr_b16 a[214:215], v151 offset:40000
    s_waitcnt lgkmcnt(12)
    v_mfma_f32_16x16x32_bf16 v[36:39], a[224:227], a[16:19], v[36:39]
    ds_read_b64_tr_b16 a[216:217], v152 offset:24640
    v_mfma_f32_16x16x32_bf16 v[36:39], a[228:231], a[24:27], v[36:39]
    ds_read_b64_tr_b16 a[218:219], v152 offset:29760
    v_mfma_f32_16x16x32_bf16 v[76:79], a[224:227], a[20:23], v[76:79]
    ds_read_b64_tr_b16 a[220:221], v152 offset:34880
    v_mfma_f32_16x16x32_bf16 v[76:79], a[228:231], a[28:31], v[76:79]
    ds_read_b64_tr_b16 a[222:223], v152 offset:40000
    s_waitcnt lgkmcnt(12)
    v_mfma_f32_16x16x32_bf16 v[0:3], a[192:195], a[32:35], v[0:3]
    ds_read_b64_tr_b16 a[224:225], v151 offset:24704
    v_mfma_f32_16x16x32_bf16 v[0:3], a[196:199], a[40:43], v[0:3]
    ds_read_b64_tr_b16 a[226:227], v151 offset:29824
    v_mfma_f32_16x16x32_bf16 v[40:43], a[192:195], a[36:39], v[40:43]
    ds_read_b64_tr_b16 a[228:229], v151 offset:34944
    v_mfma_f32_16x16x32_bf16 v[40:43], a[196:199], a[44:47], v[40:43]
    ds_read_b64_tr_b16 a[230:231], v151 offset:40064
    s_waitcnt lgkmcnt(12)
    v_mfma_f32_16x16x32_bf16 v[4:7], a[200:203], a[32:35], v[4:7]
    ds_read_b64_tr_b16 a[192:193], v152 offset:24704
    v_mfma_f32_16x16x32_bf16 v[4:7], a[204:207], a[40:43], v[4:7]
    ds_read_b64_tr_b16 a[194:195], v152 offset:29824
    v_mfma_f32_16x16x32_bf16 v[44:47], a[200:203], a[36:39], v[44:47]
    ds_read_b64_tr_b16 a[196:197], v152 offset:34944
    v_mfma_f32_16x16x32_bf16 v[44:47], a[204:207], a[44:47], v[44:47]
    ds_read_b64_tr_b16 a[198:199], v152 offset:40064
    s_waitcnt lgkmcnt(12)
    v_mfma_f32_16x16x32_bf16 v[8:11], a[208:211], a[32:35], v[8:11]
    ds_read_b64_tr_b16 a[200:201], v151 offset:24768
    v_mfma_f32_16x16x32_bf16 v[8:11], a[212:215], a[40:43], v[8:11]
    ds_read_b64_tr_b16 a[202:203], v151 offset:29888
    v_mfma_f32_16x16x32_bf16 v[48:51], a[208:211], a[36:39], v[48:51]
    ds_read_b64_tr_b16 a[204:205], v151 offset:35008
    v_mfma_f32_16x16x32_bf16 v[48:51], a[212:215], a[44:47], v[48:51]
    ds_read_b64_tr_b16 a[206:207], v151 offset:40128
    s_waitcnt lgkmcnt(12)
    v_mfma_f32_16x16x32_bf16 v[12:15], a[216:219], a[32:35], v[12:15]
    ds_read_b64_tr_b16 a[208:209], v152 offset:24768
    v_mfma_f32_16x16x32_bf16 v[12:15], a[220:223], a[40:43], v[12:15]
    ds_read_b64_tr_b16 a[210:211], v152 offset:29888
    v_mfma_f32_16x16x32_bf16 v[52:55], a[216:219], a[36:39], v[52:55]
    ds_read_b64_tr_b16 a[212:213], v152 offset:35008
    v_mfma_f32_16x16x32_bf16 v[52:55], a[220:223], a[44:47], v[52:55]
    ds_read_b64_tr_b16 a[214:215], v152 offset:40128
    s_waitcnt lgkmcnt(12)
    v_mfma_f32_16x16x32_bf16 v[16:19], a[224:227], a[32:35], v[16:19]
    ds_read_b64_tr_b16 a[216:217], v151 offset:24832
    v_mfma_f32_16x16x32_bf16 v[16:19], a[228:231], a[40:43], v[16:19]
    ds_read_b64_tr_b16 a[218:219], v151 offset:29952
    v_mfma_f32_16x16x32_bf16 v[56:59], a[224:227], a[36:39], v[56:59]
    ds_read_b64_tr_b16 a[220:221], v151 offset:35072
    v_mfma_f32_16x16x32_bf16 v[56:59], a[228:231], a[44:47], v[56:59]
    ds_read_b64_tr_b16 a[222:223], v151 offset:40192
    s_waitcnt lgkmcnt(12)
    v_mfma_f32_16x16x32_bf16 v[20:23], a[192:195], a[32:35], v[20:23]
    ds_read_b64_tr_b16 a[224:225], v152 offset:24832
    v_mfma_f32_16x16x32_bf16 v[20:23], a[196:199], a[40:43], v[20:23]
    ds_read_b64_tr_b16 a[226:227], v152 offset:29952
    v_mfma_f32_16x16x32_bf16 v[60:63], a[192:195], a[36:39], v[60:63]
    ds_read_b64_tr_b16 a[228:229], v152 offset:35072
    v_mfma_f32_16x16x32_bf16 v[60:63], a[196:199], a[44:47], v[60:63]
    ds_read_b64_tr_b16 a[230:231], v152 offset:40192
    s_waitcnt vmcnt(9)
    s_barrier
    s_waitcnt lgkmcnt(12)
    v_mfma_f32_16x16x32_bf16 v[24:27], a[200:203], a[32:35], v[24:27]
    s_add_u32 s35, s34, s38
    s_add_u32 s43, s35, 4096
    s_add_u32 m0, s38, 98304
    s_nop 0
    buffer_load_dwordx4 v140, s[8:11], s35 offen offset:0  lds
    v_mfma_f32_16x16x32_bf16 v[24:27], a[204:207], a[40:43], v[24:27]
    buffer_load_dwordx4 v140, s[8:11], s35 offen offset:1024  lds
    v_mfma_f32_16x16x32_bf16 v[64:67], a[200:203], a[36:39], v[64:67]
    buffer_load_dwordx4 v140, s[8:11], s35 offen offset:2048  lds
    v_mfma_f32_16x16x32_bf16 v[64:67], a[204:207], a[44:47], v[64:67]
    buffer_load_dwordx4 v140, s[8:11], s35 offen offset:3072  lds
    s_add_u32 m0, s38, 102400
    s_nop 0
    ds_read_b64_tr_b16 a[192:193], v153 offset:0
    ds_read_b64_tr_b16 a[194:195], v153 offset:5120
    ds_read_b64_tr_b16 a[196:197], v153 offset:10240
    ds_read_b64_tr_b16 a[198:199], v153 offset:15360
    s_waitcnt lgkmcnt(12)
    v_mfma_f32_16x16x32_bf16 v[28:31], a[208:211], a[32:35], v[28:31]
    buffer_load_dwordx4 v140, s[8:11], s43 offen offset:0  lds
    s_add_u32 s34, s34, 61440
    s_cmp_eq_u32 s34, s60
    s_cmov_b32 s34, s61
    v_mfma_f32_16x16x32_bf16 v[28:31], a[212:215], a[40:43], v[28:31]
    buffer_load_dwordx4 a[16:19], v140, s[44:47], s42 offen offset:0 sc1
    v_mfma_f32_16x16x32_bf16 v[68:71], a[208:211], a[36:39], v[68:71]
    buffer_load_dwordx4 a[20:23], v140, s[48:51], s42 offen offset:0 sc1
    v_mfma_f32_16x16x32_bf16 v[68:71], a[212:215], a[44:47], v[68:71]
    buffer_load_dwordx4 a[24:27], v140, s[44:47], s42 offen offset:1024 sc1
    ds_read_b64_tr_b16 a[200:201], v154 offset:0
    ds_read_b64_tr_b16 a[202:203], v154 offset:5120
    ds_read_b64_tr_b16 a[204:205], v154 offset:10240
    ds_read_b64_tr_b16 a[206:207], v154 offset:15360
    s_waitcnt lgkmcnt(12)
    v_mfma_f32_16x16x32_bf16 v[32:35], a[216:219], a[32:35], v[32:35]
    buffer_load_dwordx4 a[28:31], v140, s[48:51], s42 offen offset:1024 sc1
    s_add_u32 s42, s42, 6144
    s_cmp_eq_u32 s42, s62
    s_cmov_b32 s42, s63
    v_mfma_f32_16x16x32_bf16 v[32:35], a[220:223], a[40:43], v[32:35]
    ds_read_b64_tr_b16 a[208:209], v153 offset:64
    ds_read_b64_tr_b16 a[210:211], v153 offset:5184
    v_mfma_f32_16x16x32_bf16 v[72:75], a[216:219], a[36:39], v[72:75]
    ds_read_b64_tr_b16 a[212:213], v153 offset:10304
    ds_read_b64_tr_b16 a[214:215], v153 offset:15424
    v_mfma_f32_16x16x32_bf16 v[72:75], a[220:223], a[44:47], v[72:75]
    s_waitcnt lgkmcnt(12)
    v_mfma_f32_16x16x32_bf16 v[36:39], a[224:227], a[32:35], v[36:39]
    ds_read_b64_tr_b16 a[216:217], v154 offset:64
    v_mfma_f32_16x16x32_bf16 v[36:39], a[228:231], a[40:43], v[36:39]
    ds_read_b64_tr_b16 a[218:219], v154 offset:5184
    v_mfma_f32_16x16x32_bf16 v[76:79], a[224:227], a[36:39], v[76:79]
    ds_read_b64_tr_b16 a[220:221], v154 offset:10304
    v_mfma_f32_16x16x32_bf16 v[76:79], a[228:231], a[44:47], v[76:79]
    ds_read_b64_tr_b16 a[222:223], v154 offset:15424
    s_waitcnt lgkmcnt(12)
    v_mfma_f32_16x16x32_bf16 v[0:3], a[192:195], a[48:51], v[0:3]
    ds_read_b64_tr_b16 a[224:225], v153 offset:128
    v_mfma_f32_16x16x32_bf16 v[0:3], a[196:199], a[56:59], v[0:3]
    ds_read_b64_tr_b16 a[226:227], v153 offset:5248
    v_mfma_f32_16x16x32_bf16 v[40:43], a[192:195], a[52:55], v[40:43]
    ds_read_b64_tr_b16 a[228:229], v153 offset:10368
    v_mfma_f32_16x16x32_bf16 v[40:43], a[196:199], a[60:63], v[40:43]
    ds_read_b64_tr_b16 a[230:231], v153 offset:15488
    s_waitcnt lgkmcnt(12)
    v_mfma_f32_16x16x32_bf16 v[4:7], a[200:203], a[48:51], v[4:7]
    ds_read_b64_tr_b16 a[192:193], v154 offset:128
    v_mfma_f32_16x16x32_bf16 v[4:7], a[204:207], a[56:59], v[4:7]
    ds_read_b64_tr_b16 a[194:195], v154 offset:5248
    v_mfma_f32_16x16x32_bf16 v[44:47], a[200:203], a[52:55], v[44:47]
    ds_read_b64_tr_b16 a[196:197], v154 offset:10368
    v_mfma_f32_16x16x32_bf16 v[44:47], a[204:207], a[60:63], v[44:47]
    ds_read_b64_tr_b16 a[198:199], v154 offset:15488
    s_waitcnt lgkmcnt(12)
    v_mfma_f32_16x16x32_bf16 v[8:11], a[208:211], a[48:51], v[8:11]
    ds_read_b64_tr_b16 a[200:201], v153 offset:192
    v_mfma_f32_16x16x32_bf16 v[8:11], a[212:215], a[56:59], v[8:11]
    ds_read_b64_tr_b16 a[202:203], v153 offset:5312
    v_mfma_f32_16x16x32_bf16 v[48:51], a[208:211], a[52:55], v[48:51]
    ds_read_b64_tr_b16 a[204:205], v153 offset:10432
    v_mfma_f32_16x16x32_bf16 v[48:51], a[212:215], a[60:63], v[48:51]
    ds_read_b64_tr_b16 a[206:207], v153 offset:15552
    s_waitcnt lgkmcnt(12)
    v_mfma_f32_16x16x32_bf16 v[12:15], a[216:219], a[48:51], v[12:15]
    ds_read_b64_tr_b16 a[208:209], v154 offset:192
    v_mfma_f32_16x16x32_bf16 v[12:15], a[220:223], a[56:59], v[12:15]
    ds_read_b64_tr_b16 a[210:211], v154 offset:5312
    v_mfma_f32_16x16x32_bf16 v[52:55], a[216:219], a[52:55], v[52:55]
    ds_read_b64_tr_b16 a[212:213], v154 offset:10432
    v_mfma_f32_16x16x32_bf16 v[52:55], a[220:223], a[60:63], v[52:55]
    ds_read_b64_tr_b16 a[214:215], v154 offset:15552
    s_waitcnt lgkmcnt(12)
    v_mfma_f32_16x16x32_bf16 v[16:19], a[224:227], a[48:51], v[16:19]
    ds_read_b64_tr_b16 a[216:217], v153 offset:256
    v_mfma_f32_16x16x32_bf16 v[16:19], a[228:231], a[56:59], v[16:19]
    ds_read_b64_tr_b16 a[218:219], v153 offset:5376
    v_mfma_f32_16x16x32_bf16 v[56:59], a[224:227], a[52:55], v[56:59]
    ds_read_b64_tr_b16 a[220:221], v153 offset:10496
    v_mfma_f32_16x16x32_bf16 v[56:59], a[228:231], a[60:63], v[56:59]
    ds_read_b64_tr_b16 a[222:223], v153 offset:15616
    s_waitcnt lgkmcnt(12)
    v_mfma_f32_16x16x32_bf16 v[20:23], a[192:195], a[48:51], v[20:23]
    ds_read_b64_tr_b16 a[224:225], v154 offset:256
    v_mfma_f32_16x16x32_bf16 v[20:23], a[196:199], a[56:59], v[20:23]
    ds_read_b64_tr_b16 a[226:227], v154 offset:5376
    v_mfma_f32_16x16x32_bf16 v[60:63], a[192:195], a[52:55], v[60:63]
    ds_read_b64_tr_b16 a[228:229], v154 offset:10496
    v_mfma_f32_16x16x32_bf16 v[60:63], a[196:199], a[60:63], v[60:63]
    ds_read_b64_tr_b16 a[230:231], v154 offset:15616
    s_waitcnt vmcnt(9)
    s_barrier
    s_waitcnt lgkmcnt(12)
    v_mfma_f32_16x16x32_bf16 v[24:27], a[200:203], a[48:51], v[24:27]
    s_add_u32 s35, s34, s38
    s_add_u32 s43, s35, 4096
    s_add_u32 m0, s38, 122880
    s_nop 0
    buffer_load_dwordx4 v140, s[8:11], s35 offen offset:0  lds
    v_mfma_f32_16x16x32_bf16 v[24:27], a[204:207], a[56:59], v[24:27]
    ds_read_b64_tr_b16 a[192:193], v153 offset:24576
    ds_read_b64_tr_b16 a[194:195], v153 offset:29696
    v_mfma_f32_16x16x32_bf16 v[64:67], a[200:203], a[52:55], v[64:67]
    ds_read_b64_tr_b16 a[196:197], v153 offset:34816
    v_mfma_f32_16x16x32_bf16 v[64:67], a[204:207], a[60:63], v[64:67]
    ds_read_b64_tr_b16 a[198:199], v153 offset:39936
    s_waitcnt lgkmcnt(12)
    v_mfma_f32_16x16x32_bf16 v[28:31], a[208:211], a[48:51], v[28:31]
    buffer_load_dwordx4 v140, s[8:11], s35 offen offset:1024  lds
    v_mfma_f32_16x16x32_bf16 v[28:31], a[212:215], a[56:59], v[28:31]
    ds_read_b64_tr_b16 a[200:201], v154 offset:24576
    ds_read_b64_tr_b16 a[202:203], v154 offset:29696
    v_mfma_f32_16x16x32_bf16 v[68:71], a[208:211], a[52:55], v[68:71]
    ds_read_b64_tr_b16 a[204:205], v154 offset:34816
    v_mfma_f32_16x16x32_bf16 v[68:71], a[212:215], a[60:63], v[68:71]
    ds_read_b64_tr_b16 a[206:207], v154 offset:39936
    s_waitcnt lgkmcnt(12)
    v_mfma_f32_16x16x32_bf16 v[32:35], a[216:219], a[48:51], v[32:35]
    buffer_load_dwordx4 v140, s[8:11], s35 offen offset:2048  lds
    v_mfma_f32_16x16x32_bf16 v[32:35], a[220:223], a[56:59], v[32:35]
    ds_read_b64_tr_b16 a[208:209], v153 offset:24640
    ds_read_b64_tr_b16 a[210:211], v153 offset:29760
    v_mfma_f32_16x16x32_bf16 v[72:75], a[216:219], a[52:55], v[72:75]
    ds_read_b64_tr_b16 a[212:213], v153 offset:34880
    v_mfma_f32_16x16x32_bf16 v[72:75], a[220:223], a[60:63], v[72:75]
    ds_read_b64_tr_b16 a[214:215], v153 offset:40000
    s_waitcnt lgkmcnt(12)
    v_mfma_f32_16x16x32_bf16 v[36:39], a[224:227], a[48:51], v[36:39]
    buffer_load_dwordx4 v140, s[8:11], s35 offen offset:3072  lds
    s_add_u32 m0, s38, 126976
    s_nop 0
    v_mfma_f32_16x16x32_bf16 v[36:39], a[228:231], a[56:59], v[36:39]
    ds_read_b64_tr_b16 a[216:217], v154 offset:24640
    ds_read_b64_tr_b16 a[218:219], v154 offset:29760
    v_mfma_f32_16x16x32_bf16 v[76:79], a[224:227], a[52:55], v[76:79]
    ds_read_b64_tr_b16 a[220:221], v154 offset:34880
    v_mfma_f32_16x16x32_bf16 v[76:79], a[228:231], a[60:63], v[76:79]
    ds_read_b64_tr_b16 a[222:223], v154 offset:40000
    s_waitcnt lgkmcnt(12)
    v_mfma_f32_16x16x32_bf16 v[0:3], a[192:195], a[0:3], v[0:3]
    buffer_load_dwordx4 v140, s[8:11], s43 offen offset:0  lds
    s_add_u32 s34, s34, 61440
    s_cmp_eq_u32 s34, s60
    s_cmov_b32 s34, s61
    v_mfma_f32_16x16x32_bf16 v[0:3], a[196:199], a[8:11], v[0:3]
    ds_read_b64_tr_b16 a[224:225], v153 offset:24704
    ds_read_b64_tr_b16 a[226:227], v153 offset:29824
    v_mfma_f32_16x16x32_bf16 v[40:43], a[192:195], a[4:7], v[40:43]
    ds_read_b64_tr_b16 a[228:229], v153 offset:34944
    v_mfma_f32_16x16x32_bf16 v[40:43], a[196:199], a[12:15], v[40:43]
    ds_read_b64_tr_b16 a[230:231], v153 offset:40064
    s_waitcnt lgkmcnt(12)
    v_mfma_f32_16x16x32_bf16 v[4:7], a[200:203], a[0:3], v[4:7]
    ds_read_b64_tr_b16 a[192:193], v154 offset:24704
    v_mfma_f32_16x16x32_bf16 v[4:7], a[204:207], a[8:11], v[4:7]
    buffer_load_dwordx4 a[32:35], v140, s[44:47], s42 offen offset:0 sc1
    v_mfma_f32_16x16x32_bf16 v[44:47], a[200:203], a[4:7], v[44:47]
    ds_read_b64_tr_b16 a[194:195], v154 offset:29824
    ds_read_b64_tr_b16 a[196:197], v154 offset:34944
    v_mfma_f32_16x16x32_bf16 v[44:47], a[204:207], a[12:15], v[44:47]
    ds_read_b64_tr_b16 a[198:199], v154 offset:40064
    s_waitcnt lgkmcnt(12)
    v_mfma_f32_16x16x32_bf16 v[8:11], a[208:211], a[0:3], v[8:11]
    ds_read_b64_tr_b16 a[200:201], v153 offset:24768
    v_mfma_f32_16x16x32_bf16 v[8:11], a[212:215], a[8:11], v[8:11]
    buffer_load_dwordx4 a[36:39], v140, s[48:51], s42 offen offset:0 sc1
    v_mfma_f32_16x16x32_bf16 v[48:51], a[208:211], a[4:7], v[48:51]
    ds_read_b64_tr_b16 a[202:203], v153 offset:29888
    ds_read_b64_tr_b16 a[204:205], v153 offset:35008
    v_mfma_f32_16x16x32_bf16 v[48:51], a[212:215], a[12:15], v[48:51]
    ds_read_b64_tr_b16 a[206:207], v153 offset:40128
    s_waitcnt lgkmcnt(12)
    v_mfma_f32_16x16x32_bf16 v[12:15], a[216:219], a[0:3], v[12:15]
    ds_read_b64_tr_b16 a[208:209], v154 offset:24768
    v_mfma_f32_16x16x32_bf16 v[12:15], a[220:223], a[8:11], v[12:15]
    buffer_load_dwordx4 a[40:43], v140, s[44:47], s42 offen offset:1024 sc1
    v_mfma_f32_16x16x32_bf16 v[52:55], a[216:219], a[4:7], v[52:55]
    ds_read_b64_tr_b16 a[210:211], v154 offset:29888
    ds_read_b64_tr_b16 a[212:213], v154 offset:35008
    v_mfma_f32_16x16x32_bf16 v[52:55], a[220:223], a[12:15], v[52:55]
    ds_read_b64_tr_b16 a[214:215], v154 offset:40128
    s_waitcnt lgkmcnt(12)
    v_mfma_f32_16x16x32_bf16 v[16:19], a[224:227], a[0:3], v[16:19]
    ds_read_b64_tr_b16 a[216:217], v153 offset:24832
    v_mfma_f32_16x16x32_bf16 v[16:19], a[228:231], a[8:11], v[16:19]
    buffer_load_dwordx4 a[44:47], v140, s[48:51], s42 offen offset:1024 sc1
    s_add_u32 s42, s42, 6144
    s_cmp_eq_u32 s42, s62
    s_cmov_b32 s42, s63
    v_mfma_f32_16x16x32_bf16 v[56:59], a[224:227], a[4:7], v[56:59]
    ds_read_b64_tr_b16 a[218:219], v153 offset:29952
    ds_read_b64_tr_b16 a[220:221], v153 offset:35072
    v_mfma_f32_16x16x32_bf16 v[56:59], a[228:231], a[12:15], v[56:59]
    ds_read_b64_tr_b16 a[222:223], v153 offset:40192
    s_waitcnt lgkmcnt(12)
    v_mfma_f32_16x16x32_bf16 v[20:23], a[192:195], a[0:3], v[20:23]
    ds_read_b64_tr_b16 a[224:225], v154 offset:24832
    v_mfma_f32_16x16x32_bf16 v[20:23], a[196:199], a[8:11], v[20:23]
    ds_read_b64_tr_b16 a[226:227], v154 offset:29952
    v_mfma_f32_16x16x32_bf16 v[60:63], a[192:195], a[4:7], v[60:63]
    ds_read_b64_tr_b16 a[228:229], v154 offset:35072
    v_mfma_f32_16x16x32_bf16 v[60:63], a[196:199], a[12:15], v[60:63]
    ds_read_b64_tr_b16 a[230:231], v154 offset:40192
    s_waitcnt vmcnt(9)
    s_barrier
    s_waitcnt lgkmcnt(12)
    v_mfma_f32_16x16x32_bf16 v[24:27], a[200:203], a[0:3], v[24:27]
    s_add_u32 s35, s34, s38
    s_add_u32 s43, s35, 4096
    s_add_u32 m0, s38, 0
    s_nop 0
    buffer_load_dwordx4 v140, s[8:11], s35 offen offset:0  lds
    v_mfma_f32_16x16x32_bf16 v[24:27], a[204:207], a[8:11], v[24:27]
    ds_read_b64_tr_b16 a[192:193], v155 offset:0
    ds_read_b64_tr_b16 a[194:195], v155 offset:5120
    v_mfma_f32_16x16x32_bf16 v[64:67], a[200:203], a[4:7], v[64:67]
    ds_read_b64_tr_b16 a[196:197], v155 offset:10240
    v_mfma_f32_16x16x32_bf16 v[64:67], a[204:207], a[12:15], v[64:67]
    ds_read_b64_tr_b16 a[198:199], v155 offset:15360
    s_waitcnt lgkmcnt(12)
    v_mfma_f32_16x16x32_bf16 v[28:31], a[208:211], a[0:3], v[28:31]
    buffer_load_dwordx4 v140, s[8:11], s35 offen offset:1024  lds
    v_mfma_f32_16x16x32_bf16 v[28:31], a[212:215], a[8:11], v[28:31]
    ds_read_b64_tr_b16 a[200:201], v156 offset:0
    ds_read_b64_tr_b16 a[202:203], v156 offset:5120
    v_mfma_f32_16x16x32_bf16 v[68:71], a[208:211], a[4:7], v[68:71]
    ds_read_b64_tr_b16 a[204:205], v156 offset:10240
    v_mfma_f32_16x16x32_bf16 v[68:71], a[212:215], a[12:15], v[68:71]
    ds_read_b64_tr_b16 a[206:207], v156 offset:15360
    s_waitcnt lgkmcnt(12)
    v_mfma_f32_16x16x32_bf16 v[32:35], a[216:219], a[0:3], v[32:35]
    buffer_load_dwordx4 v140, s[8:11], s35 offen offset:2048  lds
    v_mfma_f32_16x16x32_bf16 v[32:35], a[220:223], a[8:11], v[32:35]
    ds_read_b64_tr_b16 a[208:209], v155 offset:64
    ds_read_b64_tr_b16 a[210:211], v155 offset:5184
    v_mfma_f32_16x16x32_bf16 v[72:75], a[216:219], a[4:7], v[72:75]
    ds_read_b64_tr_b16 a[212:213], v155 offset:10304
    v_mfma_f32_16x16x32_bf16 v[72:75], a[220:223], a[12:15], v[72:75]
    ds_read_b64_tr_b16 a[214:215], v155 offset:15424
    s_waitcnt lgkmcnt(12)
    v_mfma_f32_16x16x32_bf16 v[36:39], a[224:227], a[0:3], v[36:39]
    buffer_load_dwordx4 v140, s[8:11], s35 offen offset:3072  lds
    s_add_u32 m0, s38, 4096
    s_nop 0
    v_mfma_f32_16x16x32_bf16 v[36:39], a[228:231], a[8:11], v[36:39]
    ds_read_b64_tr_b16 a[216:217], v156 offset:64
    ds_read_b64_tr_b16 a[218:219], v156 offset:5184
    v_mfma_f32_16x16x32_bf16 v[76:79], a[224:227], a[4:7], v[76:79]
    ds_read_b64_tr_b16 a[220:221], v156 offset:10304
    v_mfma_f32_16x16x32_bf16 v[76:79], a[228:231], a[12:15], v[76:79]
    ds_read_b64_tr_b16 a[222:223], v156 offset:15424
    s_waitcnt lgkmcnt(12)
    v_mfma_f32_16x16x32_bf16 v[0:3], a[192:195], a[16:19], v[0:3]
    buffer_load_dwordx4 v140, s[8:11], s43 offen offset:0  lds
    s_add_u32 s34, s34, 61440
    s_cmp_eq_u32 s34, s60
    s_cmov_b32 s34, s61
    v_mfma_f32_16x16x32_bf16 v[0:3], a[196:199], a[24:27], v[0:3]
    ds_read_b64_tr_b16 a[224:225], v155 offset:128
    ds_read_b64_tr_b16 a[226:227], v155 offset:5248
    v_mfma_f32_16x16x32_bf16 v[40:43], a[192:195], a[20:23], v[40:43]
    ds_read_b64_tr_b16 a[228:229], v155 offset:10368
    v_mfma_f32_16x16x32_bf16 v[40:43], a[196:199], a[28:31], v[40:43]
    ds_read_b64_tr_b16 a[230:231], v155 offset:15488
    s_waitcnt lgkmcnt(12)
    v_mfma_f32_16x16x32_bf16 v[4:7], a[200:203], a[16:19], v[4:7]
    ds_read_b64_tr_b16 a[192:193], v156 offset:128
    v_mfma_f32_16x16x32_bf16 v[4:7], a[204:207], a[24:27], v[4:7]
    buffer_load_dwordx4 a[48:51], v140, s[44:47], s42 offen offset:0 sc1
    v_mfma_f32_16x16x32_bf16 v[44:47], a[200:203], a[20:23], v[44:47]
    ds_read_b64_tr_b16 a[194:195], v156 offset:5248
    ds_read_b64_tr_b16 a[196:197], v156 offset:10368
    v_mfma_f32_16x16x32_bf16 v[44:47], a[204:207], a[28:31], v[44:47]
    ds_read_b64_tr_b16 a[198:199], v156 offset:15488
    s_waitcnt lgkmcnt(12)
    v_mfma_f32_16x16x32_bf16 v[8:11], a[208:211], a[16:19], v[8:11]
    ds_read_b64_tr_b16 a[200:201], v155 offset:192
    v_mfma_f32_16x16x32_bf16 v[8:11], a[212:215], a[24:27], v[8:11]
    buffer_load_dwordx4 a[52:55], v140, s[48:51], s42 offen offset:0 sc1
    v_mfma_f32_16x16x32_bf16 v[48:51], a[208:211], a[20:23], v[48:51]
    ds_read_b64_tr_b16 a[202:203], v155 offset:5312
    ds_read_b64_tr_b16 a[204:205], v155 offset:10432
    v_mfma_f32_16x16x32_bf16 v[48:51], a[212:215], a[28:31], v[48:51]
    ds_read_b64_tr_b16 a[206:207], v155 offset:15552
    s_waitcnt lgkmcnt(12)
    v_mfma_f32_16x16x32_bf16 v[12:15], a[216:219], a[16:19], v[12:15]
    ds_read_b64_tr_b16 a[208:209], v156 offset:192
    v_mfma_f32_16x16x32_bf16 v[12:15], a[220:223], a[24:27], v[12:15]
    buffer_load_dwordx4 a[56:59], v140, s[44:47], s42 offen offset:1024 sc1
    v_mfma_f32_16x16x32_bf16 v[52:55], a[216:219], a[20:23], v[52:55]
    ds_read_b64_tr_b16 a[210:211], v156 offset:5312
    ds_read_b64_tr_b16 a[212:213], v156 offset:10432
    v_mfma_f32_16x16x32_bf16 v[52:55], a[220:223], a[28:31], v[52:55]
    ds_read_b64_tr_b16 a[214:215], v156 offset:15552
    s_waitcnt lgkmcnt(12)
    v_mfma_f32_16x16x32_bf16 v[16:19], a[224:227], a[16:19], v[16:19]
    ds_read_b64_tr_b16 a[216:217], v155 offset:256
    v_mfma_f32_16x16x32_bf16 v[16:19], a[228:231], a[24:27], v[16:19]
    buffer_load_dwordx4 a[60:63], v140, s[48:51], s42 offen offset:1024 sc1
    s_add_u32 s42, s42, 6144
    s_cmp_eq_u32 s42, s62
    s_cmov_b32 s42, s63
    v_mfma_f32_16x16x32_bf16 v[56:59], a[224:227], a[20:23], v[56:59]
    ds_read_b64_tr_b16 a[218:219], v155 offset:5376
    ds_read_b64_tr_b16 a[220:221], v155 offset:10496
    v_mfma_f32_16x16x32_bf16 v[56:59], a[228:231], a[28:31], v[56:59]
    ds_read_b64_tr_b16 a[222:223], v155 offset:15616
    s_waitcnt lgkmcnt(12)
    v_mfma_f32_16x16x32_bf16 v[20:23], a[192:195], a[16:19], v[20:23]
    ds_read_b64_tr_b16 a[224:225], v156 offset:256
    v_mfma_f32_16x16x32_bf16 v[20:23], a[196:199], a[24:27], v[20:23]
    ds_read_b64_tr_b16 a[226:227], v156 offset:5376
    v_mfma_f32_16x16x32_bf16 v[60:63], a[192:195], a[20:23], v[60:63]
    ds_read_b64_tr_b16 a[228:229], v156 offset:10496
    v_mfma_f32_16x16x32_bf16 v[60:63], a[196:199], a[28:31], v[60:63]
    ds_read_b64_tr_b16 a[230:231], v156 offset:15616
    s_waitcnt vmcnt(9)
    s_barrier
    s_waitcnt lgkmcnt(12)
    v_mfma_f32_16x16x32_bf16 v[24:27], a[200:203], a[16:19], v[24:27]
    s_add_u32 s35, s34, s38
    s_add_u32 s43, s35, 4096
    s_add_u32 m0, s38, 24576
    s_nop 0
    buffer_load_dwordx4 v140, s[8:11], s35 offen offset:0  lds
    v_mfma_f32_16x16x32_bf16 v[24:27], a[204:207], a[24:27], v[24:27]
    ds_read_b64_tr_b16 a[192:193], v155 offset:24576
    ds_read_b64_tr_b16 a[194:195], v155 offset:29696
    v_mfma_f32_16x16x32_bf16 v[64:67], a[200:203], a[20:23], v[64:67]
    ds_read_b64_tr_b16 a[196:197], v155 offset:34816
    v_mfma_f32_16x16x32_bf16 v[64:67], a[204:207], a[28:31], v[64:67]
    ds_read_b64_tr_b16 a[198:199], v155 offset:39936
    s_waitcnt lgkmcnt(12)
    v_mfma_f32_16x16x32_bf16 v[28:31], a[208:211], a[16:19], v[28:31]
    buffer_load_dwordx4 v140, s[8:11], s35 offen offset:1024  lds
    v_mfma_f32_16x16x32_bf16 v[28:31], a[212:215], a[24:27], v[28:31]
    ds_read_b64_tr_b16 a[200:201], v156 offset:24576
    ds_read_b64_tr_b16 a[202:203], v156 offset:29696
    v_mfma_f32_16x16x32_bf16 v[68:71], a[208:211], a[20:23], v[68:71]
    ds_read_b64_tr_b16 a[204:205], v156 offset:34816
    v_mfma_f32_16x16x32_bf16 v[68:71], a[212:215], a[28:31], v[68:71]
    ds_read_b64_tr_b16 a[206:207], v156 offset:39936
    s_waitcnt lgkmcnt(12)
    v_mfma_f32_16x16x32_bf16 v[32:35], a[216:219], a[16:19], v[32:35]
    buffer_load_dwordx4 v140, s[8:11], s35 offen offset:2048  lds
    v_mfma_f32_16x16x32_bf16 v[32:35], a[220:223], a[24:27], v[32:35]
    ds_read_b64_tr_b16 a[208:209], v155 offset:24640
    ds_read_b64_tr_b16 a[210:211], v155 offset:29760
    v_mfma_f32_16x16x32_bf16 v[72:75], a[216:219], a[20:23], v[72:75]
    ds_read_b64_tr_b16 a[212:213], v155 offset:34880
    v_mfma_f32_16x16x32_bf16 v[72:75], a[220:223], a[28:31], v[72:75]
    ds_read_b64_tr_b16 a[214:215], v155 offset:40000
    s_waitcnt lgkmcnt(12)
    v_mfma_f32_16x16x32_bf16 v[36:39], a[224:227], a[16:19], v[36:39]
    buffer_load_dwordx4 v140, s[8:11], s35 offen offset:3072  lds
    s_add_u32 m0, s38, 28672
    s_nop 0
    v_mfma_f32_16x16x32_bf16 v[36:39], a[228:231], a[24:27], v[36:39]
    ds_read_b64_tr_b16 a[216:217], v156 offset:24640
    ds_read_b64_tr_b16 a[218:219], v156 offset:29760
    v_mfma_f32_16x16x32_bf16 v[76:79], a[224:227], a[20:23], v[76:79]
    ds_read_b64_tr_b16 a[220:221], v156 offset:34880
    v_mfma_f32_16x16x32_bf16 v[76:79], a[228:231], a[28:31], v[76:79]
    ds_read_b64_tr_b16 a[222:223], v156 offset:40000
    s_mov_b32 s36, 163840
    buffer_load_dword v173, v160, s[52:55], s36 offen sc1
    s_waitcnt lgkmcnt(12)
    v_mfma_f32_16x16x32_bf16 v[0:3], a[192:195], a[32:35], v[0:3]
    buffer_load_dwordx4 v140, s[8:11], s43 offen offset:0  lds
    s_add_u32 s34, s34, 61440
    s_cmp_eq_u32 s34, s60
    s_cmov_b32 s34, s61
    v_mfma_f32_16x16x32_bf16 v[0:3], a[196:199], a[40:43], v[0:3]
    ds_read_b64_tr_b16 a[224:225], v155 offset:24704
    ds_read_b64_tr_b16 a[226:227], v155 offset:29824
    v_mfma_f32_16x16x32_bf16 v[40:43], a[192:195], a[36:39], v[40:43]
    ds_read_b64_tr_b16 a[228:229], v155 offset:34944
    v_mfma_f32_16x16x32_bf16 v[40:43], a[196:199], a[44:47], v[40:43]
    ds_read_b64_tr_b16 a[230:231], v155 offset:40064
    s_waitcnt lgkmcnt(12)
    v_mfma_f32_16x16x32_bf16 v[4:7], a[200:203], a[32:35], v[4:7]
    ds_read_b64_tr_b16 a[192:193], v156 offset:24704
    v_mfma_f32_16x16x32_bf16 v[4:7], a[204:207], a[40:43], v[4:7]
    buffer_load_dwordx4 a[0:3], v140, s[44:47], s42 offen offset:0 sc1
    v_mfma_f32_16x16x32_bf16 v[44:47], a[200:203], a[36:39], v[44:47]
    ds_read_b64_tr_b16 a[194:195], v156 offset:29824
    ds_read_b64_tr_b16 a[196:197], v156 offset:34944
    v_mfma_f32_16x16x32_bf16 v[44:47], a[204:207], a[44:47], v[44:47]
    ds_read_b64_tr_b16 a[198:199], v156 offset:40064
    s_waitcnt lgkmcnt(12)
    v_mfma_f32_16x16x32_bf16 v[8:11], a[208:211], a[32:35], v[8:11]
    ds_read_b64_tr_b16 a[200:201], v155 offset:24768
    v_mfma_f32_16x16x32_bf16 v[8:11], a[212:215], a[40:43], v[8:11]
    buffer_load_dwordx4 a[4:7], v140, s[48:51], s42 offen offset:0 sc1
    v_mfma_f32_16x16x32_bf16 v[48:51], a[208:211], a[36:39], v[48:51]
    ds_read_b64_tr_b16 a[202:203], v155 offset:29888
    ds_read_b64_tr_b16 a[204:205], v155 offset:35008
    v_mfma_f32_16x16x32_bf16 v[48:51], a[212:215], a[44:47], v[48:51]
    ds_read_b64_tr_b16 a[206:207], v155 offset:40128
    s_waitcnt lgkmcnt(12)
    v_mfma_f32_16x16x32_bf16 v[12:15], a[216:219], a[32:35], v[12:15]
    ds_read_b64_tr_b16 a[208:209], v156 offset:24768
    v_mfma_f32_16x16x32_bf16 v[12:15], a[220:223], a[40:43], v[12:15]
    buffer_load_dwordx4 a[8:11], v140, s[44:47], s42 offen offset:1024 sc1
    v_mfma_f32_16x16x32_bf16 v[52:55], a[216:219], a[36:39], v[52:55]
    ds_read_b64_tr_b16 a[210:211], v156 offset:29888
    ds_read_b64_tr_b16 a[212:213], v156 offset:35008
    v_mfma_f32_16x16x32_bf16 v[52:55], a[220:223], a[44:47], v[52:55]
    ds_read_b64_tr_b16 a[214:215], v156 offset:40128
    s_waitcnt lgkmcnt(12)
    v_mfma_f32_16x16x32_bf16 v[16:19], a[224:227], a[32:35], v[16:19]
    ds_read_b64_tr_b16 a[216:217], v155 offset:24832
    v_mfma_f32_16x16x32_bf16 v[16:19], a[228:231], a[40:43], v[16:19]
    buffer_load_dwordx4 a[12:15], v140, s[48:51], s42 offen offset:1024 sc1
    s_add_u32 s42, s42, 6144
    s_cmp_eq_u32 s42, s62
    s_cmov_b32 s42, s63
    v_mfma_f32_16x16x32_bf16 v[56:59], a[224:227], a[36:39], v[56:59]
    ds_read_b64_tr_b16 a[218:219], v155 offset:29952
    ds_read_b64_tr_b16 a[220:221], v155 offset:35072
    v_mfma_f32_16x16x32_bf16 v[56:59], a[228:231], a[44:47], v[56:59]
    ds_read_b64_tr_b16 a[222:223], v155 offset:40192
    s_waitcnt lgkmcnt(12)
    v_mfma_f32_16x16x32_bf16 v[20:23], a[192:195], a[32:35], v[20:23]
    ds_read_b64_tr_b16 a[224:225], v156 offset:24832
    v_mfma_f32_16x16x32_bf16 v[20:23], a[196:199], a[40:43], v[20:23]
    ds_read_b64_tr_b16 a[226:227], v156 offset:29952
    v_mfma_f32_16x16x32_bf16 v[60:63], a[192:195], a[36:39], v[60:63]
    ds_read_b64_tr_b16 a[228:229], v156 offset:35072
    v_mfma_f32_16x16x32_bf16 v[60:63], a[196:199], a[44:47], v[60:63]
    ds_read_b64_tr_b16 a[230:231], v156 offset:40192
    s_waitcnt vmcnt(10)
    s_barrier
    s_waitcnt lgkmcnt(12)
    v_mfma_f32_16x16x32_bf16 v[24:27], a[200:203], a[32:35], v[24:27]
    s_add_u32 s35, s34, s38
    s_add_u32 s43, s35, 4096
    s_add_u32 m0, s38, 49152
    s_nop 0
    buffer_load_dwordx4 v140, s[8:11], s35 offen offset:0  lds
    v_mfma_f32_16x16x32_bf16 v[24:27], a[204:207], a[40:43], v[24:27]
    ds_read_b64_tr_b16 a[192:193], v151 offset:0
    ds_read_b64_tr_b16 a[194:195], v151 offset:5120
    v_mfma_f32_16x16x32_bf16 v[64:67], a[200:203], a[36:39], v[64:67]
    ds_read_b64_tr_b16 a[196:197], v151 offset:10240
    v_mfma_f32_16x16x32_bf16 v[64:67], a[204:207], a[44:47], v[64:67]
    ds_read_b64_tr_b16 a[198:199], v151 offset:15360
    s_waitcnt lgkmcnt(12)
    v_mfma_f32_16x16x32_bf16 v[28:31], a[208:211], a[32:35], v[28:31]
    buffer_load_dwordx4 v140, s[8:11], s35 offen offset:1024  lds
    v_mfma_f32_16x16x32_bf16 v[28:31], a[212:215], a[40:43], v[28:31]
    ds_read_b64_tr_b16 a[200:201], v152 offset:0
    ds_read_b64_tr_b16 a[202:203], v152 offset:5120
    v_mfma_f32_16x16x32_bf16 v[68:71], a[208:211], a[36:39], v[68:71]
    ds_read_b64_tr_b16 a[204:205], v152 offset:10240
    v_mfma_f32_16x16x32_bf16 v[68:71], a[212:215], a[44:47], v[68:71]
    ds_read_b64_tr_b16 a[206:207], v152 offset:15360
    s_waitcnt lgkmcnt(12)
    v_mfma_f32_16x16x32_bf16 v[32:35], a[216:219], a[32:35], v[32:35]
    buffer_load_dwordx4 v140, s[8:11], s35 offen offset:2048  lds
    v_mfma_f32_16x16x32_bf16 v[32:35], a[220:223], a[40:43], v[32:35]
    ds_read_b64_tr_b16 a[208:209], v151 offset:64
    ds_read_b64_tr_b16 a[210:211], v151 offset:5184
    v_mfma_f32_16x16x32_bf16 v[72:75], a[216:219], a[36:39], v[72:75]
    ds_read_b64_tr_b16 a[212:213], v151 offset:10304
    v_mfma_f32_16x16x32_bf16 v[72:75], a[220:223], a[44:47], v[72:75]
    ds_read_b64_tr_b16 a[214:215], v151 offset:15424
    s_waitcnt lgkmcnt(12)
    v_mfma_f32_16x16x32_bf16 v[36:39], a[224:227], a[32:35], v[36:39]
    buffer_load_dwordx4 v140, s[8:11], s35 offen offset:3072  lds
    s_add_u32 m0, s38, 53248
    s_nop 0
    v_mfma_f32_16x16x32_bf16 v[36:39], a[228:231], a[40:43], v[36:39]
    ds_read_b64_tr_b16 a[216:217], v152 offset:64
    ds_read_b64_tr_b16 a[218:219], v152 offset:5184
    v_mfma_f32_16x16x32_bf16 v[76:79], a[224:227], a[36:39], v[76:79]
    ds_read_b64_tr_b16 a[220:221], v152 offset:10304
    v_mfma_f32_16x16x32_bf16 v[76:79], a[228:231], a[44:47], v[76:79]
    ds_read_b64_tr_b16 a[222:223], v152 offset:15424
    s_waitcnt lgkmcnt(12)
    v_mfma_f32_16x16x32_bf16 v[0:3], a[192:195], a[48:51], v[0:3]
    buffer_load_dwordx4 v140, s[8:11], s43 offen offset:0  lds
    s_add_u32 s60, s60, 20480
    s_add_u32 s61, s61, 20480
    s_mov_b32 s34, 20480
    s_cmp_eq_u32 s34, s60
    s_cmov_b32 s34, s61
    v_mfma_f32_16x16x32_bf16 v[0:3], a[196:199], a[56:59], v[0:3]
    ds_read_b64_tr_b16 a[224:225], v151 offset:128
    ds_read_b64_tr_b16 a[226:227], v151 offset:5248
    v_mfma_f32_16x16x32_bf16 v[40:43], a[192:195], a[52:55], v[40:43]
    ds_read_b64_tr_b16 a[228:229], v151 offset:10368
    v_mfma_f32_16x16x32_bf16 v[40:43], a[196:199], a[60:63], v[40:43]
    ds_read_b64_tr_b16 a[230:231], v151 offset:15488
    s_waitcnt lgkmcnt(12)
    v_mfma_f32_16x16x32_bf16 v[4:7], a[200:203], a[48:51], v[4:7]
    ds_read_b64_tr_b16 a[192:193], v152 offset:128
    v_mfma_f32_16x16x32_bf16 v[4:7], a[204:207], a[56:59], v[4:7]
    buffer_load_dwordx4 a[16:19], v140, s[44:47], s42 offen offset:0 sc1
    v_mfma_f32_16x16x32_bf16 v[44:47], a[200:203], a[52:55], v[44:47]
    ds_read_b64_tr_b16 a[194:195], v152 offset:5248
    ds_read_b64_tr_b16 a[196:197], v152 offset:10368
    v_mfma_f32_16x16x32_bf16 v[44:47], a[204:207], a[60:63], v[44:47]
    ds_read_b64_tr_b16 a[198:199], v152 offset:15488
    s_waitcnt lgkmcnt(12)
    v_mfma_f32_16x16x32_bf16 v[8:11], a[208:211], a[48:51], v[8:11]
    ds_read_b64_tr_b16 a[200:201], v151 offset:192
    v_mfma_f32_16x16x32_bf16 v[8:11], a[212:215], a[56:59], v[8:11]
    buffer_load_dwordx4 a[20:23], v140, s[48:51], s42 offen offset:0 sc1
    v_mfma_f32_16x16x32_bf16 v[48:51], a[208:211], a[52:55], v[48:51]
    ds_read_b64_tr_b16 a[202:203], v151 offset:5312
    ds_read_b64_tr_b16 a[204:205], v151 offset:10432
    v_mfma_f32_16x16x32_bf16 v[48:51], a[212:215], a[60:63], v[48:51]
    ds_read_b64_tr_b16 a[206:207], v151 offset:15552
    s_waitcnt lgkmcnt(12)
    v_mfma_f32_16x16x32_bf16 v[12:15], a[216:219], a[48:51], v[12:15]
    ds_read_b64_tr_b16 a[208:209], v152 offset:192
    v_mfma_f32_16x16x32_bf16 v[12:15], a[220:223], a[56:59], v[12:15]
    buffer_load_dwordx4 a[24:27], v140, s[44:47], s42 offen offset:1024 sc1
    v_mfma_f32_16x16x32_bf16 v[52:55], a[216:219], a[52:55], v[52:55]
    ds_read_b64_tr_b16 a[210:211], v152 offset:5312
    ds_read_b64_tr_b16 a[212:213], v152 offset:10432
    v_mfma_f32_16x16x32_bf16 v[52:55], a[220:223], a[60:63], v[52:55]
    ds_read_b64_tr_b16 a[214:215], v152 offset:15552
    s_waitcnt lgkmcnt(12)
    v_mfma_f32_16x16x32_bf16 v[16:19], a[224:227], a[48:51], v[16:19]
    ds_read_b64_tr_b16 a[216:217], v151 offset:256
    v_mfma_f32_16x16x32_bf16 v[16:19], a[228:231], a[56:59], v[16:19]
    buffer_load_dwordx4 a[28:31], v140, s[48:51], s42 offen offset:1024 sc1
    s_add_u32 s62, s62, 2048
    s_add_u32 s63, s63, 2048
    s_mov_b32 s42, 2048
    s_cmp_eq_u32 s42, s62
    s_cmov_b32 s42, s63
    v_mfma_f32_16x16x32_bf16 v[56:59], a[224:227], a[52:55], v[56:59]
    ds_read_b64_tr_b16 a[218:219], v151 offset:5376
    ds_read_b64_tr_b16 a[220:221], v151 offset:10496
    v_mfma_f32_16x16x32_bf16 v[56:59], a[228:231], a[60:63], v[56:59]
    ds_read_b64_tr_b16 a[222:223], v151 offset:15616
    s_waitcnt lgkmcnt(12)
    v_mfma_f32_16x16x32_bf16 v[20:23], a[192:195], a[48:51], v[20:23]
    ds_read_b64_tr_b16 a[224:225], v152 offset:256
    v_mfma_f32_16x16x32_bf16 v[20:23], a[196:199], a[56:59], v[20:23]
    ds_read_b64_tr_b16 a[226:227], v152 offset:5376
    v_mfma_f32_16x16x32_bf16 v[60:63], a[192:195], a[52:55], v[60:63]
    ds_read_b64_tr_b16 a[228:229], v152 offset:10496
    v_mfma_f32_16x16x32_bf16 v[60:63], a[196:199], a[60:63], v[60:63]
    ds_read_b64_tr_b16 a[230:231], v152 offset:15616
    s_waitcnt vmcnt(14)
    v_cmp_ne_u32 vcc, 1, v173
    s_mov_b32 s36, 163840
    s_mov_b32 s37, 0x100000
    s_nop 2
    s_cbranch_vccnz L_tail_aspin500
L_tail_aok500:
    s_waitcnt vmcnt(9)
    s_barrier
    s_waitcnt lgkmcnt(12)
    v_mfma_f32_16x16x32_bf16 v[24:27], a[200:203], a[48:51], v[24:27]
    s_add_u32 s35, s34, s38
    s_add_u32 s43, s35, 4096
    s_add_u32 m0, s38, 73728
    s_nop 0
    buffer_load_dwordx4 v140, s[8:11], s35 offen offset:0  lds
    v_mfma_f32_16x16x32_bf16 v[24:27], a[204:207], a[56:59], v[24:27]
    ds_read_b64_tr_b16 a[192:193], v151 offset:24576
    ds_read_b64_tr_b16 a[194:195], v151 offset:29696
    v_mfma_f32_16x16x32_bf16 v[64:67], a[200:203], a[52:55], v[64:67]
    ds_read_b64_tr_b16 a[196:197], v151 offset:34816
    v_mfma_f32_16x16x32_bf16 v[64:67], a[204:207], a[60:63], v[64:67]
    ds_read_b64_tr_b16 a[198:199], v151 offset:39936
    s_waitcnt lgkmcnt(12)
    v_mfma_f32_16x16x32_bf16 v[28:31], a[208:211], a[48:51], v[28:31]
    buffer_load_dwordx4 v140, s[8:11], s35 offen offset:1024  lds
    v_mfma_f32_16x16x32_bf16 v[28:31], a[212:215], a[56:59], v[28:31]
    ds_read_b64_tr_b16 a[200:201], v152 offset:24576
    ds_read_b64_tr_b16 a[202:203], v152 offset:29696
    v_mfma_f32_16x16x32_bf16 v[68:71], a[208:211], a[52:55], v[68:71]
    ds_read_b64_tr_b16 a[204:205], v152 offset:34816
    v_mfma_f32_16x16x32_bf16 v[68:71], a[212:215], a[60:63], v[68:71]
    ds_read_b64_tr_b16 a[206:207], v152 offset:39936
    s_waitcnt lgkmcnt(12)
    v_mfma_f32_16x16x32_bf16 v[32:35], a[216:219], a[48:51], v[32:35]
    buffer_load_dwordx4 v140, s[8:11], s35 offen offset:2048  lds
    v_mfma_f32_16x16x32_bf16 v[32:35], a[220:223], a[56:59], v[32:35]
    ds_read_b64_tr_b16 a[208:209], v151 offset:24640
    ds_read_b64_tr_b16 a[210:211], v151 offset:29760
    v_mfma_f32_16x16x32_bf16 v[72:75], a[216:219], a[52:55], v[72:75]
    ds_read_b64_tr_b16 a[212:213], v151 offset:34880
    v_mfma_f32_16x16x32_bf16 v[72:75], a[220:223], a[60:63], v[72:75]
    ds_read_b64_tr_b16 a[214:215], v151 offset:40000
    s_waitcnt lgkmcnt(12)
    v_mfma_f32_16x16x32_bf16 v[36:39], a[224:227], a[48:51], v[36:39]
    buffer_load_dwordx4 v140, s[8:11], s35 offen offset:3072  lds
    s_add_u32 m0, s38, 77824
    s_nop 0
    v_mfma_f32_16x16x32_bf16 v[36:39], a[228:231], a[56:59], v[36:39]
    ds_read_b64_tr_b16 a[216:217], v152 offset:24640
    ds_read_b64_tr_b16 a[218:219], v152 offset:29760
    v_mfma_f32_16x16x32_bf16 v[76:79], a[224:227], a[52:55], v[76:79]
    ds_read_b64_tr_b16 a[220:221], v152 offset:34880
    v_mfma_f32_16x16x32_bf16 v[76:79], a[228:231], a[60:63], v[76:79]
    ds_read_b64_tr_b16 a[222:223], v152 offset:40000
    s_waitcnt lgkmcnt(12)
    v_mfma_f32_16x16x32_bf16 v[0:3], a[192:195], a[0:3], v[0:3]
    buffer_load_dwordx4 v140, s[8:11], s43 offen offset:0  lds
    s_add_u32 s34, s34, 61440
    s_cmp_eq_u32 s34, s60
    s_cmov_b32 s34, s61
    v_mfma_f32_16x16x32_bf16 v[0:3], a[196:199], a[8:11], v[0:3]
    ds_read_b64_tr_b16 a[224:225], v151 offset:24704
    ds_read_b64_tr_b16 a[226:227], v151 offset:29824
    v_mfma_f32_16x16x32_bf16 v[40:43], a[192:195], a[4:7], v[40:43]
    ds_read_b64_tr_b16 a[228:229], v151 offset:34944
    v_mfma_f32_16x16x32_bf16 v[40:43], a[196:199], a[12:15], v[40:43]
    ds_read_b64_tr_b16 a[230:231], v151 offset:40064
    s_waitcnt lgkmcnt(12)
    v_mfma_f32_16x16x32_bf16 v[4:7], a[200:203], a[0:3], v[4:7]
    ds_read_b64_tr_b16 a[192:193], v152 offset:24704
    v_mfma_f32_16x16x32_bf16 v[4:7], a[204:207], a[8:11], v[4:7]
    buffer_load_dwordx4 a[32:35], v140, s[44:47], s42 offen offset:0 sc1
    v_mfma_f32_16x16x32_bf16 v[44:47], a[200:203], a[4:7], v[44:47]
    ds_read_b64_tr_b16 a[194:195], v152 offset:29824
    ds_read_b64_tr_b16 a[196:197], v152 offset:34944
    v_mfma_f32_16x16x32_bf16 v[44:47], a[204:207], a[12:15], v[44:47]
    ds_read_b64_tr_b16 a[198:199], v152 offset:40064
    s_waitcnt lgkmcnt(12)
    v_mfma_f32_16x16x32_bf16 v[8:11], a[208:211], a[0:3], v[8:11]
    ds_read_b64_tr_b16 a[200:201], v151 offset:24768
    v_mfma_f32_16x16x32_bf16 v[8:11], a[212:215], a[8:11], v[8:11]
    buffer_load_dwordx4 a[36:39], v140, s[48:51], s42 offen offset:0 sc1
    v_mfma_f32_16x16x32_bf16 v[48:51], a[208:211], a[4:7], v[48:51]
    ds_read_b64_tr_b16 a[202:203], v151 offset:29888
    ds_read_b64_tr_b16 a[204:205], v151 offset:35008
    v_mfma_f32_16x16x32_bf16 v[48:51], a[212:215], a[12:15], v[48:51]
    ds_read_b64_tr_b16 a[206:207], v151 offset:40128
    s_waitcnt lgkmcnt(12)
    v_mfma_f32_16x16x32_bf16 v[12:15], a[216:219], a[0:3], v[12:15]
    ds_read_b64_tr_b16 a[208:209], v152 offset:24768
    v_mfma_f32_16x16x32_bf16 v[12:15], a[220:223], a[8:11], v[12:15]
    buffer_load_dwordx4 a[40:43], v140, s[44:47], s42 offen offset:1024 sc1
    v_mfma_f32_16x16x32_bf16 v[52:55], a[216:219], a[4:7], v[52:55]
    ds_read_b64_tr_b16 a[210:211], v152 offset:29888
    ds_read_b64_tr_b16 a[212:213], v152 offset:35008
    v_mfma_f32_16x16x32_bf16 v[52:55], a[220:223], a[12:15], v[52:55]
    ds_read_b64_tr_b16 a[214:215], v152 offset:40128
    s_waitcnt lgkmcnt(12)
    v_mfma_f32_16x16x32_bf16 v[16:19], a[224:227], a[0:3], v[16:19]
    ds_read_b64_tr_b16 a[216:217], v151 offset:24832
    v_mfma_f32_16x16x32_bf16 v[16:19], a[228:231], a[8:11], v[16:19]
    buffer_load_dwordx4 a[44:47], v140, s[48:51], s42 offen offset:1024 sc1
    s_add_u32 s42, s42, 6144
    s_cmp_eq_u32 s42, s62
    s_cmov_b32 s42, s63
    v_mfma_f32_16x16x32_bf16 v[56:59], a[224:227], a[4:7], v[56:59]
    ds_read_b64_tr_b16 a[218:219], v151 offset:29952
    ds_read_b64_tr_b16 a[220:221], v151 offset:35072
    v_mfma_f32_16x16x32_bf16 v[56:59], a[228:231], a[12:15], v[56:59]
    ds_read_b64_tr_b16 a[222:223], v151 offset:40192
    s_waitcnt lgkmcnt(12)
    v_mfma_f32_16x16x32_bf16 v[20:23], a[192:195], a[0:3], v[20:23]
    ds_read_b64_tr_b16 a[224:225], v152 offset:24832
    v_mfma_f32_16x16x32_bf16 v[20:23], a[196:199], a[8:11], v[20:23]
    ds_read_b64_tr_b16 a[226:227], v152 offset:29952
    v_mfma_f32_16x16x32_bf16 v[60:63], a[192:195], a[4:7], v[60:63]
    ds_read_b64_tr_b16 a[228:229], v152 offset:35072
    v_mfma_f32_16x16x32_bf16 v[60:63], a[196:199], a[12:15], v[60:63]
    ds_read_b64_tr_b16 a[230:231], v152 offset:40192
    s_waitcnt vmcnt(9)
    s_barrier
    s_waitcnt lgkmcnt(12)
    v_mfma_f32_16x16x32_bf16 v[24:27], a[200:203], a[0:3], v[24:27]
    s_add_u32 s35, s34, s38
    s_add_u32 s43, s35, 4096
    s_add_u32 m0, s38, 98304
    s_nop 0
    buffer_load_dwordx4 v140, s[8:11], s35 offen offset:0  lds
    v_mfma_f32_16x16x32_bf16 v[24:27], a[204:207], a[8:11], v[24:27]
    ds_read_b64_tr_b16 a[192:193], v153 offset:0
    ds_read_b64_tr_b16 a[194:195], v153 offset:5120
    v_mfma_f32_16x16x32_bf16 v[64:67], a[200:203], a[4:7], v[64:67]
    ds_read_b64_tr_b16 a[196:197], v153 offset:10240
    v_mfma_f32_16x16x32_bf16 v[64:67], a[204:207], a[12:15], v[64:67]
    ds_read_b64_tr_b16 a[198:199], v153 offset:15360
    s_waitcnt lgkmcnt(12)
    v_mfma_f32_16x16x32_bf16 v[28:31], a[208:211], a[0:3], v[28:31]
    buffer_load_dwordx4 v140, s[8:11], s35 offen offset:1024  lds
    v_mfma_f32_16x16x32_bf16 v[28:31], a[212:215], a[8:11], v[28:31]
    ds_read_b64_tr_b16 a[200:201], v154 offset:0
    ds_read_b64_tr_b16 a[202:203], v154 offset:5120
    v_mfma_f32_16x16x32_bf16 v[68:71], a[208:211], a[4:7], v[68:71]
    ds_read_b64_tr_b16 a[204:205], v154 offset:10240
    v_mfma_f32_16x16x32_bf16 v[68:71], a[212:215], a[12:15], v[68:71]
    ds_read_b64_tr_b16 a[206:207], v154 offset:15360
    s_waitcnt lgkmcnt(12)
    v_mfma_f32_16x16x32_bf16 v[32:35], a[216:219], a[0:3], v[32:35]
    buffer_load_dwordx4 v140, s[8:11], s35 offen offset:2048  lds
    v_mfma_f32_16x16x32_bf16 v[32:35], a[220:223], a[8:11], v[32:35]
    ds_read_b64_tr_b16 a[208:209], v153 offset:64
    ds_read_b64_tr_b16 a[210:211], v153 offset:5184
    v_mfma_f32_16x16x32_bf16 v[72:75], a[216:219], a[4:7], v[72:75]
    ds_read_b64_tr_b16 a[212:213], v153 offset:10304
    v_mfma_f32_16x16x32_bf16 v[72:75], a[220:223], a[12:15], v[72:75]
    ds_read_b64_tr_b16 a[214:215], v153 offset:15424
    s_waitcnt lgkmcnt(12)
    v_mfma_f32_16x16x32_bf16 v[36:39], a[224:227], a[0:3], v[36:39]
    buffer_load_dwordx4 v140, s[8:11], s35 offen offset:3072  lds
    s_add_u32 m0, s38, 102400
    s_nop 0
    v_mfma_f32_16x16x32_bf16 v[36:39], a[228:231], a[8:11], v[36:39]
    ds_read_b64_tr_b16 a[216:217], v154 offset:64
    ds_read_b64_tr_b16 a[218:219], v154 offset:5184
    v_mfma_f32_16x16x32_bf16 v[76:79], a[224:227], a[4:7], v[76:79]
    ds_read_b64_tr_b16 a[220:221], v154 offset:10304
    v_mfma_f32_16x16x32_bf16 v[76:79], a[228:231], a[12:15], v[76:79]
    ds_read_b64_tr_b16 a[222:223], v154 offset:15424
    s_waitcnt lgkmcnt(12)
    v_mfma_f32_16x16x32_bf16 v[0:3], a[192:195], a[16:19], v[0:3]
    buffer_load_dwordx4 v140, s[8:11], s43 offen offset:0  lds
    s_add_u32 s34, s34, 61440
    s_cmp_eq_u32 s34, s60
    s_cmov_b32 s34, s61
    v_mfma_f32_16x16x32_bf16 v[0:3], a[196:199], a[24:27], v[0:3]
    ds_read_b64_tr_b16 a[224:225], v153 offset:128
    ds_read_b64_tr_b16 a[226:227], v153 offset:5248
    v_mfma_f32_16x16x32_bf16 v[40:43], a[192:195], a[20:23], v[40:43]
    ds_read_b64_tr_b16 a[228:229], v153 offset:10368
    v_mfma_f32_16x16x32_bf16 v[40:43], a[196:199], a[28:31], v[40:43]
    ds_read_b64_tr_b16 a[230:231], v153 offset:15488
    s_waitcnt lgkmcnt(12)
    v_mfma_f32_16x16x32_bf16 v[4:7], a[200:203], a[16:19], v[4:7]
    ds_read_b64_tr_b16 a[192:193], v154 offset:128
    v_mfma_f32_16x16x32_bf16 v[4:7], a[204:207], a[24:27], v[4:7]
    buffer_load_dwordx4 a[48:51], v140, s[44:47], s42 offen offset:0 sc1
    v_mfma_f32_16x16x32_bf16 v[44:47], a[200:203], a[20:23], v[44:47]
    ds_read_b64_tr_b16 a[194:195], v154 offset:5248
    ds_read_b64_tr_b16 a[196:197], v154 offset:10368
    v_mfma_f32_16x16x32_bf16 v[44:47], a[204:207], a[28:31], v[44:47]
    ds_read_b64_tr_b16 a[198:199], v154 offset:15488
    s_waitcnt lgkmcnt(12)
    v_mfma_f32_16x16x32_bf16 v[8:11], a[208:211], a[16:19], v[8:11]
    ds_read_b64_tr_b16 a[200:201], v153 offset:192
    v_mfma_f32_16x16x32_bf16 v[8:11], a[212:215], a[24:27], v[8:11]
    buffer_load_dwordx4 a[52:55], v140, s[48:51], s42 offen offset:0 sc1
    v_mfma_f32_16x16x32_bf16 v[48:51], a[208:211], a[20:23], v[48:51]
    ds_read_b64_tr_b16 a[202:203], v153 offset:5312
    ds_read_b64_tr_b16 a[204:205], v153 offset:10432
    v_mfma_f32_16x16x32_bf16 v[48:51], a[212:215], a[28:31], v[48:51]
    ds_read_b64_tr_b16 a[206:207], v153 offset:15552
    s_waitcnt lgkmcnt(12)
    v_mfma_f32_16x16x32_bf16 v[12:15], a[216:219], a[16:19], v[12:15]
    ds_read_b64_tr_b16 a[208:209], v154 offset:192
    v_mfma_f32_16x16x32_bf16 v[12:15], a[220:223], a[24:27], v[12:15]
    buffer_load_dwordx4 a[56:59], v140, s[44:47], s42 offen offset:1024 sc1
    v_mfma_f32_16x16x32_bf16 v[52:55], a[216:219], a[20:23], v[52:55]
    ds_read_b64_tr_b16 a[210:211], v154 offset:5312
    ds_read_b64_tr_b16 a[212:213], v154 offset:10432
    v_mfma_f32_16x16x32_bf16 v[52:55], a[220:223], a[28:31], v[52:55]
    ds_read_b64_tr_b16 a[214:215], v154 offset:15552
    s_waitcnt lgkmcnt(12)
    v_mfma_f32_16x16x32_bf16 v[16:19], a[224:227], a[16:19], v[16:19]
    ds_read_b64_tr_b16 a[216:217], v153 offset:256
    v_mfma_f32_16x16x32_bf16 v[16:19], a[228:231], a[24:27], v[16:19]
    buffer_load_dwordx4 a[60:63], v140, s[48:51], s42 offen offset:1024 sc1
    s_add_u32 s42, s42, 6144
    s_cmp_eq_u32 s42, s62
    s_cmov_b32 s42, s63
    v_mfma_f32_16x16x32_bf16 v[56:59], a[224:227], a[20:23], v[56:59]
    ds_read_b64_tr_b16 a[218:219], v153 offset:5376
    ds_read_b64_tr_b16 a[220:221], v153 offset:10496
    v_mfma_f32_16x16x32_bf16 v[56:59], a[228:231], a[28:31], v[56:59]
    ds_read_b64_tr_b16 a[222:223], v153 offset:15616
    s_waitcnt lgkmcnt(12)
    v_mfma_f32_16x16x32_bf16 v[20:23], a[192:195], a[16:19], v[20:23]
    ds_read_b64_tr_b16 a[224:225], v154 offset:256
    v_mfma_f32_16x16x32_bf16 v[20:23], a[196:199], a[24:27], v[20:23]
    ds_read_b64_tr_b16 a[226:227], v154 offset:5376
    v_mfma_f32_16x16x32_bf16 v[60:63], a[192:195], a[20:23], v[60:63]
    ds_read_b64_tr_b16 a[228:229], v154 offset:10496
    v_mfma_f32_16x16x32_bf16 v[60:63], a[196:199], a[28:31], v[60:63]
    ds_read_b64_tr_b16 a[230:231], v154 offset:15616
    s_waitcnt vmcnt(9)
    s_barrier
    s_waitcnt lgkmcnt(12)
    v_mfma_f32_16x16x32_bf16 v[24:27], a[200:203], a[16:19], v[24:27]
    s_add_u32 s35, s34, s38
    s_add_u32 s43, s35, 4096
    s_add_u32 m0, s38, 122880
    s_nop 0
    buffer_load_dwordx4 v140, s[8:11], s35 offen offset:0  lds
    v_mfma_f32_16x16x32_bf16 v[24:27], a[204:207], a[24:27], v[24:27]
    ds_read_b64_tr_b16 a[192:193], v153 offset:24576
    ds_read_b64_tr_b16 a[194:195], v153 offset:29696
    v_mfma_f32_16x16x32_bf16 v[64:67], a[200:203], a[20:23], v[64:67]
    ds_read_b64_tr_b16 a[196:197], v153 offset:34816
    v_mfma_f32_16x16x32_bf16 v[64:67], a[204:207], a[28:31], v[64:67]
    ds_read_b64_tr_b16 a[198:199], v153 offset:39936
    s_waitcnt lgkmcnt(12)
    v_mfma_f32_16x16x32_bf16 v[28:31], a[208:211], a[16:19], v[28:31]
    buffer_load_dwordx4 v140, s[8:11], s35 offen offset:1024  lds
    v_mfma_f32_16x16x32_bf16 v[28:31], a[212:215], a[24:27], v[28:31]
    ds_read_b64_tr_b16 a[200:201], v154 offset:24576
    ds_read_b64_tr_b16 a[202:203], v154 offset:29696
    v_mfma_f32_16x16x32_bf16 v[68:71], a[208:211], a[20:23], v[68:71]
    ds_read_b64_tr_b16 a[204:205], v154 offset:34816
    v_mfma_f32_16x16x32_bf16 v[68:71], a[212:215], a[28:31], v[68:71]
    ds_read_b64_tr_b16 a[206:207], v154 offset:39936
    s_waitcnt lgkmcnt(12)
    v_mfma_f32_16x16x32_bf16 v[32:35], a[216:219], a[16:19], v[32:35]
    buffer_load_dwordx4 v140, s[8:11], s35 offen offset:2048  lds
    v_mfma_f32_16x16x32_bf16 v[32:35], a[220:223], a[24:27], v[32:35]
    ds_read_b64_tr_b16 a[208:209], v153 offset:24640
    ds_read_b64_tr_b16 a[210:211], v153 offset:29760
    v_mfma_f32_16x16x32_bf16 v[72:75], a[216:219], a[20:23], v[72:75]
    ds_read_b64_tr_b16 a[212:213], v153 offset:34880
    v_mfma_f32_16x16x32_bf16 v[72:75], a[220:223], a[28:31], v[72:75]
    ds_read_b64_tr_b16 a[214:215], v153 offset:40000
    s_waitcnt lgkmcnt(12)
    v_mfma_f32_16x16x32_bf16 v[36:39], a[224:227], a[16:19], v[36:39]
    buffer_load_dwordx4 v140, s[8:11], s35 offen offset:3072  lds
    s_add_u32 m0, s38, 126976
    s_nop 0
    v_mfma_f32_16x16x32_bf16 v[36:39], a[228:231], a[24:27], v[36:39]
    ds_read_b64_tr_b16 a[216:217], v154 offset:24640
    ds_read_b64_tr_b16 a[218:219], v154 offset:29760
    v_mfma_f32_16x16x32_bf16 v[76:79], a[224:227], a[20:23], v[76:79]
    ds_read_b64_tr_b16 a[220:221], v154 offset:34880
    v_mfma_f32_16x16x32_bf16 v[76:79], a[228:231], a[28:31], v[76:79]
    ds_read_b64_tr_b16 a[222:223], v154 offset:40000
    s_waitcnt lgkmcnt(12)
    v_mfma_f32_16x16x32_bf16 v[0:3], a[192:195], a[32:35], v[0:3]
    buffer_load_dwordx4 v140, s[8:11], s43 offen offset:0  lds
    s_add_u32 s34, s34, 61440
    s_cmp_eq_u32 s34, s60
    s_cmov_b32 s34, s61
    v_mfma_f32_16x16x32_bf16 v[0:3], a[196:199], a[40:43], v[0:3]
    ds_read_b64_tr_b16 a[224:225], v153 offset:24704
    ds_read_b64_tr_b16 a[226:227], v153 offset:29824
    v_mfma_f32_16x16x32_bf16 v[40:43], a[192:195], a[36:39], v[40:43]
    ds_read_b64_tr_b16 a[228:229], v153 offset:34944
    v_mfma_f32_16x16x32_bf16 v[40:43], a[196:199], a[44:47], v[40:43]
    ds_read_b64_tr_b16 a[230:231], v153 offset:40064
    s_waitcnt lgkmcnt(12)
    v_mfma_f32_16x16x32_bf16 v[4:7], a[200:203], a[32:35], v[4:7]
    ds_read_b64_tr_b16 a[192:193], v154 offset:24704
    v_mfma_f32_16x16x32_bf16 v[4:7], a[204:207], a[40:43], v[4:7]
    buffer_load_dwordx4 a[0:3], v140, s[44:47], s42 offen offset:0 sc1
    v_mfma_f32_16x16x32_bf16 v[44:47], a[200:203], a[36:39], v[44:47]
    ds_read_b64_tr_b16 a[194:195], v154 offset:29824
    ds_read_b64_tr_b16 a[196:197], v154 offset:34944
    v_mfma_f32_16x16x32_bf16 v[44:47], a[204:207], a[44:47], v[44:47]
    ds_read_b64_tr_b16 a[198:199], v154 offset:40064
    s_waitcnt lgkmcnt(12)
    v_mfma_f32_16x16x32_bf16 v[8:11], a[208:211], a[32:35], v[8:11]
    ds_read_b64_tr_b16 a[200:201], v153 offset:24768
    v_mfma_f32_16x16x32_bf16 v[8:11], a[212:215], a[40:43], v[8:11]
    buffer_load_dwordx4 a[4:7], v140, s[48:51], s42 offen offset:0 sc1
    v_mfma_f32_16x16x32_bf16 v[48:51], a[208:211], a[36:39], v[48:51]
    ds_read_b64_tr_b16 a[202:203], v153 offset:29888
    ds_read_b64_tr_b16 a[204:205], v153 offset:35008
    v_mfma_f32_16x16x32_bf16 v[48:51], a[212:215], a[44:47], v[48:51]
    ds_read_b64_tr_b16 a[206:207], v153 offset:40128
    s_waitcnt lgkmcnt(12)
    v_mfma_f32_16x16x32_bf16 v[12:15], a[216:219], a[32:35], v[12:15]
    ds_read_b64_tr_b16 a[208:209], v154 offset:24768
    v_mfma_f32_16x16x32_bf16 v[12:15], a[220:223], a[40:43], v[12:15]
    buffer_load_dwordx4 a[8:11], v140, s[44:47], s42 offen offset:1024 sc1
    v_mfma_f32_16x16x32_bf16 v[52:55], a[216:219], a[36:39], v[52:55]
    ds_read_b64_tr_b16 a[210:211], v154 offset:29888
    ds_read_b64_tr_b16 a[212:213], v154 offset:35008
    v_mfma_f32_16x16x32_bf16 v[52:55], a[220:223], a[44:47], v[52:55]
    ds_read_b64_tr_b16 a[214:215], v154 offset:40128
    s_waitcnt lgkmcnt(12)
    v_mfma_f32_16x16x32_bf16 v[16:19], a[224:227], a[32:35], v[16:19]
    ds_read_b64_tr_b16 a[216:217], v153 offset:24832
    v_mfma_f32_16x16x32_bf16 v[16:19], a[228:231], a[40:43], v[16:19]
    buffer_load_dwordx4 a[12:15], v140, s[48:51], s42 offen offset:1024 sc1
    s_add_u32 s42, s42, 6144
    s_cmp_eq_u32 s42, s62
    s_cmov_b32 s42, s63
    v_mfma_f32_16x16x32_bf16 v[56:59], a[224:227], a[36:39], v[56:59]
    ds_read_b64_tr_b16 a[218:219], v153 offset:29952
    ds_read_b64_tr_b16 a[220:221], v153 offset:35072
    v_mfma_f32_16x16x32_bf16 v[56:59], a[228:231], a[44:47], v[56:59]
    ds_read_b64_tr_b16 a[222:223], v153 offset:40192
    s_waitcnt lgkmcnt(12)
    v_mfma_f32_16x16x32_bf16 v[20:23], a[192:195], a[32:35], v[20:23]
    ds_read_b64_tr_b16 a[224:225], v154 offset:24832
    v_mfma_f32_16x16x32_bf16 v[20:23], a[196:199], a[40:43], v[20:23]
    ds_read_b64_tr_b16 a[226:227], v154 offset:29952
    v_mfma_f32_16x16x32_bf16 v[60:63], a[192:195], a[36:39], v[60:63]
    ds_read_b64_tr_b16 a[228:229], v154 offset:35072
    v_mfma_f32_16x16x32_bf16 v[60:63], a[196:199], a[44:47], v[60:63]
    ds_read_b64_tr_b16 a[230:231], v154 offset:40192
    s_waitcnt vmcnt(9)
    s_barrier
    s_waitcnt lgkmcnt(12)
    v_mfma_f32_16x16x32_bf16 v[24:27], a[200:203], a[32:35], v[24:27]
    s_add_u32 s35, s34, s38
    s_add_u32 s43, s35, 4096
    s_add_u32 m0, s38, 0
    s_nop 0
    buffer_load_dwordx4 v140, s[8:11], s35 offen offset:0  lds
    v_mfma_f32_16x16x32_bf16 v[24:27], a[204:207], a[40:43], v[24:27]
    ds_read_b64_tr_b16 a[192:193], v155 offset:0
    ds_read_b64_tr_b16 a[194:195], v155 offset:5120
    v_mfma_f32_16x16x32_bf16 v[64:67], a[200:203], a[36:39], v[64:67]
    ds_read_b64_tr_b16 a[196:197], v155 offset:10240
    v_mfma_f32_16x16x32_bf16 v[64:67], a[204:207], a[44:47], v[64:67]
    ds_read_b64_tr_b16 a[198:199], v155 offset:15360
    s_waitcnt lgkmcnt(12)
    v_mfma_f32_16x16x32_bf16 v[28:31], a[208:211], a[32:35], v[28:31]
    buffer_load_dwordx4 v140, s[8:11], s35 offen offset:1024  lds
    v_mfma_f32_16x16x32_bf16 v[28:31], a[212:215], a[40:43], v[28:31]
    ds_read_b64_tr_b16 a[200:201], v156 offset:0
    ds_read_b64_tr_b16 a[202:203], v156 offset:5120
    v_mfma_f32_16x16x32_bf16 v[68:71], a[208:211], a[36:39], v[68:71]
    ds_read_b64_tr_b16 a[204:205], v156 offset:10240
    v_mfma_f32_16x16x32_bf16 v[68:71], a[212:215], a[44:47], v[68:71]
    ds_read_b64_tr_b16 a[206:207], v156 offset:15360
    s_waitcnt lgkmcnt(12)
    v_mfma_f32_16x16x32_bf16 v[32:35], a[216:219], a[32:35], v[32:35]
    buffer_load_dwordx4 v140, s[8:11], s35 offen offset:2048  lds
    v_mfma_f32_16x16x32_bf16 v[32:35], a[220:223], a[40:43], v[32:35]
    ds_read_b64_tr_b16 a[208:209], v155 offset:64
    ds_read_b64_tr_b16 a[210:211], v155 offset:5184
    v_mfma_f32_16x16x32_bf16 v[72:75], a[216:219], a[36:39], v[72:75]
    ds_read_b64_tr_b16 a[212:213], v155 offset:10304
    v_mfma_f32_16x16x32_bf16 v[72:75], a[220:223], a[44:47], v[72:75]
    ds_read_b64_tr_b16 a[214:215], v155 offset:15424
    s_waitcnt lgkmcnt(12)
    v_mfma_f32_16x16x32_bf16 v[36:39], a[224:227], a[32:35], v[36:39]
    buffer_load_dwordx4 v140, s[8:11], s35 offen offset:3072  lds
    s_add_u32 m0, s38, 4096
    s_nop 0
    v_mfma_f32_16x16x32_bf16 v[36:39], a[228:231], a[40:43], v[36:39]
    ds_read_b64_tr_b16 a[216:217], v156 offset:64
    ds_read_b64_tr_b16 a[218:219], v156 offset:5184
    v_mfma_f32_16x16x32_bf16 v[76:79], a[224:227], a[36:39], v[76:79]
    ds_read_b64_tr_b16 a[220:221], v156 offset:10304
    v_mfma_f32_16x16x32_bf16 v[76:79], a[228:231], a[44:47], v[76:79]
    ds_read_b64_tr_b16 a[222:223], v156 offset:15424
    s_waitcnt lgkmcnt(12)
    v_mfma_f32_16x16x32_bf16 v[0:3], a[192:195], a[48:51], v[0:3]
    buffer_load_dwordx4 v140, s[8:11], s43 offen offset:0  lds
    s_add_u32 s34, s34, 61440
    s_cmp_eq_u32 s34, s60
    s_cmov_b32 s34, s61
    v_mfma_f32_16x16x32_bf16 v[0:3], a[196:199], a[56:59], v[0:3]
    ds_read_b64_tr_b16 a[224:225], v155 offset:128
    ds_read_b64_tr_b16 a[226:227], v155 offset:5248
    v_mfma_f32_16x16x32_bf16 v[40:43], a[192:195], a[52:55], v[40:43]
    ds_read_b64_tr_b16 a[228:229], v155 offset:10368
    v_mfma_f32_16x16x32_bf16 v[40:43], a[196:199], a[60:63], v[40:43]
    ds_read_b64_tr_b16 a[230:231], v155 offset:15488
    s_waitcnt lgkmcnt(12)
    v_mfma_f32_16x16x32_bf16 v[4:7], a[200:203], a[48:51], v[4:7]
    ds_read_b64_tr_b16 a[192:193], v156 offset:128
    v_mfma_f32_16x16x32_bf16 v[4:7], a[204:207], a[56:59], v[4:7]
    buffer_load_dwordx4 a[16:19], v140, s[44:47], s42 offen offset:0 sc1
    v_mfma_f32_16x16x32_bf16 v[44:47], a[200:203], a[52:55], v[44:47]
    ds_read_b64_tr_b16 a[194:195], v156 offset:5248
    ds_read_b64_tr_b16 a[196:197], v156 offset:10368
    v_mfma_f32_16x16x32_bf16 v[44:47], a[204:207], a[60:63], v[44:47]
    ds_read_b64_tr_b16 a[198:199], v156 offset:15488
    s_waitcnt lgkmcnt(12)
    v_mfma_f32_16x16x32_bf16 v[8:11], a[208:211], a[48:51], v[8:11]
    ds_read_b64_tr_b16 a[200:201], v155 offset:192
    v_mfma_f32_16x16x32_bf16 v[8:11], a[212:215], a[56:59], v[8:11]
    buffer_load_dwordx4 a[20:23], v140, s[48:51], s42 offen offset:0 sc1
    v_mfma_f32_16x16x32_bf16 v[48:51], a[208:211], a[52:55], v[48:51]
    ds_read_b64_tr_b16 a[202:203], v155 offset:5312
    ds_read_b64_tr_b16 a[204:205], v155 offset:10432
    v_mfma_f32_16x16x32_bf16 v[48:51], a[212:215], a[60:63], v[48:51]
    ds_read_b64_tr_b16 a[206:207], v155 offset:15552
    s_waitcnt lgkmcnt(12)
    v_mfma_f32_16x16x32_bf16 v[12:15], a[216:219], a[48:51], v[12:15]
    ds_read_b64_tr_b16 a[208:209], v156 offset:192
    v_mfma_f32_16x16x32_bf16 v[12:15], a[220:223], a[56:59], v[12:15]
    buffer_load_dwordx4 a[24:27], v140, s[44:47], s42 offen offset:1024 sc1
    v_mfma_f32_16x16x32_bf16 v[52:55], a[216:219], a[52:55], v[52:55]
    ds_read_b64_tr_b16 a[210:211], v156 offset:5312
    ds_read_b64_tr_b16 a[212:213], v156 offset:10432
    v_mfma_f32_16x16x32_bf16 v[52:55], a[220:223], a[60:63], v[52:55]
    ds_read_b64_tr_b16 a[214:215], v156 offset:15552
    s_waitcnt lgkmcnt(12)
    v_mfma_f32_16x16x32_bf16 v[16:19], a[224:227], a[48:51], v[16:19]
    ds_read_b64_tr_b16 a[216:217], v155 offset:256
    v_mfma_f32_16x16x32_bf16 v[16:19], a[228:231], a[56:59], v[16:19]
    buffer_load_dwordx4 a[28:31], v140, s[48:51], s42 offen offset:1024 sc1
    s_add_u32 s42, s42, 6144
    s_cmp_eq_u32 s42, s62
    s_cmov_b32 s42, s63
    v_mfma_f32_16x16x32_bf16 v[56:59], a[224:227], a[52:55], v[56:59]
    ds_read_b64_tr_b16 a[218:219], v155 offset:5376
    ds_read_b64_tr_b16 a[220:221], v155 offset:10496
    v_mfma_f32_16x16x32_bf16 v[56:59], a[228:231], a[60:63], v[56:59]
    ds_read_b64_tr_b16 a[222:223], v155 offset:15616
    s_waitcnt lgkmcnt(12)
    v_mfma_f32_16x16x32_bf16 v[20:23], a[192:195], a[48:51], v[20:23]
    ds_read_b64_tr_b16 a[224:225], v156 offset:256
    v_mfma_f32_16x16x32_bf16 v[20:23], a[196:199], a[56:59], v[20:23]
    ds_read_b64_tr_b16 a[226:227], v156 offset:5376
    v_mfma_f32_16x16x32_bf16 v[60:63], a[192:195], a[52:55], v[60:63]
    ds_read_b64_tr_b16 a[228:229], v156 offset:10496
    v_mfma_f32_16x16x32_bf16 v[60:63], a[196:199], a[60:63], v[60:63]
    ds_read_b64_tr_b16 a[230:231], v156 offset:15616
    s_waitcnt vmcnt(9)
    s_barrier
    s_waitcnt lgkmcnt(12)
    v_mfma_f32_16x16x32_bf16 v[24:27], a[200:203], a[48:51], v[24:27]
    s_add_u32 s35, s34, s38
    s_add_u32 s43, s35, 4096
    s_add_u32 m0, s38, 24576
    s_nop 0
    buffer_load_dwordx4 v140, s[8:11], s35 offen offset:0  lds
    v_mfma_f32_16x16x32_bf16 v[24:27], a[204:207], a[56:59], v[24:27]
    ds_read_b64_tr_b16 a[192:193], v155 offset:24576
    ds_read_b64_tr_b16 a[194:195], v155 offset:29696
    v_mfma_f32_16x16x32_bf16 v[64:67], a[200:203], a[52:55], v[64:67]
    ds_read_b64_tr_b16 a[196:197], v155 offset:34816
    v_mfma_f32_16x16x32_bf16 v[64:67], a[204:207], a[60:63], v[64:67]
    ds_read_b64_tr_b16 a[198:199], v155 offset:39936
    s_waitcnt lgkmcnt(12)
    v_mfma_f32_16x16x32_bf16 v[28:31], a[208:211], a[48:51], v[28:31]
    buffer_load_dwordx4 v140, s[8:11], s35 offen offset:1024  lds
    v_mfma_f32_16x16x32_bf16 v[28:31], a[212:215], a[56:59], v[28:31]
    ds_read_b64_tr_b16 a[200:201], v156 offset:24576
    ds_read_b64_tr_b16 a[202:203], v156 offset:29696
    v_mfma_f32_16x16x32_bf16 v[68:71], a[208:211], a[52:55], v[68:71]
    ds_read_b64_tr_b16 a[204:205], v156 offset:34816
    v_mfma_f32_16x16x32_bf16 v[68:71], a[212:215], a[60:63], v[68:71]
    ds_read_b64_tr_b16 a[206:207], v156 offset:39936
    s_waitcnt lgkmcnt(12)
    v_mfma_f32_16x16x32_bf16 v[32:35], a[216:219], a[48:51], v[32:35]
    buffer_load_dwordx4 v140, s[8:11], s35 offen offset:2048  lds
    v_mfma_f32_16x16x32_bf16 v[32:35], a[220:223], a[56:59], v[32:35]
    ds_read_b64_tr_b16 a[208:209], v155 offset:24640
    ds_read_b64_tr_b16 a[210:211], v155 offset:29760
    v_mfma_f32_16x16x32_bf16 v[72:75], a[216:219], a[52:55], v[72:75]
    ds_read_b64_tr_b16 a[212:213], v155 offset:34880
    v_mfma_f32_16x16x32_bf16 v[72:75], a[220:223], a[60:63], v[72:75]
    ds_read_b64_tr_b16 a[214:215], v155 offset:40000
    s_waitcnt lgkmcnt(12)
    v_mfma_f32_16x16x32_bf16 v[36:39], a[224:227], a[48:51], v[36:39]
    buffer_load_dwordx4 v140, s[8:11], s35 offen offset:3072  lds
    s_add_u32 m0, s38, 28672
    s_nop 0
    v_mfma_f32_16x16x32_bf16 v[36:39], a[228:231], a[56:59], v[36:39]
    ds_read_b64_tr_b16 a[216:217], v156 offset:24640
    ds_read_b64_tr_b16 a[218:219], v156 offset:29760
    v_mfma_f32_16x16x32_bf16 v[76:79], a[224:227], a[52:55], v[76:79]
    ds_read_b64_tr_b16 a[220:221], v156 offset:34880
    v_mfma_f32_16x16x32_bf16 v[76:79], a[228:231], a[60:63], v[76:79]
    ds_read_b64_tr_b16 a[222:223], v156 offset:40000
    s_waitcnt lgkmcnt(12)
    v_mfma_f32_16x16x32_bf16 v[0:3], a[192:195], a[0:3], v[0:3]
    buffer_load_dwordx4 v140, s[8:11], s43 offen offset:0  lds
    s_add_u32 s34, s34, 61440
    s_cmp_eq_u32 s34, s60
    s_cmov_b32 s34, s61
    v_mfma_f32_16x16x32_bf16 v[0:3], a[196:199], a[8:11], v[0:3]
    ds_read_b64_tr_b16 a[224:225], v155 offset:24704
    ds_read_b64_tr_b16 a[226:227], v155 offset:29824
    v_mfma_f32_16x16x32_bf16 v[40:43], a[192:195], a[4:7], v[40:43]
    ds_read_b64_tr_b16 a[228:229], v155 offset:34944
    v_mfma_f32_16x16x32_bf16 v[40:43], a[196:199], a[12:15], v[40:43]
    ds_read_b64_tr_b16 a[230:231], v155 offset:40064
    s_waitcnt lgkmcnt(12)
    v_mfma_f32_16x16x32_bf16 v[4:7], a[200:203], a[0:3], v[4:7]
    ds_read_b64_tr_b16 a[192:193], v156 offset:24704
    v_mfma_f32_16x16x32_bf16 v[4:7], a[204:207], a[8:11], v[4:7]
    buffer_load_dwordx4 a[32:35], v140, s[44:47], s42 offen offset:0 sc1
    v_mfma_f32_16x16x32_bf16 v[44:47], a[200:203], a[4:7], v[44:47]
    ds_read_b64_tr_b16 a[194:195], v156 offset:29824
    ds_read_b64_tr_b16 a[196:197], v156 offset:34944
    v_mfma_f32_16x16x32_bf16 v[44:47], a[204:207], a[12:15], v[44:47]
    ds_read_b64_tr_b16 a[198:199], v156 offset:40064
    s_waitcnt lgkmcnt(12)
    v_mfma_f32_16x16x32_bf16 v[8:11], a[208:211], a[0:3], v[8:11]
    ds_read_b64_tr_b16 a[200:201], v155 offset:24768
    v_mfma_f32_16x16x32_bf16 v[8:11], a[212:215], a[8:11], v[8:11]
    buffer_load_dwordx4 a[36:39], v140, s[48:51], s42 offen offset:0 sc1
    v_mfma_f32_16x16x32_bf16 v[48:51], a[208:211], a[4:7], v[48:51]
    ds_read_b64_tr_b16 a[202:203], v155 offset:29888
    ds_read_b64_tr_b16 a[204:205], v155 offset:35008
    v_mfma_f32_16x16x32_bf16 v[48:51], a[212:215], a[12:15], v[48:51]
    ds_read_b64_tr_b16 a[206:207], v155 offset:40128
    s_waitcnt lgkmcnt(12)
    v_mfma_f32_16x16x32_bf16 v[12:15], a[216:219], a[0:3], v[12:15]
    ds_read_b64_tr_b16 a[208:209], v156 offset:24768
    v_mfma_f32_16x16x32_bf16 v[12:15], a[220:223], a[8:11], v[12:15]
    buffer_load_dwordx4 a[40:43], v140, s[44:47], s42 offen offset:1024 sc1
    v_mfma_f32_16x16x32_bf16 v[52:55], a[216:219], a[4:7], v[52:55]
    ds_read_b64_tr_b16 a[210:211], v156 offset:29888
    ds_read_b64_tr_b16 a[212:213], v156 offset:35008
    v_mfma_f32_16x16x32_bf16 v[52:55], a[220:223], a[12:15], v[52:55]
    ds_read_b64_tr_b16 a[214:215], v156 offset:40128
    s_waitcnt lgkmcnt(12)
    v_mfma_f32_16x16x32_bf16 v[16:19], a[224:227], a[0:3], v[16:19]
    ds_read_b64_tr_b16 a[216:217], v155 offset:24832
    v_mfma_f32_16x16x32_bf16 v[16:19], a[228:231], a[8:11], v[16:19]
    buffer_load_dwordx4 a[44:47], v140, s[48:51], s42 offen offset:1024 sc1
    s_add_u32 s42, s42, 6144
    s_cmp_eq_u32 s42, s62
    s_cmov_b32 s42, s63
    v_mfma_f32_16x16x32_bf16 v[56:59], a[224:227], a[4:7], v[56:59]
    ds_read_b64_tr_b16 a[218:219], v155 offset:29952
    ds_read_b64_tr_b16 a[220:221], v155 offset:35072
    v_mfma_f32_16x16x32_bf16 v[56:59], a[228:231], a[12:15], v[56:59]
    ds_read_b64_tr_b16 a[222:223], v155 offset:40192
    s_waitcnt lgkmcnt(12)
    v_mfma_f32_16x16x32_bf16 v[20:23], a[192:195], a[0:3], v[20:23]
    ds_read_b64_tr_b16 a[224:225], v156 offset:24832
    v_mfma_f32_16x16x32_bf16 v[20:23], a[196:199], a[8:11], v[20:23]
    ds_read_b64_tr_b16 a[226:227], v156 offset:29952
    v_mfma_f32_16x16x32_bf16 v[60:63], a[192:195], a[4:7], v[60:63]
    ds_read_b64_tr_b16 a[228:229], v156 offset:35072
    v_mfma_f32_16x16x32_bf16 v[60:63], a[196:199], a[12:15], v[60:63]
    ds_read_b64_tr_b16 a[230:231], v156 offset:40192
    s_waitcnt vmcnt(9)
    s_barrier
    s_waitcnt lgkmcnt(12)
    v_mfma_f32_16x16x32_bf16 v[24:27], a[200:203], a[0:3], v[24:27]
    s_add_u32 s35, s34, s38
    s_add_u32 s43, s35, 4096
    s_add_u32 m0, s38, 49152
    s_nop 0
    buffer_load_dwordx4 v140, s[8:11], s35 offen offset:0  lds
    v_mfma_f32_16x16x32_bf16 v[24:27], a[204:207], a[8:11], v[24:27]
    ds_read_b64_tr_b16 a[192:193], v151 offset:0
    ds_read_b64_tr_b16 a[194:195], v151 offset:5120
    v_mfma_f32_16x16x32_bf16 v[64:67], a[200:203], a[4:7], v[64:67]
    ds_read_b64_tr_b16 a[196:197], v151 offset:10240
    v_mfma_f32_16x16x32_bf16 v[64:67], a[204:207], a[12:15], v[64:67]
    ds_read_b64_tr_b16 a[198:199], v151 offset:15360
    s_waitcnt lgkmcnt(12)
    v_mfma_f32_16x16x32_bf16 v[28:31], a[208:211], a[0:3], v[28:31]
    buffer_load_dwordx4 v140, s[8:11], s35 offen offset:1024  lds
    v_mfma_f32_16x16x32_bf16 v[28:31], a[212:215], a[8:11], v[28:31]
    ds_read_b64_tr_b16 a[200:201], v152 offset:0
    ds_read_b64_tr_b16 a[202:203], v152 offset:5120
    v_mfma_f32_16x16x32_bf16 v[68:71], a[208:211], a[4:7], v[68:71]
    ds_read_b64_tr_b16 a[204:205], v152 offset:10240
    v_mfma_f32_16x16x32_bf16 v[68:71], a[212:215], a[12:15], v[68:71]
    ds_read_b64_tr_b16 a[206:207], v152 offset:15360
    s_waitcnt lgkmcnt(12)
    v_mfma_f32_16x16x32_bf16 v[32:35], a[216:219], a[0:3], v[32:35]
    buffer_load_dwordx4 v140, s[8:11], s35 offen offset:2048  lds
    v_mfma_f32_16x16x32_bf16 v[32:35], a[220:223], a[8:11], v[32:35]
    ds_read_b64_tr_b16 a[208:209], v151 offset:64
    ds_read_b64_tr_b16 a[210:211], v151 offset:5184
    v_mfma_f32_16x16x32_bf16 v[72:75], a[216:219], a[4:7], v[72:75]
    ds_read_b64_tr_b16 a[212:213], v151 offset:10304
    v_mfma_f32_16x16x32_bf16 v[72:75], a[220:223], a[12:15], v[72:75]
    ds_read_b64_tr_b16 a[214:215], v151 offset:15424
    s_waitcnt lgkmcnt(12)
    v_mfma_f32_16x16x32_bf16 v[36:39], a[224:227], a[0:3], v[36:39]
    buffer_load_dwordx4 v140, s[8:11], s35 offen offset:3072  lds
    s_add_u32 m0, s38, 53248
    s_nop 0
    v_mfma_f32_16x16x32_bf16 v[36:39], a[228:231], a[8:11], v[36:39]
    ds_read_b64_tr_b16 a[216:217], v152 offset:64
    ds_read_b64_tr_b16 a[218:219], v152 offset:5184
    v_mfma_f32_16x16x32_bf16 v[76:79], a[224:227], a[4:7], v[76:79]
    ds_read_b64_tr_b16 a[220:221], v152 offset:10304
    v_mfma_f32_16x16x32_bf16 v[76:79], a[228:231], a[12:15], v[76:79]
    ds_read_b64_tr_b16 a[222:223], v152 offset:15424
    s_waitcnt lgkmcnt(12)
    v_mfma_f32_16x16x32_bf16 v[0:3], a[192:195], a[16:19], v[0:3]
    buffer_load_dwordx4 v140, s[8:11], s43 offen offset:0  lds
    s_add_u32 s34, s34, 61440
    s_cmp_eq_u32 s34, s60
    s_cmov_b32 s34, s61
    v_mfma_f32_16x16x32_bf16 v[0:3], a[196:199], a[24:27], v[0:3]
    ds_read_b64_tr_b16 a[224:225], v151 offset:128
    ds_read_b64_tr_b16 a[226:227], v151 offset:5248
    v_mfma_f32_16x16x32_bf16 v[40:43], a[192:195], a[20:23], v[40:43]
    ds_read_b64_tr_b16 a[228:229], v151 offset:10368
    v_mfma_f32_16x16x32_bf16 v[40:43], a[196:199], a[28:31], v[40:43]
    ds_read_b64_tr_b16 a[230:231], v151 offset:15488
    s_waitcnt lgkmcnt(12)
    v_mfma_f32_16x16x32_bf16 v[4:7], a[200:203], a[16:19], v[4:7]
    ds_read_b64_tr_b16 a[192:193], v152 offset:128
    v_mfma_f32_16x16x32_bf16 v[4:7], a[204:207], a[24:27], v[4:7]
    buffer_load_dwordx4 a[48:51], v140, s[44:47], s42 offen offset:0 sc1
    v_mfma_f32_16x16x32_bf16 v[44:47], a[200:203], a[20:23], v[44:47]
    ds_read_b64_tr_b16 a[194:195], v152 offset:5248
    ds_read_b64_tr_b16 a[196:197], v152 offset:10368
    v_mfma_f32_16x16x32_bf16 v[44:47], a[204:207], a[28:31], v[44:47]
    ds_read_b64_tr_b16 a[198:199], v152 offset:15488
    s_waitcnt lgkmcnt(12)
    v_mfma_f32_16x16x32_bf16 v[8:11], a[208:211], a[16:19], v[8:11]
    ds_read_b64_tr_b16 a[200:201], v151 offset:192
    v_mfma_f32_16x16x32_bf16 v[8:11], a[212:215], a[24:27], v[8:11]
    buffer_load_dwordx4 a[52:55], v140, s[48:51], s42 offen offset:0 sc1
    v_mfma_f32_16x16x32_bf16 v[48:51], a[208:211], a[20:23], v[48:51]
    ds_read_b64_tr_b16 a[202:203], v151 offset:5312
    ds_read_b64_tr_b16 a[204:205], v151 offset:10432
    v_mfma_f32_16x16x32_bf16 v[48:51], a[212:215], a[28:31], v[48:51]
    ds_read_b64_tr_b16 a[206:207], v151 offset:15552
    s_waitcnt lgkmcnt(12)
    v_mfma_f32_16x16x32_bf16 v[12:15], a[216:219], a[16:19], v[12:15]
    ds_read_b64_tr_b16 a[208:209], v152 offset:192
    v_mfma_f32_16x16x32_bf16 v[12:15], a[220:223], a[24:27], v[12:15]
    buffer_load_dwordx4 a[56:59], v140, s[44:47], s42 offen offset:1024 sc1
    v_mfma_f32_16x16x32_bf16 v[52:55], a[216:219], a[20:23], v[52:55]
    ds_read_b64_tr_b16 a[210:211], v152 offset:5312
    ds_read_b64_tr_b16 a[212:213], v152 offset:10432
    v_mfma_f32_16x16x32_bf16 v[52:55], a[220:223], a[28:31], v[52:55]
    ds_read_b64_tr_b16 a[214:215], v152 offset:15552
    s_waitcnt lgkmcnt(12)
    v_mfma_f32_16x16x32_bf16 v[16:19], a[224:227], a[16:19], v[16:19]
    ds_read_b64_tr_b16 a[216:217], v151 offset:256
    v_mfma_f32_16x16x32_bf16 v[16:19], a[228:231], a[24:27], v[16:19]
    buffer_load_dwordx4 a[60:63], v140, s[48:51], s42 offen offset:1024 sc1
    s_add_u32 s42, s42, 6144
    s_cmp_eq_u32 s42, s62
    s_cmov_b32 s42, s63
    v_mfma_f32_16x16x32_bf16 v[56:59], a[224:227], a[20:23], v[56:59]
    ds_read_b64_tr_b16 a[218:219], v151 offset:5376
    ds_read_b64_tr_b16 a[220:221], v151 offset:10496
    v_mfma_f32_16x16x32_bf16 v[56:59], a[228:231], a[28:31], v[56:59]
    ds_read_b64_tr_b16 a[222:223], v151 offset:15616
    s_waitcnt lgkmcnt(12)
    v_mfma_f32_16x16x32_bf16 v[20:23], a[192:195], a[16:19], v[20:23]
    ds_read_b64_tr_b16 a[224:225], v152 offset:256
    v_mfma_f32_16x16x32_bf16 v[20:23], a[196:199], a[24:27], v[20:23]
    ds_read_b64_tr_b16 a[226:227], v152 offset:5376
    v_mfma_f32_16x16x32_bf16 v[60:63], a[192:195], a[20:23], v[60:63]
    ds_read_b64_tr_b16 a[228:229], v152 offset:10496
    v_mfma_f32_16x16x32_bf16 v[60:63], a[196:199], a[28:31], v[60:63]
    ds_read_b64_tr_b16 a[230:231], v152 offset:15616
    s_waitcnt vmcnt(9)
    s_barrier
    s_waitcnt lgkmcnt(12)
    v_mfma_f32_16x16x32_bf16 v[24:27], a[200:203], a[16:19], v[24:27]
    s_add_u32 s35, s34, s38
    s_add_u32 s43, s35, 4096
    s_add_u32 m0, s38, 73728
    s_nop 0
    buffer_load_dwordx4 v140, s[8:11], s35 offen offset:0  lds
    v_mfma_f32_16x16x32_bf16 v[24:27], a[204:207], a[24:27], v[24:27]
    ds_read_b64_tr_b16 a[192:193], v151 offset:24576
    ds_read_b64_tr_b16 a[194:195], v151 offset:29696
    v_mfma_f32_16x16x32_bf16 v[64:67], a[200:203], a[20:23], v[64:67]
    ds_read_b64_tr_b16 a[196:197], v151 offset:34816
    v_mfma_f32_16x16x32_bf16 v[64:67], a[204:207], a[28:31], v[64:67]
    ds_read_b64_tr_b16 a[198:199], v151 offset:39936
    s_waitcnt lgkmcnt(12)
    v_mfma_f32_16x16x32_bf16 v[28:31], a[208:211], a[16:19], v[28:31]
    buffer_load_dwordx4 v140, s[8:11], s35 offen offset:1024  lds
    v_mfma_f32_16x16x32_bf16 v[28:31], a[212:215], a[24:27], v[28:31]
    ds_read_b64_tr_b16 a[200:201], v152 offset:24576
    ds_read_b64_tr_b16 a[202:203], v152 offset:29696
    v_mfma_f32_16x16x32_bf16 v[68:71], a[208:211], a[20:23], v[68:71]
    ds_read_b64_tr_b16 a[204:205], v152 offset:34816
    v_mfma_f32_16x16x32_bf16 v[68:71], a[212:215], a[28:31], v[68:71]
    ds_read_b64_tr_b16 a[206:207], v152 offset:39936
    s_waitcnt lgkmcnt(12)
    v_mfma_f32_16x16x32_bf16 v[32:35], a[216:219], a[16:19], v[32:35]
    buffer_load_dwordx4 v140, s[8:11], s35 offen offset:2048  lds
    v_mfma_f32_16x16x32_bf16 v[32:35], a[220:223], a[24:27], v[32:35]
    ds_read_b64_tr_b16 a[208:209], v151 offset:24640
    ds_read_b64_tr_b16 a[210:211], v151 offset:29760
    v_mfma_f32_16x16x32_bf16 v[72:75], a[216:219], a[20:23], v[72:75]
    ds_read_b64_tr_b16 a[212:213], v151 offset:34880
    v_mfma_f32_16x16x32_bf16 v[72:75], a[220:223], a[28:31], v[72:75]
    ds_read_b64_tr_b16 a[214:215], v151 offset:40000
    s_waitcnt lgkmcnt(12)
    v_mfma_f32_16x16x32_bf16 v[36:39], a[224:227], a[16:19], v[36:39]
    buffer_load_dwordx4 v140, s[8:11], s35 offen offset:3072  lds
    s_add_u32 m0, s38, 77824
    s_nop 0
    v_mfma_f32_16x16x32_bf16 v[36:39], a[228:231], a[24:27], v[36:39]
    ds_read_b64_tr_b16 a[216:217], v152 offset:24640
    ds_read_b64_tr_b16 a[218:219], v152 offset:29760
    v_mfma_f32_16x16x32_bf16 v[76:79], a[224:227], a[20:23], v[76:79]
    ds_read_b64_tr_b16 a[220:221], v152 offset:34880
    v_mfma_f32_16x16x32_bf16 v[76:79], a[228:231], a[28:31], v[76:79]
    ds_read_b64_tr_b16 a[222:223], v152 offset:40000
    s_waitcnt lgkmcnt(12)
    v_mfma_f32_16x16x32_bf16 v[0:3], a[192:195], a[32:35], v[0:3]
    buffer_load_dwordx4 v140, s[8:11], s43 offen offset:0  lds
    s_add_u32 s60, s60, 20480
    s_add_u32 s61, s61, 20480
    s_mov_b32 s34, 40960
    s_cmp_eq_u32 s34, s60
    s_cmov_b32 s34, s61
    v_mfma_f32_16x16x32_bf16 v[0:3], a[196:199], a[40:43], v[0:3]
    ds_read_b64_tr_b16 a[224:225], v151 offset:24704
    ds_read_b64_tr_b16 a[226:227], v151 offset:29824
    v_mfma_f32_16x16x32_bf16 v[40:43], a[192:195], a[36:39], v[40:43]
    ds_read_b64_tr_b16 a[228:229], v151 offset:34944
    v_mfma_f32_16x16x32_bf16 v[40:43], a[196:199], a[44:47], v[40:43]
    ds_read_b64_tr_b16 a[230:231], v151 offset:40064
    s_waitcnt lgkmcnt(12)
    v_mfma_f32_16x16x32_bf16 v[4:7], a[200:203], a[32:35], v[4:7]
    ds_read_b64_tr_b16 a[192:193], v152 offset:24704
    v_mfma_f32_16x16x32_bf16 v[4:7], a[204:207], a[40:43], v[4:7]
    buffer_load_dwordx4 a[0:3], v140, s[44:47], s42 offen offset:0 sc1
    v_mfma_f32_16x16x32_bf16 v[44:47], a[200:203], a[36:39], v[44:47]
    ds_read_b64_tr_b16 a[194:195], v152 offset:29824
    ds_read_b64_tr_b16 a[196:197], v152 offset:34944
    v_mfma_f32_16x16x32_bf16 v[44:47], a[204:207], a[44:47], v[44:47]
    ds_read_b64_tr_b16 a[198:199], v152 offset:40064
    s_waitcnt lgkmcnt(12)
    v_mfma_f32_16x16x32_bf16 v[8:11], a[208:211], a[32:35], v[8:11]
    ds_read_b64_tr_b16 a[200:201], v151 offset:24768
    v_mfma_f32_16x16x32_bf16 v[8:11], a[212:215], a[40:43], v[8:11]
    buffer_load_dwordx4 a[4:7], v140, s[48:51], s42 offen offset:0 sc1
    v_mfma_f32_16x16x32_bf16 v[48:51], a[208:211], a[36:39], v[48:51]
    ds_read_b64_tr_b16 a[202:203], v151 offset:29888
    ds_read_b64_tr_b16 a[204:205], v151 offset:35008
    v_mfma_f32_16x16x32_bf16 v[48:51], a[212:215], a[44:47], v[48:51]
    ds_read_b64_tr_b16 a[206:207], v151 offset:40128
    s_waitcnt lgkmcnt(12)
    v_mfma_f32_16x16x32_bf16 v[12:15], a[216:219], a[32:35], v[12:15]
    ds_read_b64_tr_b16 a[208:209], v152 offset:24768
    v_mfma_f32_16x16x32_bf16 v[12:15], a[220:223], a[40:43], v[12:15]
    buffer_load_dwordx4 a[8:11], v140, s[44:47], s42 offen offset:1024 sc1
    v_mfma_f32_16x16x32_bf16 v[52:55], a[216:219], a[36:39], v[52:55]
    ds_read_b64_tr_b16 a[210:211], v152 offset:29888
    ds_read_b64_tr_b16 a[212:213], v152 offset:35008
    v_mfma_f32_16x16x32_bf16 v[52:55], a[220:223], a[44:47], v[52:55]
    ds_read_b64_tr_b16 a[214:215], v152 offset:40128
    s_waitcnt lgkmcnt(12)
    v_mfma_f32_16x16x32_bf16 v[16:19], a[224:227], a[32:35], v[16:19]
    ds_read_b64_tr_b16 a[216:217], v151 offset:24832
    v_mfma_f32_16x16x32_bf16 v[16:19], a[228:231], a[40:43], v[16:19]
    buffer_load_dwordx4 a[12:15], v140, s[48:51], s42 offen offset:1024 sc1
    s_add_u32 s62, s62, 2048
    s_add_u32 s63, s63, 2048
    s_mov_b32 s42, 4096
    s_cmp_eq_u32 s42, s62
    s_cmov_b32 s42, s63
    v_mfma_f32_16x16x32_bf16 v[56:59], a[224:227], a[36:39], v[56:59]
    ds_read_b64_tr_b16 a[218:219], v151 offset:29952
    ds_read_b64_tr_b16 a[220:221], v151 offset:35072
    v_mfma_f32_16x16x32_bf16 v[56:59], a[228:231], a[44:47], v[56:59]
    ds_read_b64_tr_b16 a[222:223], v151 offset:40192
    s_waitcnt lgkmcnt(12)
    v_mfma_f32_16x16x32_bf16 v[20:23], a[192:195], a[32:35], v[20:23]
    ds_read_b64_tr_b16 a[224:225], v152 offset:24832
    v_mfma_f32_16x16x32_bf16 v[20:23], a[196:199], a[40:43], v[20:23]
    ds_read_b64_tr_b16 a[226:227], v152 offset:29952
    v_mfma_f32_16x16x32_bf16 v[60:63], a[192:195], a[36:39], v[60:63]
    ds_read_b64_tr_b16 a[228:229], v152 offset:35072
    v_mfma_f32_16x16x32_bf16 v[60:63], a[196:199], a[44:47], v[60:63]
    ds_read_b64_tr_b16 a[230:231], v152 offset:40192
    s_waitcnt vmcnt(9)
    s_barrier
    s_waitcnt lgkmcnt(12)
    v_mfma_f32_16x16x32_bf16 v[24:27], a[200:203], a[32:35], v[24:27]
    s_add_u32 s35, s34, s38
    s_add_u32 s43, s35, 4096
    s_add_u32 m0, s38, 98304
    s_nop 0
    buffer_load_dwordx4 v140, s[8:11], s35 offen offset:0  lds
    v_mfma_f32_16x16x32_bf16 v[24:27], a[204:207], a[40:43], v[24:27]
    ds_read_b64_tr_b16 a[192:193], v153 offset:0
    ds_read_b64_tr_b16 a[194:195], v153 offset:5120
    v_mfma_f32_16x16x32_bf16 v[64:67], a[200:203], a[36:39], v[64:67]
    ds_read_b64_tr_b16 a[196:197], v153 offset:10240
    v_mfma_f32_16x16x32_bf16 v[64:67], a[204:207], a[44:47], v[64:67]
    ds_read_b64_tr_b16 a[198:199], v153 offset:15360
    s_waitcnt lgkmcnt(12)
    v_mfma_f32_16x16x32_bf16 v[28:31], a[208:211], a[32:35], v[28:31]
    buffer_load_dwordx4 v140, s[8:11], s35 offen offset:1024  lds
    v_mfma_f32_16x16x32_bf16 v[28:31], a[212:215], a[40:43], v[28:31]
    ds_read_b64_tr_b16 a[200:201], v154 offset:0
    ds_read_b64_tr_b16 a[202:203], v154 offset:5120
    v_mfma_f32_16x16x32_bf16 v[68:71], a[208:211], a[36:39], v[68:71]
    ds_read_b64_tr_b16 a[204:205], v154 offset:10240
    v_mfma_f32_16x16x32_bf16 v[68:71], a[212:215], a[44:47], v[68:71]
    ds_read_b64_tr_b16 a[206:207], v154 offset:15360
    s_waitcnt lgkmcnt(12)
    v_mfma_f32_16x16x32_bf16 v[32:35], a[216:219], a[32:35], v[32:35]
    buffer_load_dwordx4 v140, s[8:11], s35 offen offset:2048  lds
    v_mfma_f32_16x16x32_bf16 v[32:35], a[220:223], a[40:43], v[32:35]
    ds_read_b64_tr_b16 a[208:209], v153 offset:64
    ds_read_b64_tr_b16 a[210:211], v153 offset:5184
    v_mfma_f32_16x16x32_bf16 v[72:75], a[216:219], a[36:39], v[72:75]
    ds_read_b64_tr_b16 a[212:213], v153 offset:10304
    v_mfma_f32_16x16x32_bf16 v[72:75], a[220:223], a[44:47], v[72:75]
    ds_read_b64_tr_b16 a[214:215], v153 offset:15424
    s_waitcnt lgkmcnt(12)
    v_mfma_f32_16x16x32_bf16 v[36:39], a[224:227], a[32:35], v[36:39]
    buffer_load_dwordx4 v140, s[8:11], s35 offen offset:3072  lds
    s_add_u32 m0, s38, 102400
    s_nop 0
    v_mfma_f32_16x16x32_bf16 v[36:39], a[228:231], a[40:43], v[36:39]
    ds_read_b64_tr_b16 a[216:217], v154 offset:64
    ds_read_b64_tr_b16 a[218:219], v154 offset:5184
    v_mfma_f32_16x16x32_bf16 v[76:79], a[224:227], a[36:39], v[76:79]
    ds_read_b64_tr_b16 a[220:221], v154 offset:10304
    v_mfma_f32_16x16x32_bf16 v[76:79], a[228:231], a[44:47], v[76:79]
    ds_read_b64_tr_b16 a[222:223], v154 offset:15424
    s_waitcnt lgkmcnt(12)
    v_mfma_f32_16x16x32_bf16 v[0:3], a[192:195], a[48:51], v[0:3]
    buffer_load_dwordx4 v140, s[8:11], s43 offen offset:0  lds
    s_add_u32 s34, s34, 61440
    s_cmp_eq_u32 s34, s60
    s_cmov_b32 s34, s61
    v_mfma_f32_16x16x32_bf16 v[0:3], a[196:199], a[56:59], v[0:3]
    ds_read_b64_tr_b16 a[224:225], v153 offset:128
    ds_read_b64_tr_b16 a[226:227], v153 offset:5248
    v_mfma_f32_16x16x32_bf16 v[40:43], a[192:195], a[52:55], v[40:43]
    ds_read_b64_tr_b16 a[228:229], v153 offset:10368
    v_mfma_f32_16x16x32_bf16 v[40:43], a[196:199], a[60:63], v[40:43]
    ds_read_b64_tr_b16 a[230:231], v153 offset:15488
    s_waitcnt lgkmcnt(12)
    v_mfma_f32_16x16x32_bf16 v[4:7], a[200:203], a[48:51], v[4:7]
    ds_read_b64_tr_b16 a[192:193], v154 offset:128
    v_mfma_f32_16x16x32_bf16 v[4:7], a[204:207], a[56:59], v[4:7]
    buffer_load_dwordx4 a[16:19], v140, s[44:47], s42 offen offset:0 sc1
    v_mfma_f32_16x16x32_bf16 v[44:47], a[200:203], a[52:55], v[44:47]
    ds_read_b64_tr_b16 a[194:195], v154 offset:5248
    ds_read_b64_tr_b16 a[196:197], v154 offset:10368
    v_mfma_f32_16x16x32_bf16 v[44:47], a[204:207], a[60:63], v[44:47]
    ds_read_b64_tr_b16 a[198:199], v154 offset:15488
    s_waitcnt lgkmcnt(12)
    v_mfma_f32_16x16x32_bf16 v[8:11], a[208:211], a[48:51], v[8:11]
    ds_read_b64_tr_b16 a[200:201], v153 offset:192
    v_mfma_f32_16x16x32_bf16 v[8:11], a[212:215], a[56:59], v[8:11]
    buffer_load_dwordx4 a[20:23], v140, s[48:51], s42 offen offset:0 sc1
    v_mfma_f32_16x16x32_bf16 v[48:51], a[208:211], a[52:55], v[48:51]
    ds_read_b64_tr_b16 a[202:203], v153 offset:5312
    ds_read_b64_tr_b16 a[204:205], v153 offset:10432
    v_mfma_f32_16x16x32_bf16 v[48:51], a[212:215], a[60:63], v[48:51]
    ds_read_b64_tr_b16 a[206:207], v153 offset:15552
    s_waitcnt lgkmcnt(12)
    v_mfma_f32_16x16x32_bf16 v[12:15], a[216:219], a[48:51], v[12:15]
    ds_read_b64_tr_b16 a[208:209], v154 offset:192
    v_mfma_f32_16x16x32_bf16 v[12:15], a[220:223], a[56:59], v[12:15]
    buffer_load_dwordx4 a[24:27], v140, s[44:47], s42 offen offset:1024 sc1
    v_mfma_f32_16x16x32_bf16 v[52:55], a[216:219], a[52:55], v[52:55]
    ds_read_b64_tr_b16 a[210:211], v154 offset:5312
    ds_read_b64_tr_b16 a[212:213], v154 offset:10432
    v_mfma_f32_16x16x32_bf16 v[52:55], a[220:223], a[60:63], v[52:55]
    ds_read_b64_tr_b16 a[214:215], v154 offset:15552
    s_waitcnt lgkmcnt(12)
    v_mfma_f32_16x16x32_bf16 v[16:19], a[224:227], a[48:51], v[16:19]
    ds_read_b64_tr_b16 a[216:217], v153 offset:256
    v_mfma_f32_16x16x32_bf16 v[16:19], a[228:231], a[56:59], v[16:19]
    buffer_load_dwordx4 a[28:31], v140, s[48:51], s42 offen offset:1024 sc1
    s_add_u32 s42, s42, 6144
    s_cmp_eq_u32 s42, s62
    s_cmov_b32 s42, s63
    v_mfma_f32_16x16x32_bf16 v[56:59], a[224:227], a[52:55], v[56:59]
    ds_read_b64_tr_b16 a[218:219], v153 offset:5376
    ds_read_b64_tr_b16 a[220:221], v153 offset:10496
    v_mfma_f32_16x16x32_bf16 v[56:59], a[228:231], a[60:63], v[56:59]
    ds_read_b64_tr_b16 a[222:223], v153 offset:15616
    s_waitcnt lgkmcnt(12)
    v_mfma_f32_16x16x32_bf16 v[20:23], a[192:195], a[48:51], v[20:23]
    ds_read_b64_tr_b16 a[224:225], v154 offset:256
    v_mfma_f32_16x16x32_bf16 v[20:23], a[196:199], a[56:59], v[20:23]
    ds_read_b64_tr_b16 a[226:227], v154 offset:5376
    v_mfma_f32_16x16x32_bf16 v[60:63], a[192:195], a[52:55], v[60:63]
    ds_read_b64_tr_b16 a[228:229], v154 offset:10496
    v_mfma_f32_16x16x32_bf16 v[60:63], a[196:199], a[60:63], v[60:63]
    ds_read_b64_tr_b16 a[230:231], v154 offset:15616
    s_waitcnt vmcnt(9)
    s_barrier
    s_waitcnt lgkmcnt(12)
    v_mfma_f32_16x16x32_bf16 v[24:27], a[200:203], a[48:51], v[24:27]
    s_add_u32 s35, s34, s38
    s_add_u32 s43, s35, 4096
    s_add_u32 m0, s38, 122880
    s_nop 0
    buffer_load_dwordx4 v140, s[8:11], s35 offen offset:0  lds
    v_mfma_f32_16x16x32_bf16 v[24:27], a[204:207], a[56:59], v[24:27]
    ds_read_b64_tr_b16 a[192:193], v153 offset:24576
    ds_read_b64_tr_b16 a[194:195], v153 offset:29696
    v_mfma_f32_16x16x32_bf16 v[64:67], a[200:203], a[52:55], v[64:67]
    ds_read_b64_tr_b16 a[196:197], v153 offset:34816
    v_mfma_f32_16x16x32_bf16 v[64:67], a[204:207], a[60:63], v[64:67]
    ds_read_b64_tr_b16 a[198:199], v153 offset:39936
    s_waitcnt lgkmcnt(12)
    v_mfma_f32_16x16x32_bf16 v[28:31], a[208:211], a[48:51], v[28:31]
    buffer_load_dwordx4 v140, s[8:11], s35 offen offset:1024  lds
    v_mfma_f32_16x16x32_bf16 v[28:31], a[212:215], a[56:59], v[28:31]
    ds_read_b64_tr_b16 a[200:201], v154 offset:24576
    ds_read_b64_tr_b16 a[202:203], v154 offset:29696
    v_mfma_f32_16x16x32_bf16 v[68:71], a[208:211], a[52:55], v[68:71]
    ds_read_b64_tr_b16 a[204:205], v154 offset:34816
    v_mfma_f32_16x16x32_bf16 v[68:71], a[212:215], a[60:63], v[68:71]
    ds_read_b64_tr_b16 a[206:207], v154 offset:39936
    s_waitcnt lgkmcnt(12)
    v_mfma_f32_16x16x32_bf16 v[32:35], a[216:219], a[48:51], v[32:35]
    buffer_load_dwordx4 v140, s[8:11], s35 offen offset:2048  lds
    v_mfma_f32_16x16x32_bf16 v[32:35], a[220:223], a[56:59], v[32:35]
    ds_read_b64_tr_b16 a[208:209], v153 offset:24640
    ds_read_b64_tr_b16 a[210:211], v153 offset:29760
    v_mfma_f32_16x16x32_bf16 v[72:75], a[216:219], a[52:55], v[72:75]
    ds_read_b64_tr_b16 a[212:213], v153 offset:34880
    v_mfma_f32_16x16x32_bf16 v[72:75], a[220:223], a[60:63], v[72:75]
    ds_read_b64_tr_b16 a[214:215], v153 offset:40000
    s_waitcnt lgkmcnt(12)
    v_mfma_f32_16x16x32_bf16 v[36:39], a[224:227], a[48:51], v[36:39]
    buffer_load_dwordx4 v140, s[8:11], s35 offen offset:3072  lds
    s_add_u32 m0, s38, 126976
    s_nop 0
    v_mfma_f32_16x16x32_bf16 v[36:39], a[228:231], a[56:59], v[36:39]
    ds_read_b64_tr_b16 a[216:217], v154 offset:24640
    ds_read_b64_tr_b16 a[218:219], v154 offset:29760
    v_mfma_f32_16x16x32_bf16 v[76:79], a[224:227], a[52:55], v[76:79]
    ds_read_b64_tr_b16 a[220:221], v154 offset:34880
    v_mfma_f32_16x16x32_bf16 v[76:79], a[228:231], a[60:63], v[76:79]
    ds_read_b64_tr_b16 a[222:223], v154 offset:40000
    s_waitcnt lgkmcnt(12)
    v_mfma_f32_16x16x32_bf16 v[0:3], a[192:195], a[0:3], v[0:3]
    buffer_load_dwordx4 v140, s[8:11], s43 offen offset:0  lds
    s_add_u32 s34, s34, 61440
    s_cmp_eq_u32 s34, s60
    s_cmov_b32 s34, s61
    v_mfma_f32_16x16x32_bf16 v[0:3], a[196:199], a[8:11], v[0:3]
    ds_read_b64_tr_b16 a[224:225], v153 offset:24704
    ds_read_b64_tr_b16 a[226:227], v153 offset:29824
    v_mfma_f32_16x16x32_bf16 v[40:43], a[192:195], a[4:7], v[40:43]
    ds_read_b64_tr_b16 a[228:229], v153 offset:34944
    v_mfma_f32_16x16x32_bf16 v[40:43], a[196:199], a[12:15], v[40:43]
    ds_read_b64_tr_b16 a[230:231], v153 offset:40064
    s_waitcnt lgkmcnt(12)
    v_mfma_f32_16x16x32_bf16 v[4:7], a[200:203], a[0:3], v[4:7]
    ds_read_b64_tr_b16 a[192:193], v154 offset:24704
    v_mfma_f32_16x16x32_bf16 v[4:7], a[204:207], a[8:11], v[4:7]
    buffer_load_dwordx4 a[32:35], v140, s[44:47], s42 offen offset:0 sc1
    v_mfma_f32_16x16x32_bf16 v[44:47], a[200:203], a[4:7], v[44:47]
    ds_read_b64_tr_b16 a[194:195], v154 offset:29824
    ds_read_b64_tr_b16 a[196:197], v154 offset:34944
    v_mfma_f32_16x16x32_bf16 v[44:47], a[204:207], a[12:15], v[44:47]
    ds_read_b64_tr_b16 a[198:199], v154 offset:40064
    s_waitcnt lgkmcnt(12)
    v_mfma_f32_16x16x32_bf16 v[8:11], a[208:211], a[0:3], v[8:11]
    ds_read_b64_tr_b16 a[200:201], v153 offset:24768
    v_mfma_f32_16x16x32_bf16 v[8:11], a[212:215], a[8:11], v[8:11]
    buffer_load_dwordx4 a[36:39], v140, s[48:51], s42 offen offset:0 sc1
    v_mfma_f32_16x16x32_bf16 v[48:51], a[208:211], a[4:7], v[48:51]
    ds_read_b64_tr_b16 a[202:203], v153 offset:29888
    ds_read_b64_tr_b16 a[204:205], v153 offset:35008
    v_mfma_f32_16x16x32_bf16 v[48:51], a[212:215], a[12:15], v[48:51]
    ds_read_b64_tr_b16 a[206:207], v153 offset:40128
    s_waitcnt lgkmcnt(12)
    v_mfma_f32_16x16x32_bf16 v[12:15], a[216:219], a[0:3], v[12:15]
    ds_read_b64_tr_b16 a[208:209], v154 offset:24768
    v_mfma_f32_16x16x32_bf16 v[12:15], a[220:223], a[8:11], v[12:15]
    buffer_load_dwordx4 a[40:43], v140, s[44:47], s42 offen offset:1024 sc1
    v_mfma_f32_16x16x32_bf16 v[52:55], a[216:219], a[4:7], v[52:55]
    ds_read_b64_tr_b16 a[210:211], v154 offset:29888
    ds_read_b64_tr_b16 a[212:213], v154 offset:35008
    v_mfma_f32_16x16x32_bf16 v[52:55], a[220:223], a[12:15], v[52:55]
    ds_read_b64_tr_b16 a[214:215], v154 offset:40128
    s_waitcnt lgkmcnt(12)
    v_mfma_f32_16x16x32_bf16 v[16:19], a[224:227], a[0:3], v[16:19]
    ds_read_b64_tr_b16 a[216:217], v153 offset:24832
    v_mfma_f32_16x16x32_bf16 v[16:19], a[228:231], a[8:11], v[16:19]
    buffer_load_dwordx4 a[44:47], v140, s[48:51], s42 offen offset:1024 sc1
    s_add_u32 s42, s42, 6144
    s_cmp_eq_u32 s42, s62
    s_cmov_b32 s42, s63
    v_mfma_f32_16x16x32_bf16 v[56:59], a[224:227], a[4:7], v[56:59]
    ds_read_b64_tr_b16 a[218:219], v153 offset:29952
    ds_read_b64_tr_b16 a[220:221], v153 offset:35072
    v_mfma_f32_16x16x32_bf16 v[56:59], a[228:231], a[12:15], v[56:59]
    ds_read_b64_tr_b16 a[222:223], v153 offset:40192
    s_waitcnt lgkmcnt(12)
    v_mfma_f32_16x16x32_bf16 v[20:23], a[192:195], a[0:3], v[20:23]
    ds_read_b64_tr_b16 a[224:225], v154 offset:24832
    v_mfma_f32_16x16x32_bf16 v[20:23], a[196:199], a[8:11], v[20:23]
    ds_read_b64_tr_b16 a[226:227], v154 offset:29952
    v_mfma_f32_16x16x32_bf16 v[60:63], a[192:195], a[4:7], v[60:63]
    ds_read_b64_tr_b16 a[228:229], v154 offset:35072
    v_mfma_f32_16x16x32_bf16 v[60:63], a[196:199], a[12:15], v[60:63]
    ds_read_b64_tr_b16 a[230:231], v154 offset:40192
    s_waitcnt vmcnt(9)
    s_barrier
    s_waitcnt lgkmcnt(12)
    v_mfma_f32_16x16x32_bf16 v[24:27], a[200:203], a[0:3], v[24:27]
    s_add_u32 s35, s34, s38
    s_add_u32 s43, s35, 4096
    s_add_u32 m0, s38, 0
    s_nop 0
    buffer_load_dwordx4 v140, s[8:11], s35 offen offset:0  lds
    v_mfma_f32_16x16x32_bf16 v[24:27], a[204:207], a[8:11], v[24:27]
    ds_read_b64_tr_b16 a[192:193], v155 offset:0
    ds_read_b64_tr_b16 a[194:195], v155 offset:5120
    v_mfma_f32_16x16x32_bf16 v[64:67], a[200:203], a[4:7], v[64:67]
    ds_read_b64_tr_b16 a[196:197], v155 offset:10240
    v_mfma_f32_16x16x32_bf16 v[64:67], a[204:207], a[12:15], v[64:67]
    ds_read_b64_tr_b16 a[198:199], v155 offset:15360
    s_waitcnt lgkmcnt(12)
    v_mfma_f32_16x16x32_bf16 v[28:31], a[208:211], a[0:3], v[28:31]
    buffer_load_dwordx4 v140, s[8:11], s35 offen offset:1024  lds
    v_mfma_f32_16x16x32_bf16 v[28:31], a[212:215], a[8:11], v[28:31]
    ds_read_b64_tr_b16 a[200:201], v156 offset:0
    ds_read_b64_tr_b16 a[202:203], v156 offset:5120
    v_mfma_f32_16x16x32_bf16 v[68:71], a[208:211], a[4:7], v[68:71]
    ds_read_b64_tr_b16 a[204:205], v156 offset:10240
    v_mfma_f32_16x16x32_bf16 v[68:71], a[212:215], a[12:15], v[68:71]
    ds_read_b64_tr_b16 a[206:207], v156 offset:15360
    s_waitcnt lgkmcnt(12)
    v_mfma_f32_16x16x32_bf16 v[32:35], a[216:219], a[0:3], v[32:35]
    buffer_load_dwordx4 v140, s[8:11], s35 offen offset:2048  lds
    v_mfma_f32_16x16x32_bf16 v[32:35], a[220:223], a[8:11], v[32:35]
    ds_read_b64_tr_b16 a[208:209], v155 offset:64
    ds_read_b64_tr_b16 a[210:211], v155 offset:5184
    v_mfma_f32_16x16x32_bf16 v[72:75], a[216:219], a[4:7], v[72:75]
    ds_read_b64_tr_b16 a[212:213], v155 offset:10304
    v_mfma_f32_16x16x32_bf16 v[72:75], a[220:223], a[12:15], v[72:75]
    ds_read_b64_tr_b16 a[214:215], v155 offset:15424
    s_waitcnt lgkmcnt(12)
    v_mfma_f32_16x16x32_bf16 v[36:39], a[224:227], a[0:3], v[36:39]
    buffer_load_dwordx4 v140, s[8:11], s35 offen offset:3072  lds
    s_add_u32 m0, s38, 4096
    s_nop 0
    v_mfma_f32_16x16x32_bf16 v[36:39], a[228:231], a[8:11], v[36:39]
    ds_read_b64_tr_b16 a[216:217], v156 offset:64
    ds_read_b64_tr_b16 a[218:219], v156 offset:5184
    v_mfma_f32_16x16x32_bf16 v[76:79], a[224:227], a[4:7], v[76:79]
    ds_read_b64_tr_b16 a[220:221], v156 offset:10304
    v_mfma_f32_16x16x32_bf16 v[76:79], a[228:231], a[12:15], v[76:79]
    ds_read_b64_tr_b16 a[222:223], v156 offset:15424
    s_waitcnt lgkmcnt(12)
    v_mfma_f32_16x16x32_bf16 v[0:3], a[192:195], a[16:19], v[0:3]
    buffer_load_dwordx4 v140, s[8:11], s43 offen offset:0  lds
    s_add_u32 s34, s34, 61440
    s_cmp_eq_u32 s34, s60
    s_cmov_b32 s34, s61
    v_mfma_f32_16x16x32_bf16 v[0:3], a[196:199], a[24:27], v[0:3]
    ds_read_b64_tr_b16 a[224:225], v155 offset:128
    ds_read_b64_tr_b16 a[226:227], v155 offset:5248
    v_mfma_f32_16x16x32_bf16 v[40:43], a[192:195], a[20:23], v[40:43]
    ds_read_b64_tr_b16 a[228:229], v155 offset:10368
    v_mfma_f32_16x16x32_bf16 v[40:43], a[196:199], a[28:31], v[40:43]
    ds_read_b64_tr_b16 a[230:231], v155 offset:15488
    s_waitcnt lgkmcnt(12)
    v_mfma_f32_16x16x32_bf16 v[4:7], a[200:203], a[16:19], v[4:7]
    ds_read_b64_tr_b16 a[192:193], v156 offset:128
    v_mfma_f32_16x16x32_bf16 v[4:7], a[204:207], a[24:27], v[4:7]
    buffer_load_dwordx4 a[48:51], v140, s[44:47], s42 offen offset:0 sc1
    v_mfma_f32_16x16x32_bf16 v[44:47], a[200:203], a[20:23], v[44:47]
    ds_read_b64_tr_b16 a[194:195], v156 offset:5248
    ds_read_b64_tr_b16 a[196:197], v156 offset:10368
    v_mfma_f32_16x16x32_bf16 v[44:47], a[204:207], a[28:31], v[44:47]
    ds_read_b64_tr_b16 a[198:199], v156 offset:15488
    s_waitcnt lgkmcnt(12)
    v_mfma_f32_16x16x32_bf16 v[8:11], a[208:211], a[16:19], v[8:11]
    ds_read_b64_tr_b16 a[200:201], v155 offset:192
    v_mfma_f32_16x16x32_bf16 v[8:11], a[212:215], a[24:27], v[8:11]
    buffer_load_dwordx4 a[52:55], v140, s[48:51], s42 offen offset:0 sc1
    v_mfma_f32_16x16x32_bf16 v[48:51], a[208:211], a[20:23], v[48:51]
    ds_read_b64_tr_b16 a[202:203], v155 offset:5312
    ds_read_b64_tr_b16 a[204:205], v155 offset:10432
    v_mfma_f32_16x16x32_bf16 v[48:51], a[212:215], a[28:31], v[48:51]
    ds_read_b64_tr_b16 a[206:207], v155 offset:15552
    s_waitcnt lgkmcnt(12)
    v_mfma_f32_16x16x32_bf16 v[12:15], a[216:219], a[16:19], v[12:15]
    ds_read_b64_tr_b16 a[208:209], v156 offset:192
    v_mfma_f32_16x16x32_bf16 v[12:15], a[220:223], a[24:27], v[12:15]
    buffer_load_dwordx4 a[56:59], v140, s[44:47], s42 offen offset:1024 sc1
    v_mfma_f32_16x16x32_bf16 v[52:55], a[216:219], a[20:23], v[52:55]
    ds_read_b64_tr_b16 a[210:211], v156 offset:5312
    ds_read_b64_tr_b16 a[212:213], v156 offset:10432
    v_mfma_f32_16x16x32_bf16 v[52:55], a[220:223], a[28:31], v[52:55]
    ds_read_b64_tr_b16 a[214:215], v156 offset:15552
    s_waitcnt lgkmcnt(12)
    v_mfma_f32_16x16x32_bf16 v[16:19], a[224:227], a[16:19], v[16:19]
    ds_read_b64_tr_b16 a[216:217], v155 offset:256
    v_mfma_f32_16x16x32_bf16 v[16:19], a[228:231], a[24:27], v[16:19]
    buffer_load_dwordx4 a[60:63], v140, s[48:51], s42 offen offset:1024 sc1
    s_add_u32 s42, s42, 6144
    s_cmp_eq_u32 s42, s62
    s_cmov_b32 s42, s63
    v_mfma_f32_16x16x32_bf16 v[56:59], a[224:227], a[20:23], v[56:59]
    ds_read_b64_tr_b16 a[218:219], v155 offset:5376
    ds_read_b64_tr_b16 a[220:221], v155 offset:10496
    v_mfma_f32_16x16x32_bf16 v[56:59], a[228:231], a[28:31], v[56:59]
    ds_read_b64_tr_b16 a[222:223], v155 offset:15616
    s_waitcnt lgkmcnt(12)
    v_mfma_f32_16x16x32_bf16 v[20:23], a[192:195], a[16:19], v[20:23]
    ds_read_b64_tr_b16 a[224:225], v156 offset:256
    v_mfma_f32_16x16x32_bf16 v[20:23], a[196:199], a[24:27], v[20:23]
    ds_read_b64_tr_b16 a[226:227], v156 offset:5376
    v_mfma_f32_16x16x32_bf16 v[60:63], a[192:195], a[20:23], v[60:63]
    ds_read_b64_tr_b16 a[228:229], v156 offset:10496
    v_mfma_f32_16x16x32_bf16 v[60:63], a[196:199], a[28:31], v[60:63]
    ds_read_b64_tr_b16 a[230:231], v156 offset:15616
    s_waitcnt vmcnt(9)
    s_barrier
    s_waitcnt lgkmcnt(12)
    v_mfma_f32_16x16x32_bf16 v[24:27], a[200:203], a[16:19], v[24:27]
    s_add_u32 s35, s34, s38
    s_add_u32 s43, s35, 4096
    s_add_u32 m0, s38, 24576
    s_nop 0
    buffer_load_dwordx4 v140, s[8:11], s35 offen offset:0  lds
    v_mfma_f32_16x16x32_bf16 v[24:27], a[204:207], a[24:27], v[24:27]
    ds_read_b64_tr_b16 a[192:193], v155 offset:24576
    ds_read_b64_tr_b16 a[194:195], v155 offset:29696
    v_mfma_f32_16x16x32_bf16 v[64:67], a[200:203], a[20:23], v[64:67]
    ds_read_b64_tr_b16 a[196:197], v155 offset:34816
    v_mfma_f32_16x16x32_bf16 v[64:67], a[204:207], a[28:31], v[64:67]
    ds_read_b64_tr_b16 a[198:199], v155 offset:39936
    s_waitcnt lgkmcnt(12)
    v_mfma_f32_16x16x32_bf16 v[28:31], a[208:211], a[16:19], v[28:31]
    buffer_load_dwordx4 v140, s[8:11], s35 offen offset:1024  lds
    v_mfma_f32_16x16x32_bf16 v[28:31], a[212:215], a[24:27], v[28:31]
    ds_read_b64_tr_b16 a[200:201], v156 offset:24576
    ds_read_b64_tr_b16 a[202:203], v156 offset:29696
    v_mfma_f32_16x16x32_bf16 v[68:71], a[208:211], a[20:23], v[68:71]
    ds_read_b64_tr_b16 a[204:205], v156 offset:34816
    v_mfma_f32_16x16x32_bf16 v[68:71], a[212:215], a[28:31], v[68:71]
    ds_read_b64_tr_b16 a[206:207], v156 offset:39936
    s_waitcnt lgkmcnt(12)
    v_mfma_f32_16x16x32_bf16 v[32:35], a[216:219], a[16:19], v[32:35]
    buffer_load_dwordx4 v140, s[8:11], s35 offen offset:2048  lds
    v_mfma_f32_16x16x32_bf16 v[32:35], a[220:223], a[24:27], v[32:35]
    ds_read_b64_tr_b16 a[208:209], v155 offset:24640
    ds_read_b64_tr_b16 a[210:211], v155 offset:29760
    v_mfma_f32_16x16x32_bf16 v[72:75], a[216:219], a[20:23], v[72:75]
    ds_read_b64_tr_b16 a[212:213], v155 offset:34880
    v_mfma_f32_16x16x32_bf16 v[72:75], a[220:223], a[28:31], v[72:75]
    ds_read_b64_tr_b16 a[214:215], v155 offset:40000
    s_waitcnt lgkmcnt(12)
    v_mfma_f32_16x16x32_bf16 v[36:39], a[224:227], a[16:19], v[36:39]
    buffer_load_dwordx4 v140, s[8:11], s35 offen offset:3072  lds
    s_add_u32 m0, s38, 28672
    s_nop 0
    v_mfma_f32_16x16x32_bf16 v[36:39], a[228:231], a[24:27], v[36:39]
    ds_read_b64_tr_b16 a[216:217], v156 offset:24640
    ds_read_b64_tr_b16 a[218:219], v156 offset:29760
    v_mfma_f32_16x16x32_bf16 v[76:79], a[224:227], a[20:23], v[76:79]
    ds_read_b64_tr_b16 a[220:221], v156 offset:34880
    v_mfma_f32_16x16x32_bf16 v[76:79], a[228:231], a[28:31], v[76:79]
    ds_read_b64_tr_b16 a[222:223], v156 offset:40000
    s_waitcnt lgkmcnt(12)
    v_mfma_f32_16x16x32_bf16 v[0:3], a[192:195], a[32:35], v[0:3]
    buffer_load_dwordx4 v140, s[8:11], s43 offen offset:0  lds
    s_add_u32 s34, s34, 61440
    s_cmp_eq_u32 s34, s60
    s_cmov_b32 s34, s61
    v_mfma_f32_16x16x32_bf16 v[0:3], a[196:199], a[40:43], v[0:3]
    ds_read_b64_tr_b16 a[224:225], v155 offset:24704
    ds_read_b64_tr_b16 a[226:227], v155 offset:29824
    v_mfma_f32_16x16x32_bf16 v[40:43], a[192:195], a[36:39], v[40:43]
    ds_read_b64_tr_b16 a[228:229], v155 offset:34944
    v_mfma_f32_16x16x32_bf16 v[40:43], a[196:199], a[44:47], v[40:43]
    ds_read_b64_tr_b16 a[230:231], v155 offset:40064
    s_waitcnt lgkmcnt(12)
    v_mfma_f32_16x16x32_bf16 v[4:7], a[200:203], a[32:35], v[4:7]
    ds_read_b64_tr_b16 a[192:193], v156 offset:24704
    v_mfma_f32_16x16x32_bf16 v[4:7], a[204:207], a[40:43], v[4:7]
    buffer_load_dwordx4 a[0:3], v140, s[44:47], s42 offen offset:0 sc1
    v_mfma_f32_16x16x32_bf16 v[44:47], a[200:203], a[36:39], v[44:47]
    ds_read_b64_tr_b16 a[194:195], v156 offset:29824
    ds_read_b64_tr_b16 a[196:197], v156 offset:34944
    v_mfma_f32_16x16x32_bf16 v[44:47], a[204:207], a[44:47], v[44:47]
    ds_read_b64_tr_b16 a[198:199], v156 offset:40064
    s_waitcnt lgkmcnt(12)
    v_mfma_f32_16x16x32_bf16 v[8:11], a[208:211], a[32:35], v[8:11]
    ds_read_b64_tr_b16 a[200:201], v155 offset:24768
    v_mfma_f32_16x16x32_bf16 v[8:11], a[212:215], a[40:43], v[8:11]
    buffer_load_dwordx4 a[4:7], v140, s[48:51], s42 offen offset:0 sc1
    v_mfma_f32_16x16x32_bf16 v[48:51], a[208:211], a[36:39], v[48:51]
    ds_read_b64_tr_b16 a[202:203], v155 offset:29888
    ds_read_b64_tr_b16 a[204:205], v155 offset:35008
    v_mfma_f32_16x16x32_bf16 v[48:51], a[212:215], a[44:47], v[48:51]
    ds_read_b64_tr_b16 a[206:207], v155 offset:40128
    s_waitcnt lgkmcnt(12)
    v_mfma_f32_16x16x32_bf16 v[12:15], a[216:219], a[32:35], v[12:15]
    ds_read_b64_tr_b16 a[208:209], v156 offset:24768
    v_mfma_f32_16x16x32_bf16 v[12:15], a[220:223], a[40:43], v[12:15]
    buffer_load_dwordx4 a[8:11], v140, s[44:47], s42 offen offset:1024 sc1
    v_mfma_f32_16x16x32_bf16 v[52:55], a[216:219], a[36:39], v[52:55]
    ds_read_b64_tr_b16 a[210:211], v156 offset:29888
    ds_read_b64_tr_b16 a[212:213], v156 offset:35008
    v_mfma_f32_16x16x32_bf16 v[52:55], a[220:223], a[44:47], v[52:55]
    ds_read_b64_tr_b16 a[214:215], v156 offset:40128
    s_waitcnt lgkmcnt(12)
    v_mfma_f32_16x16x32_bf16 v[16:19], a[224:227], a[32:35], v[16:19]
    ds_read_b64_tr_b16 a[216:217], v155 offset:24832
    v_mfma_f32_16x16x32_bf16 v[16:19], a[228:231], a[40:43], v[16:19]
    buffer_load_dwordx4 a[12:15], v140, s[48:51], s42 offen offset:1024 sc1
    s_add_u32 s42, s42, 6144
    s_cmp_eq_u32 s42, s62
    s_cmov_b32 s42, s63
    v_mfma_f32_16x16x32_bf16 v[56:59], a[224:227], a[36:39], v[56:59]
    ds_read_b64_tr_b16 a[218:219], v155 offset:29952
    ds_read_b64_tr_b16 a[220:221], v155 offset:35072
    v_mfma_f32_16x16x32_bf16 v[56:59], a[228:231], a[44:47], v[56:59]
    ds_read_b64_tr_b16 a[222:223], v155 offset:40192
    s_waitcnt lgkmcnt(12)
    v_mfma_f32_16x16x32_bf16 v[20:23], a[192:195], a[32:35], v[20:23]
    ds_read_b64_tr_b16 a[224:225], v156 offset:24832
    v_mfma_f32_16x16x32_bf16 v[20:23], a[196:199], a[40:43], v[20:23]
    ds_read_b64_tr_b16 a[226:227], v156 offset:29952
    v_mfma_f32_16x16x32_bf16 v[60:63], a[192:195], a[36:39], v[60:63]
    ds_read_b64_tr_b16 a[228:229], v156 offset:35072
    v_mfma_f32_16x16x32_bf16 v[60:63], a[196:199], a[44:47], v[60:63]
    ds_read_b64_tr_b16 a[230:231], v156 offset:40192
    s_waitcnt vmcnt(9)
    s_barrier
    s_waitcnt lgkmcnt(12)
    v_mfma_f32_16x16x32_bf16 v[24:27], a[200:203], a[32:35], v[24:27]
    s_add_u32 s35, s34, s38
    s_add_u32 s43, s35, 4096
    s_add_u32 m0, s38, 49152
    s_nop 0
    buffer_load_dwordx4 v140, s[8:11], s35 offen offset:0  lds
    v_mfma_f32_16x16x32_bf16 v[24:27], a[204:207], a[40:43], v[24:27]
    ds_read_b64_tr_b16 a[192:193], v151 offset:0
    ds_read_b64_tr_b16 a[194:195], v151 offset:5120
    v_mfma_f32_16x16x32_bf16 v[64:67], a[200:203], a[36:39], v[64:67]
    ds_read_b64_tr_b16 a[196:197], v151 offset:10240
    v_mfma_f32_16x16x32_bf16 v[64:67], a[204:207], a[44:47], v[64:67]
    ds_read_b64_tr_b16 a[198:199], v151 offset:15360
    s_waitcnt lgkmcnt(12)
    v_mfma_f32_16x16x32_bf16 v[28:31], a[208:211], a[32:35], v[28:31]
    buffer_load_dwordx4 v140, s[8:11], s35 offen offset:1024  lds
    v_mfma_f32_16x16x32_bf16 v[28:31], a[212:215], a[40:43], v[28:31]
    ds_read_b64_tr_b16 a[200:201], v152 offset:0
    ds_read_b64_tr_b16 a[202:203], v152 offset:5120
    v_mfma_f32_16x16x32_bf16 v[68:71], a[208:211], a[36:39], v[68:71]
    ds_read_b64_tr_b16 a[204:205], v152 offset:10240
    v_mfma_f32_16x16x32_bf16 v[68:71], a[212:215], a[44:47], v[68:71]
    ds_read_b64_tr_b16 a[206:207], v152 offset:15360
    s_waitcnt lgkmcnt(12)
    v_mfma_f32_16x16x32_bf16 v[32:35], a[216:219], a[32:35], v[32:35]
    buffer_load_dwordx4 v140, s[8:11], s35 offen offset:2048  lds
    v_mfma_f32_16x16x32_bf16 v[32:35], a[220:223], a[40:43], v[32:35]
    ds_read_b64_tr_b16 a[208:209], v151 offset:64
    ds_read_b64_tr_b16 a[210:211], v151 offset:5184
    v_mfma_f32_16x16x32_bf16 v[72:75], a[216:219], a[36:39], v[72:75]
    ds_read_b64_tr_b16 a[212:213], v151 offset:10304
    v_mfma_f32_16x16x32_bf16 v[72:75], a[220:223], a[44:47], v[72:75]
    ds_read_b64_tr_b16 a[214:215], v151 offset:15424
    s_waitcnt lgkmcnt(12)
    v_mfma_f32_16x16x32_bf16 v[36:39], a[224:227], a[32:35], v[36:39]
    buffer_load_dwordx4 v140, s[8:11], s35 offen offset:3072  lds
    s_add_u32 m0, s38, 53248
    s_nop 0
    v_mfma_f32_16x16x32_bf16 v[36:39], a[228:231], a[40:43], v[36:39]
    ds_read_b64_tr_b16 a[216:217], v152 offset:64
    ds_read_b64_tr_b16 a[218:219], v152 offset:5184
    v_mfma_f32_16x16x32_bf16 v[76:79], a[224:227], a[36:39], v[76:79]
    ds_read_b64_tr_b16 a[220:221], v152 offset:10304
    v_mfma_f32_16x16x32_bf16 v[76:79], a[228:231], a[44:47], v[76:79]
    ds_read_b64_tr_b16 a[222:223], v152 offset:15424
    s_waitcnt lgkmcnt(12)
    v_mfma_f32_16x16x32_bf16 v[0:3], a[192:195], a[48:51], v[0:3]
    buffer_load_dwordx4 v140, s[8:11], s43 offen offset:0  lds
    s_add_u32 s34, s34, 61440
    s_cmp_eq_u32 s34, s60
    s_cmov_b32 s34, s61
    v_mfma_f32_16x16x32_bf16 v[0:3], a[196:199], a[56:59], v[0:3]
    ds_read_b64_tr_b16 a[224:225], v151 offset:128
    ds_read_b64_tr_b16 a[226:227], v151 offset:5248
    v_mfma_f32_16x16x32_bf16 v[40:43], a[192:195], a[52:55], v[40:43]
    ds_read_b64_tr_b16 a[228:229], v151 offset:10368
    v_mfma_f32_16x16x32_bf16 v[40:43], a[196:199], a[60:63], v[40:43]
    ds_read_b64_tr_b16 a[230:231], v151 offset:15488
    s_waitcnt lgkmcnt(12)
    v_mfma_f32_16x16x32_bf16 v[4:7], a[200:203], a[48:51], v[4:7]
    ds_read_b64_tr_b16 a[192:193], v152 offset:128
    v_mfma_f32_16x16x32_bf16 v[4:7], a[204:207], a[56:59], v[4:7]
    buffer_load_dwordx4 a[16:19], v140, s[44:47], s42 offen offset:0 sc1
    v_mfma_f32_16x16x32_bf16 v[44:47], a[200:203], a[52:55], v[44:47]
    ds_read_b64_tr_b16 a[194:195], v152 offset:5248
    ds_read_b64_tr_b16 a[196:197], v152 offset:10368
    v_mfma_f32_16x16x32_bf16 v[44:47], a[204:207], a[60:63], v[44:47]
    ds_read_b64_tr_b16 a[198:199], v152 offset:15488
    s_waitcnt lgkmcnt(12)
    v_mfma_f32_16x16x32_bf16 v[8:11], a[208:211], a[48:51], v[8:11]
    ds_read_b64_tr_b16 a[200:201], v151 offset:192
    v_mfma_f32_16x16x32_bf16 v[8:11], a[212:215], a[56:59], v[8:11]
    buffer_load_dwordx4 a[20:23], v140, s[48:51], s42 offen offset:0 sc1
    v_mfma_f32_16x16x32_bf16 v[48:51], a[208:211], a[52:55], v[48:51]
    ds_read_b64_tr_b16 a[202:203], v151 offset:5312
    ds_read_b64_tr_b16 a[204:205], v151 offset:10432
    v_mfma_f32_16x16x32_bf16 v[48:51], a[212:215], a[60:63], v[48:51]
    ds_read_b64_tr_b16 a[206:207], v151 offset:15552
    s_waitcnt lgkmcnt(12)
    v_mfma_f32_16x16x32_bf16 v[12:15], a[216:219], a[48:51], v[12:15]
    ds_read_b64_tr_b16 a[208:209], v152 offset:192
    v_mfma_f32_16x16x32_bf16 v[12:15], a[220:223], a[56:59], v[12:15]
    buffer_load_dwordx4 a[24:27], v140, s[44:47], s42 offen offset:1024 sc1
    v_mfma_f32_16x16x32_bf16 v[52:55], a[216:219], a[52:55], v[52:55]
    ds_read_b64_tr_b16 a[210:211], v152 offset:5312
    ds_read_b64_tr_b16 a[212:213], v152 offset:10432
    v_mfma_f32_16x16x32_bf16 v[52:55], a[220:223], a[60:63], v[52:55]
    ds_read_b64_tr_b16 a[214:215], v152 offset:15552
    s_waitcnt lgkmcnt(12)
    v_mfma_f32_16x16x32_bf16 v[16:19], a[224:227], a[48:51], v[16:19]
    ds_read_b64_tr_b16 a[216:217], v151 offset:256
    v_mfma_f32_16x16x32_bf16 v[16:19], a[228:231], a[56:59], v[16:19]
    buffer_load_dwordx4 a[28:31], v140, s[48:51], s42 offen offset:1024 sc1
    s_add_u32 s42, s42, 6144
    s_cmp_eq_u32 s42, s62
    s_cmov_b32 s42, s63
    v_mfma_f32_16x16x32_bf16 v[56:59], a[224:227], a[52:55], v[56:59]
    ds_read_b64_tr_b16 a[218:219], v151 offset:5376
    ds_read_b64_tr_b16 a[220:221], v151 offset:10496
    v_mfma_f32_16x16x32_bf16 v[56:59], a[228:231], a[60:63], v[56:59]
    ds_read_b64_tr_b16 a[222:223], v151 offset:15616
    s_waitcnt lgkmcnt(12)
    v_mfma_f32_16x16x32_bf16 v[20:23], a[192:195], a[48:51], v[20:23]
    ds_read_b64_tr_b16 a[224:225], v152 offset:256
    v_mfma_f32_16x16x32_bf16 v[20:23], a[196:199], a[56:59], v[20:23]
    ds_read_b64_tr_b16 a[226:227], v152 offset:5376
    v_mfma_f32_16x16x32_bf16 v[60:63], a[192:195], a[52:55], v[60:63]
    ds_read_b64_tr_b16 a[228:229], v152 offset:10496
    v_mfma_f32_16x16x32_bf16 v[60:63], a[196:199], a[60:63], v[60:63]
    ds_read_b64_tr_b16 a[230:231], v152 offset:15616
    s_waitcnt vmcnt(9)
    s_barrier
    s_waitcnt lgkmcnt(12)
    v_mfma_f32_16x16x32_bf16 v[24:27], a[200:203], a[48:51], v[24:27]
    s_add_u32 s35, s34, s38
    s_add_u32 s43, s35, 4096
    s_add_u32 m0, s38, 73728
    s_nop 0
    buffer_load_dwordx4 v140, s[8:11], s35 offen offset:0  lds
    v_mfma_f32_16x16x32_bf16 v[24:27], a[204:207], a[56:59], v[24:27]
    ds_read_b64_tr_b16 a[192:193], v151 offset:24576
    ds_read_b64_tr_b16 a[194:195], v151 offset:29696
    v_mfma_f32_16x16x32_bf16 v[64:67], a[200:203], a[52:55], v[64:67]
    ds_read_b64_tr_b16 a[196:197], v151 offset:34816
    v_mfma_f32_16x16x32_bf16 v[64:67], a[204:207], a[60:63], v[64:67]
    ds_read_b64_tr_b16 a[198:199], v151 offset:39936
    s_waitcnt lgkmcnt(12)
    v_mfma_f32_16x16x32_bf16 v[28:31], a[208:211], a[48:51], v[28:31]
    buffer_load_dwordx4 v140, s[8:11], s35 offen offset:1024  lds
    v_mfma_f32_16x16x32_bf16 v[28:31], a[212:215], a[56:59], v[28:31]
    ds_read_b64_tr_b16 a[200:201], v152 offset:24576
    ds_read_b64_tr_b16 a[202:203], v152 offset:29696
    v_mfma_f32_16x16x32_bf16 v[68:71], a[208:211], a[52:55], v[68:71]
    ds_read_b64_tr_b16 a[204:205], v152 offset:34816
    v_mfma_f32_16x16x32_bf16 v[68:71], a[212:215], a[60:63], v[68:71]
    ds_read_b64_tr_b16 a[206:207], v152 offset:39936
    s_waitcnt lgkmcnt(12)
    v_mfma_f32_16x16x32_bf16 v[32:35], a[216:219], a[48:51], v[32:35]
    buffer_load_dwordx4 v140, s[8:11], s35 offen offset:2048  lds
    v_mfma_f32_16x16x32_bf16 v[32:35], a[220:223], a[56:59], v[32:35]
    ds_read_b64_tr_b16 a[208:209], v151 offset:24640
    ds_read_b64_tr_b16 a[210:211], v151 offset:29760
    v_mfma_f32_16x16x32_bf16 v[72:75], a[216:219], a[52:55], v[72:75]
    ds_read_b64_tr_b16 a[212:213], v151 offset:34880
    v_mfma_f32_16x16x32_bf16 v[72:75], a[220:223], a[60:63], v[72:75]
    ds_read_b64_tr_b16 a[214:215], v151 offset:40000
    s_waitcnt lgkmcnt(12)
    v_mfma_f32_16x16x32_bf16 v[36:39], a[224:227], a[48:51], v[36:39]
    buffer_load_dwordx4 v140, s[8:11], s35 offen offset:3072  lds
    s_add_u32 m0, s38, 77824
    s_nop 0
    v_mfma_f32_16x16x32_bf16 v[36:39], a[228:231], a[56:59], v[36:39]
    ds_read_b64_tr_b16 a[216:217], v152 offset:24640
    ds_read_b64_tr_b16 a[218:219], v152 offset:29760
    v_mfma_f32_16x16x32_bf16 v[76:79], a[224:227], a[52:55], v[76:79]
    ds_read_b64_tr_b16 a[220:221], v152 offset:34880
    v_mfma_f32_16x16x32_bf16 v[76:79], a[228:231], a[60:63], v[76:79]
    ds_read_b64_tr_b16 a[222:223], v152 offset:40000
    s_waitcnt lgkmcnt(12)
    v_mfma_f32_16x16x32_bf16 v[0:3], a[192:195], a[0:3], v[0:3]
    buffer_load_dwordx4 v140, s[8:11], s43 offen offset:0  lds
    s_add_u32 s34, s34, 61440
    s_cmp_eq_u32 s34, s60
    s_cmov_b32 s34, s61
    v_mfma_f32_16x16x32_bf16 v[0:3], a[196:199], a[8:11], v[0:3]
    ds_read_b64_tr_b16 a[224:225], v151 offset:24704
    ds_read_b64_tr_b16 a[226:227], v151 offset:29824
    v_mfma_f32_16x16x32_bf16 v[40:43], a[192:195], a[4:7], v[40:43]
    ds_read_b64_tr_b16 a[228:229], v151 offset:34944
    v_mfma_f32_16x16x32_bf16 v[40:43], a[196:199], a[12:15], v[40:43]
    ds_read_b64_tr_b16 a[230:231], v151 offset:40064
    s_waitcnt lgkmcnt(12)
    v_mfma_f32_16x16x32_bf16 v[4:7], a[200:203], a[0:3], v[4:7]
    ds_read_b64_tr_b16 a[192:193], v152 offset:24704
    v_mfma_f32_16x16x32_bf16 v[4:7], a[204:207], a[8:11], v[4:7]
    buffer_load_dwordx4 a[32:35], v140, s[44:47], s42 offen offset:0 sc1
    v_mfma_f32_16x16x32_bf16 v[44:47], a[200:203], a[4:7], v[44:47]
    ds_read_b64_tr_b16 a[194:195], v152 offset:29824
    ds_read_b64_tr_b16 a[196:197], v152 offset:34944
    v_mfma_f32_16x16x32_bf16 v[44:47], a[204:207], a[12:15], v[44:47]
    ds_read_b64_tr_b16 a[198:199], v152 offset:40064
    s_waitcnt lgkmcnt(12)
    v_mfma_f32_16x16x32_bf16 v[8:11], a[208:211], a[0:3], v[8:11]
    ds_read_b64_tr_b16 a[200:201], v151 offset:24768
    v_mfma_f32_16x16x32_bf16 v[8:11], a[212:215], a[8:11], v[8:11]
    buffer_load_dwordx4 a[36:39], v140, s[48:51], s42 offen offset:0 sc1
    v_mfma_f32_16x16x32_bf16 v[48:51], a[208:211], a[4:7], v[48:51]
    ds_read_b64_tr_b16 a[202:203], v151 offset:29888
    ds_read_b64_tr_b16 a[204:205], v151 offset:35008
    v_mfma_f32_16x16x32_bf16 v[48:51], a[212:215], a[12:15], v[48:51]
    ds_read_b64_tr_b16 a[206:207], v151 offset:40128
    s_waitcnt lgkmcnt(12)
    v_mfma_f32_16x16x32_bf16 v[12:15], a[216:219], a[0:3], v[12:15]
    ds_read_b64_tr_b16 a[208:209], v152 offset:24768
    v_mfma_f32_16x16x32_bf16 v[12:15], a[220:223], a[8:11], v[12:15]
    buffer_load_dwordx4 a[40:43], v140, s[44:47], s42 offen offset:1024 sc1
    v_mfma_f32_16x16x32_bf16 v[52:55], a[216:219], a[4:7], v[52:55]
    ds_read_b64_tr_b16 a[210:211], v152 offset:29888
    ds_read_b64_tr_b16 a[212:213], v152 offset:35008
    v_mfma_f32_16x16x32_bf16 v[52:55], a[220:223], a[12:15], v[52:55]
    ds_read_b64_tr_b16 a[214:215], v152 offset:40128
    s_waitcnt lgkmcnt(12)
    v_mfma_f32_16x16x32_bf16 v[16:19], a[224:227], a[0:3], v[16:19]
    ds_read_b64_tr_b16 a[216:217], v151 offset:24832
    v_mfma_f32_16x16x32_bf16 v[16:19], a[228:231], a[8:11], v[16:19]
    buffer_load_dwordx4 a[44:47], v140, s[48:51], s42 offen offset:1024 sc1
    s_add_u32 s42, s42, 6144
    s_cmp_eq_u32 s42, s62
    s_cmov_b32 s42, s63
    v_mfma_f32_16x16x32_bf16 v[56:59], a[224:227], a[4:7], v[56:59]
    ds_read_b64_tr_b16 a[218:219], v151 offset:29952
    ds_read_b64_tr_b16 a[220:221], v151 offset:35072
    v_mfma_f32_16x16x32_bf16 v[56:59], a[228:231], a[12:15], v[56:59]
    ds_read_b64_tr_b16 a[222:223], v151 offset:40192
    s_waitcnt lgkmcnt(12)
    v_mfma_f32_16x16x32_bf16 v[20:23], a[192:195], a[0:3], v[20:23]
    ds_read_b64_tr_b16 a[224:225], v152 offset:24832
    v_mfma_f32_16x16x32_bf16 v[20:23], a[196:199], a[8:11], v[20:23]
    ds_read_b64_tr_b16 a[226:227], v152 offset:29952
    v_mfma_f32_16x16x32_bf16 v[60:63], a[192:195], a[4:7], v[60:63]
    ds_read_b64_tr_b16 a[228:229], v152 offset:35072
    v_mfma_f32_16x16x32_bf16 v[60:63], a[196:199], a[12:15], v[60:63]
    ds_read_b64_tr_b16 a[230:231], v152 offset:40192
    s_waitcnt vmcnt(9)
    s_barrier
    s_waitcnt lgkmcnt(12)
    v_mfma_f32_16x16x32_bf16 v[24:27], a[200:203], a[0:3], v[24:27]
    s_add_u32 s35, s34, s38
    s_add_u32 s43, s35, 4096
    s_add_u32 m0, s38, 98304
    s_nop 0
    buffer_load_dwordx4 v140, s[8:11], s35 offen offset:0  lds
    v_mfma_f32_16x16x32_bf16 v[24:27], a[204:207], a[8:11], v[24:27]
    ds_read_b64_tr_b16 a[192:193], v153 offset:0
    ds_read_b64_tr_b16 a[194:195], v153 offset:5120
    v_mfma_f32_16x16x32_bf16 v[64:67], a[200:203], a[4:7], v[64:67]
    ds_read_b64_tr_b16 a[196:197], v153 offset:10240
    v_mfma_f32_16x16x32_bf16 v[64:67], a[204:207], a[12:15], v[64:67]
    ds_read_b64_tr_b16 a[198:199], v153 offset:15360
    s_waitcnt lgkmcnt(12)
    v_mfma_f32_16x16x32_bf16 v[28:31], a[208:211], a[0:3], v[28:31]
    buffer_load_dwordx4 v140, s[8:11], s35 offen offset:1024  lds
    v_mfma_f32_16x16x32_bf16 v[28:31], a[212:215], a[8:11], v[28:31]
    ds_read_b64_tr_b16 a[200:201], v154 offset:0
    ds_read_b64_tr_b16 a[202:203], v154 offset:5120
    v_mfma_f32_16x16x32_bf16 v[68:71], a[208:211], a[4:7], v[68:71]
    ds_read_b64_tr_b16 a[204:205], v154 offset:10240
    v_mfma_f32_16x16x32_bf16 v[68:71], a[212:215], a[12:15], v[68:71]
    ds_read_b64_tr_b16 a[206:207], v154 offset:15360
    s_waitcnt lgkmcnt(12)
    v_mfma_f32_16x16x32_bf16 v[32:35], a[216:219], a[0:3], v[32:35]
    buffer_load_dwordx4 v140, s[8:11], s35 offen offset:2048  lds
    v_mfma_f32_16x16x32_bf16 v[32:35], a[220:223], a[8:11], v[32:35]
    ds_read_b64_tr_b16 a[208:209], v153 offset:64
    ds_read_b64_tr_b16 a[210:211], v153 offset:5184
    v_mfma_f32_16x16x32_bf16 v[72:75], a[216:219], a[4:7], v[72:75]
    ds_read_b64_tr_b16 a[212:213], v153 offset:10304
    v_mfma_f32_16x16x32_bf16 v[72:75], a[220:223], a[12:15], v[72:75]
    ds_read_b64_tr_b16 a[214:215], v153 offset:15424
    s_waitcnt lgkmcnt(12)
    v_mfma_f32_16x16x32_bf16 v[36:39], a[224:227], a[0:3], v[36:39]
    buffer_load_dwordx4 v140, s[8:11], s35 offen offset:3072  lds
    s_add_u32 m0, s38, 102400
    s_nop 0
    v_mfma_f32_16x16x32_bf16 v[36:39], a[228:231], a[8:11], v[36:39]
    ds_read_b64_tr_b16 a[216:217], v154 offset:64
    ds_read_b64_tr_b16 a[218:219], v154 offset:5184
    v_mfma_f32_16x16x32_bf16 v[76:79], a[224:227], a[4:7], v[76:79]
    ds_read_b64_tr_b16 a[220:221], v154 offset:10304
    v_mfma_f32_16x16x32_bf16 v[76:79], a[228:231], a[12:15], v[76:79]
    ds_read_b64_tr_b16 a[222:223], v154 offset:15424
    s_waitcnt lgkmcnt(12)
    v_mfma_f32_16x16x32_bf16 v[0:3], a[192:195], a[16:19], v[0:3]
    buffer_load_dwordx4 v140, s[8:11], s43 offen offset:0  lds
    s_add_u32 s60, s60, 20480
    s_add_u32 s61, s61, 20480
    s_mov_b32 s34, 61440
    s_cmp_eq_u32 s34, s60
    s_cmov_b32 s34, s61
    v_mfma_f32_16x16x32_bf16 v[0:3], a[196:199], a[24:27], v[0:3]
    ds_read_b64_tr_b16 a[224:225], v153 offset:128
    ds_read_b64_tr_b16 a[226:227], v153 offset:5248
    v_mfma_f32_16x16x32_bf16 v[40:43], a[192:195], a[20:23], v[40:43]
    ds_read_b64_tr_b16 a[228:229], v153 offset:10368
    v_mfma_f32_16x16x32_bf16 v[40:43], a[196:199], a[28:31], v[40:43]
    ds_read_b64_tr_b16 a[230:231], v153 offset:15488
    s_waitcnt lgkmcnt(12)
    v_mfma_f32_16x16x32_bf16 v[4:7], a[200:203], a[16:19], v[4:7]
    ds_read_b64_tr_b16 a[192:193], v154 offset:128
    v_mfma_f32_16x16x32_bf16 v[4:7], a[204:207], a[24:27], v[4:7]
    buffer_load_dwordx4 a[48:51], v140, s[44:47], s42 offen offset:0 sc1
    v_mfma_f32_16x16x32_bf16 v[44:47], a[200:203], a[20:23], v[44:47]
    ds_read_b64_tr_b16 a[194:195], v154 offset:5248
    ds_read_b64_tr_b16 a[196:197], v154 offset:10368
    v_mfma_f32_16x16x32_bf16 v[44:47], a[204:207], a[28:31], v[44:47]
    ds_read_b64_tr_b16 a[198:199], v154 offset:15488
    s_waitcnt lgkmcnt(12)
    v_mfma_f32_16x16x32_bf16 v[8:11], a[208:211], a[16:19], v[8:11]
    ds_read_b64_tr_b16 a[200:201], v153 offset:192
    v_mfma_f32_16x16x32_bf16 v[8:11], a[212:215], a[24:27], v[8:11]
    buffer_load_dwordx4 a[52:55], v140, s[48:51], s42 offen offset:0 sc1
    v_mfma_f32_16x16x32_bf16 v[48:51], a[208:211], a[20:23], v[48:51]
    ds_read_b64_tr_b16 a[202:203], v153 offset:5312
    ds_read_b64_tr_b16 a[204:205], v153 offset:10432
    v_mfma_f32_16x16x32_bf16 v[48:51], a[212:215], a[28:31], v[48:51]
    ds_read_b64_tr_b16 a[206:207], v153 offset:15552
    s_waitcnt lgkmcnt(12)
    v_mfma_f32_16x16x32_bf16 v[12:15], a[216:219], a[16:19], v[12:15]
    ds_read_b64_tr_b16 a[208:209], v154 offset:192
    v_mfma_f32_16x16x32_bf16 v[12:15], a[220:223], a[24:27], v[12:15]
    buffer_load_dwordx4 a[56:59], v140, s[44:47], s42 offen offset:1024 sc1
    v_mfma_f32_16x16x32_bf16 v[52:55], a[216:219], a[20:23], v[52:55]
    ds_read_b64_tr_b16 a[210:211], v154 offset:5312
    ds_read_b64_tr_b16 a[212:213], v154 offset:10432
    v_mfma_f32_16x16x32_bf16 v[52:55], a[220:223], a[28:31], v[52:55]
    ds_read_b64_tr_b16 a[214:215], v154 offset:15552
    s_waitcnt lgkmcnt(12)
    v_mfma_f32_16x16x32_bf16 v[16:19], a[224:227], a[16:19], v[16:19]
    ds_read_b64_tr_b16 a[216:217], v153 offset:256
    v_mfma_f32_16x16x32_bf16 v[16:19], a[228:231], a[24:27], v[16:19]
    buffer_load_dwordx4 a[60:63], v140, s[48:51], s42 offen offset:1024 sc1
    s_add_u32 s62, s62, 2048
    s_add_u32 s63, s63, 2048
    s_mov_b32 s42, 6144
    s_cmp_eq_u32 s42, s62
    s_cmov_b32 s42, s63
    v_mfma_f32_16x16x32_bf16 v[56:59], a[224:227], a[20:23], v[56:59]
    ds_read_b64_tr_b16 a[218:219], v153 offset:5376
    ds_read_b64_tr_b16 a[220:221], v153 offset:10496
    v_mfma_f32_16x16x32_bf16 v[56:59], a[228:231], a[28:31], v[56:59]
    ds_read_b64_tr_b16 a[222:223], v153 offset:15616
    s_waitcnt lgkmcnt(12)
    v_mfma_f32_16x16x32_bf16 v[20:23], a[192:195], a[16:19], v[20:23]
    ds_read_b64_tr_b16 a[224:225], v154 offset:256
    v_mfma_f32_16x16x32_bf16 v[20:23], a[196:199], a[24:27], v[20:23]
    ds_read_b64_tr_b16 a[226:227], v154 offset:5376
    v_mfma_f32_16x16x32_bf16 v[60:63], a[192:195], a[20:23], v[60:63]
    ds_read_b64_tr_b16 a[228:229], v154 offset:10496
    v_mfma_f32_16x16x32_bf16 v[60:63], a[196:199], a[28:31], v[60:63]
    ds_read_b64_tr_b16 a[230:231], v154 offset:15616
    s_waitcnt vmcnt(9)
    s_barrier
    s_waitcnt lgkmcnt(12)
    v_mfma_f32_16x16x32_bf16 v[24:27], a[200:203], a[16:19], v[24:27]
    ds_read_b64_tr_b16 a[192:193], v153 offset:24576
    v_mfma_f32_16x16x32_bf16 v[24:27], a[204:207], a[24:27], v[24:27]
    ds_read_b64_tr_b16 a[194:195], v153 offset:29696
    v_mfma_f32_16x16x32_bf16 v[64:67], a[200:203], a[20:23], v[64:67]
    ds_read_b64_tr_b16 a[196:197], v153 offset:34816
    v_mfma_f32_16x16x32_bf16 v[64:67], a[204:207], a[28:31], v[64:67]
    ds_read_b64_tr_b16 a[198:199], v153 offset:39936
    s_waitcnt lgkmcnt(12)
    v_mfma_f32_16x16x32_bf16 v[28:31], a[208:211], a[16:19], v[28:31]
    ds_read_b64_tr_b16 a[200:201], v154 offset:24576
    v_mfma_f32_16x16x32_bf16 v[28:31], a[212:215], a[24:27], v[28:31]
    ds_read_b64_tr_b16 a[202:203], v154 offset:29696
    v_mfma_f32_16x16x32_bf16 v[68:71], a[208:211], a[20:23], v[68:71]
    ds_read_b64_tr_b16 a[204:205], v154 offset:34816
    v_mfma_f32_16x16x32_bf16 v[68:71], a[212:215], a[28:31], v[68:71]
    ds_read_b64_tr_b16 a[206:207], v154 offset:39936
    s_waitcnt lgkmcnt(12)
    v_mfma_f32_16x16x32_bf16 v[32:35], a[216:219], a[16:19], v[32:35]
    ds_read_b64_tr_b16 a[208:209], v153 offset:24640
    v_mfma_f32_16x16x32_bf16 v[32:35], a[220:223], a[24:27], v[32:35]
    ds_read_b64_tr_b16 a[210:211], v153 offset:29760
    v_mfma_f32_16x16x32_bf16 v[72:75], a[216:219], a[20:23], v[72:75]
    ds_read_b64_tr_b16 a[212:213], v153 offset:34880
    v_mfma_f32_16x16x32_bf16 v[72:75], a[220:223], a[28:31], v[72:75]
    ds_read_b64_tr_b16 a[214:215], v153 offset:40000
    s_waitcnt lgkmcnt(12)
    v_mfma_f32_16x16x32_bf16 v[36:39], a[224:227], a[16:19], v[36:39]
    ds_read_b64_tr_b16 a[216:217], v154 offset:24640
    v_mfma_f32_16x16x32_bf16 v[36:39], a[228:231], a[24:27], v[36:39]
    ds_read_b64_tr_b16 a[218:219], v154 offset:29760
    v_mfma_f32_16x16x32_bf16 v[76:79], a[224:227], a[20:23], v[76:79]
    ds_read_b64_tr_b16 a[220:221], v154 offset:34880
    v_mfma_f32_16x16x32_bf16 v[76:79], a[228:231], a[28:31], v[76:79]
    ds_read_b64_tr_b16 a[222:223], v154 offset:40000
    s_waitcnt lgkmcnt(12)
    v_mfma_f32_16x16x32_bf16 v[0:3], a[192:195], a[32:35], v[0:3]
    ds_read_b64_tr_b16 a[224:225], v153 offset:24704
    v_mfma_f32_16x16x32_bf16 v[0:3], a[196:199], a[40:43], v[0:3]
    ds_read_b64_tr_b16 a[226:227], v153 offset:29824
    v_mfma_f32_16x16x32_bf16 v[40:43], a[192:195], a[36:39], v[40:43]
    ds_read_b64_tr_b16 a[228:229], v153 offset:34944
    v_mfma_f32_16x16x32_bf16 v[40:43], a[196:199], a[44:47], v[40:43]
    ds_read_b64_tr_b16 a[230:231], v153 offset:40064
    s_waitcnt lgkmcnt(12)
    v_mfma_f32_16x16x32_bf16 v[4:7], a[200:203], a[32:35], v[4:7]
    ds_read_b64_tr_b16 a[192:193], v154 offset:24704
    v_mfma_f32_16x16x32_bf16 v[4:7], a[204:207], a[40:43], v[4:7]
    ds_read_b64_tr_b16 a[194:195], v154 offset:29824
    v_mfma_f32_16x16x32_bf16 v[44:47], a[200:203], a[36:39], v[44:47]
    ds_read_b64_tr_b16 a[196:197], v154 offset:34944
    v_mfma_f32_16x16x32_bf16 v[44:47], a[204:207], a[44:47], v[44:47]
    ds_read_b64_tr_b16 a[198:199], v154 offset:40064
    s_waitcnt lgkmcnt(12)
    v_mfma_f32_16x16x32_bf16 v[8:11], a[208:211], a[32:35], v[8:11]
    ds_read_b64_tr_b16 a[200:201], v153 offset:24768
    v_mfma_f32_16x16x32_bf16 v[8:11], a[212:215], a[40:43], v[8:11]
    ds_read_b64_tr_b16 a[202:203], v153 offset:29888
    v_mfma_f32_16x16x32_bf16 v[48:51], a[208:211], a[36:39], v[48:51]
    ds_read_b64_tr_b16 a[204:205], v153 offset:35008
    v_mfma_f32_16x16x32_bf16 v[48:51], a[212:215], a[44:47], v[48:51]
    ds_read_b64_tr_b16 a[206:207], v153 offset:40128
    s_waitcnt lgkmcnt(12)
    v_mfma_f32_16x16x32_bf16 v[12:15], a[216:219], a[32:35], v[12:15]
    ds_read_b64_tr_b16 a[208:209], v154 offset:24768
    v_mfma_f32_16x16x32_bf16 v[12:15], a[220:223], a[40:43], v[12:15]
    ds_read_b64_tr_b16 a[210:211], v154 offset:29888
    v_mfma_f32_16x16x32_bf16 v[52:55], a[216:219], a[36:39], v[52:55]
    ds_read_b64_tr_b16 a[212:213], v154 offset:35008
    v_mfma_f32_16x16x32_bf16 v[52:55], a[220:223], a[44:47], v[52:55]
    ds_read_b64_tr_b16 a[214:215], v154 offset:40128
    s_waitcnt lgkmcnt(12)
    v_mfma_f32_16x16x32_bf16 v[16:19], a[224:227], a[32:35], v[16:19]
    ds_read_b64_tr_b16 a[216:217], v153 offset:24832
    v_mfma_f32_16x16x32_bf16 v[16:19], a[228:231], a[40:43], v[16:19]
    ds_read_b64_tr_b16 a[218:219], v153 offset:29952
    v_mfma_f32_16x16x32_bf16 v[56:59], a[224:227], a[36:39], v[56:59]
    ds_read_b64_tr_b16 a[220:221], v153 offset:35072
    v_mfma_f32_16x16x32_bf16 v[56:59], a[228:231], a[44:47], v[56:59]
    ds_read_b64_tr_b16 a[222:223], v153 offset:40192
    s_waitcnt lgkmcnt(12)
    v_mfma_f32_16x16x32_bf16 v[20:23], a[192:195], a[32:35], v[20:23]
    ds_read_b64_tr_b16 a[224:225], v154 offset:24832
    v_mfma_f32_16x16x32_bf16 v[20:23], a[196:199], a[40:43], v[20:23]
    ds_read_b64_tr_b16 a[226:227], v154 offset:29952
    v_mfma_f32_16x16x32_bf16 v[60:63], a[192:195], a[36:39], v[60:63]
    ds_read_b64_tr_b16 a[228:229], v154 offset:35072
    v_mfma_f32_16x16x32_bf16 v[60:63], a[196:199], a[44:47], v[60:63]
    ds_read_b64_tr_b16 a[230:231], v154 offset:40192
    s_waitcnt vmcnt(0)
    s_barrier
    s_waitcnt lgkmcnt(12)
    v_mfma_f32_16x16x32_bf16 v[24:27], a[200:203], a[32:35], v[24:27]
    ds_read_b64_tr_b16 a[192:193], v155 offset:0
    v_mfma_f32_16x16x32_bf16 v[24:27], a[204:207], a[40:43], v[24:27]
    ds_read_b64_tr_b16 a[194:195], v155 offset:5120
    v_mfma_f32_16x16x32_bf16 v[64:67], a[200:203], a[36:39], v[64:67]
    ds_read_b64_tr_b16 a[196:197], v155 offset:10240
    v_mfma_f32_16x16x32_bf16 v[64:67], a[204:207], a[44:47], v[64:67]
    ds_read_b64_tr_b16 a[198:199], v155 offset:15360
    s_waitcnt lgkmcnt(12)
    v_mfma_f32_16x16x32_bf16 v[28:31], a[208:211], a[32:35], v[28:31]
    ds_read_b64_tr_b16 a[200:201], v156 offset:0
    v_mfma_f32_16x16x32_bf16 v[28:31], a[212:215], a[40:43], v[28:31]
    ds_read_b64_tr_b16 a[202:203], v156 offset:5120
    v_mfma_f32_16x16x32_bf16 v[68:71], a[208:211], a[36:39], v[68:71]
    ds_read_b64_tr_b16 a[204:205], v156 offset:10240
    v_mfma_f32_16x16x32_bf16 v[68:71], a[212:215], a[44:47], v[68:71]
    ds_read_b64_tr_b16 a[206:207], v156 offset:15360
    s_waitcnt lgkmcnt(12)
    v_mfma_f32_16x16x32_bf16 v[32:35], a[216:219], a[32:35], v[32:35]
    ds_read_b64_tr_b16 a[208:209], v155 offset:64
    v_mfma_f32_16x16x32_bf16 v[32:35], a[220:223], a[40:43], v[32:35]
    ds_read_b64_tr_b16 a[210:211], v155 offset:5184
    v_mfma_f32_16x16x32_bf16 v[72:75], a[216:219], a[36:39], v[72:75]
    ds_read_b64_tr_b16 a[212:213], v155 offset:10304
    v_mfma_f32_16x16x32_bf16 v[72:75], a[220:223], a[44:47], v[72:75]
    ds_read_b64_tr_b16 a[214:215], v155 offset:15424
    s_waitcnt lgkmcnt(12)
    v_mfma_f32_16x16x32_bf16 v[36:39], a[224:227], a[32:35], v[36:39]
    ds_read_b64_tr_b16 a[216:217], v156 offset:64
    v_mfma_f32_16x16x32_bf16 v[36:39], a[228:231], a[40:43], v[36:39]
    ds_read_b64_tr_b16 a[218:219], v156 offset:5184
    v_mfma_f32_16x16x32_bf16 v[76:79], a[224:227], a[36:39], v[76:79]
    ds_read_b64_tr_b16 a[220:221], v156 offset:10304
    v_mfma_f32_16x16x32_bf16 v[76:79], a[228:231], a[44:47], v[76:79]
    ds_read_b64_tr_b16 a[222:223], v156 offset:15424
    s_waitcnt lgkmcnt(12)
    v_mfma_f32_16x16x32_bf16 v[0:3], a[192:195], a[48:51], v[0:3]
    ds_read_b64_tr_b16 a[224:225], v155 offset:128
    v_mfma_f32_16x16x32_bf16 v[0:3], a[196:199], a[56:59], v[0:3]
    ds_read_b64_tr_b16 a[226:227], v155 offset:5248
    v_mfma_f32_16x16x32_bf16 v[40:43], a[192:195], a[52:55], v[40:43]
    ds_read_b64_tr_b16 a[228:229], v155 offset:10368
    v_mfma_f32_16x16x32_bf16 v[40:43], a[196:199], a[60:63], v[40:43]
    ds_read_b64_tr_b16 a[230:231], v155 offset:15488
    s_waitcnt lgkmcnt(12)
    v_mfma_f32_16x16x32_bf16 v[4:7], a[200:203], a[48:51], v[4:7]
    ds_read_b64_tr_b16 a[192:193], v156 offset:128
    v_mfma_f32_16x16x32_bf16 v[4:7], a[204:207], a[56:59], v[4:7]
    ds_read_b64_tr_b16 a[194:195], v156 offset:5248
    v_mfma_f32_16x16x32_bf16 v[44:47], a[200:203], a[52:55], v[44:47]
    ds_read_b64_tr_b16 a[196:197], v156 offset:10368
    v_mfma_f32_16x16x32_bf16 v[44:47], a[204:207], a[60:63], v[44:47]
    ds_read_b64_tr_b16 a[198:199], v156 offset:15488
    s_waitcnt lgkmcnt(12)
    v_mfma_f32_16x16x32_bf16 v[8:11], a[208:211], a[48:51], v[8:11]
    ds_read_b64_tr_b16 a[200:201], v155 offset:192
    v_mfma_f32_16x16x32_bf16 v[8:11], a[212:215], a[56:59], v[8:11]
    ds_read_b64_tr_b16 a[202:203], v155 offset:5312
    v_mfma_f32_16x16x32_bf16 v[48:51], a[208:211], a[52:55], v[48:51]
    ds_read_b64_tr_b16 a[204:205], v155 offset:10432
    v_mfma_f32_16x16x32_bf16 v[48:51], a[212:215], a[60:63], v[48:51]
    ds_read_b64_tr_b16 a[206:207], v155 offset:15552
    s_waitcnt lgkmcnt(12)
    v_mfma_f32_16x16x32_bf16 v[12:15], a[216:219], a[48:51], v[12:15]
    ds_read_b64_tr_b16 a[208:209], v156 offset:192
    v_cvt_pk_bf16_f32 v88, v0, v1
    v_cvt_pk_bf16_f32 v89, v2, v3
    v_mfma_f32_16x16x32_bf16 v[12:15], a[220:223], a[56:59], v[12:15]
    ds_read_b64_tr_b16 a[210:211], v156 offset:5312
    v_cvt_pk_bf16_f32 v90, v4, v5
    v_cvt_pk_bf16_f32 v91, v6, v7
    v_mfma_f32_16x16x32_bf16 v[52:55], a[216:219], a[52:55], v[52:55]
    ds_read_b64_tr_b16 a[212:213], v156 offset:10432
    buffer_store_dwordx4 v[88:91], v140, s[84:87], s28 offen offset:0 sc1
    v_cvt_pk_bf16_f32 v92, v40, v41
    v_mfma_f32_16x16x32_bf16 v[52:55], a[220:223], a[60:63], v[52:55]
    ds_read_b64_tr_b16 a[214:215], v156 offset:15552
    v_cvt_pk_bf16_f32 v93, v42, v43
    v_cvt_pk_bf16_f32 v94, v44, v45
    s_waitcnt lgkmcnt(12)
    v_mfma_f32_16x16x32_bf16 v[16:19], a[224:227], a[48:51], v[16:19]
    ds_read_b64_tr_b16 a[216:217], v155 offset:256
    v_cvt_pk_bf16_f32 v95, v46, v47
    buffer_store_dwordx4 v[92:95], v140, s[84:87], s30 offen offset:0 sc1
    v_mfma_f32_16x16x32_bf16 v[16:19], a[228:231], a[56:59], v[16:19]
    ds_read_b64_tr_b16 a[218:219], v155 offset:5376
    v_mfma_f32_16x16x32_bf16 v[56:59], a[224:227], a[52:55], v[56:59]
    ds_read_b64_tr_b16 a[220:221], v155 offset:10496
    v_mfma_f32_16x16x32_bf16 v[56:59], a[228:231], a[60:63], v[56:59]
    ds_read_b64_tr_b16 a[222:223], v155 offset:15616
    s_waitcnt lgkmcnt(12)
    v_mfma_f32_16x16x32_bf16 v[20:23], a[192:195], a[48:51], v[20:23]
    ds_read_b64_tr_b16 a[224:225], v156 offset:256
    v_cvt_pk_bf16_f32 v96, v8, v9
    v_cvt_pk_bf16_f32 v97, v10, v11
    v_mfma_f32_16x16x32_bf16 v[20:23], a[196:199], a[56:59], v[20:23]
    ds_read_b64_tr_b16 a[226:227], v156 offset:5376
    v_cvt_pk_bf16_f32 v98, v12, v13
    v_cvt_pk_bf16_f32 v99, v14, v15
    v_mfma_f32_16x16x32_bf16 v[60:63], a[192:195], a[52:55], v[60:63]
    ds_read_b64_tr_b16 a[228:229], v156 offset:10496
    buffer_store_dwordx4 v[96:99], v140, s[84:87], s28 offen offset:1024 sc1
    v_cvt_pk_bf16_f32 v100, v48, v49
    v_mfma_f32_16x16x32_bf16 v[60:63], a[196:199], a[60:63], v[60:63]
    ds_read_b64_tr_b16 a[230:231], v156 offset:15616
    v_cvt_pk_bf16_f32 v101, v50, v51
    v_cvt_pk_bf16_f32 v102, v52, v53
    s_waitcnt lgkmcnt(12)
    v_mfma_f32_16x16x32_bf16 v[24:27], a[200:203], a[48:51], v[24:27]
    v_cvt_pk_bf16_f32 v103, v54, v55
    buffer_store_dwordx4 v[100:103], v140, s[84:87], s30 offen offset:1024 sc1
    v_mfma_f32_16x16x32_bf16 v[24:27], a[204:207], a[56:59], v[24:27]
    v_mfma_f32_16x16x32_bf16 v[64:67], a[200:203], a[52:55], v[64:67]
    v_mfma_f32_16x16x32_bf16 v[64:67], a[204:207], a[60:63], v[64:67]
    s_waitcnt lgkmcnt(8)
    v_mfma_f32_16x16x32_bf16 v[28:31], a[208:211], a[48:51], v[28:31]
    v_cvt_pk_bf16_f32 v104, v16, v17
    v_cvt_pk_bf16_f32 v105, v18, v19
    v_mfma_f32_16x16x32_bf16 v[28:31], a[212:215], a[56:59], v[28:31]
    v_cvt_pk_bf16_f32 v106, v20, v21
    v_cvt_pk_bf16_f32 v107, v22, v23
    v_mfma_f32_16x16x32_bf16 v[68:71], a[208:211], a[52:55], v[68:71]
    buffer_store_dwordx4 v[104:107], v140, s[84:87], s28 offen offset:2048 sc1
    v_cvt_pk_bf16_f32 v108, v56, v57
    v_mfma_f32_16x16x32_bf16 v[68:71], a[212:215], a[60:63], v[68:71]
    v_cvt_pk_bf16_f32 v109, v58, v59
    v_cvt_pk_bf16_f32 v110, v60, v61
    s_waitcnt lgkmcnt(4)
    v_mfma_f32_16x16x32_bf16 v[32:35], a[216:219], a[48:51], v[32:35]
    v_cvt_pk_bf16_f32 v111, v62, v63
    buffer_store_dwordx4 v[108:111], v140, s[84:87], s30 offen offset:2048 sc1
    v_mfma_f32_16x16x32_bf16 v[32:35], a[220:223], a[56:59], v[32:35]
    v_mfma_f32_16x16x32_bf16 v[72:75], a[216:219], a[52:55], v[72:75]
    v_mfma_f32_16x16x32_bf16 v[72:75], a[220:223], a[60:63], v[72:75]
    s_waitcnt lgkmcnt(0)
    v_mfma_f32_16x16x32_bf16 v[36:39], a[224:227], a[48:51], v[36:39]
    v_cvt_pk_bf16_f32 v112, v24, v25
    v_cvt_pk_bf16_f32 v113, v26, v27
    v_mfma_f32_16x16x32_bf16 v[36:39], a[228:231], a[56:59], v[36:39]
    v_cvt_pk_bf16_f32 v114, v28, v29
    v_cvt_pk_bf16_f32 v115, v30, v31
    v_mfma_f32_16x16x32_bf16 v[76:79], a[224:227], a[52:55], v[76:79]
    buffer_store_dwordx4 v[112:115], v140, s[84:87], s28 offen offset:3072 sc1
    v_cvt_pk_bf16_f32 v116, v64, v65
    v_mfma_f32_16x16x32_bf16 v[76:79], a[228:231], a[60:63], v[76:79]
    v_cvt_pk_bf16_f32 v117, v66, v67
    v_cvt_pk_bf16_f32 v118, v68, v69
    v_cvt_pk_bf16_f32 v119, v70, v71
    buffer_store_dwordx4 v[116:119], v140, s[84:87], s30 offen offset:3072 sc1
    v_cvt_pk_bf16_f32 v88, v32, v33
    v_cvt_pk_bf16_f32 v89, v34, v35
    v_cvt_pk_bf16_f32 v90, v36, v37
    v_cvt_pk_bf16_f32 v91, v38, v39
    buffer_store_dwordx4 v[88:91], v140, s[84:87], s29 offen offset:0 sc1
    v_cvt_pk_bf16_f32 v92, v72, v73
    v_cvt_pk_bf16_f32 v93, v74, v75
    v_cvt_pk_bf16_f32 v94, v76, v77
    v_cvt_pk_bf16_f32 v95, v78, v79
    buffer_store_dwordx4 v[92:95], v140, s[84:87], s31 offen offset:0 sc1
    s_add_u32 s36, s21, 0
    s_waitcnt vmcnt(0)
    s_barrier
    buffer_store_dword v147, v146, s[52:55], s36 offen sc1
    v_mov_b32 v190, 0x3f80
    v_mov_b32 v191, 1.0
    v_mov_b32 v188, 0xbdd2d3e8
    v_mov_b32 v189, 0xc0135761
    s_getreg_b32 s26, hwreg(HW_REG_XCC_ID, 0, 4)
    s_or_b32 s26, s26, 0x100
    v_cmp_eq_u32 vcc, s26, v184
    v_add_u32 v164, 262144, v143
    s_nop 0
    v_cndmask_b32 v143, v143, v164, vcc
    v_cmp_eq_u32 vcc, s26, v185
    v_add_u32 v164, 262144, v144
    s_nop 0
    v_cndmask_b32 v144, v144, v164, vcc
    v_cmp_eq_u32 vcc, s26, v186
    v_add_u32 v164, 262144, v145
    s_nop 0
    v_cndmask_b32 v145, v145, v164, vcc
    v_and_b32 v1, 7, v162
    v_bfe_u32 v2, v162, 4, 2
    v_bfe_u32 v3, v162, 3, 1
    s_lshl_b32 s26, s24, 1
    v_add_u32 v3, s26, v3
    s_lshl_b32 s26, s3, 3
    s_add_u32 s26, s26, s25
    s_lshr_b32 s27, s26, 1
    s_mul_i32 s32, s27, 20480
    s_mul_i32 s27, s27, 20480
    s_and_b32 s37, s26, 1
    s_lshl_b32 s37, s37, 7
    s_mul_i32 s26, s26, 10240
    v_lshlrev_b32 v5, 10, v3
    v_lshl_add_u32 v5, v2, 8, v5
    v_lshl_add_u32 v5, v1, 4, v5
    v_add_u32 v5, s37, v5
    v_lshlrev_b32 v9, 4, v162
    s_mov_b32 s41, 2147418112
    s_cmp_lt_u32 s24, 2
    s_cmov_b32 s41, 16384
    s_cselect_b32 s37, 0, 2147418112
    s_add_u32 s32, s32, 33554432
    s_add_u32 s27, s27, 50331648
    s_add_u32 s60, s6, 5120
    s_addc_u32 s61, s7, 0
    s_mov_b32 s62, 7680
    s_mov_b32 s63, 0x20000
    s_add_u32 s44, s6, s32
    s_addc_u32 s45, s7, 0
    s_mov_b32 s46, 7884800
    s_mov_b32 s47, 0x20000
    s_add_u32 s48, s4, s26
    s_addc_u32 s49, s5, 0
    s_mov_b32 s50, 10240
    s_mov_b32 s51, 0x20000
    s_add_u32 s84, s6, s27
    s_addc_u32 s85, s7, 0
    s_mov_b32 s86, 6311936
    s_mov_b32 s87, 0x20000
    s_mov_b32 s36, 4096
    buffer_load_dwordx4 v[12:15], v9, s[60:63], 0 offen
    buffer_load_dwordx4 v[16:19], v9, s[60:63], s36 offen
    v_mul_u32_u24 v8, 1280, v1
    v_lshl_add_u32 v8, v3, 6, v8
    v_bfe_u32 v4, v162, 4, 1
    v_lshl_add_u32 v8, v4, 5, v8
    v_bfe_u32 v4, v162, 5, 1
    v_lshl_add_u32 v8, v4, 4, v8
    buffer_load_dwordx4 v[68:71], v8, s[48:51], 0 offen offset:0
    buffer_load_dwordx4 v[72:75], v8, s[48:51], 0 offen offset:512
    buffer_load_dwordx4 v[76:79], v8, s[48:51], s37 offen offset:1024
    v_mul_u32_u24 v7, 48, v1
    v_add_u32 v7, 155648, v7
    s_lshl_b32 s36, s24, 3
    v_add_u32 v6, s36, v7
    v_lshlrev_b32 v8, 7, v3
    v_lshl_add_u32 v8, v2, 4, v8
    v_add_u32 v8, 147456, v8
    v_add_u32 v10, 147456, v9
    v_cmp_le_u32 vcc, 1024, v9
    s_nop 1
    v_cndmask_b32 v4, 0, 1.0, vcc
    s_waitcnt vmcnt(3)
    v_add_f32 v16, v16, v4
    v_add_f32 v17, v17, v4
    v_add_f32 v18, v18, v4
    v_add_f32 v19, v19, v4
    ds_write_b128 v10, v[12:15]
    ds_write_b128 v10, v[16:19] offset:4096
    s_waitcnt lgkmcnt(0)
    s_mov_b32 s36, 0
    s_cmp_eq_u32 s24, 0
    s_cbranch_scc1 L_tail_w0_0
    s_getpc_b64 s[26:27]
L_tail_cp0:
    v_subrev_u32 v171, 64, v162
    v_lshlrev_b32 v171, 7, v171
    v_min_u32 v171, L_attn_tailcode_end-L_tail_cp0, v171
    global_load_dword v171, v171, s[26:27]
    s_mov_b32 s34, 0
    s_add_u32 s8, s6, s17
    s_addc_u32 s9, s7, 0
    s_mov_b32 s10, 102400
    s_mov_b32 s11, 0x20000
    s_add_u32 s35, s34, s90
    s_add_u32 s43, s35, 4096
    s_add_u32 m0, s90, 122880
    s_nop 0
    buffer_load_dwordx4 v140, s[8:11], s35 offen offset:0  lds
    buffer_load_dwordx4 v140, s[8:11], s35 offen offset:1024  lds
    buffer_load_dwordx4 v140, s[8:11], s35 offen offset:2048  lds
    buffer_load_dwordx4 v140, s[8:11], s35 offen offset:3072  lds
    s_add_u32 m0, s90, 126976
    s_nop 0
    buffer_load_dwordx4 v140, s[8:11], s43 offen offset:0  lds
    buffer_load_dwordx4 v140, s[8:11], s43 offen offset:1024  lds
    buffer_load_dwordx4 v140, s[8:11], s43 offen offset:2048  lds
    s_add_u32 s34, s34, 20480
    s_add_u32 s35, s34, s90
    s_add_u32 s43, s35, 4096
    s_add_u32 m0, s90, 0
    s_nop 0
    buffer_load_dwordx4 v140, s[8:11], s35 offen offset:0  lds
    buffer_load_dwordx4 v140, s[8:11], s35 offen offset:1024  lds
    buffer_load_dwordx4 v140, s[8:11], s35 offen offset:2048  lds
    buffer_load_dwordx4 v140, s[8:11], s35 offen offset:3072  lds
    s_add_u32 m0, s90, 4096
    s_nop 0
    buffer_load_dwordx4 v140, s[8:11], s43 offen offset:0  lds
    buffer_load_dwordx4 v140, s[8:11], s43 offen offset:1024  lds
    buffer_load_dwordx4 v140, s[8:11], s43 offen offset:2048  lds
    s_add_u32 s34, s34, 20480
    s_add_u32 s35, s34, s90
    s_add_u32 s43, s35, 4096
    s_add_u32 m0, s90, 24576
    s_nop 0
    buffer_load_dwordx4 v140, s[8:11], s35 offen offset:0  lds
    buffer_load_dwordx4 v140, s[8:11], s35 offen offset:1024  lds
    buffer_load_dwordx4 v140, s[8:11], s35 offen offset:2048  lds
    buffer_load_dwordx4 v140, s[8:11], s35 offen offset:3072  lds
    s_add_u32 m0, s90, 28672
    s_nop 0
    buffer_load_dwordx4 v140, s[8:11], s43 offen offset:0  lds
    buffer_load_dwordx4 v140, s[8:11], s43 offen offset:1024  lds
    buffer_load_dwordx4 v140, s[8:11], s43 offen offset:2048  lds
    s_add_u32 s34, s34, 20480
L_tail_got0:
    s_barrier
    s_mov_b32 s36, 0
    buffer_load_dwordx4 v[20:23], v5, s[44:47], s36 offen sc1
    s_mov_b32 s36, 2621440
    buffer_load_dwordx4 v[24:27], v5, s[44:47], s36 offen sc1
    s_mov_b32 s36, 5242880
    buffer_load_dwordx4 v[28:31], v5, s[44:47], s36 offen sc1
    s_mov_b32 s36, 7864320
    buffer_load_dwordx4 v[32:35], v5, s[44:47], s36 offen sc1
    s_mov_b32 s36, 8192
    buffer_load_dwordx4 v[36:39], v5, s[44:47], s36 offen sc1
    s_mov_b32 s36, 2629632
    buffer_load_dwordx4 v[40:43], v5, s[44:47], s36 offen sc1
    s_mov_b32 s36, 5251072
    buffer_load_dwordx4 v[44:47], v5, s[44:47], s36 offen sc1
    s_mov_b32 s36, 7872512
    buffer_load_dwordx4 v[48:51], v5, s[44:47], s36 offen sc1
    s_add_u32 s36, s41, 0
    buffer_load_dwordx4 v[52:55], v5, s[44:47], s36 offen sc1
    s_add_u32 s36, s41, 2621440
    buffer_load_dwordx4 v[56:59], v5, s[44:47], s36 offen sc1
    s_add_u32 s36, s41, 5242880
    buffer_load_dwordx4 v[60:63], v5, s[44:47], s36 offen sc1
    s_add_u32 s36, s41, 7864320
    buffer_load_dwordx4 v[64:67], v5, s[44:47], s36 offen sc1
    ds_read_b128 v[80:83], v8 offset:0
    ds_read_b128 v[84:87], v8 offset:64
    s_waitcnt vmcnt(8)
    v_lshlrev_b32 v104, 16, v20
    v_and_b32 v105, 0xffff0000, v20
    v_lshlrev_b32 v106, 16, v21
    v_and_b32 v107, 0xffff0000, v21
    v_lshlrev_b32 v108, 16, v22
    v_and_b32 v109, 0xffff0000, v22
    v_lshlrev_b32 v110, 16, v23
    v_and_b32 v111, 0xffff0000, v23
    v_dot2c_f32_bf16 v104, v24, v190
    v_dot2c_f32_bf16 v105, v24, v191
    v_dot2c_f32_bf16 v106, v25, v190
    v_dot2c_f32_bf16 v107, v25, v191
    v_dot2c_f32_bf16 v108, v26, v190
    v_dot2c_f32_bf16 v109, v26, v191
    v_dot2c_f32_bf16 v110, v27, v190
    v_dot2c_f32_bf16 v111, v27, v191
    v_dot2c_f32_bf16 v104, v28, v190
    v_dot2c_f32_bf16 v105, v28, v191
    v_dot2c_f32_bf16 v106, v29, v190
    v_dot2c_f32_bf16 v107, v29, v191
    v_dot2c_f32_bf16 v108, v30, v190
    v_dot2c_f32_bf16 v109, v30, v191
    v_dot2c_f32_bf16 v110, v31, v190
    v_dot2c_f32_bf16 v111, v31, v191
    v_dot2c_f32_bf16 v104, v32, v190
    v_dot2c_f32_bf16 v105, v32, v191
    v_dot2c_f32_bf16 v106, v33, v190
    v_dot2c_f32_bf16 v107, v33, v191
    v_dot2c_f32_bf16 v108, v34, v190
    v_dot2c_f32_bf16 v109, v34, v191
    v_dot2c_f32_bf16 v110, v35, v190
    v_dot2c_f32_bf16 v111, v35, v191
    v_permlane16_swap_b32 v68, v70
    v_permlane16_swap_b32 v69, v71
    v_lshlrev_b32 v12, 16, v68
    v_and_b32 v13, 0xffff0000, v68
    v_lshlrev_b32 v14, 16, v69
    v_and_b32 v15, 0xffff0000, v69
    v_lshlrev_b32 v16, 16, v70
    v_and_b32 v17, 0xffff0000, v70
    v_lshlrev_b32 v18, 16, v71
    v_and_b32 v19, 0xffff0000, v71
    s_waitcnt lgkmcnt(0)
    v_pk_fma_f32 v[104:105], v[104:105], v[80:81], v[12:13]
    v_pk_fma_f32 v[106:107], v[106:107], v[82:83], v[14:15]
    v_pk_fma_f32 v[108:109], v[108:109], v[84:85], v[16:17]
    v_pk_fma_f32 v[110:111], v[110:111], v[86:87], v[18:19]
    ds_read_b128 v[88:91], v8 offset:1024
    ds_read_b128 v[92:95], v8 offset:1088
    s_waitcnt vmcnt(4)
    v_lshlrev_b32 v112, 16, v36
    v_and_b32 v113, 0xffff0000, v36
    v_lshlrev_b32 v114, 16, v37
    v_and_b32 v115, 0xffff0000, v37
    v_lshlrev_b32 v116, 16, v38
    v_and_b32 v117, 0xffff0000, v38
    v_lshlrev_b32 v118, 16, v39
    v_and_b32 v119, 0xffff0000, v39
    v_dot2c_f32_bf16 v112, v40, v190
    v_dot2c_f32_bf16 v113, v40, v191
    v_dot2c_f32_bf16 v114, v41, v190
    v_dot2c_f32_bf16 v115, v41, v191
    v_dot2c_f32_bf16 v116, v42, v190
    v_dot2c_f32_bf16 v117, v42, v191
    v_dot2c_f32_bf16 v118, v43, v190
    v_dot2c_f32_bf16 v119, v43, v191
    v_dot2c_f32_bf16 v112, v44, v190
    v_dot2c_f32_bf16 v113, v44, v191
    v_dot2c_f32_bf16 v114, v45, v190
    v_dot2c_f32_bf16 v115, v45, v191
    v_dot2c_f32_bf16 v116, v46, v190
    v_dot2c_f32_bf16 v117, v46, v191
    v_dot2c_f32_bf16 v118, v47, v190
    v_dot2c_f32_bf16 v119, v47, v191
    v_dot2c_f32_bf16 v112, v48, v190
    v_dot2c_f32_bf16 v113, v48, v191
    v_dot2c_f32_bf16 v114, v49, v190
    v_dot2c_f32_bf16 v115, v49, v191
    v_dot2c_f32_bf16 v116, v50, v190
    v_dot2c_f32_bf16 v117, v50, v191
    v_dot2c_f32_bf16 v118, v51, v190
    v_dot2c_f32_bf16 v119, v51, v191
    v_permlane16_swap_b32 v72, v74
    v_permlane16_swap_b32 v73, v75
    v_lshlrev_b32 v12, 16, v72
    v_and_b32 v13, 0xffff0000, v72
    v_lshlrev_b32 v14, 16, v73
    v_and_b32 v15, 0xffff0000, v73
    v_lshlrev_b32 v16, 16, v74
    v_and_b32 v17, 0xffff0000, v74
    v_lshlrev_b32 v18, 16, v75
    v_and_b32 v19, 0xffff0000, v75
    s_waitcnt lgkmcnt(0)
    v_pk_fma_f32 v[112:113], v[112:113], v[88:89], v[12:13]
    v_pk_fma_f32 v[114:115], v[114:115], v[90:91], v[14:15]
    v_pk_fma_f32 v[116:117], v[116:117], v[92:93], v[16:17]
    v_pk_fma_f32 v[118:119], v[118:119], v[94:95], v[18:19]
    ds_read_b128 v[96:99], v8 offset:2048
    ds_read_b128 v[100:103], v8 offset:2112
    s_waitcnt vmcnt(0)
    v_lshlrev_b32 v120, 16, v52
    v_and_b32 v121, 0xffff0000, v52
    v_lshlrev_b32 v122, 16, v53
    v_and_b32 v123, 0xffff0000, v53
    v_lshlrev_b32 v124, 16, v54
    v_and_b32 v125, 0xffff0000, v54
    v_lshlrev_b32 v126, 16, v55
    v_and_b32 v127, 0xffff0000, v55
    v_dot2c_f32_bf16 v120, v56, v190
    v_dot2c_f32_bf16 v121, v56, v191
    v_dot2c_f32_bf16 v122, v57, v190
    v_dot2c_f32_bf16 v123, v57, v191
    v_dot2c_f32_bf16 v124, v58, v190
    v_dot2c_f32_bf16 v125, v58, v191
    v_dot2c_f32_bf16 v126, v59, v190
    v_dot2c_f32_bf16 v127, v59, v191
    v_dot2c_f32_bf16 v120, v60, v190
    v_dot2c_f32_bf16 v121, v60, v191
    v_dot2c_f32_bf16 v122, v61, v190
    v_dot2c_f32_bf16 v123, v61, v191
    v_dot2c_f32_bf16 v124, v62, v190
    v_dot2c_f32_bf16 v125, v62, v191
    v_dot2c_f32_bf16 v126, v63, v190
    v_dot2c_f32_bf16 v127, v63, v191
    v_dot2c_f32_bf16 v120, v64, v190
    v_dot2c_f32_bf16 v121, v64, v191
    v_dot2c_f32_bf16 v122, v65, v190
    v_dot2c_f32_bf16 v123, v65, v191
    v_dot2c_f32_bf16 v124, v66, v190
    v_dot2c_f32_bf16 v125, v66, v191
    v_dot2c_f32_bf16 v126, v67, v190
    v_dot2c_f32_bf16 v127, v67, v191
    v_permlane16_swap_b32 v76, v78
    v_permlane16_swap_b32 v77, v79
    v_lshlrev_b32 v12, 16, v76
    v_and_b32 v13, 0xffff0000, v76
    v_lshlrev_b32 v14, 16, v77
    v_and_b32 v15, 0xffff0000, v77
    v_lshlrev_b32 v16, 16, v78
    v_and_b32 v17, 0xffff0000, v78
    v_lshlrev_b32 v18, 16, v79
    v_and_b32 v19, 0xffff0000, v79
    s_waitcnt lgkmcnt(0)
    v_pk_fma_f32 v[120:121], v[120:121], v[96:97], v[12:13]
    v_pk_fma_f32 v[122:123], v[122:123], v[98:99], v[14:15]
    v_pk_fma_f32 v[124:125], v[124:125], v[100:101], v[16:17]
    v_pk_fma_f32 v[126:127], v[126:127], v[102:103], v[18:19]
    v_pk_add_f32 v[138:139], v[104:105], v[106:107]
    v_pk_mul_f32 v[12:13], v[104:105], v[104:105]
    v_pk_fma_f32 v[12:13], v[106:107], v[106:107], v[12:13]
    v_pk_add_f32 v[138:139], v[138:139], v[108:109]
    v_pk_fma_f32 v[12:13], v[108:109], v[108:109], v[12:13]
    v_pk_add_f32 v[138:139], v[138:139], v[110:111]
    v_pk_fma_f32 v[12:13], v[110:111], v[110:111], v[12:13]
    v_pk_add_f32 v[138:139], v[138:139], v[112:113]
    v_pk_fma_f32 v[12:13], v[112:113], v[112:113], v[12:13]
    v_pk_add_f32 v[138:139], v[138:139], v[114:115]
    v_pk_fma_f32 v[12:13], v[114:115], v[114:115], v[12:13]
    v_pk_add_f32 v[138:139], v[138:139], v[116:117]
    v_pk_fma_f32 v[12:13], v[116:117], v[116:117], v[12:13]
    v_pk_add_f32 v[138:139], v[138:139], v[118:119]
    v_pk_fma_f32 v[12:13], v[118:119], v[118:119], v[12:13]
    v_pk_add_f32 v[138:139], v[138:139], v[120:121]
    v_pk_fma_f32 v[12:13], v[120:121], v[120:121], v[12:13]
    v_pk_add_f32 v[138:139], v[138:139], v[122:123]
    v_pk_fma_f32 v[12:13], v[122:123], v[122:123], v[12:13]
    v_pk_add_f32 v[138:139], v[138:139], v[124:125]
    v_pk_fma_f32 v[12:13], v[124:125], v[124:125], v[12:13]
    v_pk_add_f32 v[138:139], v[138:139], v[126:127]
    v_pk_fma_f32 v[12:13], v[126:127], v[126:127], v[12:13]
    v_add_f32 v138, v138, v139
    v_add_f32 v139, v12, v13
    v_mov_b32 v12, v138
    v_mov_b32 v13, v139
    s_nop 0
    v_permlane32_swap_b32 v138, v12
    v_permlane32_swap_b32 v139, v13
    v_add_f32 v138, v138, v12
    v_add_f32 v139, v139, v13
    v_mov_b32 v12, v138
    v_mov_b32 v13, v139
    s_nop 0
    v_permlane16_swap_b32 v138, v12
    v_permlane16_swap_b32 v139, v13
    v_add_f32 v138, v138, v12
    v_add_f32 v139, v139, v13
    s_nop 0
    v_add_f32_dpp v138, v138, v138 row_ror:8 row_mask:0xf bank_mask:0xf
    v_add_f32_dpp v139, v139, v139 row_ror:8 row_mask:0xf bank_mask:0xf
    ds_write_b64 v6, v[138:139] offset:0
    v_cvt_pk_bf16_f32 v20, v104, v105
    v_cvt_pk_bf16_f32 v21, v106, v107
    v_cvt_pk_bf16_f32 v22, v108, v109
    v_cvt_pk_bf16_f32 v23, v110, v111
    v_cvt_pk_bf16_f32 v24, v112, v113
    v_cvt_pk_bf16_f32 v25, v114, v115
    v_cvt_pk_bf16_f32 v26, v116, v117
    v_cvt_pk_bf16_f32 v27, v118, v119
    v_cvt_pk_bf16_f32 v28, v120, v121
    v_cvt_pk_bf16_f32 v29, v122, v123
    v_cvt_pk_bf16_f32 v30, v124, v125
    v_cvt_pk_bf16_f32 v31, v126, v127
    s_mov_b32 s36, 0
    buffer_store_dwordx4 v[20:23], v5, s[84:87], s36 offen sc1
    s_mov_b32 s36, 8192
    buffer_store_dwordx4 v[24:27], v5, s[84:87], s36 offen sc1
    s_add_u32 s36, s41, 0
    buffer_store_dwordx4 v[28:31], v5, s[84:87], s36 offen sc1
    ds_read_b128 v[32:35], v8 offset:5120
    ds_read_b128 v[36:39], v8 offset:5184
    ds_read_b128 v[40:43], v8 offset:2560
    ds_read_b128 v[44:47], v8 offset:2624
    ds_read_b128 v[48:51], v8 offset:6144
    ds_read_b128 v[52:55], v8 offset:6208
    ds_read_b128 v[56:59], v8 offset:3584
    ds_read_b128 v[60:63], v8 offset:3648
    ds_read_b128 v[64:67], v8 offset:7168
    ds_read_b128 v[68:71], v8 offset:7232
    ds_read_b128 v[72:75], v8 offset:4608
    ds_read_b128 v[76:79], v8 offset:4672
    s_add_u32 s35, s34, s38
    s_add_u32 s43, s35, 4096
    s_add_u32 m0, s38, 49152
    s_nop 0
    buffer_load_dwordx4 v140, s[8:11], s35 offen offset:0  lds
    buffer_load_dwordx4 v140, s[8:11], s35 offen offset:1024  lds
    buffer_load_dwordx4 v140, s[8:11], s35 offen offset:2048  lds
    buffer_load_dwordx4 v140, s[8:11], s35 offen offset:3072  lds
    s_add_u32 m0, s38, 53248
    s_nop 0
    buffer_load_dwordx4 v140, s[8:11], s43 offen offset:0  lds
    s_add_u32 s34, s34, 20480
    s_waitcnt lgkmcnt(12)
    s_barrier
    ds_read_b128 v[12:15], v7 offset:0
    ds_read_b128 v[16:19], v7 offset:16
    s_waitcnt lgkmcnt(0)
    v_add_f32 v12, v12, v16
    v_add_f32 v13, v13, v17
    v_add_f32 v14, v14, v18
    v_add_f32 v15, v15, v19
    v_add_f32 v138, v12, v14
    v_add_f32 v139, v13, v15
    v_mul_f32 v138, 0x3acccccd, v138
    v_mul_f32 v139, 0x3acccccd, v139
    v_fma_f32 v139, -v138, v138, v139
    v_max_f32 v139, 0, v139
    v_add_f32 v139, 0x3727c5ac, v139
    v_rsq_f32 v139, v139
    s_nop 0
    v_mul_f32 v138, v138, v139
    v_pk_fma_f32 v[104:105], v[104:105], v[138:139], v[138:139] op_sel:[0,1,0] op_sel_hi:[1,1,0] neg_lo:[0,0,1] neg_hi:[0,0,1]
    v_pk_fma_f32 v[106:107], v[106:107], v[138:139], v[138:139] op_sel:[0,1,0] op_sel_hi:[1,1,0] neg_lo:[0,0,1] neg_hi:[0,0,1]
    v_pk_fma_f32 v[108:109], v[108:109], v[138:139], v[138:139] op_sel:[0,1,0] op_sel_hi:[1,1,0] neg_lo:[0,0,1] neg_hi:[0,0,1]
    v_pk_fma_f32 v[110:111], v[110:111], v[138:139], v[138:139] op_sel:[0,1,0] op_sel_hi:[1,1,0] neg_lo:[0,0,1] neg_hi:[0,0,1]
    s_waitcnt lgkmcnt(10)
    v_pk_fma_f32 v[104:105], v[104:105], v[32:33], v[40:41]
    v_pk_fma_f32 v[106:107], v[106:107], v[34:35], v[42:43]
    v_pk_fma_f32 v[108:109], v[108:109], v[36:37], v[44:45]
    v_pk_fma_f32 v[110:111], v[110:111], v[38:39], v[46:47]
    v_pk_fma_f32 v[112:113], v[112:113], v[138:139], v[138:139] op_sel:[0,1,0] op_sel_hi:[1,1,0] neg_lo:[0,0,1] neg_hi:[0,0,1]
    v_pk_fma_f32 v[114:115], v[114:115], v[138:139], v[138:139] op_sel:[0,1,0] op_sel_hi:[1,1,0] neg_lo:[0,0,1] neg_hi:[0,0,1]
    v_pk_fma_f32 v[116:117], v[116:117], v[138:139], v[138:139] op_sel:[0,1,0] op_sel_hi:[1,1,0] neg_lo:[0,0,1] neg_hi:[0,0,1]
    v_pk_fma_f32 v[118:119], v[118:119], v[138:139], v[138:139] op_sel:[0,1,0] op_sel_hi:[1,1,0] neg_lo:[0,0,1] neg_hi:[0,0,1]
    s_waitcnt lgkmcnt(6)
    v_pk_fma_f32 v[112:113], v[112:113], v[48:49], v[56:57]
    v_pk_fma_f32 v[114:115], v[114:115], v[50:51], v[58:59]
    v_pk_fma_f32 v[116:117], v[116:117], v[52:53], v[60:61]
    v_pk_fma_f32 v[118:119], v[118:119], v[54:55], v[62:63]
    v_pk_fma_f32 v[120:121], v[120:121], v[138:139], v[138:139] op_sel:[0,1,0] op_sel_hi:[1,1,0] neg_lo:[0,0,1] neg_hi:[0,0,1]
    v_pk_fma_f32 v[122:123], v[122:123], v[138:139], v[138:139] op_sel:[0,1,0] op_sel_hi:[1,1,0] neg_lo:[0,0,1] neg_hi:[0,0,1]
    v_pk_fma_f32 v[124:125], v[124:125], v[138:139], v[138:139] op_sel:[0,1,0] op_sel_hi:[1,1,0] neg_lo:[0,0,1] neg_hi:[0,0,1]
    v_pk_fma_f32 v[126:127], v[126:127], v[138:139], v[138:139] op_sel:[0,1,0] op_sel_hi:[1,1,0] neg_lo:[0,0,1] neg_hi:[0,0,1]
    s_waitcnt lgkmcnt(2)
    v_pk_fma_f32 v[120:121], v[120:121], v[64:65], v[72:73]
    v_pk_fma_f32 v[122:123], v[122:123], v[66:67], v[74:75]
    v_pk_fma_f32 v[124:125], v[124:125], v[68:69], v[76:77]
    v_pk_fma_f32 v[126:127], v[126:127], v[70:71], v[78:79]
    s_cmp_lt_u32 s24, 2
    s_cselect_b64 s[26:27], -1, 0
    v_cndmask_b32 v120, 0, v120, s[26:27]
    v_cndmask_b32 v121, 0, v121, s[26:27]
    v_cndmask_b32 v122, 0, v122, s[26:27]
    v_cndmask_b32 v123, 0, v123, s[26:27]
    v_cndmask_b32 v124, 0, v124, s[26:27]
    v_cndmask_b32 v125, 0, v125, s[26:27]
    v_cndmask_b32 v126, 0, v126, s[26:27]
    v_cndmask_b32 v127, 0, v127, s[26:27]
    v_pk_add_f32 v[138:139], v[104:105], v[106:107]
    v_pk_mul_f32 v[12:13], v[104:105], v[104:105]
    v_pk_fma_f32 v[12:13], v[106:107], v[106:107], v[12:13]
    v_pk_add_f32 v[138:139], v[138:139], v[108:109]
    v_pk_fma_f32 v[12:13], v[108:109], v[108:109], v[12:13]
    v_pk_add_f32 v[138:139], v[138:139], v[110:111]
    v_pk_fma_f32 v[12:13], v[110:111], v[110:111], v[12:13]
    v_pk_add_f32 v[138:139], v[138:139], v[112:113]
    v_pk_fma_f32 v[12:13], v[112:113], v[112:113], v[12:13]
    v_pk_add_f32 v[138:139], v[138:139], v[114:115]
    v_pk_fma_f32 v[12:13], v[114:115], v[114:115], v[12:13]
    v_pk_add_f32 v[138:139], v[138:139], v[116:117]
    v_pk_fma_f32 v[12:13], v[116:117], v[116:117], v[12:13]
    v_pk_add_f32 v[138:139], v[138:139], v[118:119]
    v_pk_fma_f32 v[12:13], v[118:119], v[118:119], v[12:13]
    v_pk_add_f32 v[138:139], v[138:139], v[120:121]
    v_pk_fma_f32 v[12:13], v[120:121], v[120:121], v[12:13]
    v_pk_add_f32 v[138:139], v[138:139], v[122:123]
    v_pk_fma_f32 v[12:13], v[122:123], v[122:123], v[12:13]
    v_pk_add_f32 v[138:139], v[138:139], v[124:125]
    v_pk_fma_f32 v[12:13], v[124:125], v[124:125], v[12:13]
    v_pk_add_f32 v[138:139], v[138:139], v[126:127]
    v_pk_fma_f32 v[12:13], v[126:127], v[126:127], v[12:13]
    v_add_f32 v138, v138, v139
    v_add_f32 v139, v12, v13
    v_mov_b32 v12, v138
    v_mov_b32 v13, v139
    s_nop 0
    v_permlane32_swap_b32 v138, v12
    v_permlane32_swap_b32 v139, v13
    v_add_f32 v138, v138, v12
    v_add_f32 v139, v139, v13
    v_mov_b32 v12, v138
    v_mov_b32 v13, v139
    s_nop 0
    v_permlane16_swap_b32 v138, v12
    v_permlane16_swap_b32 v139, v13
    v_add_f32 v138, v138, v12
    v_add_f32 v139, v139, v13
    s_nop 0
    v_add_f32_dpp v138, v138, v138 row_ror:8 row_mask:0xf bank_mask:0xf
    v_add_f32_dpp v139, v139, v139 row_ror:8 row_mask:0xf bank_mask:0xf
    ds_write_b64 v6, v[138:139] offset:384
    v_cvt_pk_bf16_f32 v20, v104, v105
    v_cvt_pk_bf16_f32 v21, v106, v107
    v_cvt_pk_bf16_f32 v22, v108, v109
    v_cvt_pk_bf16_f32 v23, v110, v111
    v_cvt_pk_bf16_f32 v24, v112, v113
    v_cvt_pk_bf16_f32 v25, v114, v115
    v_cvt_pk_bf16_f32 v26, v116, v117
    v_cvt_pk_bf16_f32 v27, v118, v119
    v_cvt_pk_bf16_f32 v28, v120, v121
    v_cvt_pk_bf16_f32 v29, v122, v123
    v_cvt_pk_bf16_f32 v30, v124, v125
    v_cvt_pk_bf16_f32 v31, v126, v127
    s_mov_b32 s36, 3145728
    buffer_store_dwordx4 v[20:23], v5, s[84:87], s36 offen sc1
    s_mov_b32 s36, 3153920
    buffer_store_dwordx4 v[24:27], v5, s[84:87], s36 offen sc1
    s_add_u32 s36, s41, 3145728
    buffer_store_dwordx4 v[28:31], v5, s[84:87], s36 offen sc1
    s_waitcnt lgkmcnt(0)
    s_barrier
    ds_read_b128 v[12:15], v7 offset:384
    ds_read_b128 v[16:19], v7 offset:400
    s_waitcnt lgkmcnt(0)
    v_add_f32 v12, v12, v16
    v_add_f32 v13, v13, v17
    v_add_f32 v14, v14, v18
    v_add_f32 v15, v15, v19
    v_add_f32 v138, v12, v14
    v_add_f32 v139, v13, v15
    v_mul_f32 v138, 0x3acccccd, v138
    v_mul_f32 v139, 0x3acccccd, v139
    v_fma_f32 v139, -v138, v138, v139
    v_max_f32 v139, 0, v139
    v_add_f32 v139, 0x3727c5ac, v139
    v_rsq_f32 v139, v139
    s_nop 0
    v_mul_f32 v138, v138, v139
    v_pk_fma_f32 v[104:105], v[104:105], v[138:139], v[138:139] op_sel:[0,1,0] op_sel_hi:[1,1,0] neg_lo:[0,0,1] neg_hi:[0,0,1]
    v_pk_fma_f32 v[106:107], v[106:107], v[138:139], v[138:139] op_sel:[0,1,0] op_sel_hi:[1,1,0] neg_lo:[0,0,1] neg_hi:[0,0,1]
    v_pk_fma_f32 v[108:109], v[108:109], v[138:139], v[138:139] op_sel:[0,1,0] op_sel_hi:[1,1,0] neg_lo:[0,0,1] neg_hi:[0,0,1]
    v_pk_fma_f32 v[110:111], v[110:111], v[138:139], v[138:139] op_sel:[0,1,0] op_sel_hi:[1,1,0] neg_lo:[0,0,1] neg_hi:[0,0,1]
    v_pk_fma_f32 v[112:113], v[112:113], v[138:139], v[138:139] op_sel:[0,1,0] op_sel_hi:[1,1,0] neg_lo:[0,0,1] neg_hi:[0,0,1]
    v_pk_fma_f32 v[114:115], v[114:115], v[138:139], v[138:139] op_sel:[0,1,0] op_sel_hi:[1,1,0] neg_lo:[0,0,1] neg_hi:[0,0,1]
    v_pk_fma_f32 v[116:117], v[116:117], v[138:139], v[138:139] op_sel:[0,1,0] op_sel_hi:[1,1,0] neg_lo:[0,0,1] neg_hi:[0,0,1]
    v_pk_fma_f32 v[118:119], v[118:119], v[138:139], v[138:139] op_sel:[0,1,0] op_sel_hi:[1,1,0] neg_lo:[0,0,1] neg_hi:[0,0,1]
    v_pk_fma_f32 v[120:121], v[120:121], v[138:139], v[138:139] op_sel:[0,1,0] op_sel_hi:[1,1,0] neg_lo:[0,0,1] neg_hi:[0,0,1]
    v_pk_fma_f32 v[122:123], v[122:123], v[138:139], v[138:139] op_sel:[0,1,0] op_sel_hi:[1,1,0] neg_lo:[0,0,1] neg_hi:[0,0,1]
    v_pk_fma_f32 v[124:125], v[124:125], v[138:139], v[138:139] op_sel:[0,1,0] op_sel_hi:[1,1,0] neg_lo:[0,0,1] neg_hi:[0,0,1]
    v_pk_fma_f32 v[126:127], v[126:127], v[138:139], v[138:139] op_sel:[0,1,0] op_sel_hi:[1,1,0] neg_lo:[0,0,1] neg_hi:[0,0,1]
    v_cvt_pk_bf16_f32 v32, v104, v105
    v_cvt_pk_bf16_f32 v33, v106, v107
    v_cvt_pk_bf16_f32 v34, v108, v109
    v_cvt_pk_bf16_f32 v35, v110, v111
    v_cvt_pk_bf16_f32 v36, v112, v113
    v_cvt_pk_bf16_f32 v37, v114, v115
    v_cvt_pk_bf16_f32 v38, v116, v117
    v_cvt_pk_bf16_f32 v39, v118, v119
    v_cvt_pk_bf16_f32 v40, v120, v121
    v_cvt_pk_bf16_f32 v41, v122, v123
    v_cvt_pk_bf16_f32 v42, v124, v125
    v_cvt_pk_bf16_f32 v43, v126, v127
    s_mov_b32 s36, 6291456
    buffer_store_dwordx4 v[32:35], v5, s[84:87], s36 offen sc1
    s_mov_b32 s36, 6299648
    buffer_store_dwordx4 v[36:39], v5, s[84:87], s36 offen sc1
    s_add_u32 s36, s41, 6291456
    buffer_store_dwordx4 v[40:43], v5, s[84:87], s36 offen sc1
    v_lshrrev_b32 v164, 2, v161
    v_mul_u32_u24 v164, 160, v164
    v_and_b32 v165, 3, v161
    v_lshl_add_u32 v164, v165, 3, v164
    v_mov_b32 v148, v164
    v_add_u32 v149, 49152, v148
    v_add_u32 v150, 98304, v148
    v_lshrrev_b32 v164, 2, v161
    v_mul_u32_u24 v164, 192, v164
    v_and_b32 v165, 3, v161
    v_lshl_add_u32 v164, v165, 3, v164
    v_bfe_u32 v165, v161, 4, 1
    v_lshl_add_u32 v151, v165, 5, v164
    v_xor_b32 v165, 1, v165
    v_lshl_add_u32 v152, v165, 5, v164
    v_add_u32 v153, 49152, v151
    v_add_u32 v154, 49152, v152
    v_add_u32 v155, 98304, v151
    v_add_u32 v156, 98304, v152
    s_lshl_b32 s33, s3, 2
    s_add_u32 s33, s33, s24
    s_mul_i32 s36, s33, 20480
    v_add_u32 v141, s36, v140
    s_mul_i32 s36, s25, 5
    s_and_b32 s37, s36, 1
    s_lshr_b32 s26, s36, 1
    s_lshl_b32 s26, s26, 10
    s_cmp_eq_u32 s37, 0
    s_cselect_b32 s0, s26, 2147418112
    s_cselect_b32 s1, 2147418112, s26
    s_add_u32 s27, s26, 2048
    s_add_u32 s26, s26, 512
    s_cmp_eq_u32 s37, 0
    s_cselect_b32 s2, s27, s26
    s_cselect_b64 s[100:101], -1, 0
    v_lshrrev_b32 v164, 5, v161
    v_mul_u32_u24 v164, 504, v164
    v_sub_u32 v157, v140, v164
    v_cmp_gt_u32 vcc, 32, v161
    v_mov_b32 v164, 2147418112
    s_nop 0
    v_cndmask_b32 v158, v164, v141, vcc
    s_add_u32 s36, s22, 32768
    s_waitcnt vmcnt(0)
    s_barrier
    s_add_u32 s37, s36, 262144
    buffer_store_dword v147, v146, s[52:55], s37 offen
    buffer_store_dword v147, v146, s[52:55], s36 offen sc1
    s_mul_i32 s27, s33, 20480
    s_add_u32 s27, s27, 56623104
    s_add_u32 s44, s6, s27
    s_addc_u32 s45, s7, 0
    s_mov_b32 s46, 20480
    s_mov_b32 s47, 0x20000
    s_add_u32 s84, s6, 59768832
    s_addc_u32 s85, s7, 0
    s_mov_b32 s86, 2621440
    s_mov_b32 s87, 0x20000
    s_mov_b32 s42, 0
    s_mov_b32 s36, 32768
    s_cmp_eq_u32 s24, 0
    s_cbranch_scc1 L_tail_w0_1
    s_add_u32 s35, s34, s90
    s_add_u32 s43, s35, 4096
    s_add_u32 m0, s90, 73728
    s_nop 0
    buffer_load_dwordx4 v140, s[8:11], s35 offen offset:0  lds
    buffer_load_dwordx4 v140, s[8:11], s35 offen offset:1024  lds
    buffer_load_dwordx4 v140, s[8:11], s35 offen offset:2048  lds
    buffer_load_dwordx4 v140, s[8:11], s35 offen offset:3072  lds
    s_add_u32 m0, s90, 77824
    s_nop 0
    buffer_load_dwordx4 v140, s[8:11], s43 offen offset:0  lds
    buffer_load_dwordx4 v140, s[8:11], s43 offen offset:1024  lds
    buffer_load_dwordx4 v140, s[8:11], s43 offen offset:2048  lds
    s_add_u32 s34, s34, 20480
    s_mov_b32 s34, 0
    s_add_u32 s8, s6, s18
    s_addc_u32 s9, s7, 0
    s_mov_b32 s10, 102400
    s_mov_b32 s11, 0x20000
    s_add_u32 s35, s34, s90
    s_add_u32 s43, s35, 4096
    s_add_u32 m0, s90, 98304
    s_nop 0
    buffer_load_dwordx4 v140, s[8:11], s35 offen offset:0  lds
    buffer_load_dwordx4 v140, s[8:11], s35 offen offset:1024  lds
    buffer_load_dwordx4 v140, s[8:11], s35 offen offset:2048  lds
    buffer_load_dwordx4 v140, s[8:11], s35 offen offset:3072  lds
    s_add_u32 m0, s90, 102400
    s_nop 0
    buffer_load_dwordx4 v140, s[8:11], s43 offen offset:0  lds
    buffer_load_dwordx4 v140, s[8:11], s43 offen offset:1024  lds
    buffer_load_dwordx4 v140, s[8:11], s43 offen offset:2048  lds
    s_add_u32 s34, s34, 20480
L_tail_got1:
    s_barrier
    buffer_load_dwordx4 a[0:3], v140, s[44:47], s42 offen offset:0 sc1
    buffer_load_dwordx4 a[4:7], v140, s[44:47], s42 offen offset:1024 sc1
    buffer_load_dwordx4 a[8:11], v140, s[44:47], s42 offen offset:2048 sc1
    buffer_load_dwordx4 a[12:15], v140, s[44:47], s42 offen offset:3072 sc1
    s_add_u32 s42, s42, 4096
    buffer_load_dwordx4 a[16:19], v140, s[44:47], s42 offen offset:0 sc1
    buffer_load_dwordx4 a[20:23], v140, s[44:47], s42 offen offset:1024 sc1
    buffer_load_dwordx4 a[24:27], v140, s[44:47], s42 offen offset:2048 sc1
    buffer_load_dwordx4 a[28:31], v140, s[44:47], s42 offen offset:3072 sc1
    s_add_u32 s42, s42, 4096
    s_waitcnt vmcnt(4)
    s_barrier
    ds_read_b64_tr_b16 a[192:193], v150 offset:24576
    ds_read_b64_tr_b16 a[194:195], v150 offset:27136
    ds_read_b64_tr_b16 a[196:197], v150 offset:29696
    ds_read_b64_tr_b16 a[198:199], v150 offset:32256
    ds_read_b64_tr_b16 a[200:201], v150 offset:34816
    ds_read_b64_tr_b16 a[202:203], v150 offset:37376
    ds_read_b64_tr_b16 a[204:205], v150 offset:39936
    ds_read_b64_tr_b16 a[206:207], v150 offset:42496
    ds_read_b64_tr_b16 a[208:209], v150 offset:24608
    ds_read_b64_tr_b16 a[210:211], v150 offset:27168
    ds_read_b64_tr_b16 a[212:213], v150 offset:29728
    ds_read_b64_tr_b16 a[214:215], v150 offset:32288
    ds_read_b64_tr_b16 a[216:217], v150 offset:34848
    ds_read_b64_tr_b16 a[218:219], v150 offset:37408
    ds_read_b64_tr_b16 a[220:221], v150 offset:39968
    ds_read_b64_tr_b16 a[222:223], v150 offset:42528
    s_waitcnt lgkmcnt(8)
    v_mfma_f32_16x16x32_bf16 v[0:3], a[192:195], a[0:3], 0
    ds_read_b64_tr_b16 a[224:225], v150 offset:24640
    ds_read_b64_tr_b16 a[226:227], v150 offset:27200
    buffer_load_dwordx4 a[32:35], v140, s[44:47], s42 offen offset:0 sc1
    v_mfma_f32_16x16x32_bf16 v[0:3], a[196:199], a[4:7], v[0:3]
    ds_read_b64_tr_b16 a[228:229], v150 offset:29760
    ds_read_b64_tr_b16 a[230:231], v150 offset:32320
    v_mfma_f32_16x16x32_bf16 v[0:3], a[200:203], a[8:11], v[0:3]
    ds_read_b64_tr_b16 a[232:233], v150 offset:34880
    ds_read_b64_tr_b16 a[234:235], v150 offset:37440
    buffer_load_dwordx4 a[36:39], v140, s[44:47], s42 offen offset:1024 sc1
    v_mfma_f32_16x16x32_bf16 v[0:3], a[204:207], a[12:15], v[0:3]
    ds_read_b64_tr_b16 a[236:237], v150 offset:40000
    ds_read_b64_tr_b16 a[238:239], v150 offset:42560
    s_waitcnt lgkmcnt(8)
    v_mfma_f32_16x16x32_bf16 v[4:7], a[208:211], a[0:3], 0
    ds_read_b64_tr_b16 a[192:193], v150 offset:24672
    ds_read_b64_tr_b16 a[194:195], v150 offset:27232
    buffer_load_dwordx4 a[40:43], v140, s[44:47], s42 offen offset:2048 sc1
    v_mfma_f32_16x16x32_bf16 v[4:7], a[212:215], a[4:7], v[4:7]
    ds_read_b64_tr_b16 a[196:197], v150 offset:29792
    ds_read_b64_tr_b16 a[198:199], v150 offset:32352
    v_mfma_f32_16x16x32_bf16 v[4:7], a[216:219], a[8:11], v[4:7]
    ds_read_b64_tr_b16 a[200:201], v150 offset:34912
    ds_read_b64_tr_b16 a[202:203], v150 offset:37472
    v_mfma_f32_16x16x32_bf16 v[4:7], a[220:223], a[12:15], v[4:7]
    ds_read_b64_tr_b16 a[204:205], v150 offset:40032
    ds_read_b64_tr_b16 a[206:207], v150 offset:42592
    buffer_load_dwordx4 a[44:47], v140, s[44:47], s42 offen offset:3072 sc1
    s_add_u32 s42, s42, 4096
    s_waitcnt lgkmcnt(8)
    v_mfma_f32_16x16x32_bf16 v[8:11], a[224:227], a[0:3], 0
    ds_read_b64_tr_b16 a[208:209], v150 offset:24704
    ds_read_b64_tr_b16 a[210:211], v150 offset:27264
    v_mfma_f32_16x16x32_bf16 v[8:11], a[228:231], a[4:7], v[8:11]
    ds_read_b64_tr_b16 a[212:213], v150 offset:29824
    ds_read_b64_tr_b16 a[214:215], v150 offset:32384
    v_mfma_f32_16x16x32_bf16 v[8:11], a[232:235], a[8:11], v[8:11]
    ds_read_b64_tr_b16 a[216:217], v150 offset:34944
    ds_read_b64_tr_b16 a[218:219], v150 offset:37504
    v_mfma_f32_16x16x32_bf16 v[8:11], a[236:239], a[12:15], v[8:11]
    ds_read_b64_tr_b16 a[220:221], v150 offset:40064
    ds_read_b64_tr_b16 a[222:223], v150 offset:42624
    s_waitcnt vmcnt(4)
    s_waitcnt lgkmcnt(8)
    v_mfma_f32_16x16x32_bf16 v[12:15], a[192:195], a[0:3], 0
    ds_read_b64_tr_b16 a[224:225], v148 offset:0
    ds_read_b64_tr_b16 a[226:227], v148 offset:2560
    buffer_load_dwordx4 a[48:51], v140, s[44:47], s42 offen offset:0 sc1
    v_mfma_f32_16x16x32_bf16 v[12:15], a[196:199], a[4:7], v[12:15]
    ds_read_b64_tr_b16 a[228:229], v148 offset:5120
    ds_read_b64_tr_b16 a[230:231], v148 offset:7680
    v_mfma_f32_16x16x32_bf16 v[12:15], a[200:203], a[8:11], v[12:15]
    ds_read_b64_tr_b16 a[232:233], v148 offset:10240
    ds_read_b64_tr_b16 a[234:235], v148 offset:12800
    buffer_load_dwordx4 a[52:55], v140, s[44:47], s42 offen offset:1024 sc1
    v_mfma_f32_16x16x32_bf16 v[12:15], a[204:207], a[12:15], v[12:15]
    ds_read_b64_tr_b16 a[236:237], v148 offset:15360
    ds_read_b64_tr_b16 a[238:239], v148 offset:17920
    s_waitcnt lgkmcnt(8)
    v_mfma_f32_16x16x32_bf16 v[16:19], a[208:211], a[0:3], 0
    ds_read_b64_tr_b16 a[192:193], v148 offset:32
    ds_read_b64_tr_b16 a[194:195], v148 offset:2592
    buffer_load_dwordx4 a[56:59], v140, s[44:47], s42 offen offset:2048 sc1
    v_mfma_f32_16x16x32_bf16 v[16:19], a[212:215], a[4:7], v[16:19]
    ds_read_b64_tr_b16 a[196:197], v148 offset:5152
    ds_read_b64_tr_b16 a[198:199], v148 offset:7712
    v_mfma_f32_16x16x32_bf16 v[16:19], a[216:219], a[8:11], v[16:19]
    ds_read_b64_tr_b16 a[200:201], v148 offset:10272
    ds_read_b64_tr_b16 a[202:203], v148 offset:12832
    v_mfma_f32_16x16x32_bf16 v[16:19], a[220:223], a[12:15], v[16:19]
    ds_read_b64_tr_b16 a[204:205], v148 offset:15392
    ds_read_b64_tr_b16 a[206:207], v148 offset:17952
    buffer_load_dwordx4 a[60:63], v140, s[44:47], s42 offen offset:3072 sc1
    s_add_u32 s42, s42, 4096
    s_waitcnt lgkmcnt(8)
    v_mfma_f32_16x16x32_bf16 v[0:3], a[224:227], a[16:19], v[0:3]
    ds_read_b64_tr_b16 a[208:209], v148 offset:64
    ds_read_b64_tr_b16 a[210:211], v148 offset:2624
    v_mfma_f32_16x16x32_bf16 v[0:3], a[228:231], a[20:23], v[0:3]
    ds_read_b64_tr_b16 a[212:213], v148 offset:5184
    ds_read_b64_tr_b16 a[214:215], v148 offset:7744
    v_mfma_f32_16x16x32_bf16 v[0:3], a[232:235], a[24:27], v[0:3]
    ds_read_b64_tr_b16 a[216:217], v148 offset:10304
    ds_read_b64_tr_b16 a[218:219], v148 offset:12864
    v_mfma_f32_16x16x32_bf16 v[0:3], a[236:239], a[28:31], v[0:3]
    ds_read_b64_tr_b16 a[220:221], v148 offset:15424
    ds_read_b64_tr_b16 a[222:223], v148 offset:17984
    s_waitcnt lgkmcnt(8)
    v_mfma_f32_16x16x32_bf16 v[4:7], a[192:195], a[16:19], v[4:7]
    ds_read_b64_tr_b16 a[224:225], v148 offset:96
    ds_read_b64_tr_b16 a[226:227], v148 offset:2656
    v_mfma_f32_16x16x32_bf16 v[4:7], a[196:199], a[20:23], v[4:7]
    ds_read_b64_tr_b16 a[228:229], v148 offset:5216
    ds_read_b64_tr_b16 a[230:231], v148 offset:7776
    v_mfma_f32_16x16x32_bf16 v[4:7], a[200:203], a[24:27], v[4:7]
    ds_read_b64_tr_b16 a[232:233], v148 offset:10336
    ds_read_b64_tr_b16 a[234:235], v148 offset:12896
    v_mfma_f32_16x16x32_bf16 v[4:7], a[204:207], a[28:31], v[4:7]
    ds_read_b64_tr_b16 a[236:237], v148 offset:15456
    ds_read_b64_tr_b16 a[238:239], v148 offset:18016
    s_waitcnt lgkmcnt(8)
    v_mfma_f32_16x16x32_bf16 v[8:11], a[208:211], a[16:19], v[8:11]
    ds_read_b64_tr_b16 a[192:193], v148 offset:128
    ds_read_b64_tr_b16 a[194:195], v148 offset:2688
    v_mfma_f32_16x16x32_bf16 v[8:11], a[212:215], a[20:23], v[8:11]
    ds_read_b64_tr_b16 a[196:197], v148 offset:5248
    ds_read_b64_tr_b16 a[198:199], v148 offset:7808
    v_mfma_f32_16x16x32_bf16 v[8:11], a[216:219], a[24:27], v[8:11]
    ds_read_b64_tr_b16 a[200:201], v148 offset:10368
    ds_read_b64_tr_b16 a[202:203], v148 offset:12928
    v_mfma_f32_16x16x32_bf16 v[8:11], a[220:223], a[28:31], v[8:11]
    ds_read_b64_tr_b16 a[204:205], v148 offset:15488
    ds_read_b64_tr_b16 a[206:207], v148 offset:18048
    s_waitcnt vmcnt(4)
    s_waitcnt lgkmcnt(8)
    v_mfma_f32_16x16x32_bf16 v[12:15], a[224:227], a[16:19], v[12:15]
    ds_read_b64_tr_b16 a[208:209], v148 offset:24576
    ds_read_b64_tr_b16 a[210:211], v148 offset:27136
    buffer_load_dwordx4 a[0:3], v140, s[44:47], s42 offen offset:0 sc1
    v_mfma_f32_16x16x32_bf16 v[12:15], a[228:231], a[20:23], v[12:15]
    ds_read_b64_tr_b16 a[212:213], v148 offset:29696
    ds_read_b64_tr_b16 a[214:215], v148 offset:32256
    v_mfma_f32_16x16x32_bf16 v[12:15], a[232:235], a[24:27], v[12:15]
    ds_read_b64_tr_b16 a[216:217], v148 offset:34816
    ds_read_b64_tr_b16 a[218:219], v148 offset:37376
    v_mfma_f32_16x16x32_bf16 v[12:15], a[236:239], a[28:31], v[12:15]
    ds_read_b64_tr_b16 a[220:221], v148 offset:39936
    ds_read_b64_tr_b16 a[222:223], v148 offset:42496
    s_waitcnt lgkmcnt(8)
    v_mfma_f32_16x16x32_bf16 v[16:19], a[192:195], a[16:19], v[16:19]
    ds_read_b64_tr_b16 a[224:225], v148 offset:24608
    ds_read_b64_tr_b16 a[226:227], v148 offset:27168
    buffer_load_dwordx4 a[4:7], v140, s[44:47], s42 offen offset:1024 sc1
    v_mfma_f32_16x16x32_bf16 v[16:19], a[196:199], a[20:23], v[16:19]
    ds_read_b64_tr_b16 a[228:229], v148 offset:29728
    ds_read_b64_tr_b16 a[230:231], v148 offset:32288
    v_mfma_f32_16x16x32_bf16 v[16:19], a[200:203], a[24:27], v[16:19]
    ds_read_b64_tr_b16 a[232:233], v148 offset:34848
    ds_read_b64_tr_b16 a[234:235], v148 offset:37408
    v_mfma_f32_16x16x32_bf16 v[16:19], a[204:207], a[28:31], v[16:19]
    ds_read_b64_tr_b16 a[236:237], v148 offset:39968
    ds_read_b64_tr_b16 a[238:239], v148 offset:42528
    s_waitcnt lgkmcnt(8)
    v_mfma_f32_16x16x32_bf16 v[0:3], a[208:211], a[32:35], v[0:3]
    ds_read_b64_tr_b16 a[192:193], v148 offset:24640
    ds_read_b64_tr_b16 a[194:195], v148 offset:27200
    buffer_load_dwordx4 a[8:11], v140, s[44:47], s42 offen offset:2048 sc1
    v_mfma_f32_16x16x32_bf16 v[0:3], a[212:215], a[36:39], v[0:3]
    ds_read_b64_tr_b16 a[196:197], v148 offset:29760
    ds_read_b64_tr_b16 a[198:199], v148 offset:32320
    v_mfma_f32_16x16x32_bf16 v[0:3], a[216:219], a[40:43], v[0:3]
    ds_read_b64_tr_b16 a[200:201], v148 offset:34880
    ds_read_b64_tr_b16 a[202:203], v148 offset:37440
    v_mfma_f32_16x16x32_bf16 v[0:3], a[220:223], a[44:47], v[0:3]
    ds_read_b64_tr_b16 a[204:205], v148 offset:40000
    ds_read_b64_tr_b16 a[206:207], v148 offset:42560
    s_waitcnt lgkmcnt(8)
    v_mfma_f32_16x16x32_bf16 v[4:7], a[224:227], a[32:35], v[4:7]
    ds_read_b64_tr_b16 a[208:209], v148 offset:24672
    ds_read_b64_tr_b16 a[210:211], v148 offset:27232
    v_mfma_f32_16x16x32_bf16 v[4:7], a[228:231], a[36:39], v[4:7]
    ds_read_b64_tr_b16 a[212:213], v148 offset:29792
    ds_read_b64_tr_b16 a[214:215], v148 offset:32352
    buffer_load_dwordx4 a[12:15], v140, s[44:47], s42 offen offset:3072 sc1
    s_add_u32 s42, s42, 4096
    v_mfma_f32_16x16x32_bf16 v[4:7], a[232:235], a[40:43], v[4:7]
    ds_read_b64_tr_b16 a[216:217], v148 offset:34912
    ds_read_b64_tr_b16 a[218:219], v148 offset:37472
    v_mfma_f32_16x16x32_bf16 v[4:7], a[236:239], a[44:47], v[4:7]
    ds_read_b64_tr_b16 a[220:221], v148 offset:40032
    ds_read_b64_tr_b16 a[222:223], v148 offset:42592
    s_waitcnt lgkmcnt(8)
    v_mfma_f32_16x16x32_bf16 v[8:11], a[192:195], a[32:35], v[8:11]
    ds_read_b64_tr_b16 a[224:225], v148 offset:24704
    ds_read_b64_tr_b16 a[226:227], v148 offset:27264
    v_mfma_f32_16x16x32_bf16 v[8:11], a[196:199], a[36:39], v[8:11]
    ds_read_b64_tr_b16 a[228:229], v148 offset:29824
    ds_read_b64_tr_b16 a[230:231], v148 offset:32384
    v_mfma_f32_16x16x32_bf16 v[8:11], a[200:203], a[40:43], v[8:11]
    ds_read_b64_tr_b16 a[232:233], v148 offset:34944
    ds_read_b64_tr_b16 a[234:235], v148 offset:37504
    v_mfma_f32_16x16x32_bf16 v[8:11], a[204:207], a[44:47], v[8:11]
    ds_read_b64_tr_b16 a[236:237], v148 offset:40064
    ds_read_b64_tr_b16 a[238:239], v148 offset:42624
    s_waitcnt vmcnt(4)
    s_waitcnt lgkmcnt(8)
    v_mfma_f32_16x16x32_bf16 v[12:15], a[208:211], a[32:35], v[12:15]
    ds_read_b64_tr_b16 a[192:193], v149 offset:0
    ds_read_b64_tr_b16 a[194:195], v149 offset:2560
    v_mfma_f32_16x16x32_bf16 v[12:15], a[212:215], a[36:39], v[12:15]
    ds_read_b64_tr_b16 a[196:197], v149 offset:5120
    ds_read_b64_tr_b16 a[198:199], v149 offset:7680
    v_mfma_f32_16x16x32_bf16 v[12:15], a[216:219], a[40:43], v[12:15]
    ds_read_b64_tr_b16 a[200:201], v149 offset:10240
    ds_read_b64_tr_b16 a[202:203], v149 offset:12800
    v_mfma_f32_16x16x32_bf16 v[12:15], a[220:223], a[44:47], v[12:15]
    ds_read_b64_tr_b16 a[204:205], v149 offset:15360
    ds_read_b64_tr_b16 a[206:207], v149 offset:17920
    s_waitcnt lgkmcnt(8)
    v_mfma_f32_16x16x32_bf16 v[16:19], a[224:227], a[32:35], v[16:19]
    ds_read_b64_tr_b16 a[208:209], v149 offset:32
    ds_read_b64_tr_b16 a[210:211], v149 offset:2592
    v_mfma_f32_16x16x32_bf16 v[16:19], a[228:231], a[36:39], v[16:19]
    ds_read_b64_tr_b16 a[212:213], v149 offset:5152
    ds_read_b64_tr_b16 a[214:215], v149 offset:7712
    v_mfma_f32_16x16x32_bf16 v[16:19], a[232:235], a[40:43], v[16:19]
    ds_read_b64_tr_b16 a[216:217], v149 offset:10272
    ds_read_b64_tr_b16 a[218:219], v149 offset:12832
    v_mfma_f32_16x16x32_bf16 v[16:19], a[236:239], a[44:47], v[16:19]
    ds_read_b64_tr_b16 a[220:221], v149 offset:15392
    ds_read_b64_tr_b16 a[222:223], v149 offset:17952
    s_waitcnt lgkmcnt(8)
    v_mfma_f32_16x16x32_bf16 v[0:3], a[192:195], a[48:51], v[0:3]
    ds_read_b64_tr_b16 a[224:225], v149 offset:64
    ds_read_b64_tr_b16 a[226:227], v149 offset:2624
    v_mfma_f32_16x16x32_bf16 v[0:3], a[196:199], a[52:55], v[0:3]
    ds_read_b64_tr_b16 a[228:229], v149 offset:5184
    ds_read_b64_tr_b16 a[230:231], v149 offset:7744
    v_mfma_f32_16x16x32_bf16 v[0:3], a[200:203], a[56:59], v[0:3]
    ds_read_b64_tr_b16 a[232:233], v149 offset:10304
    ds_read_b64_tr_b16 a[234:235], v149 offset:12864
    v_mfma_f32_16x16x32_bf16 v[0:3], a[204:207], a[60:63], v[0:3]
    ds_read_b64_tr_b16 a[236:237], v149 offset:15424
    ds_read_b64_tr_b16 a[238:239], v149 offset:17984
    s_waitcnt lgkmcnt(8)
    v_mfma_f32_16x16x32_bf16 v[4:7], a[208:211], a[48:51], v[4:7]
    ds_read_b64_tr_b16 a[192:193], v149 offset:96
    ds_read_b64_tr_b16 a[194:195], v149 offset:2656
    v_mfma_f32_16x16x32_bf16 v[4:7], a[212:215], a[52:55], v[4:7]
    ds_read_b64_tr_b16 a[196:197], v149 offset:5216
    ds_read_b64_tr_b16 a[198:199], v149 offset:7776
    v_mfma_f32_16x16x32_bf16 v[4:7], a[216:219], a[56:59], v[4:7]
    ds_read_b64_tr_b16 a[200:201], v149 offset:10336
    ds_read_b64_tr_b16 a[202:203], v149 offset:12896
    v_mfma_f32_16x16x32_bf16 v[4:7], a[220:223], a[60:63], v[4:7]
    ds_read_b64_tr_b16 a[204:205], v149 offset:15456
    ds_read_b64_tr_b16 a[206:207], v149 offset:18016
    s_waitcnt lgkmcnt(8)
    v_mfma_f32_16x16x32_bf16 v[8:11], a[224:227], a[48:51], v[8:11]
    ds_read_b64_tr_b16 a[208:209], v149 offset:128
    ds_read_b64_tr_b16 a[210:211], v149 offset:2688
    v_mfma_f32_16x16x32_bf16 v[8:11], a[228:231], a[52:55], v[8:11]
    ds_read_b64_tr_b16 a[212:213], v149 offset:5248
    ds_read_b64_tr_b16 a[214:215], v149 offset:7808
    v_mfma_f32_16x16x32_bf16 v[8:11], a[232:235], a[56:59], v[8:11]
    ds_read_b64_tr_b16 a[216:217], v149 offset:10368
    ds_read_b64_tr_b16 a[218:219], v149 offset:12928
    v_mfma_f32_16x16x32_bf16 v[8:11], a[236:239], a[60:63], v[8:11]
    ds_read_b64_tr_b16 a[220:221], v149 offset:15488
    ds_read_b64_tr_b16 a[222:223], v149 offset:18048
    s_waitcnt vmcnt(0)
    s_barrier
    s_waitcnt lgkmcnt(8)
    v_mfma_f32_16x16x32_bf16 v[12:15], a[192:195], a[48:51], v[12:15]
    ds_read_b64_tr_b16 a[224:225], v149 offset:24576
    ds_read_b64_tr_b16 a[226:227], v149 offset:27136
    v_mfma_f32_16x16x32_bf16 v[12:15], a[196:199], a[52:55], v[12:15]
    ds_read_b64_tr_b16 a[228:229], v149 offset:29696
    ds_read_b64_tr_b16 a[230:231], v149 offset:32256
    v_mfma_f32_16x16x32_bf16 v[12:15], a[200:203], a[56:59], v[12:15]
    ds_read_b64_tr_b16 a[232:233], v149 offset:34816
    ds_read_b64_tr_b16 a[234:235], v149 offset:37376
    v_mfma_f32_16x16x32_bf16 v[12:15], a[204:207], a[60:63], v[12:15]
    ds_read_b64_tr_b16 a[236:237], v149 offset:39936
    ds_read_b64_tr_b16 a[238:239], v149 offset:42496
    s_waitcnt lgkmcnt(8)
    v_mfma_f32_16x16x32_bf16 v[16:19], a[208:211], a[48:51], v[16:19]
    ds_read_b64_tr_b16 a[192:193], v149 offset:24608
    ds_read_b64_tr_b16 a[194:195], v149 offset:27168
    v_mfma_f32_16x16x32_bf16 v[16:19], a[212:215], a[52:55], v[16:19]
    ds_read_b64_tr_b16 a[196:197], v149 offset:29728
    ds_read_b64_tr_b16 a[198:199], v149 offset:32288
    v_mfma_f32_16x16x32_bf16 v[16:19], a[216:219], a[56:59], v[16:19]
    ds_read_b64_tr_b16 a[200:201], v149 offset:34848
    ds_read_b64_tr_b16 a[202:203], v149 offset:37408
    v_mfma_f32_16x16x32_bf16 v[16:19], a[220:223], a[60:63], v[16:19]
    ds_read_b64_tr_b16 a[204:205], v149 offset:39968
    ds_read_b64_tr_b16 a[206:207], v149 offset:42528
    s_waitcnt lgkmcnt(8)
    v_mfma_f32_16x16x32_bf16 v[0:3], a[224:227], a[0:3], v[0:3]
    ds_read_b64_tr_b16 a[208:209], v149 offset:24640
    ds_read_b64_tr_b16 a[210:211], v149 offset:27200
    v_mfma_f32_16x16x32_bf16 v[0:3], a[228:231], a[4:7], v[0:3]
    ds_read_b64_tr_b16 a[212:213], v149 offset:29760
    ds_read_b64_tr_b16 a[214:215], v149 offset:32320
    v_mfma_f32_16x16x32_bf16 v[0:3], a[232:235], a[8:11], v[0:3]
    ds_read_b64_tr_b16 a[216:217], v149 offset:34880
    ds_read_b64_tr_b16 a[218:219], v149 offset:37440
    v_mfma_f32_16x16x32_bf16 v[0:3], a[236:239], a[12:15], v[0:3]
    ds_read_b64_tr_b16 a[220:221], v149 offset:40000
    ds_read_b64_tr_b16 a[222:223], v149 offset:42560
    s_waitcnt lgkmcnt(8)
    v_mfma_f32_16x16x32_bf16 v[4:7], a[192:195], a[0:3], v[4:7]
    ds_read_b64_tr_b16 a[224:225], v149 offset:24672
    ds_read_b64_tr_b16 a[226:227], v149 offset:27232
    v_mfma_f32_16x16x32_bf16 v[4:7], a[196:199], a[4:7], v[4:7]
    ds_read_b64_tr_b16 a[228:229], v149 offset:29792
    ds_read_b64_tr_b16 a[230:231], v149 offset:32352
    v_mfma_f32_16x16x32_bf16 v[4:7], a[200:203], a[8:11], v[4:7]
    ds_read_b64_tr_b16 a[232:233], v149 offset:34912
    ds_read_b64_tr_b16 a[234:235], v149 offset:37472
    v_mfma_f32_16x16x32_bf16 v[4:7], a[204:207], a[12:15], v[4:7]
    ds_read_b64_tr_b16 a[236:237], v149 offset:40032
    ds_read_b64_tr_b16 a[238:239], v149 offset:42592
    s_waitcnt lgkmcnt(8)
    v_mfma_f32_16x16x32_bf16 v[8:11], a[208:211], a[0:3], v[8:11]
    ds_read_b64_tr_b16 a[192:193], v149 offset:24704
    ds_read_b64_tr_b16 a[194:195], v149 offset:27264
    v_mfma_f32_16x16x32_bf16 v[8:11], a[212:215], a[4:7], v[8:11]
    ds_read_b64_tr_b16 a[196:197], v149 offset:29824
    ds_read_b64_tr_b16 a[198:199], v149 offset:32384
    v_mfma_f32_16x16x32_bf16 v[8:11], a[216:219], a[8:11], v[8:11]
    ds_read_b64_tr_b16 a[200:201], v149 offset:34944
    ds_read_b64_tr_b16 a[202:203], v149 offset:37504
    v_mfma_f32_16x16x32_bf16 v[8:11], a[220:223], a[12:15], v[8:11]
    ds_read_b64_tr_b16 a[204:205], v149 offset:40064
    ds_read_b64_tr_b16 a[206:207], v149 offset:42624
    s_waitcnt lgkmcnt(8)
    v_mfma_f32_16x16x32_bf16 v[12:15], a[224:227], a[0:3], v[12:15]
    v_mfma_f32_16x16x32_bf16 v[12:15], a[228:231], a[4:7], v[12:15]
    v_mfma_f32_16x16x32_bf16 v[12:15], a[232:235], a[8:11], v[12:15]
    v_mfma_f32_16x16x32_bf16 v[12:15], a[236:239], a[12:15], v[12:15]
    s_waitcnt lgkmcnt(0)
    v_mfma_f32_16x16x32_bf16 v[16:19], a[192:195], a[0:3], v[16:19]
    v_mfma_f32_16x16x32_bf16 v[16:19], a[196:199], a[4:7], v[16:19]
    v_mfma_f32_16x16x32_bf16 v[16:19], a[200:203], a[8:11], v[16:19]
    v_mfma_f32_16x16x32_bf16 v[16:19], a[204:207], a[12:15], v[16:19]
    s_add_u32 s35, s34, s38
    s_add_u32 s43, s35, 4096
    s_add_u32 m0, s38, 122880
    s_nop 0
    buffer_load_dwordx4 v140, s[8:11], s35 offen offset:0  lds
    v_pk_mul_f32 v[104:105], v[0:1], v[0:1]
    v_pk_mul_f32 v[106:107], v[2:3], v[2:3]
    v_pk_mul_f32 v[108:109], v[4:5], v[4:5]
    v_pk_mul_f32 v[110:111], v[6:7], v[6:7]
    v_pk_mul_f32 v[112:113], v[8:9], v[8:9]
    v_pk_mul_f32 v[114:115], v[10:11], v[10:11]
    v_pk_mul_f32 v[116:117], v[12:13], v[12:13]
    v_pk_mul_f32 v[118:119], v[14:15], v[14:15]
    v_pk_mul_f32 v[120:121], v[16:17], v[16:17]
    v_pk_mul_f32 v[122:123], v[18:19], v[18:19]
    v_pk_fma_f32 v[104:105], v[104:105], v[188:189], v[188:189] op_sel:[0,0,1] op_sel_hi:[1,0,1]
    buffer_load_dwordx4 v140, s[8:11], s35 offen offset:1024  lds
    v_pk_fma_f32 v[106:107], v[106:107], v[188:189], v[188:189] op_sel:[0,0,1] op_sel_hi:[1,0,1]
    v_pk_fma_f32 v[108:109], v[108:109], v[188:189], v[188:189] op_sel:[0,0,1] op_sel_hi:[1,0,1]
    v_pk_fma_f32 v[110:111], v[110:111], v[188:189], v[188:189] op_sel:[0,0,1] op_sel_hi:[1,0,1]
    v_pk_fma_f32 v[112:113], v[112:113], v[188:189], v[188:189] op_sel:[0,0,1] op_sel_hi:[1,0,1]
    v_pk_fma_f32 v[114:115], v[114:115], v[188:189], v[188:189] op_sel:[0,0,1] op_sel_hi:[1,0,1]
    v_pk_fma_f32 v[116:117], v[116:117], v[188:189], v[188:189] op_sel:[0,0,1] op_sel_hi:[1,0,1]
    v_pk_fma_f32 v[118:119], v[118:119], v[188:189], v[188:189] op_sel:[0,0,1] op_sel_hi:[1,0,1]
    v_pk_fma_f32 v[120:121], v[120:121], v[188:189], v[188:189] op_sel:[0,0,1] op_sel_hi:[1,0,1]
    v_pk_fma_f32 v[122:123], v[122:123], v[188:189], v[188:189] op_sel:[0,0,1] op_sel_hi:[1,0,1]
    v_pk_mul_f32 v[104:105], v[104:105], v[0:1]
    v_pk_mul_f32 v[106:107], v[106:107], v[2:3]
    buffer_load_dwordx4 v140, s[8:11], s35 offen offset:2048  lds
    v_pk_mul_f32 v[108:109], v[108:109], v[4:5]
    v_pk_mul_f32 v[110:111], v[110:111], v[6:7]
    v_pk_mul_f32 v[112:113], v[112:113], v[8:9]
    v_pk_mul_f32 v[114:115], v[114:115], v[10:11]
    v_pk_mul_f32 v[116:117], v[116:117], v[12:13]
    v_pk_mul_f32 v[118:119], v[118:119], v[14:15]
    v_pk_mul_f32 v[120:121], v[120:121], v[16:17]
    v_pk_mul_f32 v[122:123], v[122:123], v[18:19]
    v_exp_f32 v104, v104
    v_exp_f32 v105, v105
    v_exp_f32 v106, v106
    buffer_load_dwordx4 v140, s[8:11], s35 offen offset:3072  lds
    s_add_u32 m0, s38, 126976
    s_nop 0
    v_exp_f32 v107, v107
    v_exp_f32 v108, v108
    v_exp_f32 v109, v109
    v_exp_f32 v110, v110
    v_exp_f32 v111, v111
    v_exp_f32 v112, v112
    v_exp_f32 v113, v113
    v_exp_f32 v114, v114
    v_exp_f32 v115, v115
    v_exp_f32 v116, v116
    v_exp_f32 v117, v117
    buffer_load_dwordx4 v140, s[8:11], s43 offen offset:0  lds
    s_add_u32 s34, s34, 20480
    v_exp_f32 v118, v118
    v_exp_f32 v119, v119
    v_exp_f32 v120, v120
    v_exp_f32 v121, v121
    v_exp_f32 v122, v122
    v_exp_f32 v123, v123
    v_pk_add_f32 v[104:105], v[104:105], 1.0 op_sel_hi:[1,0]
    v_pk_add_f32 v[106:107], v[106:107], 1.0 op_sel_hi:[1,0]
    v_pk_add_f32 v[108:109], v[108:109], 1.0 op_sel_hi:[1,0]
    v_pk_add_f32 v[110:111], v[110:111], 1.0 op_sel_hi:[1,0]
    v_pk_add_f32 v[112:113], v[112:113], 1.0 op_sel_hi:[1,0]
    v_pk_add_f32 v[114:115], v[114:115], 1.0 op_sel_hi:[1,0]
    v_pk_add_f32 v[116:117], v[116:117], 1.0 op_sel_hi:[1,0]
    v_pk_add_f32 v[118:119], v[118:119], 1.0 op_sel_hi:[1,0]
    v_pk_add_f32 v[120:121], v[120:121], 1.0 op_sel_hi:[1,0]
    v_pk_add_f32 v[122:123], v[122:123], 1.0 op_sel_hi:[1,0]
    v_rcp_f32 v104, v104
    v_rcp_f32 v105, v105
    v_rcp_f32 v106, v106
    v_rcp_f32 v107, v107
    v_rcp_f32 v108, v108
    v_rcp_f32 v109, v109
    v_rcp_f32 v110, v110
    v_rcp_f32 v111, v111
    v_rcp_f32 v112, v112
    v_rcp_f32 v113, v113
    v_rcp_f32 v114, v114
    v_rcp_f32 v115, v115
    v_rcp_f32 v116, v116
    v_rcp_f32 v117, v117
    v_rcp_f32 v118, v118
    v_rcp_f32 v119, v119
    v_rcp_f32 v120, v120
    v_rcp_f32 v121, v121
    v_rcp_f32 v122, v122
    v_rcp_f32 v123, v123
    v_pk_mul_f32 v[0:1], v[0:1], v[104:105]
    v_pk_mul_f32 v[2:3], v[2:3], v[106:107]
    v_pk_mul_f32 v[4:5], v[4:5], v[108:109]
    v_pk_mul_f32 v[6:7], v[6:7], v[110:111]
    v_pk_mul_f32 v[8:9], v[8:9], v[112:113]
    v_pk_mul_f32 v[10:11], v[10:11], v[114:115]
    v_pk_mul_f32 v[12:13], v[12:13], v[116:117]
    v_pk_mul_f32 v[14:15], v[14:15], v[118:119]
    v_pk_mul_f32 v[16:17], v[16:17], v[120:121]
    v_pk_mul_f32 v[18:19], v[18:19], v[122:123]
    v_cvt_pk_bf16_f32 v88, v0, v1
    v_cvt_pk_bf16_f32 v89, v2, v3
    v_cvt_pk_bf16_f32 v90, v4, v5
    v_cvt_pk_bf16_f32 v91, v6, v7
    v_cvt_pk_bf16_f32 v92, v8, v9
    v_cvt_pk_bf16_f32 v93, v10, v11
    v_cvt_pk_bf16_f32 v94, v12, v13
    v_cvt_pk_bf16_f32 v95, v14, v15
    v_cvt_pk_bf16_f32 v96, v16, v17
    v_cvt_pk_bf16_f32 v97, v18, v19
    v_cndmask_b32 v100, v88, v96, s[100:101]
    v_cndmask_b32 v101, v89, v97, s[100:101]
    v_mov_b32 v102, v100
    v_mov_b32 v103, v101
    buffer_store_dwordx4 v[88:91], v141, s[84:87], s0 offen offset:0 sc1
    buffer_store_dwordx4 v[92:95], v141, s[84:87], s0 offen offset:1024 sc1
    buffer_store_dwordx4 v[90:93], v141, s[84:87], s1 offen offset:1024 sc1
    buffer_store_dwordx4 v[94:97], v141, s[84:87], s1 offen offset:2048 sc1
    v_permlane32_swap_b32 v100, v102
    v_permlane32_swap_b32 v101, v103
    buffer_store_dwordx4 v[100:103], v158, s[84:87], s2 offen sc1
    s_add_u32 s36, s22, 65536
    s_waitcnt vmcnt(0)
    s_barrier
    s_add_u32 s37, s36, 262144
    buffer_store_dword v147, v146, s[52:55], s37 offen
    buffer_store_dword v147, v146, s[52:55], s36 offen sc1
    s_add_u32 s44, s6, 59768832
    s_addc_u32 s45, s7, 0
    s_mov_b32 s46, 2621440
    s_mov_b32 s47, 0x20000
    s_add_u32 s60, s6, 53477376
    s_addc_u32 s61, s7, 0
    s_mov_b32 s62, 2621440
    s_mov_b32 s63, 0x20000
    s_add_u32 s84, s6, 62914560
    s_addc_u32 s85, s7, 0
    s_mov_b32 s86, 2752512
    s_mov_b32 s87, 0x20000
    s_lshl_b32 s26, s33, 4
    v_and_b32 v167, 15, v161
    v_and_b32 v168, 0x300, v140
    v_add_u32 v167, s26, v167
    v_mov_b32 v169, 0x80000000
    v_add_u32 v166, -1, v167
    v_cmp_gt_i32 vcc, 0, v166
    v_lshrrev_b32 v170, 4, v166
    v_and_b32 v166, 15, v166
    v_mul_u32_u24 v170, 20480, v170
    v_lshl_add_u32 v166, v166, 4, v168
    v_add_u32 v166, v170, v166
    v_cndmask_b32 v176, v166, v169, vcc
    v_sub_u32 v170, v157, v140
    v_add_u32 v180, v176, v170
    v_add_u32 v166, 1, v167
    v_cmp_gt_i32 vcc, 0, v166
    v_lshrrev_b32 v170, 4, v166
    v_and_b32 v166, 15, v166
    v_mul_u32_u24 v170, 20480, v170
    v_lshl_add_u32 v166, v166, 4, v168
    v_add_u32 v166, v170, v166
    v_cndmask_b32 v177, v166, v169, vcc
    v_sub_u32 v170, v157, v140
    v_add_u32 v181, v177, v170
    v_add_u32 v166, -2, v167
    v_cmp_gt_i32 vcc, 0, v166
    v_lshrrev_b32 v170, 4, v166
    v_and_b32 v166, 15, v166
    v_mul_u32_u24 v170, 20480, v170
    v_lshl_add_u32 v166, v166, 4, v168
    v_add_u32 v166, v170, v166
    v_cndmask_b32 v178, v166, v169, vcc
    v_sub_u32 v170, v157, v140
    v_add_u32 v182, v178, v170
    v_add_u32 v166, 2, v167
    v_cmp_gt_i32 vcc, 0, v166
    v_lshrrev_b32 v170, 4, v166
    v_and_b32 v166, 15, v166
    v_mul_u32_u24 v170, 20480, v170
    v_lshl_add_u32 v166, v166, 4, v168
    v_add_u32 v166, v170, v166
    v_cndmask_b32 v179, v166, v169, vcc
    v_sub_u32 v170, v157, v140
    v_add_u32 v183, v179, v170
    s_mov_b32 s42, 0
    s_mov_b32 s36, 65536
    s_cmp_eq_u32 s24, 0
    s_cbranch_scc1 L_tail_w0_2
    s_add_u32 s35, s34, s90
    s_add_u32 s43, s35, 4096
    s_add_u32 m0, s90, 0
    s_nop 0
    buffer_load_dwordx4 v140, s[8:11], s35 offen offset:0  lds
    buffer_load_dwordx4 v140, s[8:11], s35 offen offset:1024  lds
    buffer_load_dwordx4 v140, s[8:11], s35 offen offset:2048  lds
    buffer_load_dwordx4 v140, s[8:11], s35 offen offset:3072  lds
    s_add_u32 m0, s90, 4096
    s_nop 0
    buffer_load_dwordx4 v140, s[8:11], s43 offen offset:0  lds
    buffer_load_dwordx4 v140, s[8:11], s43 offen offset:1024  lds
    buffer_load_dwordx4 v140, s[8:11], s43 offen offset:2048  lds
    s_add_u32 s34, s34, 20480
    s_add_u32 s35, s34, s90
    s_add_u32 s43, s35, 4096
    s_add_u32 m0, s90, 24576
    s_nop 0
    buffer_load_dwordx4 v140, s[8:11], s35 offen offset:0  lds
    buffer_load_dwordx4 v140, s[8:11], s35 offen offset:1024  lds
    buffer_load_dwordx4 v140, s[8:11], s35 offen offset:2048  lds
    buffer_load_dwordx4 v140, s[8:11], s35 offen offset:3072  lds
    s_add_u32 m0, s90, 28672
    s_nop 0
    buffer_load_dwordx4 v140, s[8:11], s43 offen offset:0  lds
    buffer_load_dwordx4 v140, s[8:11], s43 offen offset:1024  lds
    buffer_load_dwordx4 v140, s[8:11], s43 offen offset:2048  lds
    s_add_u32 s34, s34, 20480
    s_add_u32 s35, s34, s90
    s_add_u32 s43, s35, 4096
    s_add_u32 m0, s90, 49152
    s_nop 0
    buffer_load_dwordx4 v140, s[8:11], s35 offen offset:0  lds
    buffer_load_dwordx4 v140, s[8:11], s35 offen offset:1024  lds
    buffer_load_dwordx4 v140, s[8:11], s35 offen offset:2048  lds
    buffer_load_dwordx4 v140, s[8:11], s35 offen offset:3072  lds
    s_add_u32 m0, s90, 53248
    s_nop 0
    buffer_load_dwordx4 v140, s[8:11], s43 offen offset:0  lds
    buffer_load_dwordx4 v140, s[8:11], s43 offen offset:1024  lds
    buffer_load_dwordx4 v140, s[8:11], s43 offen offset:2048  lds
    s_add_u32 s34, s34, 20480
L_tail_got2:
    s_barrier
    buffer_load_dwordx4 a[0:3], v176, s[44:47], s42 offen offset:0 sc1
    buffer_load_dwordx4 a[4:7], v176, s[44:47], s42 offen offset:1024 sc1
    buffer_load_dwordx2 a[8:9], v180, s[44:47], s42 offen offset:2048 sc1
    buffer_load_dwordx2 a[10:11], v180, s[44:47], s42 offen offset:2560 sc1
    buffer_load_dwordx4 a[12:15], v176, s[44:47], s42 offen offset:3072 sc1
    s_add_u32 s42, s42, 4096
    buffer_load_dwordx4 a[16:19], v176, s[44:47], s42 offen offset:0 sc1
    buffer_load_dwordx4 a[20:23], v177, s[44:47], s42 offen offset:1024 sc1
    buffer_load_dwordx4 a[24:27], v177, s[44:47], s42 offen offset:2048 sc1
    buffer_load_dwordx2 a[28:29], v181, s[44:47], s42 offen offset:3072 sc1
    buffer_load_dwordx2 a[30:31], v181, s[44:47], s42 offen offset:3584 sc1
    s_add_u32 s42, s42, 4096
    s_waitcnt vmcnt(5)
    ds_read_b64_tr_b16 a[192:193], v150 offset:0
    ds_read_b64_tr_b16 a[194:195], v150 offset:2560
    ds_read_b64_tr_b16 a[196:197], v150 offset:5120
    ds_read_b64_tr_b16 a[198:199], v150 offset:7680
    ds_read_b64_tr_b16 a[200:201], v150 offset:10240
    ds_read_b64_tr_b16 a[202:203], v150 offset:12800
    ds_read_b64_tr_b16 a[204:205], v150 offset:15360
    ds_read_b64_tr_b16 a[206:207], v150 offset:17920
    ds_read_b64_tr_b16 a[208:209], v150 offset:32
    ds_read_b64_tr_b16 a[210:211], v150 offset:2592
    ds_read_b64_tr_b16 a[212:213], v150 offset:5152
    ds_read_b64_tr_b16 a[214:215], v150 offset:7712
    ds_read_b64_tr_b16 a[216:217], v150 offset:10272
    ds_read_b64_tr_b16 a[218:219], v150 offset:12832
    ds_read_b64_tr_b16 a[220:221], v150 offset:15392
    ds_read_b64_tr_b16 a[222:223], v150 offset:17952
    s_waitcnt lgkmcnt(8)
    v_mfma_f32_16x16x32_bf16 v[0:3], a[192:195], a[0:3], 0
    ds_read_b64_tr_b16 a[224:225], v150 offset:64
    ds_read_b64_tr_b16 a[226:227], v150 offset:2624
    buffer_load_dwordx4 a[32:35], v177, s[44:47], s42 offen offset:0 sc1
    v_mfma_f32_16x16x32_bf16 v[0:3], a[196:199], a[4:7], v[0:3]
    ds_read_b64_tr_b16 a[228:229], v150 offset:5184
    ds_read_b64_tr_b16 a[230:231], v150 offset:7744
    v_mfma_f32_16x16x32_bf16 v[0:3], a[200:203], a[8:11], v[0:3]
    ds_read_b64_tr_b16 a[232:233], v150 offset:10304
    ds_read_b64_tr_b16 a[234:235], v150 offset:12864
    buffer_load_dwordx4 a[36:39], v177, s[44:47], s42 offen offset:1024 sc1
    v_mfma_f32_16x16x32_bf16 v[0:3], a[204:207], a[12:15], v[0:3]
    ds_read_b64_tr_b16 a[236:237], v150 offset:15424
    ds_read_b64_tr_b16 a[238:239], v150 offset:17984
    s_waitcnt lgkmcnt(8)
    v_mfma_f32_16x16x32_bf16 v[4:7], a[208:211], a[0:3], 0
    ds_read_b64_tr_b16 a[192:193], v150 offset:96
    ds_read_b64_tr_b16 a[194:195], v150 offset:2656
    buffer_load_dwordx4 a[40:43], v178, s[44:47], s42 offen offset:2048 sc1
    v_mfma_f32_16x16x32_bf16 v[4:7], a[212:215], a[4:7], v[4:7]
    ds_read_b64_tr_b16 a[196:197], v150 offset:5216
    ds_read_b64_tr_b16 a[198:199], v150 offset:7776
    v_mfma_f32_16x16x32_bf16 v[4:7], a[216:219], a[8:11], v[4:7]
    ds_read_b64_tr_b16 a[200:201], v150 offset:10336
    ds_read_b64_tr_b16 a[202:203], v150 offset:12896
    v_mfma_f32_16x16x32_bf16 v[4:7], a[220:223], a[12:15], v[4:7]
    ds_read_b64_tr_b16 a[204:205], v150 offset:15456
    ds_read_b64_tr_b16 a[206:207], v150 offset:18016
    buffer_load_dwordx4 a[44:47], v178, s[44:47], s42 offen offset:3072 sc1
    s_add_u32 s42, s42, 4096
    s_waitcnt lgkmcnt(8)
    v_mfma_f32_16x16x32_bf16 v[8:11], a[224:227], a[0:3], 0
    ds_read_b64_tr_b16 a[208:209], v150 offset:128
    ds_read_b64_tr_b16 a[210:211], v150 offset:2688
    v_mfma_f32_16x16x32_bf16 v[8:11], a[228:231], a[4:7], v[8:11]
    ds_read_b64_tr_b16 a[212:213], v150 offset:5248
    ds_read_b64_tr_b16 a[214:215], v150 offset:7808
    v_mfma_f32_16x16x32_bf16 v[8:11], a[232:235], a[8:11], v[8:11]
    ds_read_b64_tr_b16 a[216:217], v150 offset:10368
    ds_read_b64_tr_b16 a[218:219], v150 offset:12928
    v_mfma_f32_16x16x32_bf16 v[8:11], a[236:239], a[12:15], v[8:11]
    ds_read_b64_tr_b16 a[220:221], v150 offset:15488
    ds_read_b64_tr_b16 a[222:223], v150 offset:18048
    s_waitcnt vmcnt(4)
    s_barrier
    s_waitcnt lgkmcnt(8)
    v_mfma_f32_16x16x32_bf16 v[12:15], a[192:195], a[0:3], 0
    ds_read_b64_tr_b16 a[224:225], v150 offset:24576
    ds_read_b64_tr_b16 a[226:227], v150 offset:27136
    buffer_load_dwordx2 a[48:49], v182, s[44:47], s42 offen offset:0 sc1
    v_mfma_f32_16x16x32_bf16 v[12:15], a[196:199], a[4:7], v[12:15]
    ds_read_b64_tr_b16 a[228:229], v150 offset:29696
    ds_read_b64_tr_b16 a[230:231], v150 offset:32256
    buffer_load_dwordx2 a[50:51], v182, s[44:47], s42 offen offset:512 sc1
    v_mfma_f32_16x16x32_bf16 v[12:15], a[200:203], a[8:11], v[12:15]
    ds_read_b64_tr_b16 a[232:233], v150 offset:34816
    ds_read_b64_tr_b16 a[234:235], v150 offset:37376
    v_mfma_f32_16x16x32_bf16 v[12:15], a[204:207], a[12:15], v[12:15]
    ds_read_b64_tr_b16 a[236:237], v150 offset:39936
    ds_read_b64_tr_b16 a[238:239], v150 offset:42496
    buffer_load_dwordx4 a[52:55], v178, s[44:47], s42 offen offset:1024 sc1
    s_waitcnt lgkmcnt(8)
    v_mfma_f32_16x16x32_bf16 v[16:19], a[208:211], a[0:3], 0
    ds_read_b64_tr_b16 a[192:193], v150 offset:24608
    ds_read_b64_tr_b16 a[194:195], v150 offset:27168
    v_mfma_f32_16x16x32_bf16 v[16:19], a[212:215], a[4:7], v[16:19]
    ds_read_b64_tr_b16 a[196:197], v150 offset:29728
    ds_read_b64_tr_b16 a[198:199], v150 offset:32288
    buffer_load_dwordx4 a[56:59], v178, s[44:47], s42 offen offset:2048 sc1
    v_mfma_f32_16x16x32_bf16 v[16:19], a[216:219], a[8:11], v[16:19]
    ds_read_b64_tr_b16 a[200:201], v150 offset:34848
    ds_read_b64_tr_b16 a[202:203], v150 offset:37408
    v_mfma_f32_16x16x32_bf16 v[16:19], a[220:223], a[12:15], v[16:19]
    ds_read_b64_tr_b16 a[204:205], v150 offset:39968
    ds_read_b64_tr_b16 a[206:207], v150 offset:42528
    buffer_load_dwordx4 a[60:63], v179, s[44:47], s42 offen offset:3072 sc1
    s_add_u32 s42, s42, 4096
    s_waitcnt lgkmcnt(8)
    v_mfma_f32_16x16x32_bf16 v[0:3], a[224:227], a[16:19], v[0:3]
    ds_read_b64_tr_b16 a[208:209], v150 offset:24640
    ds_read_b64_tr_b16 a[210:211], v150 offset:27200
    v_mfma_f32_16x16x32_bf16 v[0:3], a[228:231], a[20:23], v[0:3]
    ds_read_b64_tr_b16 a[212:213], v150 offset:29760
    ds_read_b64_tr_b16 a[214:215], v150 offset:32320
    v_mfma_f32_16x16x32_bf16 v[0:3], a[232:235], a[24:27], v[0:3]
    ds_read_b64_tr_b16 a[216:217], v150 offset:34880
    ds_read_b64_tr_b16 a[218:219], v150 offset:37440
    v_mfma_f32_16x16x32_bf16 v[0:3], a[236:239], a[28:31], v[0:3]
    ds_read_b64_tr_b16 a[220:221], v150 offset:40000
    ds_read_b64_tr_b16 a[222:223], v150 offset:42560
    s_waitcnt lgkmcnt(8)
    v_mfma_f32_16x16x32_bf16 v[4:7], a[192:195], a[16:19], v[4:7]
    ds_read_b64_tr_b16 a[224:225], v150 offset:24672
    ds_read_b64_tr_b16 a[226:227], v150 offset:27232
    v_mfma_f32_16x16x32_bf16 v[4:7], a[196:199], a[20:23], v[4:7]
    ds_read_b64_tr_b16 a[228:229], v150 offset:29792
    ds_read_b64_tr_b16 a[230:231], v150 offset:32352
    v_mfma_f32_16x16x32_bf16 v[4:7], a[200:203], a[24:27], v[4:7]
    ds_read_b64_tr_b16 a[232:233], v150 offset:34912
    ds_read_b64_tr_b16 a[234:235], v150 offset:37472
    v_mfma_f32_16x16x32_bf16 v[4:7], a[204:207], a[28:31], v[4:7]
    ds_read_b64_tr_b16 a[236:237], v150 offset:40032
    ds_read_b64_tr_b16 a[238:239], v150 offset:42592
    s_waitcnt lgkmcnt(8)
    v_mfma_f32_16x16x32_bf16 v[8:11], a[208:211], a[16:19], v[8:11]
    ds_read_b64_tr_b16 a[192:193], v150 offset:24704
    ds_read_b64_tr_b16 a[194:195], v150 offset:27264
    v_mfma_f32_16x16x32_bf16 v[8:11], a[212:215], a[20:23], v[8:11]
    ds_read_b64_tr_b16 a[196:197], v150 offset:29824
    ds_read_b64_tr_b16 a[198:199], v150 offset:32384
    v_mfma_f32_16x16x32_bf16 v[8:11], a[216:219], a[24:27], v[8:11]
    ds_read_b64_tr_b16 a[200:201], v150 offset:34944
    ds_read_b64_tr_b16 a[202:203], v150 offset:37504
    v_mfma_f32_16x16x32_bf16 v[8:11], a[220:223], a[28:31], v[8:11]
    ds_read_b64_tr_b16 a[204:205], v150 offset:40064
    ds_read_b64_tr_b16 a[206:207], v150 offset:42624
    s_waitcnt vmcnt(5)
    s_barrier
    s_waitcnt lgkmcnt(8)
    v_mfma_f32_16x16x32_bf16 v[12:15], a[224:227], a[16:19], v[12:15]
    ds_read_b64_tr_b16 a[208:209], v148 offset:0
    ds_read_b64_tr_b16 a[210:211], v148 offset:2560
    buffer_load_dwordx4 a[0:3], v179, s[44:47], s42 offen offset:0 sc1
    v_mfma_f32_16x16x32_bf16 v[12:15], a[228:231], a[20:23], v[12:15]
    ds_read_b64_tr_b16 a[212:213], v148 offset:5120
    ds_read_b64_tr_b16 a[214:215], v148 offset:7680
    v_mfma_f32_16x16x32_bf16 v[12:15], a[232:235], a[24:27], v[12:15]
    ds_read_b64_tr_b16 a[216:217], v148 offset:10240
    ds_read_b64_tr_b16 a[218:219], v148 offset:12800
    v_mfma_f32_16x16x32_bf16 v[12:15], a[236:239], a[28:31], v[12:15]
    ds_read_b64_tr_b16 a[220:221], v148 offset:15360
    ds_read_b64_tr_b16 a[222:223], v148 offset:17920
    buffer_load_dwordx2 a[4:5], v183, s[44:47], s42 offen offset:1024 sc1
    s_waitcnt lgkmcnt(8)
    v_mfma_f32_16x16x32_bf16 v[16:19], a[192:195], a[16:19], v[16:19]
    ds_read_b64_tr_b16 a[224:225], v148 offset:32
    ds_read_b64_tr_b16 a[226:227], v148 offset:2592
    v_mfma_f32_16x16x32_bf16 v[16:19], a[196:199], a[20:23], v[16:19]
    ds_read_b64_tr_b16 a[228:229], v148 offset:5152
    ds_read_b64_tr_b16 a[230:231], v148 offset:7712
    v_mfma_f32_16x16x32_bf16 v[16:19], a[200:203], a[24:27], v[16:19]
    ds_read_b64_tr_b16 a[232:233], v148 offset:10272
    ds_read_b64_tr_b16 a[234:235], v148 offset:12832
    v_mfma_f32_16x16x32_bf16 v[16:19], a[204:207], a[28:31], v[16:19]
    ds_read_b64_tr_b16 a[236:237], v148 offset:15392
    ds_read_b64_tr_b16 a[238:239], v148 offset:17952
    buffer_load_dwordx2 a[6:7], v183, s[44:47], s42 offen offset:1536 sc1
    s_waitcnt lgkmcnt(8)
    v_mfma_f32_16x16x32_bf16 v[0:3], a[208:211], a[32:35], v[0:3]
    ds_read_b64_tr_b16 a[192:193], v148 offset:64
    ds_read_b64_tr_b16 a[194:195], v148 offset:2624
    v_mfma_f32_16x16x32_bf16 v[0:3], a[212:215], a[36:39], v[0:3]
    ds_read_b64_tr_b16 a[196:197], v148 offset:5184
    ds_read_b64_tr_b16 a[198:199], v148 offset:7744
    v_mfma_f32_16x16x32_bf16 v[0:3], a[216:219], a[40:43], v[0:3]
    ds_read_b64_tr_b16 a[200:201], v148 offset:10304
    ds_read_b64_tr_b16 a[202:203], v148 offset:12864
    buffer_load_dwordx4 a[8:11], v179, s[44:47], s42 offen offset:2048 sc1
    v_mfma_f32_16x16x32_bf16 v[0:3], a[220:223], a[44:47], v[0:3]
    ds_read_b64_tr_b16 a[204:205], v148 offset:15424
    ds_read_b64_tr_b16 a[206:207], v148 offset:17984
    s_waitcnt lgkmcnt(8)
    v_mfma_f32_16x16x32_bf16 v[4:7], a[224:227], a[32:35], v[4:7]
    ds_read_b64_tr_b16 a[208:209], v148 offset:96
    ds_read_b64_tr_b16 a[210:211], v148 offset:2656
    v_mfma_f32_16x16x32_bf16 v[4:7], a[228:231], a[36:39], v[4:7]
    ds_read_b64_tr_b16 a[212:213], v148 offset:5216
    ds_read_b64_tr_b16 a[214:215], v148 offset:7776
    v_mfma_f32_16x16x32_bf16 v[4:7], a[232:235], a[40:43], v[4:7]
    ds_read_b64_tr_b16 a[216:217], v148 offset:10336
    ds_read_b64_tr_b16 a[218:219], v148 offset:12896
    buffer_load_dwordx4 a[12:15], v179, s[44:47], s42 offen offset:3072 sc1
    s_add_u32 s42, s42, 4096
    v_mfma_f32_16x16x32_bf16 v[4:7], a[236:239], a[44:47], v[4:7]
    ds_read_b64_tr_b16 a[220:221], v148 offset:15456
    ds_read_b64_tr_b16 a[222:223], v148 offset:18016
    s_waitcnt lgkmcnt(8)
    v_mfma_f32_16x16x32_bf16 v[8:11], a[192:195], a[32:35], v[8:11]
    ds_read_b64_tr_b16 a[224:225], v148 offset:128
    ds_read_b64_tr_b16 a[226:227], v148 offset:2688
    v_mfma_f32_16x16x32_bf16 v[8:11], a[196:199], a[36:39], v[8:11]
    ds_read_b64_tr_b16 a[228:229], v148 offset:5248
    ds_read_b64_tr_b16 a[230:231], v148 offset:7808
    v_mfma_f32_16x16x32_bf16 v[8:11], a[200:203], a[40:43], v[8:11]
    ds_read_b64_tr_b16 a[232:233], v148 offset:10368
    ds_read_b64_tr_b16 a[234:235], v148 offset:12928
    v_mfma_f32_16x16x32_bf16 v[8:11], a[204:207], a[44:47], v[8:11]
    ds_read_b64_tr_b16 a[236:237], v148 offset:15488
    ds_read_b64_tr_b16 a[238:239], v148 offset:18048
    s_waitcnt vmcnt(5)
    s_barrier
    s_waitcnt lgkmcnt(8)
    v_mfma_f32_16x16x32_bf16 v[12:15], a[208:211], a[32:35], v[12:15]
    ds_read_b64_tr_b16 a[192:193], v148 offset:24576
    ds_read_b64_tr_b16 a[194:195], v148 offset:27136
    buffer_load_dwordx4 v[48:51], v141, s[60:63], s0 offen offset:0 sc1
    v_mfma_f32_16x16x32_bf16 v[12:15], a[212:215], a[36:39], v[12:15]
    ds_read_b64_tr_b16 a[196:197], v148 offset:29696
    ds_read_b64_tr_b16 a[198:199], v148 offset:32256
    v_mfma_f32_16x16x32_bf16 v[12:15], a[216:219], a[40:43], v[12:15]
    ds_read_b64_tr_b16 a[200:201], v148 offset:34816
    ds_read_b64_tr_b16 a[202:203], v148 offset:37376
    buffer_load_dwordx4 v[52:55], v141, s[60:63], s0 offen offset:1024 sc1
    v_mfma_f32_16x16x32_bf16 v[12:15], a[220:223], a[44:47], v[12:15]
    ds_read_b64_tr_b16 a[204:205], v148 offset:39936
    ds_read_b64_tr_b16 a[206:207], v148 offset:42496
    s_waitcnt lgkmcnt(8)
    v_mfma_f32_16x16x32_bf16 v[16:19], a[224:227], a[32:35], v[16:19]
    ds_read_b64_tr_b16 a[208:209], v148 offset:24608
    ds_read_b64_tr_b16 a[210:211], v148 offset:27168
    v_mfma_f32_16x16x32_bf16 v[16:19], a[228:231], a[36:39], v[16:19]
    ds_read_b64_tr_b16 a[212:213], v148 offset:29728
    ds_read_b64_tr_b16 a[214:215], v148 offset:32288
    buffer_load_dwordx2 v[56:57], v141, s[60:63], s0 offen offset:2048 sc1
    v_mfma_f32_16x16x32_bf16 v[16:19], a[232:235], a[40:43], v[16:19]
    ds_read_b64_tr_b16 a[216:217], v148 offset:34848
    ds_read_b64_tr_b16 a[218:219], v148 offset:37408
    v_mfma_f32_16x16x32_bf16 v[16:19], a[236:239], a[44:47], v[16:19]
    ds_read_b64_tr_b16 a[220:221], v148 offset:39968
    ds_read_b64_tr_b16 a[222:223], v148 offset:42528
    s_waitcnt lgkmcnt(8)
    v_mfma_f32_16x16x32_bf16 v[0:3], a[192:195], a[48:51], v[0:3]
    ds_read_b64_tr_b16 a[224:225], v148 offset:24640
    ds_read_b64_tr_b16 a[226:227], v148 offset:27200
    buffer_load_dwordx2 v[58:59], v141, s[60:63], s1 offen offset:8 sc1
    v_mfma_f32_16x16x32_bf16 v[0:3], a[196:199], a[52:55], v[0:3]
    ds_read_b64_tr_b16 a[228:229], v148 offset:29760
    ds_read_b64_tr_b16 a[230:231], v148 offset:32320
    v_mfma_f32_16x16x32_bf16 v[0:3], a[200:203], a[56:59], v[0:3]
    ds_read_b64_tr_b16 a[232:233], v148 offset:34880
    ds_read_b64_tr_b16 a[234:235], v148 offset:37440
    v_mfma_f32_16x16x32_bf16 v[0:3], a[204:207], a[60:63], v[0:3]
    ds_read_b64_tr_b16 a[236:237], v148 offset:40000
    ds_read_b64_tr_b16 a[238:239], v148 offset:42560
    buffer_load_dwordx4 v[60:63], v141, s[60:63], s1 offen offset:1024 sc1
    s_waitcnt lgkmcnt(8)
    v_mfma_f32_16x16x32_bf16 v[4:7], a[208:211], a[48:51], v[4:7]
    ds_read_b64_tr_b16 a[192:193], v148 offset:24672
    ds_read_b64_tr_b16 a[194:195], v148 offset:27232
    v_mfma_f32_16x16x32_bf16 v[4:7], a[212:215], a[52:55], v[4:7]
    ds_read_b64_tr_b16 a[196:197], v148 offset:29792
    ds_read_b64_tr_b16 a[198:199], v148 offset:32352
    v_mfma_f32_16x16x32_bf16 v[4:7], a[216:219], a[56:59], v[4:7]
    ds_read_b64_tr_b16 a[200:201], v148 offset:34912
    ds_read_b64_tr_b16 a[202:203], v148 offset:37472
    buffer_load_dwordx4 v[64:67], v141, s[60:63], s1 offen offset:2048 sc1
    v_mfma_f32_16x16x32_bf16 v[4:7], a[220:223], a[60:63], v[4:7]
    ds_read_b64_tr_b16 a[204:205], v148 offset:40032
    ds_read_b64_tr_b16 a[206:207], v148 offset:42592
    s_waitcnt lgkmcnt(8)
    v_mfma_f32_16x16x32_bf16 v[8:11], a[224:227], a[48:51], v[8:11]
    ds_read_b64_tr_b16 a[208:209], v148 offset:24704
    ds_read_b64_tr_b16 a[210:211], v148 offset:27264
    v_mfma_f32_16x16x32_bf16 v[8:11], a[228:231], a[52:55], v[8:11]
    ds_read_b64_tr_b16 a[212:213], v148 offset:29824
    ds_read_b64_tr_b16 a[214:215], v148 offset:32384
    v_mfma_f32_16x16x32_bf16 v[8:11], a[232:235], a[56:59], v[8:11]
    ds_read_b64_tr_b16 a[216:217], v148 offset:34944
    ds_read_b64_tr_b16 a[218:219], v148 offset:37504
    v_mfma_f32_16x16x32_bf16 v[8:11], a[236:239], a[60:63], v[8:11]
    ds_read_b64_tr_b16 a[220:221], v148 offset:40064
    ds_read_b64_tr_b16 a[222:223], v148 offset:42624
    s_waitcnt vmcnt(6)
    s_barrier
    s_waitcnt lgkmcnt(8)
    v_mfma_f32_16x16x32_bf16 v[12:15], a[192:195], a[48:51], v[12:15]
    ds_read_b64_tr_b16 a[224:225], v149 offset:0
    ds_read_b64_tr_b16 a[226:227], v149 offset:2560
    v_mfma_f32_16x16x32_bf16 v[12:15], a[196:199], a[52:55], v[12:15]
    ds_read_b64_tr_b16 a[228:229], v149 offset:5120
    ds_read_b64_tr_b16 a[230:231], v149 offset:7680
    v_mfma_f32_16x16x32_bf16 v[12:15], a[200:203], a[56:59], v[12:15]
    ds_read_b64_tr_b16 a[232:233], v149 offset:10240
    ds_read_b64_tr_b16 a[234:235], v149 offset:12800
    v_mfma_f32_16x16x32_bf16 v[12:15], a[204:207], a[60:63], v[12:15]
    ds_read_b64_tr_b16 a[236:237], v149 offset:15360
    ds_read_b64_tr_b16 a[238:239], v149 offset:17920
    s_waitcnt lgkmcnt(8)
    v_mfma_f32_16x16x32_bf16 v[16:19], a[208:211], a[48:51], v[16:19]
    ds_read_b64_tr_b16 a[192:193], v149 offset:32
    ds_read_b64_tr_b16 a[194:195], v149 offset:2592
    v_mfma_f32_16x16x32_bf16 v[16:19], a[212:215], a[52:55], v[16:19]
    ds_read_b64_tr_b16 a[196:197], v149 offset:5152
    ds_read_b64_tr_b16 a[198:199], v149 offset:7712
    v_mfma_f32_16x16x32_bf16 v[16:19], a[216:219], a[56:59], v[16:19]
    ds_read_b64_tr_b16 a[200:201], v149 offset:10272
    ds_read_b64_tr_b16 a[202:203], v149 offset:12832
    v_mfma_f32_16x16x32_bf16 v[16:19], a[220:223], a[60:63], v[16:19]
    ds_read_b64_tr_b16 a[204:205], v149 offset:15392
    ds_read_b64_tr_b16 a[206:207], v149 offset:17952
    s_waitcnt lgkmcnt(8)
    v_mfma_f32_16x16x32_bf16 v[0:3], a[224:227], a[0:3], v[0:3]
    ds_read_b64_tr_b16 a[208:209], v149 offset:64
    ds_read_b64_tr_b16 a[210:211], v149 offset:2624
    v_mfma_f32_16x16x32_bf16 v[0:3], a[228:231], a[4:7], v[0:3]
    ds_read_b64_tr_b16 a[212:213], v149 offset:5184
    ds_read_b64_tr_b16 a[214:215], v149 offset:7744
    v_mfma_f32_16x16x32_bf16 v[0:3], a[232:235], a[8:11], v[0:3]
    ds_read_b64_tr_b16 a[216:217], v149 offset:10304
    ds_read_b64_tr_b16 a[218:219], v149 offset:12864
    v_mfma_f32_16x16x32_bf16 v[0:3], a[236:239], a[12:15], v[0:3]
    ds_read_b64_tr_b16 a[220:221], v149 offset:15424
    ds_read_b64_tr_b16 a[222:223], v149 offset:17984
    s_waitcnt lgkmcnt(8)
    v_mfma_f32_16x16x32_bf16 v[4:7], a[192:195], a[0:3], v[4:7]
    ds_read_b64_tr_b16 a[224:225], v149 offset:96
    ds_read_b64_tr_b16 a[226:227], v149 offset:2656
    v_mfma_f32_16x16x32_bf16 v[4:7], a[196:199], a[4:7], v[4:7]
    ds_read_b64_tr_b16 a[228:229], v149 offset:5216
    ds_read_b64_tr_b16 a[230:231], v149 offset:7776
    v_mfma_f32_16x16x32_bf16 v[4:7], a[200:203], a[8:11], v[4:7]
    ds_read_b64_tr_b16 a[232:233], v149 offset:10336
    ds_read_b64_tr_b16 a[234:235], v149 offset:12896
    v_mfma_f32_16x16x32_bf16 v[4:7], a[204:207], a[12:15], v[4:7]
    ds_read_b64_tr_b16 a[236:237], v149 offset:15456
    ds_read_b64_tr_b16 a[238:239], v149 offset:18016
    s_waitcnt lgkmcnt(8)
    v_mfma_f32_16x16x32_bf16 v[8:11], a[208:211], a[0:3], v[8:11]
    ds_read_b64_tr_b16 a[192:193], v149 offset:128
    ds_read_b64_tr_b16 a[194:195], v149 offset:2688
    v_mfma_f32_16x16x32_bf16 v[8:11], a[212:215], a[4:7], v[8:11]
    ds_read_b64_tr_b16 a[196:197], v149 offset:5248
    ds_read_b64_tr_b16 a[198:199], v149 offset:7808
    v_mfma_f32_16x16x32_bf16 v[8:11], a[216:219], a[8:11], v[8:11]
    ds_read_b64_tr_b16 a[200:201], v149 offset:10368
    ds_read_b64_tr_b16 a[202:203], v149 offset:12928
    v_mfma_f32_16x16x32_bf16 v[8:11], a[220:223], a[12:15], v[8:11]
    ds_read_b64_tr_b16 a[204:205], v149 offset:15488
    ds_read_b64_tr_b16 a[206:207], v149 offset:18048
    s_waitcnt lgkmcnt(8)
    v_mfma_f32_16x16x32_bf16 v[12:15], a[224:227], a[0:3], v[12:15]
    v_mfma_f32_16x16x32_bf16 v[12:15], a[228:231], a[4:7], v[12:15]
    v_mfma_f32_16x16x32_bf16 v[12:15], a[232:235], a[8:11], v[12:15]
    v_mfma_f32_16x16x32_bf16 v[12:15], a[236:239], a[12:15], v[12:15]
    s_waitcnt lgkmcnt(0)
    v_mfma_f32_16x16x32_bf16 v[16:19], a[192:195], a[0:3], v[16:19]
    v_mfma_f32_16x16x32_bf16 v[16:19], a[196:199], a[4:7], v[16:19]
    v_mfma_f32_16x16x32_bf16 v[16:19], a[200:203], a[8:11], v[16:19]
    v_mfma_f32_16x16x32_bf16 v[16:19], a[204:207], a[12:15], v[16:19]
    s_mov_b32 s34, 0
    s_add_u32 s8, s6, s19
    s_addc_u32 s9, s7, 0
    s_mov_b32 s10, 122880
    s_mov_b32 s11, 0x20000
    s_add_u32 s35, s34, s39
    s_add_u32 s43, s35, 4096
    s_add_u32 m0, s39, 73728
    s_nop 0
    buffer_load_dwordx4 v140, s[8:11], s35 offen offset:0  lds
    s_waitcnt vmcnt(1)
    v_or_b32 v48, v48, v58
    v_or_b32 v49, v49, v59
    v_or_b32 v50, v50, v60
    v_or_b32 v51, v51, v61
    v_or_b32 v52, v52, v62
    v_or_b32 v53, v53, v63
    v_or_b32 v54, v54, v64
    buffer_load_dwordx4 v140, s[8:11], s35 offen offset:1024  lds
    v_or_b32 v55, v55, v65
    v_or_b32 v56, v56, v66
    v_or_b32 v57, v57, v67
    v_dot2c_f32_bf16 v0, v48, v190
    v_dot2c_f32_bf16 v1, v48, v191
    v_dot2c_f32_bf16 v2, v49, v190
    v_dot2c_f32_bf16 v3, v49, v191
    v_dot2c_f32_bf16 v4, v50, v190
    buffer_load_dwordx4 v140, s[8:11], s35 offen offset:2048  lds
    v_dot2c_f32_bf16 v5, v50, v191
    v_dot2c_f32_bf16 v6, v51, v190
    v_dot2c_f32_bf16 v7, v51, v191
    v_dot2c_f32_bf16 v8, v52, v190
    v_dot2c_f32_bf16 v9, v52, v191
    v_dot2c_f32_bf16 v10, v53, v190
    v_dot2c_f32_bf16 v11, v53, v191
    v_dot2c_f32_bf16 v12, v54, v190
    buffer_load_dwordx4 v140, s[8:11], s35 offen offset:3072  lds
    s_add_u32 m0, s39, 77824
    s_nop 0
    v_dot2c_f32_bf16 v13, v54, v191
    v_dot2c_f32_bf16 v14, v55, v190
    v_dot2c_f32_bf16 v15, v55, v191
    v_dot2c_f32_bf16 v16, v56, v190
    v_dot2c_f32_bf16 v17, v56, v191
    v_dot2c_f32_bf16 v18, v57, v190
    v_dot2c_f32_bf16 v19, v57, v191
    v_cvt_pk_bf16_f32 v128, v0, v1
    buffer_load_dwordx4 v140, s[8:11], s43 offen offset:0  lds
    v_cvt_pk_bf16_f32 v129, v2, v3
    v_cvt_pk_bf16_f32 v130, v4, v5
    v_cvt_pk_bf16_f32 v131, v6, v7
    v_cvt_pk_bf16_f32 v132, v8, v9
    v_cvt_pk_bf16_f32 v133, v10, v11
    v_cvt_pk_bf16_f32 v134, v12, v13
    v_cvt_pk_bf16_f32 v135, v14, v15
    v_cvt_pk_bf16_f32 v136, v16, v17
    buffer_load_dwordx4 v140, s[8:11], s43 offen offset:1024  lds
    s_add_u32 s34, s34, 24576
    v_cvt_pk_bf16_f32 v137, v18, v19
    v_cndmask_b32 v108, v128, v136, s[100:101]
    v_cndmask_b32 v109, v129, v137, s[100:101]
    v_mov_b32 v110, v108
    v_mov_b32 v111, v109
    buffer_store_dwordx4 v[128:131], v141, s[84:87], s0 offen offset:0 sc1
    buffer_store_dwordx4 v[132:135], v141, s[84:87], s0 offen offset:1024 sc1
    buffer_store_dwordx4 v[130:133], v141, s[84:87], s1 offen offset:1024 sc1
    buffer_store_dwordx4 v[134:137], v141, s[84:87], s1 offen offset:2048 sc1
    v_permlane32_swap_b32 v108, v110
    v_permlane32_swap_b32 v109, v111
    buffer_store_dwordx4 v[108:111], v158, s[84:87], s2 offen sc1
    v_pk_add_f32 v[88:89], v[0:1], v[2:3]
    v_pk_mul_f32 v[90:91], v[0:1], v[0:1]
    v_pk_fma_f32 v[90:91], v[2:3], v[2:3], v[90:91]
    v_pk_add_f32 v[88:89], v[88:89], v[4:5]
    v_pk_fma_f32 v[90:91], v[4:5], v[4:5], v[90:91]
    v_pk_add_f32 v[88:89], v[88:89], v[6:7]
    v_pk_fma_f32 v[90:91], v[6:7], v[6:7], v[90:91]
    v_pk_add_f32 v[88:89], v[88:89], v[8:9]
    v_pk_fma_f32 v[90:91], v[8:9], v[8:9], v[90:91]
    v_pk_add_f32 v[88:89], v[88:89], v[10:11]
    v_pk_fma_f32 v[90:91], v[10:11], v[10:11], v[90:91]
    v_pk_add_f32 v[88:89], v[88:89], v[12:13]
    v_pk_fma_f32 v[90:91], v[12:13], v[12:13], v[90:91]
    v_pk_add_f32 v[88:89], v[88:89], v[14:15]
    v_pk_fma_f32 v[90:91], v[14:15], v[14:15], v[90:91]
    v_pk_add_f32 v[88:89], v[88:89], v[16:17]
    v_pk_fma_f32 v[90:91], v[16:17], v[16:17], v[90:91]
    v_pk_add_f32 v[88:89], v[88:89], v[18:19]
    v_pk_fma_f32 v[90:91], v[18:19], v[18:19], v[90:91]
    v_add_f32 v88, v88, v89
    v_add_f32 v89, v90, v91
    v_mov_b32 v90, v88
    v_mov_b32 v91, v89
    s_nop 0
    v_permlane32_swap_b32 v88, v90
    v_permlane32_swap_b32 v89, v91
    v_add_f32 v88, v88, v90
    v_add_f32 v89, v89, v91
    v_mov_b32 v90, v88
    v_mov_b32 v91, v89
    s_nop 0
    v_permlane16_swap_b32 v88, v90
    v_permlane16_swap_b32 v89, v91
    v_add_f32 v88, v88, v90
    v_add_f32 v89, v89, v91
    v_cmp_gt_u32 vcc, 16, v161
    v_lshlrev_b32 v166, 3, v161
    v_mov_b32 v167, 2147418112
    s_mul_i32 s26, s33, 1024
    s_lshl_b32 s27, s25, 7
    s_add_u32 s26, s26, s27
    s_add_u32 s26, s26, 2621440
    v_cndmask_b32 v166, v167, v166, vcc
    buffer_store_dwordx2 v[88:89], v166, s[84:87], s26 offen sc1
    s_add_u32 s36, s22, 98304
    s_waitcnt vmcnt(0)
    s_barrier
    s_add_u32 s37, s36, 262144
    buffer_store_dword v147, v146, s[52:55], s37 offen
    buffer_store_dword v147, v146, s[52:55], s36 offen sc1
    s_lshr_b32 s26, s3, 1
    s_lshl_b32 s26, s26, 3
    s_lshl_b32 s27, s24, 1
    s_add_u32 s26, s26, s27
    s_mul_i32 s27, s26, 20480
    s_add_u32 s27, s27, 62914560
    s_add_u32 s44, s6, s27
    s_addc_u32 s45, s7, 0
    s_mov_b32 s46, 20480
    s_mov_b32 s47, 0x20000
    s_add_u32 s27, s27, 20480
    s_add_u32 s48, s6, s27
    s_addc_u32 s49, s7, 0
    s_mov_b32 s50, 20480
    s_mov_b32 s51, 0x20000
    s_add_u32 s60, s6, 65536000
    s_addc_u32 s61, s7, 0
    s_mov_b32 s62, 131072
    s_mov_b32 s63, 0x20000
    s_add_u32 s28, s6, 15360
    s_addc_u32 s29, s7, 0
    s_mov_b32 s30, 6144
    s_mov_b32 s31, 0x20000
    s_add_u32 s84, s6, 67108864
    s_addc_u32 s85, s7, 0
    s_mov_b32 s86, 6291456
    s_mov_b32 s87, 0x20000
    v_and_b32 v166, 15, v161
    v_lshrrev_b32 v167, 4, v161
    v_lshlrev_b32 v166, 3, v166
    v_lshl_add_u32 v166, v167, 8, v166
    v_lshlrev_b32 v167, 4, v167
    s_mul_i32 s4, s26, 1024
    s_add_u32 s15, s4, 1024
    s_mul_i32 s5, s40, 384
    s_mul_i32 s26, s26, 49152
    s_mul_i32 s27, s40, 3072
    s_add_u32 s41, s26, s27
    s_add_u32 s32, s41, 49152
    s_mov_b32 s42, 0
    s_mov_b32 s36, 98304
    s_cmp_eq_u32 s24, 0
    s_cbranch_scc1 L_tail_w0_3
    s_getpc_b64 s[26:27]
L_tail_cp3:
    v_subrev_u32 v171, 64, v162
    v_lshlrev_b32 v171, 7, v171
    v_min_u32 v171, L_attn_tailcode_end-L_tail_cp3, v171
    global_load_dword v171, v171, s[26:27]
    s_add_u32 s35, s34, s91
    s_add_u32 s43, s35, 4096
    s_add_u32 m0, s91, 98304
    s_nop 0
    buffer_load_dwordx4 v140, s[8:11], s35 offen offset:0  lds
    buffer_load_dwordx4 v140, s[8:11], s35 offen offset:1024  lds
    buffer_load_dwordx4 v140, s[8:11], s35 offen offset:2048  lds
    buffer_load_dwordx4 v140, s[8:11], s35 offen offset:3072  lds
    s_add_u32 m0, s91, 102400
    s_nop 0
    buffer_load_dwordx4 v140, s[8:11], s43 offen offset:0  lds
    buffer_load_dwordx4 v140, s[8:11], s43 offen offset:1024  lds
    buffer_load_dwordx4 v140, s[8:11], s43 offen offset:2048  lds
    buffer_load_dwordx4 v140, s[8:11], s43 offen offset:3072  lds
    s_add_u32 s34, s34, 24576
    s_add_u32 s35, s34, s91
    s_add_u32 s43, s35, 4096
    s_add_u32 m0, s91, 122880
    s_nop 0
    buffer_load_dwordx4 v140, s[8:11], s35 offen offset:0  lds
    buffer_load_dwordx4 v140, s[8:11], s35 offen offset:1024  lds
    buffer_load_dwordx4 v140, s[8:11], s35 offen offset:2048  lds
    buffer_load_dwordx4 v140, s[8:11], s35 offen offset:3072  lds
    s_add_u32 m0, s91, 126976
    s_nop 0
    buffer_load_dwordx4 v140, s[8:11], s43 offen offset:0  lds
    buffer_load_dwordx4 v140, s[8:11], s43 offen offset:1024  lds
    buffer_load_dwordx4 v140, s[8:11], s43 offen offset:2048  lds
    buffer_load_dwordx4 v140, s[8:11], s43 offen offset:3072  lds
    s_add_u32 s34, s34, 24576
    s_add_u32 s35, s34, s91
    s_add_u32 s43, s35, 4096
    s_add_u32 m0, s91, 0
    s_nop 0
    buffer_load_dwordx4 v140, s[8:11], s35 offen offset:0  lds
    buffer_load_dwordx4 v140, s[8:11], s35 offen offset:1024  lds
    buffer_load_dwordx4 v140, s[8:11], s35 offen offset:2048  lds
    buffer_load_dwordx4 v140, s[8:11], s35 offen offset:3072  lds
    s_add_u32 m0, s91, 4096
    s_nop 0
    buffer_load_dwordx4 v140, s[8:11], s43 offen offset:0  lds
    buffer_load_dwordx4 v140, s[8:11], s43 offen offset:1024  lds
    buffer_load_dwordx4 v140, s[8:11], s43 offen offset:2048  lds
    buffer_load_dwordx4 v140, s[8:11], s43 offen offset:3072  lds
    s_add_u32 s34, s34, 24576
L_tail_got3:
    s_barrier
    buffer_load_dwordx4 a[0:3], v140, s[44:47], s42 offen offset:0 sc1
    buffer_load_dwordx4 a[4:7], v140, s[48:51], s42 offen offset:0 sc1
    buffer_load_dwordx4 a[8:11], v140, s[44:47], s42 offen offset:1024 sc1
    buffer_load_dwordx4 a[12:15], v140, s[48:51], s42 offen offset:1024 sc1
    buffer_load_dwordx2 a[16:17], v157, s[44:47], s42 offen offset:2048 sc1
    buffer_load_dwordx2 a[18:19], v157, s[44:47], s42 offen offset:2560 sc1
    buffer_load_dwordx2 a[20:21], v157, s[48:51], s42 offen offset:2048 sc1
    buffer_load_dwordx2 a[22:23], v157, s[48:51], s42 offen offset:2560 sc1
    buffer_load_dwordx4 a[24:27], v140, s[44:47], s42 offen offset:3072 sc1
    buffer_load_dwordx4 a[28:31], v140, s[48:51], s42 offen offset:3072 sc1
    s_add_u32 s42, s42, 4096
    buffer_load_dwordx4 a[32:35], v140, s[44:47], s42 offen offset:0 sc1
    buffer_load_dwordx4 a[36:39], v140, s[48:51], s42 offen offset:0 sc1
    buffer_load_dwordx4 a[40:43], v140, s[44:47], s42 offen offset:1024 sc1
    buffer_load_dwordx4 a[44:47], v140, s[48:51], s42 offen offset:1024 sc1
    buffer_load_dwordx4 a[48:51], v140, s[44:47], s42 offen offset:2048 sc1
    buffer_load_dwordx4 a[52:55], v140, s[48:51], s42 offen offset:2048 sc1
    buffer_load_dwordx2 a[56:57], v157, s[44:47], s42 offen offset:3072 sc1
    buffer_load_dwordx2 a[58:59], v157, s[44:47], s42 offen offset:3584 sc1
    buffer_load_dwordx2 a[60:61], v157, s[48:51], s42 offen offset:3072 sc1
    buffer_load_dwordx2 a[62:63], v157, s[48:51], s42 offen offset:3584 sc1
    s_add_u32 s42, s42, 4096
    s_waitcnt vmcnt(10)
    s_barrier
    ds_read_b64_tr_b16 a[192:193], v153 offset:24576
    ds_read_b64_tr_b16 a[194:195], v153 offset:27648
    ds_read_b64_tr_b16 a[196:197], v153 offset:30720
    ds_read_b64_tr_b16 a[198:199], v153 offset:33792
    ds_read_b64_tr_b16 a[200:201], v153 offset:36864
    ds_read_b64_tr_b16 a[202:203], v153 offset:39936
    ds_read_b64_tr_b16 a[204:205], v153 offset:43008
    ds_read_b64_tr_b16 a[206:207], v153 offset:46080
    ds_read_b64_tr_b16 a[208:209], v154 offset:24576
    ds_read_b64_tr_b16 a[210:211], v154 offset:27648
    ds_read_b64_tr_b16 a[212:213], v154 offset:30720
    ds_read_b64_tr_b16 a[214:215], v154 offset:33792
    ds_read_b64_tr_b16 a[216:217], v154 offset:36864
    ds_read_b64_tr_b16 a[218:219], v154 offset:39936
    ds_read_b64_tr_b16 a[220:221], v154 offset:43008
    ds_read_b64_tr_b16 a[222:223], v154 offset:46080
    s_waitcnt lgkmcnt(8)
    v_mfma_f32_16x16x32_bf16 v[0:3], a[192:195], a[0:3], 0
    buffer_load_dwordx4 a[64:67], v140, s[44:47], s42 offen offset:0 sc1
    v_mfma_f32_16x16x32_bf16 v[0:3], a[196:199], a[8:11], v[0:3]
    ds_read_b64_tr_b16 a[224:225], v153 offset:24640
    ds_read_b64_tr_b16 a[226:227], v153 offset:27712
    v_mfma_f32_16x16x32_bf16 v[0:3], a[200:203], a[16:19], v[0:3]
    ds_read_b64_tr_b16 a[228:229], v153 offset:30784
    v_mfma_f32_16x16x32_bf16 v[0:3], a[204:207], a[24:27], v[0:3]
    buffer_load_dwordx4 a[68:71], v140, s[48:51], s42 offen offset:0 sc1
    v_mfma_f32_16x16x32_bf16 v[24:27], a[192:195], a[4:7], 0
    ds_read_b64_tr_b16 a[230:231], v153 offset:33856
    ds_read_b64_tr_b16 a[232:233], v153 offset:36928
    v_mfma_f32_16x16x32_bf16 v[24:27], a[196:199], a[12:15], v[24:27]
    ds_read_b64_tr_b16 a[234:235], v153 offset:40000
    v_mfma_f32_16x16x32_bf16 v[24:27], a[200:203], a[20:23], v[24:27]
    ds_read_b64_tr_b16 a[236:237], v153 offset:43072
    v_mfma_f32_16x16x32_bf16 v[24:27], a[204:207], a[28:31], v[24:27]
    buffer_load_dwordx4 a[72:75], v140, s[44:47], s42 offen offset:1024 sc1
    ds_read_b64_tr_b16 a[238:239], v153 offset:46144
    s_waitcnt lgkmcnt(8)
    v_mfma_f32_16x16x32_bf16 v[4:7], a[208:211], a[0:3], 0
    ds_read_b64_tr_b16 a[192:193], v154 offset:24640
    v_mfma_f32_16x16x32_bf16 v[4:7], a[212:215], a[8:11], v[4:7]
    ds_read_b64_tr_b16 a[194:195], v154 offset:27712
    v_mfma_f32_16x16x32_bf16 v[4:7], a[216:219], a[16:19], v[4:7]
    ds_read_b64_tr_b16 a[196:197], v154 offset:30784
    v_mfma_f32_16x16x32_bf16 v[4:7], a[220:223], a[24:27], v[4:7]
    buffer_load_dwordx4 a[76:79], v140, s[48:51], s42 offen offset:1024 sc1
    v_mfma_f32_16x16x32_bf16 v[28:31], a[208:211], a[4:7], 0
    ds_read_b64_tr_b16 a[198:199], v154 offset:33856
    ds_read_b64_tr_b16 a[200:201], v154 offset:36928
    v_mfma_f32_16x16x32_bf16 v[28:31], a[212:215], a[12:15], v[28:31]
    ds_read_b64_tr_b16 a[202:203], v154 offset:40000
    v_mfma_f32_16x16x32_bf16 v[28:31], a[216:219], a[20:23], v[28:31]
    buffer_load_dwordx4 a[80:83], v140, s[44:47], s42 offen offset:2048 sc1
    v_mfma_f32_16x16x32_bf16 v[28:31], a[220:223], a[28:31], v[28:31]
    ds_read_b64_tr_b16 a[204:205], v154 offset:43072
    ds_read_b64_tr_b16 a[206:207], v154 offset:46144
    s_waitcnt lgkmcnt(8)
    v_mfma_f32_16x16x32_bf16 v[8:11], a[224:227], a[0:3], 0
    ds_read_b64_tr_b16 a[208:209], v153 offset:24704
    v_mfma_f32_16x16x32_bf16 v[8:11], a[228:231], a[8:11], v[8:11]
    ds_read_b64_tr_b16 a[210:211], v153 offset:27776
    v_mfma_f32_16x16x32_bf16 v[8:11], a[232:235], a[16:19], v[8:11]
    buffer_load_dwordx4 a[84:87], v140, s[48:51], s42 offen offset:2048 sc1
    v_mfma_f32_16x16x32_bf16 v[8:11], a[236:239], a[24:27], v[8:11]
    ds_read_b64_tr_b16 a[212:213], v153 offset:30848
    ds_read_b64_tr_b16 a[214:215], v153 offset:33920
    v_mfma_f32_16x16x32_bf16 v[32:35], a[224:227], a[4:7], 0
    ds_read_b64_tr_b16 a[216:217], v153 offset:36992
    v_mfma_f32_16x16x32_bf16 v[32:35], a[228:231], a[12:15], v[32:35]
    ds_read_b64_tr_b16 a[218:219], v153 offset:40064
    v_mfma_f32_16x16x32_bf16 v[32:35], a[232:235], a[20:23], v[32:35]
    buffer_load_dwordx4 a[88:91], v140, s[44:47], s42 offen offset:3072 sc1
    v_mfma_f32_16x16x32_bf16 v[32:35], a[236:239], a[28:31], v[32:35]
    ds_read_b64_tr_b16 a[220:221], v153 offset:43136
    ds_read_b64_tr_b16 a[222:223], v153 offset:46208
    s_waitcnt lgkmcnt(8)
    v_mfma_f32_16x16x32_bf16 v[12:15], a[192:195], a[0:3], 0
    ds_read_b64_tr_b16 a[224:225], v154 offset:24704
    v_mfma_f32_16x16x32_bf16 v[12:15], a[196:199], a[8:11], v[12:15]
    ds_read_b64_tr_b16 a[226:227], v154 offset:27776
    v_mfma_f32_16x16x32_bf16 v[12:15], a[200:203], a[16:19], v[12:15]
    buffer_load_dwordx4 a[92:95], v140, s[48:51], s42 offen offset:3072 sc1
    s_add_u32 s42, s42, 4096
    v_mfma_f32_16x16x32_bf16 v[12:15], a[204:207], a[24:27], v[12:15]
    ds_read_b64_tr_b16 a[228:229], v154 offset:30848
    ds_read_b64_tr_b16 a[230:231], v154 offset:33920
    v_mfma_f32_16x16x32_bf16 v[36:39], a[192:195], a[4:7], 0
    ds_read_b64_tr_b16 a[232:233], v154 offset:36992
    v_mfma_f32_16x16x32_bf16 v[36:39], a[196:199], a[12:15], v[36:39]
    ds_read_b64_tr_b16 a[234:235], v154 offset:40064
    v_mfma_f32_16x16x32_bf16 v[36:39], a[200:203], a[20:23], v[36:39]
    ds_read_b64_tr_b16 a[236:237], v154 offset:43136
    v_mfma_f32_16x16x32_bf16 v[36:39], a[204:207], a[28:31], v[36:39]
    ds_read_b64_tr_b16 a[238:239], v154 offset:46208
    s_waitcnt vmcnt(8)
    s_waitcnt lgkmcnt(8)
    v_mfma_f32_16x16x32_bf16 v[16:19], a[208:211], a[0:3], 0
    buffer_load_dwordx2 a[96:97], v157, s[44:47], s42 offen offset:0 sc1
    v_mfma_f32_16x16x32_bf16 v[16:19], a[212:215], a[8:11], v[16:19]
    ds_read_b64_tr_b16 a[192:193], v155 offset:0
    ds_read_b64_tr_b16 a[194:195], v155 offset:3072
    v_mfma_f32_16x16x32_bf16 v[16:19], a[216:219], a[16:19], v[16:19]
    buffer_load_dwordx2 a[98:99], v157, s[44:47], s42 offen offset:512 sc1
    v_mfma_f32_16x16x32_bf16 v[16:19], a[220:223], a[24:27], v[16:19]
    ds_read_b64_tr_b16 a[196:197], v155 offset:6144
    ds_read_b64_tr_b16 a[198:199], v155 offset:9216
    v_mfma_f32_16x16x32_bf16 v[40:43], a[208:211], a[4:7], 0
    ds_read_b64_tr_b16 a[200:201], v155 offset:12288
    v_mfma_f32_16x16x32_bf16 v[40:43], a[212:215], a[12:15], v[40:43]
    buffer_load_dwordx2 a[100:101], v157, s[48:51], s42 offen offset:0 sc1
    v_mfma_f32_16x16x32_bf16 v[40:43], a[216:219], a[20:23], v[40:43]
    ds_read_b64_tr_b16 a[202:203], v155 offset:15360
    ds_read_b64_tr_b16 a[204:205], v155 offset:18432
    v_mfma_f32_16x16x32_bf16 v[40:43], a[220:223], a[28:31], v[40:43]
    ds_read_b64_tr_b16 a[206:207], v155 offset:21504
    s_waitcnt lgkmcnt(8)
    v_mfma_f32_16x16x32_bf16 v[20:23], a[224:227], a[0:3], 0
    buffer_load_dwordx2 a[102:103], v157, s[48:51], s42 offen offset:512 sc1
    v_mfma_f32_16x16x32_bf16 v[20:23], a[228:231], a[8:11], v[20:23]
    ds_read_b64_tr_b16 a[208:209], v156 offset:0
    ds_read_b64_tr_b16 a[210:211], v156 offset:3072
    v_mfma_f32_16x16x32_bf16 v[20:23], a[232:235], a[16:19], v[20:23]
    ds_read_b64_tr_b16 a[212:213], v156 offset:6144
    v_mfma_f32_16x16x32_bf16 v[20:23], a[236:239], a[24:27], v[20:23]
    buffer_load_dwordx4 a[104:107], v140, s[44:47], s42 offen offset:1024 sc1
    v_mfma_f32_16x16x32_bf16 v[44:47], a[224:227], a[4:7], 0
    ds_read_b64_tr_b16 a[214:215], v156 offset:9216
    ds_read_b64_tr_b16 a[216:217], v156 offset:12288
    v_mfma_f32_16x16x32_bf16 v[44:47], a[228:231], a[12:15], v[44:47]
    ds_read_b64_tr_b16 a[218:219], v156 offset:15360
    v_mfma_f32_16x16x32_bf16 v[44:47], a[232:235], a[20:23], v[44:47]
    buffer_load_dwordx4 a[108:111], v140, s[48:51], s42 offen offset:1024 sc1
    v_mfma_f32_16x16x32_bf16 v[44:47], a[236:239], a[28:31], v[44:47]
    ds_read_b64_tr_b16 a[220:221], v156 offset:18432
    ds_read_b64_tr_b16 a[222:223], v156 offset:21504
    s_waitcnt lgkmcnt(8)
    v_mfma_f32_16x16x32_bf16 v[0:3], a[192:195], a[32:35], v[0:3]
    ds_read_b64_tr_b16 a[224:225], v155 offset:64
    v_mfma_f32_16x16x32_bf16 v[0:3], a[196:199], a[40:43], v[0:3]
    ds_read_b64_tr_b16 a[226:227], v155 offset:3136
    v_mfma_f32_16x16x32_bf16 v[0:3], a[200:203], a[48:51], v[0:3]
    ds_read_b64_tr_b16 a[228:229], v155 offset:6208
    v_mfma_f32_16x16x32_bf16 v[0:3], a[204:207], a[56:59], v[0:3]
    ds_read_b64_tr_b16 a[230:231], v155 offset:9280
    v_mfma_f32_16x16x32_bf16 v[24:27], a[192:195], a[36:39], v[24:27]
    ds_read_b64_tr_b16 a[232:233], v155 offset:12352
    v_mfma_f32_16x16x32_bf16 v[24:27], a[196:199], a[44:47], v[24:27]
    ds_read_b64_tr_b16 a[234:235], v155 offset:15424
    v_mfma_f32_16x16x32_bf16 v[24:27], a[200:203], a[52:55], v[24:27]
    ds_read_b64_tr_b16 a[236:237], v155 offset:18496
    v_mfma_f32_16x16x32_bf16 v[24:27], a[204:207], a[60:63], v[24:27]
    ds_read_b64_tr_b16 a[238:239], v155 offset:21568
    s_waitcnt lgkmcnt(8)
    v_mfma_f32_16x16x32_bf16 v[4:7], a[208:211], a[32:35], v[4:7]
    ds_read_b64_tr_b16 a[192:193], v156 offset:64
    v_mfma_f32_16x16x32_bf16 v[4:7], a[212:215], a[40:43], v[4:7]
    ds_read_b64_tr_b16 a[194:195], v156 offset:3136
    v_mfma_f32_16x16x32_bf16 v[4:7], a[216:219], a[48:51], v[4:7]
    ds_read_b64_tr_b16 a[196:197], v156 offset:6208
    v_mfma_f32_16x16x32_bf16 v[4:7], a[220:223], a[56:59], v[4:7]
    buffer_load_dwordx4 a[112:115], v140, s[44:47], s42 offen offset:2048 sc1
    v_mfma_f32_16x16x32_bf16 v[28:31], a[208:211], a[36:39], v[28:31]
    ds_read_b64_tr_b16 a[198:199], v156 offset:9280
    ds_read_b64_tr_b16 a[200:201], v156 offset:12352
    v_mfma_f32_16x16x32_bf16 v[28:31], a[212:215], a[44:47], v[28:31]
    ds_read_b64_tr_b16 a[202:203], v156 offset:15424
    v_mfma_f32_16x16x32_bf16 v[28:31], a[216:219], a[52:55], v[28:31]
    ds_read_b64_tr_b16 a[204:205], v156 offset:18496
    v_mfma_f32_16x16x32_bf16 v[28:31], a[220:223], a[60:63], v[28:31]
    ds_read_b64_tr_b16 a[206:207], v156 offset:21568
    s_waitcnt lgkmcnt(8)
    v_mfma_f32_16x16x32_bf16 v[8:11], a[224:227], a[32:35], v[8:11]
    buffer_load_dwordx4 a[116:119], v140, s[48:51], s42 offen offset:2048 sc1
    v_mfma_f32_16x16x32_bf16 v[8:11], a[228:231], a[40:43], v[8:11]
    ds_read_b64_tr_b16 a[208:209], v155 offset:128
    ds_read_b64_tr_b16 a[210:211], v155 offset:3200
    v_mfma_f32_16x16x32_bf16 v[8:11], a[232:235], a[48:51], v[8:11]
    ds_read_b64_tr_b16 a[212:213], v155 offset:6272
    v_mfma_f32_16x16x32_bf16 v[8:11], a[236:239], a[56:59], v[8:11]
    ds_read_b64_tr_b16 a[214:215], v155 offset:9344
    v_mfma_f32_16x16x32_bf16 v[32:35], a[224:227], a[36:39], v[32:35]
    buffer_load_dwordx4 a[120:123], v140, s[44:47], s42 offen offset:3072 sc1
    v_mfma_f32_16x16x32_bf16 v[32:35], a[228:231], a[44:47], v[32:35]
    ds_read_b64_tr_b16 a[216:217], v155 offset:12416
    ds_read_b64_tr_b16 a[218:219], v155 offset:15488
    v_mfma_f32_16x16x32_bf16 v[32:35], a[232:235], a[52:55], v[32:35]
    ds_read_b64_tr_b16 a[220:221], v155 offset:18560
    v_mfma_f32_16x16x32_bf16 v[32:35], a[236:239], a[60:63], v[32:35]
    ds_read_b64_tr_b16 a[222:223], v155 offset:21632
    s_waitcnt lgkmcnt(8)
    v_mfma_f32_16x16x32_bf16 v[12:15], a[192:195], a[32:35], v[12:15]
    ds_read_b64_tr_b16 a[224:225], v156 offset:128
    v_mfma_f32_16x16x32_bf16 v[12:15], a[196:199], a[40:43], v[12:15]
    buffer_load_dwordx4 a[124:127], v140, s[48:51], s42 offen offset:3072 sc1
    s_add_u32 s42, s42, 4096
    v_mfma_f32_16x16x32_bf16 v[12:15], a[200:203], a[48:51], v[12:15]
    ds_read_b64_tr_b16 a[226:227], v156 offset:3200
    ds_read_b64_tr_b16 a[228:229], v156 offset:6272
    v_mfma_f32_16x16x32_bf16 v[12:15], a[204:207], a[56:59], v[12:15]
    ds_read_b64_tr_b16 a[230:231], v156 offset:9344
    v_mfma_f32_16x16x32_bf16 v[36:39], a[192:195], a[36:39], v[36:39]
    ds_read_b64_tr_b16 a[232:233], v156 offset:12416
    v_mfma_f32_16x16x32_bf16 v[36:39], a[196:199], a[44:47], v[36:39]
    ds_read_b64_tr_b16 a[234:235], v156 offset:15488
    v_mfma_f32_16x16x32_bf16 v[36:39], a[200:203], a[52:55], v[36:39]
    ds_read_b64_tr_b16 a[236:237], v156 offset:18560
    v_mfma_f32_16x16x32_bf16 v[36:39], a[204:207], a[60:63], v[36:39]
    ds_read_b64_tr_b16 a[238:239], v156 offset:21632
    s_waitcnt vmcnt(10)
    s_waitcnt lgkmcnt(8)
    v_mfma_f32_16x16x32_bf16 v[16:19], a[208:211], a[32:35], v[16:19]
    s_add_u32 s35, s34, s39
    s_add_u32 s43, s35, 4096
    s_add_u32 m0, s39, 24576
    s_nop 0
    buffer_load_dwordx4 v140, s[8:11], s35 offen offset:0  lds
    v_mfma_f32_16x16x32_bf16 v[16:19], a[212:215], a[40:43], v[16:19]
    ds_read_b64_tr_b16 a[192:193], v155 offset:24576
    ds_read_b64_tr_b16 a[194:195], v155 offset:27648
    v_mfma_f32_16x16x32_bf16 v[16:19], a[216:219], a[48:51], v[16:19]
    buffer_load_dwordx4 v140, s[8:11], s35 offen offset:1024  lds
    v_mfma_f32_16x16x32_bf16 v[16:19], a[220:223], a[56:59], v[16:19]
    ds_read_b64_tr_b16 a[196:197], v155 offset:30720
    ds_read_b64_tr_b16 a[198:199], v155 offset:33792
    v_mfma_f32_16x16x32_bf16 v[40:43], a[208:211], a[36:39], v[40:43]
    ds_read_b64_tr_b16 a[200:201], v155 offset:36864
    v_mfma_f32_16x16x32_bf16 v[40:43], a[212:215], a[44:47], v[40:43]
    buffer_load_dwordx4 v140, s[8:11], s35 offen offset:2048  lds
    v_mfma_f32_16x16x32_bf16 v[40:43], a[216:219], a[52:55], v[40:43]
    ds_read_b64_tr_b16 a[202:203], v155 offset:39936
    ds_read_b64_tr_b16 a[204:205], v155 offset:43008
    v_mfma_f32_16x16x32_bf16 v[40:43], a[220:223], a[60:63], v[40:43]
    ds_read_b64_tr_b16 a[206:207], v155 offset:46080
    s_waitcnt lgkmcnt(8)
    v_mfma_f32_16x16x32_bf16 v[20:23], a[224:227], a[32:35], v[20:23]
    buffer_load_dwordx4 v140, s[8:11], s35 offen offset:3072  lds
    s_add_u32 m0, s39, 28672
    s_nop 0
    v_mfma_f32_16x16x32_bf16 v[20:23], a[228:231], a[40:43], v[20:23]
    ds_read_b64_tr_b16 a[208:209], v156 offset:24576
    ds_read_b64_tr_b16 a[210:211], v156 offset:27648
    v_mfma_f32_16x16x32_bf16 v[20:23], a[232:235], a[48:51], v[20:23]
    ds_read_b64_tr_b16 a[212:213], v156 offset:30720
    v_mfma_f32_16x16x32_bf16 v[20:23], a[236:239], a[56:59], v[20:23]
    buffer_load_dwordx4 v140, s[8:11], s43 offen offset:0  lds
    v_mfma_f32_16x16x32_bf16 v[44:47], a[224:227], a[36:39], v[44:47]
    ds_read_b64_tr_b16 a[214:215], v156 offset:33792
    ds_read_b64_tr_b16 a[216:217], v156 offset:36864
    v_mfma_f32_16x16x32_bf16 v[44:47], a[228:231], a[44:47], v[44:47]
    ds_read_b64_tr_b16 a[218:219], v156 offset:39936
    v_mfma_f32_16x16x32_bf16 v[44:47], a[232:235], a[52:55], v[44:47]
    buffer_load_dwordx4 v140, s[8:11], s43 offen offset:1024  lds
    s_add_u32 s34, s34, 24576
    v_mfma_f32_16x16x32_bf16 v[44:47], a[236:239], a[60:63], v[44:47]
    ds_read_b64_tr_b16 a[220:221], v156 offset:43008
    ds_read_b64_tr_b16 a[222:223], v156 offset:46080
    s_waitcnt lgkmcnt(8)
    v_mfma_f32_16x16x32_bf16 v[0:3], a[192:195], a[64:67], v[0:3]
    ds_read_b64_tr_b16 a[224:225], v155 offset:24640
    v_mfma_f32_16x16x32_bf16 v[0:3], a[196:199], a[72:75], v[0:3]
    buffer_load_dwordx4 a[0:3], v140, s[44:47], s42 offen offset:0 sc1
    v_mfma_f32_16x16x32_bf16 v[0:3], a[200:203], a[80:83], v[0:3]
    ds_read_b64_tr_b16 a[226:227], v155 offset:27712
    ds_read_b64_tr_b16 a[228:229], v155 offset:30784
    v_mfma_f32_16x16x32_bf16 v[0:3], a[204:207], a[88:91], v[0:3]
    ds_read_b64_tr_b16 a[230:231], v155 offset:33856
    v_mfma_f32_16x16x32_bf16 v[24:27], a[192:195], a[68:71], v[24:27]
    buffer_load_dwordx4 a[4:7], v140, s[48:51], s42 offen offset:0 sc1
    v_mfma_f32_16x16x32_bf16 v[24:27], a[196:199], a[76:79], v[24:27]
    ds_read_b64_tr_b16 a[232:233], v155 offset:36928
    ds_read_b64_tr_b16 a[234:235], v155 offset:40000
    v_mfma_f32_16x16x32_bf16 v[24:27], a[200:203], a[84:87], v[24:27]
    buffer_load_dwordx2 a[8:9], v157, s[44:47], s42 offen offset:1024 sc1
    v_mfma_f32_16x16x32_bf16 v[24:27], a[204:207], a[92:95], v[24:27]
    ds_read_b64_tr_b16 a[236:237], v155 offset:43072
    ds_read_b64_tr_b16 a[238:239], v155 offset:46144
    s_waitcnt lgkmcnt(8)
    v_mfma_f32_16x16x32_bf16 v[4:7], a[208:211], a[64:67], v[4:7]
    ds_read_b64_tr_b16 a[192:193], v156 offset:24640
    v_mfma_f32_16x16x32_bf16 v[4:7], a[212:215], a[72:75], v[4:7]
    buffer_load_dwordx2 a[10:11], v157, s[44:47], s42 offen offset:1536 sc1
    v_mfma_f32_16x16x32_bf16 v[4:7], a[216:219], a[80:83], v[4:7]
    ds_read_b64_tr_b16 a[194:195], v156 offset:27712
    ds_read_b64_tr_b16 a[196:197], v156 offset:30784
    v_mfma_f32_16x16x32_bf16 v[4:7], a[220:223], a[88:91], v[4:7]
    ds_read_b64_tr_b16 a[198:199], v156 offset:33856
    v_mfma_f32_16x16x32_bf16 v[28:31], a[208:211], a[68:71], v[28:31]
    buffer_load_dwordx2 a[12:13], v157, s[48:51], s42 offen offset:1024 sc1
    v_mfma_f32_16x16x32_bf16 v[28:31], a[212:215], a[76:79], v[28:31]
    ds_read_b64_tr_b16 a[200:201], v156 offset:36928
    ds_read_b64_tr_b16 a[202:203], v156 offset:40000
    v_mfma_f32_16x16x32_bf16 v[28:31], a[216:219], a[84:87], v[28:31]
    ds_read_b64_tr_b16 a[204:205], v156 offset:43072
    v_mfma_f32_16x16x32_bf16 v[28:31], a[220:223], a[92:95], v[28:31]
    buffer_load_dwordx2 a[14:15], v157, s[48:51], s42 offen offset:1536 sc1
    ds_read_b64_tr_b16 a[206:207], v156 offset:46144
    s_waitcnt lgkmcnt(8)
    v_mfma_f32_16x16x32_bf16 v[8:11], a[224:227], a[64:67], v[8:11]
    ds_read_b64_tr_b16 a[208:209], v155 offset:24704
    v_mfma_f32_16x16x32_bf16 v[8:11], a[228:231], a[72:75], v[8:11]
    ds_read_b64_tr_b16 a[210:211], v155 offset:27776
    v_mfma_f32_16x16x32_bf16 v[8:11], a[232:235], a[80:83], v[8:11]
    buffer_load_dwordx4 a[16:19], v140, s[44:47], s42 offen offset:2048 sc1
    v_mfma_f32_16x16x32_bf16 v[8:11], a[236:239], a[88:91], v[8:11]
    ds_read_b64_tr_b16 a[212:213], v155 offset:30848
    ds_read_b64_tr_b16 a[214:215], v155 offset:33920
    v_mfma_f32_16x16x32_bf16 v[32:35], a[224:227], a[68:71], v[32:35]
    ds_read_b64_tr_b16 a[216:217], v155 offset:36992
    v_mfma_f32_16x16x32_bf16 v[32:35], a[228:231], a[76:79], v[32:35]
    buffer_load_dwordx4 a[20:23], v140, s[48:51], s42 offen offset:2048 sc1
    v_mfma_f32_16x16x32_bf16 v[32:35], a[232:235], a[84:87], v[32:35]
    ds_read_b64_tr_b16 a[218:219], v155 offset:40064
    ds_read_b64_tr_b16 a[220:221], v155 offset:43136
    v_mfma_f32_16x16x32_bf16 v[32:35], a[236:239], a[92:95], v[32:35]
    ds_read_b64_tr_b16 a[222:223], v155 offset:46208
    s_waitcnt lgkmcnt(8)
    v_mfma_f32_16x16x32_bf16 v[12:15], a[192:195], a[64:67], v[12:15]
    buffer_load_dwordx4 a[24:27], v140, s[44:47], s42 offen offset:3072 sc1
    v_mfma_f32_16x16x32_bf16 v[12:15], a[196:199], a[72:75], v[12:15]
    ds_read_b64_tr_b16 a[224:225], v156 offset:24704
    ds_read_b64_tr_b16 a[226:227], v156 offset:27776
    v_mfma_f32_16x16x32_bf16 v[12:15], a[200:203], a[80:83], v[12:15]
    ds_read_b64_tr_b16 a[228:229], v156 offset:30848
    v_mfma_f32_16x16x32_bf16 v[12:15], a[204:207], a[88:91], v[12:15]
    buffer_load_dwordx4 a[28:31], v140, s[48:51], s42 offen offset:3072 sc1
    s_add_u32 s42, s42, 4096
    v_mfma_f32_16x16x32_bf16 v[36:39], a[192:195], a[68:71], v[36:39]
    ds_read_b64_tr_b16 a[230:231], v156 offset:33920
    ds_read_b64_tr_b16 a[232:233], v156 offset:36992
    v_mfma_f32_16x16x32_bf16 v[36:39], a[196:199], a[76:79], v[36:39]
    ds_read_b64_tr_b16 a[234:235], v156 offset:40064
    v_mfma_f32_16x16x32_bf16 v[36:39], a[200:203], a[84:87], v[36:39]
    ds_read_b64_tr_b16 a[236:237], v156 offset:43136
    v_mfma_f32_16x16x32_bf16 v[36:39], a[204:207], a[92:95], v[36:39]
    ds_read_b64_tr_b16 a[238:239], v156 offset:46208
    s_waitcnt vmcnt(16)
    s_waitcnt lgkmcnt(8)
    v_mfma_f32_16x16x32_bf16 v[16:19], a[208:211], a[64:67], v[16:19]
    buffer_load_dwordx2 v[48:49], v166, s[60:63], s4 offen offset:0 sc1
    v_mfma_f32_16x16x32_bf16 v[16:19], a[212:215], a[72:75], v[16:19]
    ds_read_b64_tr_b16 a[192:193], v151 offset:0
    ds_read_b64_tr_b16 a[194:195], v151 offset:3072
    v_mfma_f32_16x16x32_bf16 v[16:19], a[216:219], a[80:83], v[16:19]
    ds_read_b64_tr_b16 a[196:197], v151 offset:6144
    v_mfma_f32_16x16x32_bf16 v[16:19], a[220:223], a[88:91], v[16:19]
    ds_read_b64_tr_b16 a[198:199], v151 offset:9216
    v_mfma_f32_16x16x32_bf16 v[40:43], a[208:211], a[68:71], v[40:43]
    buffer_load_dwordx2 v[50:51], v166, s[60:63], s4 offen offset:128 sc1
    v_mfma_f32_16x16x32_bf16 v[40:43], a[212:215], a[76:79], v[40:43]
    ds_read_b64_tr_b16 a[200:201], v151 offset:12288
    ds_read_b64_tr_b16 a[202:203], v151 offset:15360
    v_mfma_f32_16x16x32_bf16 v[40:43], a[216:219], a[84:87], v[40:43]
    ds_read_b64_tr_b16 a[204:205], v151 offset:18432
    v_mfma_f32_16x16x32_bf16 v[40:43], a[220:223], a[92:95], v[40:43]
    ds_read_b64_tr_b16 a[206:207], v151 offset:21504
    s_waitcnt lgkmcnt(8)
    v_mfma_f32_16x16x32_bf16 v[20:23], a[224:227], a[64:67], v[20:23]
    ds_read_b64_tr_b16 a[208:209], v152 offset:0
    v_mfma_f32_16x16x32_bf16 v[20:23], a[228:231], a[72:75], v[20:23]
    buffer_load_dwordx2 v[52:53], v166, s[60:63], s15 offen offset:0 sc1
    v_mfma_f32_16x16x32_bf16 v[20:23], a[232:235], a[80:83], v[20:23]
    ds_read_b64_tr_b16 a[210:211], v152 offset:3072
    ds_read_b64_tr_b16 a[212:213], v152 offset:6144
    v_mfma_f32_16x16x32_bf16 v[20:23], a[236:239], a[88:91], v[20:23]
    ds_read_b64_tr_b16 a[214:215], v152 offset:9216
    v_mfma_f32_16x16x32_bf16 v[44:47], a[224:227], a[68:71], v[44:47]
    ds_read_b64_tr_b16 a[216:217], v152 offset:12288
    v_mfma_f32_16x16x32_bf16 v[44:47], a[228:231], a[76:79], v[44:47]
    buffer_load_dwordx2 v[54:55], v166, s[60:63], s15 offen offset:128 sc1
    v_mfma_f32_16x16x32_bf16 v[44:47], a[232:235], a[84:87], v[44:47]
    ds_read_b64_tr_b16 a[218:219], v152 offset:15360
    ds_read_b64_tr_b16 a[220:221], v152 offset:18432
    v_mfma_f32_16x16x32_bf16 v[44:47], a[236:239], a[92:95], v[44:47]
    ds_read_b64_tr_b16 a[222:223], v152 offset:21504
    s_waitcnt lgkmcnt(8)
    v_mfma_f32_16x16x32_bf16 v[0:3], a[192:195], a[96:99], v[0:3]
    ds_read_b64_tr_b16 a[224:225], v151 offset:64
    v_mfma_f32_16x16x32_bf16 v[0:3], a[196:199], a[104:107], v[0:3]
    ds_read_b64_tr_b16 a[226:227], v151 offset:3136
    v_mfma_f32_16x16x32_bf16 v[0:3], a[200:203], a[112:115], v[0:3]
    buffer_load_dwordx4 v[56:59], v167, s[28:31], s5 offen offset:0
    v_mfma_f32_16x16x32_bf16 v[0:3], a[204:207], a[120:123], v[0:3]
    ds_read_b64_tr_b16 a[228:229], v151 offset:6208
    ds_read_b64_tr_b16 a[230:231], v151 offset:9280
    v_mfma_f32_16x16x32_bf16 v[24:27], a[192:195], a[100:103], v[24:27]
    ds_read_b64_tr_b16 a[232:233], v151 offset:12352
    v_mfma_f32_16x16x32_bf16 v[24:27], a[196:199], a[108:111], v[24:27]
    ds_read_b64_tr_b16 a[234:235], v151 offset:15424
    v_mfma_f32_16x16x32_bf16 v[24:27], a[200:203], a[116:119], v[24:27]
    buffer_load_dwordx4 v[60:63], v167, s[28:31], s5 offen offset:64
    v_mfma_f32_16x16x32_bf16 v[24:27], a[204:207], a[124:127], v[24:27]
    ds_read_b64_tr_b16 a[236:237], v151 offset:18496
    ds_read_b64_tr_b16 a[238:239], v151 offset:21568
    s_waitcnt lgkmcnt(8)
    v_mfma_f32_16x16x32_bf16 v[4:7], a[208:211], a[96:99], v[4:7]
    ds_read_b64_tr_b16 a[192:193], v152 offset:64
    v_mfma_f32_16x16x32_bf16 v[4:7], a[212:215], a[104:107], v[4:7]
    ds_read_b64_tr_b16 a[194:195], v152 offset:3136
    v_mfma_f32_16x16x32_bf16 v[4:7], a[216:219], a[112:115], v[4:7]
    ds_read_b64_tr_b16 a[196:197], v152 offset:6208
    v_mfma_f32_16x16x32_bf16 v[4:7], a[220:223], a[120:123], v[4:7]
    buffer_load_dwordx4 v[64:67], v167, s[28:31], s5 offen offset:128
    v_mfma_f32_16x16x32_bf16 v[28:31], a[208:211], a[100:103], v[28:31]
    ds_read_b64_tr_b16 a[198:199], v152 offset:9280
    ds_read_b64_tr_b16 a[200:201], v152 offset:12352
    v_mfma_f32_16x16x32_bf16 v[28:31], a[212:215], a[108:111], v[28:31]
    ds_read_b64_tr_b16 a[202:203], v152 offset:15424
    v_mfma_f32_16x16x32_bf16 v[28:31], a[216:219], a[116:119], v[28:31]
    ds_read_b64_tr_b16 a[204:205], v152 offset:18496
    v_mfma_f32_16x16x32_bf16 v[28:31], a[220:223], a[124:127], v[28:31]
    ds_read_b64_tr_b16 a[206:207], v152 offset:21568
    s_waitcnt lgkmcnt(8)
    v_mfma_f32_16x16x32_bf16 v[8:11], a[224:227], a[96:99], v[8:11]
    buffer_load_dwordx4 v[68:71], v167, s[28:31], s5 offen offset:192
    v_mfma_f32_16x16x32_bf16 v[8:11], a[228:231], a[104:107], v[8:11]
    ds_read_b64_tr_b16 a[208:209], v151 offset:128
    ds_read_b64_tr_b16 a[210:211], v151 offset:3200
    v_mfma_f32_16x16x32_bf16 v[8:11], a[232:235], a[112:115], v[8:11]
    ds_read_b64_tr_b16 a[212:213], v151 offset:6272
    v_mfma_f32_16x16x32_bf16 v[8:11], a[236:239], a[120:123], v[8:11]
    ds_read_b64_tr_b16 a[214:215], v151 offset:9344
    v_mfma_f32_16x16x32_bf16 v[32:35], a[224:227], a[100:103], v[32:35]
    buffer_load_dwordx4 v[72:75], v167, s[28:31], s5 offen offset:256
    v_mfma_f32_16x16x32_bf16 v[32:35], a[228:231], a[108:111], v[32:35]
    ds_read_b64_tr_b16 a[216:217], v151 offset:12416
    ds_read_b64_tr_b16 a[218:219], v151 offset:15488
    v_mfma_f32_16x16x32_bf16 v[32:35], a[232:235], a[116:119], v[32:35]
    ds_read_b64_tr_b16 a[220:221], v151 offset:18560
    v_mfma_f32_16x16x32_bf16 v[32:35], a[236:239], a[124:127], v[32:35]
    ds_read_b64_tr_b16 a[222:223], v151 offset:21632
    s_waitcnt lgkmcnt(8)
    v_mfma_f32_16x16x32_bf16 v[12:15], a[192:195], a[96:99], v[12:15]
    ds_read_b64_tr_b16 a[224:225], v152 offset:128
    v_mfma_f32_16x16x32_bf16 v[12:15], a[196:199], a[104:107], v[12:15]
    buffer_load_dwordx4 v[76:79], v167, s[28:31], s5 offen offset:320
    v_mfma_f32_16x16x32_bf16 v[12:15], a[200:203], a[112:115], v[12:15]
    ds_read_b64_tr_b16 a[226:227], v152 offset:3200
    ds_read_b64_tr_b16 a[228:229], v152 offset:6272
    v_mfma_f32_16x16x32_bf16 v[12:15], a[204:207], a[120:123], v[12:15]
    ds_read_b64_tr_b16 a[230:231], v152 offset:9344
    v_mfma_f32_16x16x32_bf16 v[36:39], a[192:195], a[100:103], v[36:39]
    ds_read_b64_tr_b16 a[232:233], v152 offset:12416
    v_mfma_f32_16x16x32_bf16 v[36:39], a[196:199], a[108:111], v[36:39]
    ds_read_b64_tr_b16 a[234:235], v152 offset:15488
    v_mfma_f32_16x16x32_bf16 v[36:39], a[200:203], a[116:119], v[36:39]
    ds_read_b64_tr_b16 a[236:237], v152 offset:18560
    v_mfma_f32_16x16x32_bf16 v[36:39], a[204:207], a[124:127], v[36:39]
    ds_read_b64_tr_b16 a[238:239], v152 offset:21632
    s_waitcnt vmcnt(10)
    s_barrier
    s_waitcnt lgkmcnt(8)
    v_mfma_f32_16x16x32_bf16 v[16:19], a[208:211], a[96:99], v[16:19]
    ds_read_b64_tr_b16 a[192:193], v151 offset:24576
    v_mfma_f32_16x16x32_bf16 v[16:19], a[212:215], a[104:107], v[16:19]
    ds_read_b64_tr_b16 a[194:195], v151 offset:27648
    v_mfma_f32_16x16x32_bf16 v[16:19], a[216:219], a[112:115], v[16:19]
    ds_read_b64_tr_b16 a[196:197], v151 offset:30720
    v_mfma_f32_16x16x32_bf16 v[16:19], a[220:223], a[120:123], v[16:19]
    ds_read_b64_tr_b16 a[198:199], v151 offset:33792
    v_mfma_f32_16x16x32_bf16 v[40:43], a[208:211], a[100:103], v[40:43]
    ds_read_b64_tr_b16 a[200:201], v151 offset:36864
    v_mfma_f32_16x16x32_bf16 v[40:43], a[212:215], a[108:111], v[40:43]
    ds_read_b64_tr_b16 a[202:203], v151 offset:39936
    v_mfma_f32_16x16x32_bf16 v[40:43], a[216:219], a[116:119], v[40:43]
    ds_read_b64_tr_b16 a[204:205], v151 offset:43008
    v_mfma_f32_16x16x32_bf16 v[40:43], a[220:223], a[124:127], v[40:43]
    ds_read_b64_tr_b16 a[206:207], v151 offset:46080
    s_waitcnt lgkmcnt(8)
    v_mfma_f32_16x16x32_bf16 v[20:23], a[224:227], a[96:99], v[20:23]
    ds_read_b64_tr_b16 a[208:209], v152 offset:24576
    v_mfma_f32_16x16x32_bf16 v[20:23], a[228:231], a[104:107], v[20:23]
    ds_read_b64_tr_b16 a[210:211], v152 offset:27648
    v_mfma_f32_16x16x32_bf16 v[20:23], a[232:235], a[112:115], v[20:23]
    ds_read_b64_tr_b16 a[212:213], v152 offset:30720
    v_mfma_f32_16x16x32_bf16 v[20:23], a[236:239], a[120:123], v[20:23]
    ds_read_b64_tr_b16 a[214:215], v152 offset:33792
    v_mfma_f32_16x16x32_bf16 v[44:47], a[224:227], a[100:103], v[44:47]
    ds_read_b64_tr_b16 a[216:217], v152 offset:36864
    v_mfma_f32_16x16x32_bf16 v[44:47], a[228:231], a[108:111], v[44:47]
    ds_read_b64_tr_b16 a[218:219], v152 offset:39936
    v_mfma_f32_16x16x32_bf16 v[44:47], a[232:235], a[116:119], v[44:47]
    ds_read_b64_tr_b16 a[220:221], v152 offset:43008
    v_mfma_f32_16x16x32_bf16 v[44:47], a[236:239], a[124:127], v[44:47]
    ds_read_b64_tr_b16 a[222:223], v152 offset:46080
    s_waitcnt lgkmcnt(8)
    v_mfma_f32_16x16x32_bf16 v[0:3], a[192:195], a[0:3], v[0:3]
    ds_read_b64_tr_b16 a[224:225], v151 offset:24640
    v_mfma_f32_16x16x32_bf16 v[0:3], a[196:199], a[8:11], v[0:3]
    ds_read_b64_tr_b16 a[226:227], v151 offset:27712
    v_mfma_f32_16x16x32_bf16 v[0:3], a[200:203], a[16:19], v[0:3]
    ds_read_b64_tr_b16 a[228:229], v151 offset:30784
    v_mfma_f32_16x16x32_bf16 v[0:3], a[204:207], a[24:27], v[0:3]
    ds_read_b64_tr_b16 a[230:231], v151 offset:33856
    v_mfma_f32_16x16x32_bf16 v[24:27], a[192:195], a[4:7], v[24:27]
    ds_read_b64_tr_b16 a[232:233], v151 offset:36928
    v_mfma_f32_16x16x32_bf16 v[24:27], a[196:199], a[12:15], v[24:27]
    ds_read_b64_tr_b16 a[234:235], v151 offset:40000
    v_mfma_f32_16x16x32_bf16 v[24:27], a[200:203], a[20:23], v[24:27]
    ds_read_b64_tr_b16 a[236:237], v151 offset:43072
    v_mfma_f32_16x16x32_bf16 v[24:27], a[204:207], a[28:31], v[24:27]
    ds_read_b64_tr_b16 a[238:239], v151 offset:46144
    s_waitcnt lgkmcnt(8)
    v_mfma_f32_16x16x32_bf16 v[4:7], a[208:211], a[0:3], v[4:7]
    ds_read_b64_tr_b16 a[192:193], v152 offset:24640
    v_mfma_f32_16x16x32_bf16 v[4:7], a[212:215], a[8:11], v[4:7]
    ds_read_b64_tr_b16 a[194:195], v152 offset:27712
    v_mfma_f32_16x16x32_bf16 v[4:7], a[216:219], a[16:19], v[4:7]
    ds_read_b64_tr_b16 a[196:197], v152 offset:30784
    v_mfma_f32_16x16x32_bf16 v[4:7], a[220:223], a[24:27], v[4:7]
    ds_read_b64_tr_b16 a[198:199], v152 offset:33856
    v_mfma_f32_16x16x32_bf16 v[28:31], a[208:211], a[4:7], v[28:31]
    ds_read_b64_tr_b16 a[200:201], v152 offset:36928
    v_mfma_f32_16x16x32_bf16 v[28:31], a[212:215], a[12:15], v[28:31]
    ds_read_b64_tr_b16 a[202:203], v152 offset:40000
    v_mfma_f32_16x16x32_bf16 v[28:31], a[216:219], a[20:23], v[28:31]
    ds_read_b64_tr_b16 a[204:205], v152 offset:43072
    v_mfma_f32_16x16x32_bf16 v[28:31], a[220:223], a[28:31], v[28:31]
    ds_read_b64_tr_b16 a[206:207], v152 offset:46144
    s_waitcnt lgkmcnt(8)
    v_mfma_f32_16x16x32_bf16 v[8:11], a[224:227], a[0:3], v[8:11]
    ds_read_b64_tr_b16 a[208:209], v151 offset:24704
    v_mfma_f32_16x16x32_bf16 v[8:11], a[228:231], a[8:11], v[8:11]
    ds_read_b64_tr_b16 a[210:211], v151 offset:27776
    v_mfma_f32_16x16x32_bf16 v[8:11], a[232:235], a[16:19], v[8:11]
    ds_read_b64_tr_b16 a[212:213], v151 offset:30848
    v_mfma_f32_16x16x32_bf16 v[8:11], a[236:239], a[24:27], v[8:11]
    ds_read_b64_tr_b16 a[214:215], v151 offset:33920
    v_mfma_f32_16x16x32_bf16 v[32:35], a[224:227], a[4:7], v[32:35]
    ds_read_b64_tr_b16 a[216:217], v151 offset:36992
    v_mfma_f32_16x16x32_bf16 v[32:35], a[228:231], a[12:15], v[32:35]
    ds_read_b64_tr_b16 a[218:219], v151 offset:40064
    v_mfma_f32_16x16x32_bf16 v[32:35], a[232:235], a[20:23], v[32:35]
    ds_read_b64_tr_b16 a[220:221], v151 offset:43136
    v_mfma_f32_16x16x32_bf16 v[32:35], a[236:239], a[28:31], v[32:35]
    ds_read_b64_tr_b16 a[222:223], v151 offset:46208
    s_waitcnt lgkmcnt(8)
    v_mfma_f32_16x16x32_bf16 v[12:15], a[192:195], a[0:3], v[12:15]
    ds_read_b64_tr_b16 a[224:225], v152 offset:24704
    v_mfma_f32_16x16x32_bf16 v[12:15], a[196:199], a[8:11], v[12:15]
    ds_read_b64_tr_b16 a[226:227], v152 offset:27776
    v_mfma_f32_16x16x32_bf16 v[12:15], a[200:203], a[16:19], v[12:15]
    ds_read_b64_tr_b16 a[228:229], v152 offset:30848
    v_mfma_f32_16x16x32_bf16 v[12:15], a[204:207], a[24:27], v[12:15]
    ds_read_b64_tr_b16 a[230:231], v152 offset:33920
    v_mfma_f32_16x16x32_bf16 v[36:39], a[192:195], a[4:7], v[36:39]
    ds_read_b64_tr_b16 a[232:233], v152 offset:36992
    v_mfma_f32_16x16x32_bf16 v[36:39], a[196:199], a[12:15], v[36:39]
    ds_read_b64_tr_b16 a[234:235], v152 offset:40064
    v_mfma_f32_16x16x32_bf16 v[36:39], a[200:203], a[20:23], v[36:39]
    ds_read_b64_tr_b16 a[236:237], v152 offset:43136
    v_mfma_f32_16x16x32_bf16 v[36:39], a[204:207], a[28:31], v[36:39]
    ds_read_b64_tr_b16 a[238:239], v152 offset:46208
    s_waitcnt lgkmcnt(8)
    v_mfma_f32_16x16x32_bf16 v[16:19], a[208:211], a[0:3], v[16:19]
    v_mfma_f32_16x16x32_bf16 v[16:19], a[212:215], a[8:11], v[16:19]
    v_mfma_f32_16x16x32_bf16 v[16:19], a[216:219], a[16:19], v[16:19]
    v_mfma_f32_16x16x32_bf16 v[16:19], a[220:223], a[24:27], v[16:19]
    v_mfma_f32_16x16x32_bf16 v[40:43], a[208:211], a[4:7], v[40:43]
    v_mfma_f32_16x16x32_bf16 v[40:43], a[212:215], a[12:15], v[40:43]
    v_mfma_f32_16x16x32_bf16 v[40:43], a[216:219], a[20:23], v[40:43]
    v_mfma_f32_16x16x32_bf16 v[40:43], a[220:223], a[28:31], v[40:43]
    s_waitcnt lgkmcnt(0)
    v_mfma_f32_16x16x32_bf16 v[20:23], a[224:227], a[0:3], v[20:23]
    v_mfma_f32_16x16x32_bf16 v[20:23], a[228:231], a[8:11], v[20:23]
    v_mfma_f32_16x16x32_bf16 v[20:23], a[232:235], a[16:19], v[20:23]
    v_mfma_f32_16x16x32_bf16 v[20:23], a[236:239], a[24:27], v[20:23]
    v_mfma_f32_16x16x32_bf16 v[44:47], a[224:227], a[4:7], v[44:47]
    v_mfma_f32_16x16x32_bf16 v[44:47], a[228:231], a[12:15], v[44:47]
    v_mfma_f32_16x16x32_bf16 v[44:47], a[232:235], a[20:23], v[44:47]
    v_mfma_f32_16x16x32_bf16 v[44:47], a[236:239], a[28:31], v[44:47]
    s_mov_b32 s34, 0
    s_add_u32 s8, s6, s20
    s_addc_u32 s9, s7, 0
    s_mov_b32 s10, 245760
    s_mov_b32 s11, 0x20000
    s_add_u32 s35, s34, s38
    s_add_u32 s43, s35, 4096
    s_add_u32 m0, s38, 49152
    s_nop 0
    buffer_load_dwordx4 v140, s[8:11], s35 offen offset:0  lds
    s_waitcnt vmcnt(1)
    v_add_f32 v48, v48, v50
    v_add_f32 v49, v49, v51
    v_add_f32 v52, v52, v54
    v_add_f32 v53, v53, v55
    v_mov_b32 v88, v48
    buffer_load_dwordx4 v140, s[8:11], s35 offen offset:1024  lds
    v_mov_b32 v89, v49
    v_mov_b32 v90, v52
    v_mov_b32 v91, v53
    v_permlane32_swap_b32 v48, v88
    v_permlane32_swap_b32 v49, v89
    v_permlane32_swap_b32 v52, v90
    buffer_load_dwordx4 v140, s[8:11], s35 offen offset:2048  lds
    v_permlane32_swap_b32 v53, v91
    v_add_f32 v48, v48, v88
    v_add_f32 v49, v49, v89
    v_add_f32 v52, v52, v90
    v_add_f32 v53, v53, v91
    v_mov_b32 v88, v48
    buffer_load_dwordx4 v140, s[8:11], s35 offen offset:3072  lds
    s_add_u32 m0, s38, 53248
    s_nop 0
    v_mov_b32 v89, v49
    v_mov_b32 v90, v52
    v_mov_b32 v91, v53
    v_permlane16_swap_b32 v48, v88
    v_permlane16_swap_b32 v49, v89
    v_permlane16_swap_b32 v52, v90
    buffer_load_dwordx4 v140, s[8:11], s43 offen offset:0  lds
    s_add_u32 s34, s34, 20480
    s_add_u32 s35, s34, s38
    s_add_u32 s43, s35, 4096
    s_add_u32 m0, s38, 73728
    s_nop 0
    v_permlane16_swap_b32 v53, v91
    v_add_f32 v48, v48, v88
    v_add_f32 v49, v49, v89
    v_add_f32 v52, v52, v90
    v_add_f32 v53, v53, v91
    v_mul_f32 v48, 0x3acccccd, v48
    buffer_load_dwordx4 v140, s[8:11], s35 offen offset:0  lds
    v_mul_f32 v49, 0x3acccccd, v49
    v_fma_f32 v49, -v48, v48, v49
    v_max_f32 v49, 0, v49
    v_add_f32 v49, 0x3727c5ac, v49
    v_rsq_f32 v49, v49
    v_mul_f32 v52, 0x3acccccd, v52
    buffer_load_dwordx4 v140, s[8:11], s35 offen offset:1024  lds
    v_mul_f32 v53, 0x3acccccd, v53
    v_fma_f32 v53, -v52, v52, v53
    v_max_f32 v53, 0, v53
    v_add_f32 v53, 0x3727c5ac, v53
    v_rsq_f32 v53, v53
    v_pk_fma_f32 v[0:1], v[48:49], v[56:57], v[0:1] op_sel_hi:[0,1,1] neg_lo:[1,0,0] neg_hi:[1,0,0]
    buffer_load_dwordx4 v140, s[8:11], s35 offen offset:2048  lds
    v_pk_fma_f32 v[2:3], v[48:49], v[58:59], v[2:3] op_sel_hi:[0,1,1] neg_lo:[1,0,0] neg_hi:[1,0,0]
    v_pk_fma_f32 v[4:5], v[48:49], v[60:61], v[4:5] op_sel_hi:[0,1,1] neg_lo:[1,0,0] neg_hi:[1,0,0]
    v_pk_fma_f32 v[6:7], v[48:49], v[62:63], v[6:7] op_sel_hi:[0,1,1] neg_lo:[1,0,0] neg_hi:[1,0,0]
    v_pk_fma_f32 v[8:9], v[48:49], v[64:65], v[8:9] op_sel_hi:[0,1,1] neg_lo:[1,0,0] neg_hi:[1,0,0]
    v_pk_fma_f32 v[10:11], v[48:49], v[66:67], v[10:11] op_sel_hi:[0,1,1] neg_lo:[1,0,0] neg_hi:[1,0,0]
    v_pk_fma_f32 v[12:13], v[48:49], v[68:69], v[12:13] op_sel_hi:[0,1,1] neg_lo:[1,0,0] neg_hi:[1,0,0]
    buffer_load_dwordx4 v140, s[8:11], s35 offen offset:3072  lds
    s_add_u32 m0, s38, 77824
    s_nop 0
    v_pk_fma_f32 v[14:15], v[48:49], v[70:71], v[14:15] op_sel_hi:[0,1,1] neg_lo:[1,0,0] neg_hi:[1,0,0]
    v_pk_fma_f32 v[16:17], v[48:49], v[72:73], v[16:17] op_sel_hi:[0,1,1] neg_lo:[1,0,0] neg_hi:[1,0,0]
    v_pk_fma_f32 v[18:19], v[48:49], v[74:75], v[18:19] op_sel_hi:[0,1,1] neg_lo:[1,0,0] neg_hi:[1,0,0]
    v_pk_fma_f32 v[20:21], v[48:49], v[76:77], v[20:21] op_sel_hi:[0,1,1] neg_lo:[1,0,0] neg_hi:[1,0,0]
    v_pk_fma_f32 v[22:23], v[48:49], v[78:79], v[22:23] op_sel_hi:[0,1,1] neg_lo:[1,0,0] neg_hi:[1,0,0]
    v_pk_mul_f32 v[0:1], v[0:1], v[48:49] op_sel:[0,1] op_sel_hi:[1,1]
    buffer_load_dwordx4 v140, s[8:11], s43 offen offset:0  lds
    s_add_u32 s34, s34, 20480
    v_pk_mul_f32 v[2:3], v[2:3], v[48:49] op_sel:[0,1] op_sel_hi:[1,1]
    v_pk_mul_f32 v[4:5], v[4:5], v[48:49] op_sel:[0,1] op_sel_hi:[1,1]
    v_pk_mul_f32 v[6:7], v[6:7], v[48:49] op_sel:[0,1] op_sel_hi:[1,1]
    v_pk_mul_f32 v[8:9], v[8:9], v[48:49] op_sel:[0,1] op_sel_hi:[1,1]
    v_pk_mul_f32 v[10:11], v[10:11], v[48:49] op_sel:[0,1] op_sel_hi:[1,1]
    v_pk_mul_f32 v[12:13], v[12:13], v[48:49] op_sel:[0,1] op_sel_hi:[1,1]
    v_pk_mul_f32 v[14:15], v[14:15], v[48:49] op_sel:[0,1] op_sel_hi:[1,1]
    v_pk_mul_f32 v[16:17], v[16:17], v[48:49] op_sel:[0,1] op_sel_hi:[1,1]
    v_pk_mul_f32 v[18:19], v[18:19], v[48:49] op_sel:[0,1] op_sel_hi:[1,1]
    v_pk_mul_f32 v[20:21], v[20:21], v[48:49] op_sel:[0,1] op_sel_hi:[1,1]
    v_pk_mul_f32 v[22:23], v[22:23], v[48:49] op_sel:[0,1] op_sel_hi:[1,1]
    v_pk_fma_f32 v[24:25], v[52:53], v[56:57], v[24:25] op_sel_hi:[0,1,1] neg_lo:[1,0,0] neg_hi:[1,0,0]
    v_pk_fma_f32 v[26:27], v[52:53], v[58:59], v[26:27] op_sel_hi:[0,1,1] neg_lo:[1,0,0] neg_hi:[1,0,0]
    v_pk_fma_f32 v[28:29], v[52:53], v[60:61], v[28:29] op_sel_hi:[0,1,1] neg_lo:[1,0,0] neg_hi:[1,0,0]
    v_pk_fma_f32 v[30:31], v[52:53], v[62:63], v[30:31] op_sel_hi:[0,1,1] neg_lo:[1,0,0] neg_hi:[1,0,0]
    v_pk_fma_f32 v[32:33], v[52:53], v[64:65], v[32:33] op_sel_hi:[0,1,1] neg_lo:[1,0,0] neg_hi:[1,0,0]
    v_pk_fma_f32 v[34:35], v[52:53], v[66:67], v[34:35] op_sel_hi:[0,1,1] neg_lo:[1,0,0] neg_hi:[1,0,0]
    v_pk_fma_f32 v[36:37], v[52:53], v[68:69], v[36:37] op_sel_hi:[0,1,1] neg_lo:[1,0,0] neg_hi:[1,0,0]
    v_pk_fma_f32 v[38:39], v[52:53], v[70:71], v[38:39] op_sel_hi:[0,1,1] neg_lo:[1,0,0] neg_hi:[1,0,0]
    v_pk_fma_f32 v[40:41], v[52:53], v[72:73], v[40:41] op_sel_hi:[0,1,1] neg_lo:[1,0,0] neg_hi:[1,0,0]
    v_pk_fma_f32 v[42:43], v[52:53], v[74:75], v[42:43] op_sel_hi:[0,1,1] neg_lo:[1,0,0] neg_hi:[1,0,0]
    v_pk_fma_f32 v[44:45], v[52:53], v[76:77], v[44:45] op_sel_hi:[0,1,1] neg_lo:[1,0,0] neg_hi:[1,0,0]
    v_pk_fma_f32 v[46:47], v[52:53], v[78:79], v[46:47] op_sel_hi:[0,1,1] neg_lo:[1,0,0] neg_hi:[1,0,0]
    v_pk_mul_f32 v[24:25], v[24:25], v[52:53] op_sel:[0,1] op_sel_hi:[1,1]
    v_pk_mul_f32 v[26:27], v[26:27], v[52:53] op_sel:[0,1] op_sel_hi:[1,1]
    v_pk_mul_f32 v[28:29], v[28:29], v[52:53] op_sel:[0,1] op_sel_hi:[1,1]
    v_pk_mul_f32 v[30:31], v[30:31], v[52:53] op_sel:[0,1] op_sel_hi:[1,1]
    v_pk_mul_f32 v[32:33], v[32:33], v[52:53] op_sel:[0,1] op_sel_hi:[1,1]
    v_pk_mul_f32 v[34:35], v[34:35], v[52:53] op_sel:[0,1] op_sel_hi:[1,1]
    v_pk_mul_f32 v[36:37], v[36:37], v[52:53] op_sel:[0,1] op_sel_hi:[1,1]
    v_pk_mul_f32 v[38:39], v[38:39], v[52:53] op_sel:[0,1] op_sel_hi:[1,1]
    v_pk_mul_f32 v[40:41], v[40:41], v[52:53] op_sel:[0,1] op_sel_hi:[1,1]
    v_pk_mul_f32 v[42:43], v[42:43], v[52:53] op_sel:[0,1] op_sel_hi:[1,1]
    v_pk_mul_f32 v[44:45], v[44:45], v[52:53] op_sel:[0,1] op_sel_hi:[1,1]
    v_pk_mul_f32 v[46:47], v[46:47], v[52:53] op_sel:[0,1] op_sel_hi:[1,1]
    v_pk_mul_f32 v[88:89], v[0:1], v[0:1]
    v_pk_mul_f32 v[90:91], v[2:3], v[2:3]
    v_pk_mul_f32 v[92:93], v[4:5], v[4:5]
    v_pk_mul_f32 v[94:95], v[6:7], v[6:7]
    v_pk_fma_f32 v[88:89], v[88:89], v[188:189], v[188:189] op_sel:[0,0,1] op_sel_hi:[1,0,1]
    v_pk_fma_f32 v[90:91], v[90:91], v[188:189], v[188:189] op_sel:[0,0,1] op_sel_hi:[1,0,1]
    v_pk_fma_f32 v[92:93], v[92:93], v[188:189], v[188:189] op_sel:[0,0,1] op_sel_hi:[1,0,1]
    v_pk_fma_f32 v[94:95], v[94:95], v[188:189], v[188:189] op_sel:[0,0,1] op_sel_hi:[1,0,1]
    v_pk_mul_f32 v[88:89], v[88:89], v[0:1]
    v_pk_mul_f32 v[90:91], v[90:91], v[2:3]
    v_pk_mul_f32 v[92:93], v[92:93], v[4:5]
    v_pk_mul_f32 v[94:95], v[94:95], v[6:7]
    v_exp_f32 v88, v88
    v_exp_f32 v89, v89
    v_exp_f32 v90, v90
    v_exp_f32 v91, v91
    v_exp_f32 v92, v92
    v_exp_f32 v93, v93
    v_exp_f32 v94, v94
    v_exp_f32 v95, v95
    v_pk_add_f32 v[88:89], v[88:89], 1.0 op_sel_hi:[1,0]
    v_pk_add_f32 v[90:91], v[90:91], 1.0 op_sel_hi:[1,0]
    v_pk_add_f32 v[92:93], v[92:93], 1.0 op_sel_hi:[1,0]
    v_pk_add_f32 v[94:95], v[94:95], 1.0 op_sel_hi:[1,0]
    v_rcp_f32 v88, v88
    v_rcp_f32 v89, v89
    v_rcp_f32 v90, v90
    v_rcp_f32 v91, v91
    v_rcp_f32 v92, v92
    v_rcp_f32 v93, v93
    v_rcp_f32 v94, v94
    v_rcp_f32 v95, v95
    v_pk_mul_f32 v[0:1], v[0:1], v[88:89]
    v_pk_mul_f32 v[2:3], v[2:3], v[90:91]
    v_pk_mul_f32 v[4:5], v[4:5], v[92:93]
    v_pk_mul_f32 v[6:7], v[6:7], v[94:95]
    v_cvt_pk_bf16_f32 v100, v0, v1
    v_cvt_pk_bf16_f32 v101, v2, v3
    v_cvt_pk_bf16_f32 v102, v4, v5
    v_cvt_pk_bf16_f32 v103, v6, v7
    buffer_store_dwordx4 v[100:103], v140, s[84:87], s41 offen offset:0 sc1
    v_pk_mul_f32 v[88:89], v[8:9], v[8:9]
    v_pk_mul_f32 v[90:91], v[10:11], v[10:11]
    v_pk_mul_f32 v[92:93], v[12:13], v[12:13]
    v_pk_mul_f32 v[94:95], v[14:15], v[14:15]
    v_pk_fma_f32 v[88:89], v[88:89], v[188:189], v[188:189] op_sel:[0,0,1] op_sel_hi:[1,0,1]
    v_pk_fma_f32 v[90:91], v[90:91], v[188:189], v[188:189] op_sel:[0,0,1] op_sel_hi:[1,0,1]
    v_pk_fma_f32 v[92:93], v[92:93], v[188:189], v[188:189] op_sel:[0,0,1] op_sel_hi:[1,0,1]
    v_pk_fma_f32 v[94:95], v[94:95], v[188:189], v[188:189] op_sel:[0,0,1] op_sel_hi:[1,0,1]
    v_pk_mul_f32 v[88:89], v[88:89], v[8:9]
    v_pk_mul_f32 v[90:91], v[90:91], v[10:11]
    v_pk_mul_f32 v[92:93], v[92:93], v[12:13]
    v_pk_mul_f32 v[94:95], v[94:95], v[14:15]
    v_exp_f32 v88, v88
    v_exp_f32 v89, v89
    v_exp_f32 v90, v90
    v_exp_f32 v91, v91
    v_exp_f32 v92, v92
    v_exp_f32 v93, v93
    v_exp_f32 v94, v94
    v_exp_f32 v95, v95
    v_pk_add_f32 v[88:89], v[88:89], 1.0 op_sel_hi:[1,0]
    v_pk_add_f32 v[90:91], v[90:91], 1.0 op_sel_hi:[1,0]
    v_pk_add_f32 v[92:93], v[92:93], 1.0 op_sel_hi:[1,0]
    v_pk_add_f32 v[94:95], v[94:95], 1.0 op_sel_hi:[1,0]
    v_rcp_f32 v88, v88
    v_rcp_f32 v89, v89
    v_rcp_f32 v90, v90
    v_rcp_f32 v91, v91
    v_rcp_f32 v92, v92
    v_rcp_f32 v93, v93
    v_rcp_f32 v94, v94
    v_rcp_f32 v95, v95
    v_pk_mul_f32 v[8:9], v[8:9], v[88:89]
    v_pk_mul_f32 v[10:11], v[10:11], v[90:91]
    v_pk_mul_f32 v[12:13], v[12:13], v[92:93]
    v_pk_mul_f32 v[14:15], v[14:15], v[94:95]
    v_cvt_pk_bf16_f32 v104, v8, v9
    v_cvt_pk_bf16_f32 v105, v10, v11
    v_cvt_pk_bf16_f32 v106, v12, v13
    v_cvt_pk_bf16_f32 v107, v14, v15
    buffer_store_dwordx4 v[104:107], v140, s[84:87], s41 offen offset:1024 sc1
    v_pk_mul_f32 v[88:89], v[16:17], v[16:17]
    v_pk_mul_f32 v[90:91], v[18:19], v[18:19]
    v_pk_mul_f32 v[92:93], v[20:21], v[20:21]
    v_pk_mul_f32 v[94:95], v[22:23], v[22:23]
    v_pk_fma_f32 v[88:89], v[88:89], v[188:189], v[188:189] op_sel:[0,0,1] op_sel_hi:[1,0,1]
    v_pk_fma_f32 v[90:91], v[90:91], v[188:189], v[188:189] op_sel:[0,0,1] op_sel_hi:[1,0,1]
    v_pk_fma_f32 v[92:93], v[92:93], v[188:189], v[188:189] op_sel:[0,0,1] op_sel_hi:[1,0,1]
    v_pk_fma_f32 v[94:95], v[94:95], v[188:189], v[188:189] op_sel:[0,0,1] op_sel_hi:[1,0,1]
    v_pk_mul_f32 v[88:89], v[88:89], v[16:17]
    v_pk_mul_f32 v[90:91], v[90:91], v[18:19]
    v_pk_mul_f32 v[92:93], v[92:93], v[20:21]
    v_pk_mul_f32 v[94:95], v[94:95], v[22:23]
    v_exp_f32 v88, v88
    v_exp_f32 v89, v89
    v_exp_f32 v90, v90
    v_exp_f32 v91, v91
    v_exp_f32 v92, v92
    v_exp_f32 v93, v93
    v_exp_f32 v94, v94
    v_exp_f32 v95, v95
    v_pk_add_f32 v[88:89], v[88:89], 1.0 op_sel_hi:[1,0]
    v_pk_add_f32 v[90:91], v[90:91], 1.0 op_sel_hi:[1,0]
    v_pk_add_f32 v[92:93], v[92:93], 1.0 op_sel_hi:[1,0]
    v_pk_add_f32 v[94:95], v[94:95], 1.0 op_sel_hi:[1,0]
    v_rcp_f32 v88, v88
    v_rcp_f32 v89, v89
    v_rcp_f32 v90, v90
    v_rcp_f32 v91, v91
    v_rcp_f32 v92, v92
    v_rcp_f32 v93, v93
    v_rcp_f32 v94, v94
    v_rcp_f32 v95, v95
    v_pk_mul_f32 v[16:17], v[16:17], v[88:89]
    v_pk_mul_f32 v[18:19], v[18:19], v[90:91]
    v_pk_mul_f32 v[20:21], v[20:21], v[92:93]
    v_pk_mul_f32 v[22:23], v[22:23], v[94:95]
    v_cvt_pk_bf16_f32 v108, v16, v17
    v_cvt_pk_bf16_f32 v109, v18, v19
    v_cvt_pk_bf16_f32 v110, v20, v21
    v_cvt_pk_bf16_f32 v111, v22, v23
    buffer_store_dwordx4 v[108:111], v140, s[84:87], s41 offen offset:2048 sc1
    v_pk_mul_f32 v[88:89], v[24:25], v[24:25]
    v_pk_mul_f32 v[90:91], v[26:27], v[26:27]
    v_pk_mul_f32 v[92:93], v[28:29], v[28:29]
    v_pk_mul_f32 v[94:95], v[30:31], v[30:31]
    v_pk_fma_f32 v[88:89], v[88:89], v[188:189], v[188:189] op_sel:[0,0,1] op_sel_hi:[1,0,1]
    v_pk_fma_f32 v[90:91], v[90:91], v[188:189], v[188:189] op_sel:[0,0,1] op_sel_hi:[1,0,1]
    v_pk_fma_f32 v[92:93], v[92:93], v[188:189], v[188:189] op_sel:[0,0,1] op_sel_hi:[1,0,1]
    v_pk_fma_f32 v[94:95], v[94:95], v[188:189], v[188:189] op_sel:[0,0,1] op_sel_hi:[1,0,1]
    v_pk_mul_f32 v[88:89], v[88:89], v[24:25]
    v_pk_mul_f32 v[90:91], v[90:91], v[26:27]
    v_pk_mul_f32 v[92:93], v[92:93], v[28:29]
    v_pk_mul_f32 v[94:95], v[94:95], v[30:31]
    v_exp_f32 v88, v88
    v_exp_f32 v89, v89
    v_exp_f32 v90, v90
    v_exp_f32 v91, v91
    v_exp_f32 v92, v92
    v_exp_f32 v93, v93
    v_exp_f32 v94, v94
    v_exp_f32 v95, v95
    v_pk_add_f32 v[88:89], v[88:89], 1.0 op_sel_hi:[1,0]
    v_pk_add_f32 v[90:91], v[90:91], 1.0 op_sel_hi:[1,0]
    v_pk_add_f32 v[92:93], v[92:93], 1.0 op_sel_hi:[1,0]
    v_pk_add_f32 v[94:95], v[94:95], 1.0 op_sel_hi:[1,0]
    v_rcp_f32 v88, v88
    v_rcp_f32 v89, v89
    v_rcp_f32 v90, v90
    v_rcp_f32 v91, v91
    v_rcp_f32 v92, v92
    v_rcp_f32 v93, v93
    v_rcp_f32 v94, v94
    v_rcp_f32 v95, v95
    v_pk_mul_f32 v[24:25], v[24:25], v[88:89]
    v_pk_mul_f32 v[26:27], v[26:27], v[90:91]
    v_pk_mul_f32 v[28:29], v[28:29], v[92:93]
    v_pk_mul_f32 v[30:31], v[30:31], v[94:95]
    v_cvt_pk_bf16_f32 v112, v24, v25
    v_cvt_pk_bf16_f32 v113, v26, v27
    v_cvt_pk_bf16_f32 v114, v28, v29
    v_cvt_pk_bf16_f32 v115, v30, v31
    buffer_store_dwordx4 v[112:115], v140, s[84:87], s32 offen offset:0 sc1
    v_pk_mul_f32 v[88:89], v[32:33], v[32:33]
    v_pk_mul_f32 v[90:91], v[34:35], v[34:35]
    v_pk_mul_f32 v[92:93], v[36:37], v[36:37]
    v_pk_mul_f32 v[94:95], v[38:39], v[38:39]
    v_pk_fma_f32 v[88:89], v[88:89], v[188:189], v[188:189] op_sel:[0,0,1] op_sel_hi:[1,0,1]
    v_pk_fma_f32 v[90:91], v[90:91], v[188:189], v[188:189] op_sel:[0,0,1] op_sel_hi:[1,0,1]
    v_pk_fma_f32 v[92:93], v[92:93], v[188:189], v[188:189] op_sel:[0,0,1] op_sel_hi:[1,0,1]
    v_pk_fma_f32 v[94:95], v[94:95], v[188:189], v[188:189] op_sel:[0,0,1] op_sel_hi:[1,0,1]
    v_pk_mul_f32 v[88:89], v[88:89], v[32:33]
    v_pk_mul_f32 v[90:91], v[90:91], v[34:35]
    v_pk_mul_f32 v[92:93], v[92:93], v[36:37]
    v_pk_mul_f32 v[94:95], v[94:95], v[38:39]
    v_exp_f32 v88, v88
    v_exp_f32 v89, v89
    v_exp_f32 v90, v90
    v_exp_f32 v91, v91
    v_exp_f32 v92, v92
    v_exp_f32 v93, v93
    v_exp_f32 v94, v94
    v_exp_f32 v95, v95
    v_pk_add_f32 v[88:89], v[88:89], 1.0 op_sel_hi:[1,0]
    v_pk_add_f32 v[90:91], v[90:91], 1.0 op_sel_hi:[1,0]
    v_pk_add_f32 v[92:93], v[92:93], 1.0 op_sel_hi:[1,0]
    v_pk_add_f32 v[94:95], v[94:95], 1.0 op_sel_hi:[1,0]
    v_rcp_f32 v88, v88
    v_rcp_f32 v89, v89
    v_rcp_f32 v90, v90
    v_rcp_f32 v91, v91
    v_rcp_f32 v92, v92
    v_rcp_f32 v93, v93
    v_rcp_f32 v94, v94
    v_rcp_f32 v95, v95
    v_pk_mul_f32 v[32:33], v[32:33], v[88:89]
    v_pk_mul_f32 v[34:35], v[34:35], v[90:91]
    v_pk_mul_f32 v[36:37], v[36:37], v[92:93]
    v_pk_mul_f32 v[38:39], v[38:39], v[94:95]
    v_cvt_pk_bf16_f32 v100, v32, v33
    v_cvt_pk_bf16_f32 v101, v34, v35
    v_cvt_pk_bf16_f32 v102, v36, v37
    v_cvt_pk_bf16_f32 v103, v38, v39
    buffer_store_dwordx4 v[100:103], v140, s[84:87], s32 offen offset:1024 sc1
    v_pk_mul_f32 v[88:89], v[40:41], v[40:41]
    v_pk_mul_f32 v[90:91], v[42:43], v[42:43]
    v_pk_mul_f32 v[92:93], v[44:45], v[44:45]
    v_pk_mul_f32 v[94:95], v[46:47], v[46:47]
    v_pk_fma_f32 v[88:89], v[88:89], v[188:189], v[188:189] op_sel:[0,0,1] op_sel_hi:[1,0,1]
    v_pk_fma_f32 v[90:91], v[90:91], v[188:189], v[188:189] op_sel:[0,0,1] op_sel_hi:[1,0,1]
    v_pk_fma_f32 v[92:93], v[92:93], v[188:189], v[188:189] op_sel:[0,0,1] op_sel_hi:[1,0,1]
    v_pk_fma_f32 v[94:95], v[94:95], v[188:189], v[188:189] op_sel:[0,0,1] op_sel_hi:[1,0,1]
    v_pk_mul_f32 v[88:89], v[88:89], v[40:41]
    v_pk_mul_f32 v[90:91], v[90:91], v[42:43]
    v_pk_mul_f32 v[92:93], v[92:93], v[44:45]
    v_pk_mul_f32 v[94:95], v[94:95], v[46:47]
    v_exp_f32 v88, v88
    v_exp_f32 v89, v89
    v_exp_f32 v90, v90
    v_exp_f32 v91, v91
    v_exp_f32 v92, v92
    v_exp_f32 v93, v93
    v_exp_f32 v94, v94
    v_exp_f32 v95, v95
    v_pk_add_f32 v[88:89], v[88:89], 1.0 op_sel_hi:[1,0]
    v_pk_add_f32 v[90:91], v[90:91], 1.0 op_sel_hi:[1,0]
    v_pk_add_f32 v[92:93], v[92:93], 1.0 op_sel_hi:[1,0]
    v_pk_add_f32 v[94:95], v[94:95], 1.0 op_sel_hi:[1,0]
    v_rcp_f32 v88, v88
    v_rcp_f32 v89, v89
    v_rcp_f32 v90, v90
    v_rcp_f32 v91, v91
    v_rcp_f32 v92, v92
    v_rcp_f32 v93, v93
    v_rcp_f32 v94, v94
    v_rcp_f32 v95, v95
    v_pk_mul_f32 v[40:41], v[40:41], v[88:89]
    v_pk_mul_f32 v[42:43], v[42:43], v[90:91]
    v_pk_mul_f32 v[44:45], v[44:45], v[92:93]
    v_pk_mul_f32 v[46:47], v[46:47], v[94:95]
    v_cvt_pk_bf16_f32 v104, v40, v41
    v_cvt_pk_bf16_f32 v105, v42, v43
    v_cvt_pk_bf16_f32 v106, v44, v45
    v_cvt_pk_bf16_f32 v107, v46, v47
    buffer_store_dwordx4 v[104:107], v140, s[84:87], s32 offen offset:2048 sc1
    s_add_u32 s36, s22, 131072
    s_waitcnt vmcnt(0)
    s_barrier
    s_add_u32 s37, s36, 262144
    buffer_store_dword v147, v146, s[52:55], s37 offen
    buffer_store_dword v147, v146, s[52:55], s36 offen sc1
    s_mul_i32 s27, s33, 49152
    s_add_u32 s27, s27, 67108864
    s_add_u32 s44, s6, s27
    s_addc_u32 s45, s7, 0
    s_mov_b32 s46, 49152
    s_mov_b32 s47, 0x20000
    s_add_u32 s60, s6, 50331648
    s_addc_u32 s61, s7, 0
    s_mov_b32 s62, 2621440
    s_mov_b32 s63, 0x20000
    s_add_u32 s28, s6, 12800
    s_addc_u32 s29, s7, 0
    s_mov_b32 s30, 2560
    s_mov_b32 s31, 0x20000
    s_mov_b32 s84, s80
    s_mov_b32 s85, s81
    s_mov_b32 s86, 2621440
    s_mov_b32 s87, 0x20000
    v_lshrrev_b32 v166, 4, v161
    v_lshlrev_b32 v166, 4, v166
    s_mul_i32 s4, s25, 320
    v_and_b32 v167, 15, v161
    v_mul_u32_u24 v167, 1280, v167
    v_lshrrev_b32 v168, 4, v161
    v_lshl_add_u32 v167, v168, 3, v167
    s_mul_i32 s5, s33, 20480
    s_mul_i32 s26, s25, 160
    s_add_u32 s5, s5, s26
    v_and_b32 v169, 15, v161
    v_mul_u32_u24 v169, 1280, v169
    v_bfe_u32 v170, v161, 4, 1
    v_lshl_add_u32 v169, v170, 5, v169
    v_lshrrev_b32 v170, 5, v161
    v_lshl_add_u32 v169, v170, 4, v169
    s_mov_b32 s42, 0
    s_mov_b32 s36, 131072
    s_cmp_eq_u32 s24, 0
    s_cbranch_scc1 L_tail_w0_4
    s_add_u32 s35, s34, s90
    s_add_u32 s43, s35, 4096
    s_add_u32 m0, s90, 98304
    s_nop 0
    buffer_load_dwordx4 v140, s[8:11], s35 offen offset:0  lds
    buffer_load_dwordx4 v140, s[8:11], s35 offen offset:1024  lds
    buffer_load_dwordx4 v140, s[8:11], s35 offen offset:2048  lds
    buffer_load_dwordx4 v140, s[8:11], s35 offen offset:3072  lds
    s_add_u32 m0, s90, 102400
    s_nop 0
    buffer_load_dwordx4 v140, s[8:11], s43 offen offset:0  lds
    buffer_load_dwordx4 v140, s[8:11], s43 offen offset:1024  lds
    buffer_load_dwordx4 v140, s[8:11], s43 offen offset:2048  lds
    s_add_u32 s34, s34, 20480
    s_add_u32 s35, s34, s90
    s_add_u32 s43, s35, 4096
    s_add_u32 m0, s90, 122880
    s_nop 0
    buffer_load_dwordx4 v140, s[8:11], s35 offen offset:0  lds
    buffer_load_dwordx4 v140, s[8:11], s35 offen offset:1024  lds
    buffer_load_dwordx4 v140, s[8:11], s35 offen offset:2048  lds
    buffer_load_dwordx4 v140, s[8:11], s35 offen offset:3072  lds
    s_add_u32 m0, s90, 126976
    s_nop 0
    buffer_load_dwordx4 v140, s[8:11], s43 offen offset:0  lds
    buffer_load_dwordx4 v140, s[8:11], s43 offen offset:1024  lds
    buffer_load_dwordx4 v140, s[8:11], s43 offen offset:2048  lds
    s_add_u32 s34, s34, 20480
    s_add_u32 s35, s34, s90
    s_add_u32 s43, s35, 4096
    s_add_u32 m0, s90, 0
    s_nop 0
    buffer_load_dwordx4 v140, s[8:11], s35 offen offset:0  lds
    buffer_load_dwordx4 v140, s[8:11], s35 offen offset:1024  lds
    buffer_load_dwordx4 v140, s[8:11], s35 offen offset:2048  lds
    buffer_load_dwordx4 v140, s[8:11], s35 offen offset:3072  lds
    s_add_u32 m0, s90, 4096
    s_nop 0
    buffer_load_dwordx4 v140, s[8:11], s43 offen offset:0  lds
    buffer_load_dwordx4 v140, s[8:11], s43 offen offset:1024  lds
    buffer_load_dwordx4 v140, s[8:11], s43 offen offset:2048  lds
    s_add_u32 s34, s34, 20480
L_tail_got4:
    s_barrier
    buffer_load_dwordx4 a[0:3], v140, s[44:47], s42 offen offset:0 sc1
    buffer_load_dwordx4 a[4:7], v140, s[44:47], s42 offen offset:1024 sc1
    buffer_load_dwordx4 a[8:11], v140, s[44:47], s42 offen offset:2048 sc1
    buffer_load_dwordx4 a[12:15], v140, s[44:47], s42 offen offset:3072 sc1
    s_add_u32 s42, s42, 4096
    buffer_load_dwordx4 a[16:19], v140, s[44:47], s42 offen offset:0 sc1
    buffer_load_dwordx4 a[20:23], v140, s[44:47], s42 offen offset:1024 sc1
    buffer_load_dwordx4 a[24:27], v140, s[44:47], s42 offen offset:2048 sc1
    buffer_load_dwordx4 a[28:31], v140, s[44:47], s42 offen offset:3072 sc1
    s_add_u32 s42, s42, 4096
    s_waitcnt vmcnt(4)
    s_barrier
    ds_read_b64_tr_b16 a[192:193], v149 offset:0
    ds_read_b64_tr_b16 a[194:195], v149 offset:2560
    ds_read_b64_tr_b16 a[196:197], v149 offset:5120
    ds_read_b64_tr_b16 a[198:199], v149 offset:7680
    ds_read_b64_tr_b16 a[200:201], v149 offset:10240
    ds_read_b64_tr_b16 a[202:203], v149 offset:12800
    ds_read_b64_tr_b16 a[204:205], v149 offset:15360
    ds_read_b64_tr_b16 a[206:207], v149 offset:17920
    ds_read_b64_tr_b16 a[208:209], v149 offset:32
    ds_read_b64_tr_b16 a[210:211], v149 offset:2592
    ds_read_b64_tr_b16 a[212:213], v149 offset:5152
    ds_read_b64_tr_b16 a[214:215], v149 offset:7712
    ds_read_b64_tr_b16 a[216:217], v149 offset:10272
    ds_read_b64_tr_b16 a[218:219], v149 offset:12832
    ds_read_b64_tr_b16 a[220:221], v149 offset:15392
    ds_read_b64_tr_b16 a[222:223], v149 offset:17952
    s_waitcnt lgkmcnt(8)
    v_mfma_f32_16x16x32_bf16 v[0:3], a[192:195], a[0:3], 0
    ds_read_b64_tr_b16 a[224:225], v149 offset:64
    ds_read_b64_tr_b16 a[226:227], v149 offset:2624
    buffer_load_dwordx4 a[32:35], v140, s[44:47], s42 offen offset:0 sc1
    v_mfma_f32_16x16x32_bf16 v[0:3], a[196:199], a[4:7], v[0:3]
    ds_read_b64_tr_b16 a[228:229], v149 offset:5184
    ds_read_b64_tr_b16 a[230:231], v149 offset:7744
    v_mfma_f32_16x16x32_bf16 v[0:3], a[200:203], a[8:11], v[0:3]
    ds_read_b64_tr_b16 a[232:233], v149 offset:10304
    ds_read_b64_tr_b16 a[234:235], v149 offset:12864
    buffer_load_dwordx4 a[36:39], v140, s[44:47], s42 offen offset:1024 sc1
    v_mfma_f32_16x16x32_bf16 v[0:3], a[204:207], a[12:15], v[0:3]
    ds_read_b64_tr_b16 a[236:237], v149 offset:15424
    ds_read_b64_tr_b16 a[238:239], v149 offset:17984
    s_waitcnt lgkmcnt(8)
    v_mfma_f32_16x16x32_bf16 v[4:7], a[208:211], a[0:3], 0
    ds_read_b64_tr_b16 a[192:193], v149 offset:96
    ds_read_b64_tr_b16 a[194:195], v149 offset:2656
    buffer_load_dwordx4 a[40:43], v140, s[44:47], s42 offen offset:2048 sc1
    v_mfma_f32_16x16x32_bf16 v[4:7], a[212:215], a[4:7], v[4:7]
    ds_read_b64_tr_b16 a[196:197], v149 offset:5216
    ds_read_b64_tr_b16 a[198:199], v149 offset:7776
    v_mfma_f32_16x16x32_bf16 v[4:7], a[216:219], a[8:11], v[4:7]
    ds_read_b64_tr_b16 a[200:201], v149 offset:10336
    ds_read_b64_tr_b16 a[202:203], v149 offset:12896
    v_mfma_f32_16x16x32_bf16 v[4:7], a[220:223], a[12:15], v[4:7]
    ds_read_b64_tr_b16 a[204:205], v149 offset:15456
    ds_read_b64_tr_b16 a[206:207], v149 offset:18016
    buffer_load_dwordx4 a[44:47], v140, s[44:47], s42 offen offset:3072 sc1
    s_add_u32 s42, s42, 4096
    s_waitcnt lgkmcnt(8)
    v_mfma_f32_16x16x32_bf16 v[8:11], a[224:227], a[0:3], 0
    ds_read_b64_tr_b16 a[208:209], v149 offset:128
    ds_read_b64_tr_b16 a[210:211], v149 offset:2688
    v_mfma_f32_16x16x32_bf16 v[8:11], a[228:231], a[4:7], v[8:11]
    ds_read_b64_tr_b16 a[212:213], v149 offset:5248
    ds_read_b64_tr_b16 a[214:215], v149 offset:7808
    v_mfma_f32_16x16x32_bf16 v[8:11], a[232:235], a[8:11], v[8:11]
    ds_read_b64_tr_b16 a[216:217], v149 offset:10368
    ds_read_b64_tr_b16 a[218:219], v149 offset:12928
    v_mfma_f32_16x16x32_bf16 v[8:11], a[236:239], a[12:15], v[8:11]
    ds_read_b64_tr_b16 a[220:221], v149 offset:15488
    ds_read_b64_tr_b16 a[222:223], v149 offset:18048
    s_waitcnt vmcnt(4)
    s_waitcnt lgkmcnt(8)
    v_mfma_f32_16x16x32_bf16 v[12:15], a[192:195], a[0:3], 0
    ds_read_b64_tr_b16 a[224:225], v149 offset:24576
    ds_read_b64_tr_b16 a[226:227], v149 offset:27136
    buffer_load_dwordx4 a[48:51], v140, s[44:47], s42 offen offset:0 sc1
    v_mfma_f32_16x16x32_bf16 v[12:15], a[196:199], a[4:7], v[12:15]
    ds_read_b64_tr_b16 a[228:229], v149 offset:29696
    ds_read_b64_tr_b16 a[230:231], v149 offset:32256
    v_mfma_f32_16x16x32_bf16 v[12:15], a[200:203], a[8:11], v[12:15]
    ds_read_b64_tr_b16 a[232:233], v149 offset:34816
    ds_read_b64_tr_b16 a[234:235], v149 offset:37376
    buffer_load_dwordx4 a[52:55], v140, s[44:47], s42 offen offset:1024 sc1
    v_mfma_f32_16x16x32_bf16 v[12:15], a[204:207], a[12:15], v[12:15]
    ds_read_b64_tr_b16 a[236:237], v149 offset:39936
    ds_read_b64_tr_b16 a[238:239], v149 offset:42496
    s_waitcnt lgkmcnt(8)
    v_mfma_f32_16x16x32_bf16 v[16:19], a[208:211], a[0:3], 0
    ds_read_b64_tr_b16 a[192:193], v149 offset:24608
    ds_read_b64_tr_b16 a[194:195], v149 offset:27168
    buffer_load_dwordx4 a[56:59], v140, s[44:47], s42 offen offset:2048 sc1
    v_mfma_f32_16x16x32_bf16 v[16:19], a[212:215], a[4:7], v[16:19]
    ds_read_b64_tr_b16 a[196:197], v149 offset:29728
    ds_read_b64_tr_b16 a[198:199], v149 offset:32288
    v_mfma_f32_16x16x32_bf16 v[16:19], a[216:219], a[8:11], v[16:19]
    ds_read_b64_tr_b16 a[200:201], v149 offset:34848
    ds_read_b64_tr_b16 a[202:203], v149 offset:37408
    v_mfma_f32_16x16x32_bf16 v[16:19], a[220:223], a[12:15], v[16:19]
    ds_read_b64_tr_b16 a[204:205], v149 offset:39968
    ds_read_b64_tr_b16 a[206:207], v149 offset:42528
    buffer_load_dwordx4 a[60:63], v140, s[44:47], s42 offen offset:3072 sc1
    s_add_u32 s42, s42, 4096
    s_waitcnt lgkmcnt(8)
    v_mfma_f32_16x16x32_bf16 v[0:3], a[224:227], a[16:19], v[0:3]
    ds_read_b64_tr_b16 a[208:209], v149 offset:24640
    ds_read_b64_tr_b16 a[210:211], v149 offset:27200
    v_mfma_f32_16x16x32_bf16 v[0:3], a[228:231], a[20:23], v[0:3]
    ds_read_b64_tr_b16 a[212:213], v149 offset:29760
    ds_read_b64_tr_b16 a[214:215], v149 offset:32320
    v_mfma_f32_16x16x32_bf16 v[0:3], a[232:235], a[24:27], v[0:3]
    ds_read_b64_tr_b16 a[216:217], v149 offset:34880
    ds_read_b64_tr_b16 a[218:219], v149 offset:37440
    v_mfma_f32_16x16x32_bf16 v[0:3], a[236:239], a[28:31], v[0:3]
    ds_read_b64_tr_b16 a[220:221], v149 offset:40000
    ds_read_b64_tr_b16 a[222:223], v149 offset:42560
    s_waitcnt lgkmcnt(8)
    v_mfma_f32_16x16x32_bf16 v[4:7], a[192:195], a[16:19], v[4:7]
    ds_read_b64_tr_b16 a[224:225], v149 offset:24672
    ds_read_b64_tr_b16 a[226:227], v149 offset:27232
    v_mfma_f32_16x16x32_bf16 v[4:7], a[196:199], a[20:23], v[4:7]
    ds_read_b64_tr_b16 a[228:229], v149 offset:29792
    ds_read_b64_tr_b16 a[230:231], v149 offset:32352
    v_mfma_f32_16x16x32_bf16 v[4:7], a[200:203], a[24:27], v[4:7]
    ds_read_b64_tr_b16 a[232:233], v149 offset:34912
    ds_read_b64_tr_b16 a[234:235], v149 offset:37472
    v_mfma_f32_16x16x32_bf16 v[4:7], a[204:207], a[28:31], v[4:7]
    ds_read_b64_tr_b16 a[236:237], v149 offset:40032
    ds_read_b64_tr_b16 a[238:239], v149 offset:42592
    s_waitcnt lgkmcnt(8)
    v_mfma_f32_16x16x32_bf16 v[8:11], a[208:211], a[16:19], v[8:11]
    ds_read_b64_tr_b16 a[192:193], v149 offset:24704
    ds_read_b64_tr_b16 a[194:195], v149 offset:27264
    v_mfma_f32_16x16x32_bf16 v[8:11], a[212:215], a[20:23], v[8:11]
    ds_read_b64_tr_b16 a[196:197], v149 offset:29824
    ds_read_b64_tr_b16 a[198:199], v149 offset:32384
    v_mfma_f32_16x16x32_bf16 v[8:11], a[216:219], a[24:27], v[8:11]
    ds_read_b64_tr_b16 a[200:201], v149 offset:34944
    ds_read_b64_tr_b16 a[202:203], v149 offset:37504
    v_mfma_f32_16x16x32_bf16 v[8:11], a[220:223], a[28:31], v[8:11]
    ds_read_b64_tr_b16 a[204:205], v149 offset:40064
    ds_read_b64_tr_b16 a[206:207], v149 offset:42624
    s_waitcnt vmcnt(4)
    s_waitcnt lgkmcnt(8)
    v_mfma_f32_16x16x32_bf16 v[12:15], a[224:227], a[16:19], v[12:15]
    ds_read_b64_tr_b16 a[208:209], v150 offset:0
    ds_read_b64_tr_b16 a[210:211], v150 offset:2560
    buffer_load_dwordx4 a[0:3], v140, s[44:47], s42 offen offset:0 sc1
    v_mfma_f32_16x16x32_bf16 v[12:15], a[228:231], a[20:23], v[12:15]
    ds_read_b64_tr_b16 a[212:213], v150 offset:5120
    ds_read_b64_tr_b16 a[214:215], v150 offset:7680
    v_mfma_f32_16x16x32_bf16 v[12:15], a[232:235], a[24:27], v[12:15]
    ds_read_b64_tr_b16 a[216:217], v150 offset:10240
    ds_read_b64_tr_b16 a[218:219], v150 offset:12800
    v_mfma_f32_16x16x32_bf16 v[12:15], a[236:239], a[28:31], v[12:15]
    ds_read_b64_tr_b16 a[220:221], v150 offset:15360
    ds_read_b64_tr_b16 a[222:223], v150 offset:17920
    s_waitcnt lgkmcnt(8)
    v_mfma_f32_16x16x32_bf16 v[16:19], a[192:195], a[16:19], v[16:19]
    ds_read_b64_tr_b16 a[224:225], v150 offset:32
    ds_read_b64_tr_b16 a[226:227], v150 offset:2592
    buffer_load_dwordx4 a[4:7], v140, s[44:47], s42 offen offset:1024 sc1
    v_mfma_f32_16x16x32_bf16 v[16:19], a[196:199], a[20:23], v[16:19]
    ds_read_b64_tr_b16 a[228:229], v150 offset:5152
    ds_read_b64_tr_b16 a[230:231], v150 offset:7712
    v_mfma_f32_16x16x32_bf16 v[16:19], a[200:203], a[24:27], v[16:19]
    ds_read_b64_tr_b16 a[232:233], v150 offset:10272
    ds_read_b64_tr_b16 a[234:235], v150 offset:12832
    v_mfma_f32_16x16x32_bf16 v[16:19], a[204:207], a[28:31], v[16:19]
    ds_read_b64_tr_b16 a[236:237], v150 offset:15392
    ds_read_b64_tr_b16 a[238:239], v150 offset:17952
    s_waitcnt lgkmcnt(8)
    v_mfma_f32_16x16x32_bf16 v[0:3], a[208:211], a[32:35], v[0:3]
    ds_read_b64_tr_b16 a[192:193], v150 offset:64
    ds_read_b64_tr_b16 a[194:195], v150 offset:2624
    buffer_load_dwordx4 a[8:11], v140, s[44:47], s42 offen offset:2048 sc1
    v_mfma_f32_16x16x32_bf16 v[0:3], a[212:215], a[36:39], v[0:3]
    ds_read_b64_tr_b16 a[196:197], v150 offset:5184
    ds_read_b64_tr_b16 a[198:199], v150 offset:7744
    v_mfma_f32_16x16x32_bf16 v[0:3], a[216:219], a[40:43], v[0:3]
    ds_read_b64_tr_b16 a[200:201], v150 offset:10304
    ds_read_b64_tr_b16 a[202:203], v150 offset:12864
    v_mfma_f32_16x16x32_bf16 v[0:3], a[220:223], a[44:47], v[0:3]
    ds_read_b64_tr_b16 a[204:205], v150 offset:15424
    ds_read_b64_tr_b16 a[206:207], v150 offset:17984
    s_waitcnt lgkmcnt(8)
    v_mfma_f32_16x16x32_bf16 v[4:7], a[224:227], a[32:35], v[4:7]
    ds_read_b64_tr_b16 a[208:209], v150 offset:96
    ds_read_b64_tr_b16 a[210:211], v150 offset:2656
    v_mfma_f32_16x16x32_bf16 v[4:7], a[228:231], a[36:39], v[4:7]
    ds_read_b64_tr_b16 a[212:213], v150 offset:5216
    ds_read_b64_tr_b16 a[214:215], v150 offset:7776
    buffer_load_dwordx4 a[12:15], v140, s[44:47], s42 offen offset:3072 sc1
    s_add_u32 s42, s42, 4096
    v_mfma_f32_16x16x32_bf16 v[4:7], a[232:235], a[40:43], v[4:7]
    ds_read_b64_tr_b16 a[216:217], v150 offset:10336
    ds_read_b64_tr_b16 a[218:219], v150 offset:12896
    v_mfma_f32_16x16x32_bf16 v[4:7], a[236:239], a[44:47], v[4:7]
    ds_read_b64_tr_b16 a[220:221], v150 offset:15456
    ds_read_b64_tr_b16 a[222:223], v150 offset:18016
    s_waitcnt lgkmcnt(8)
    v_mfma_f32_16x16x32_bf16 v[8:11], a[192:195], a[32:35], v[8:11]
    ds_read_b64_tr_b16 a[224:225], v150 offset:128
    ds_read_b64_tr_b16 a[226:227], v150 offset:2688
    v_mfma_f32_16x16x32_bf16 v[8:11], a[196:199], a[36:39], v[8:11]
    ds_read_b64_tr_b16 a[228:229], v150 offset:5248
    ds_read_b64_tr_b16 a[230:231], v150 offset:7808
    v_mfma_f32_16x16x32_bf16 v[8:11], a[200:203], a[40:43], v[8:11]
    ds_read_b64_tr_b16 a[232:233], v150 offset:10368
    ds_read_b64_tr_b16 a[234:235], v150 offset:12928
    v_mfma_f32_16x16x32_bf16 v[8:11], a[204:207], a[44:47], v[8:11]
    ds_read_b64_tr_b16 a[236:237], v150 offset:15488
    ds_read_b64_tr_b16 a[238:239], v150 offset:18048
    s_waitcnt vmcnt(4)
    s_waitcnt lgkmcnt(8)
    v_mfma_f32_16x16x32_bf16 v[12:15], a[208:211], a[32:35], v[12:15]
    ds_read_b64_tr_b16 a[192:193], v150 offset:24576
    ds_read_b64_tr_b16 a[194:195], v150 offset:27136
    s_add_u32 s35, s34, s38
    s_add_u32 s43, s35, 4096
    s_add_u32 m0, s38, 24576
    s_nop 0
    buffer_load_dwordx4 v140, s[8:11], s35 offen offset:0  lds
    v_mfma_f32_16x16x32_bf16 v[12:15], a[212:215], a[36:39], v[12:15]
    ds_read_b64_tr_b16 a[196:197], v150 offset:29696
    ds_read_b64_tr_b16 a[198:199], v150 offset:32256
    buffer_load_dwordx4 v140, s[8:11], s35 offen offset:1024  lds
    v_mfma_f32_16x16x32_bf16 v[12:15], a[216:219], a[40:43], v[12:15]
    ds_read_b64_tr_b16 a[200:201], v150 offset:34816
    ds_read_b64_tr_b16 a[202:203], v150 offset:37376
    v_mfma_f32_16x16x32_bf16 v[12:15], a[220:223], a[44:47], v[12:15]
    ds_read_b64_tr_b16 a[204:205], v150 offset:39936
    ds_read_b64_tr_b16 a[206:207], v150 offset:42496
    buffer_load_dwordx4 v140, s[8:11], s35 offen offset:2048  lds
    s_waitcnt lgkmcnt(8)
    v_mfma_f32_16x16x32_bf16 v[16:19], a[224:227], a[32:35], v[16:19]
    ds_read_b64_tr_b16 a[208:209], v150 offset:24608
    ds_read_b64_tr_b16 a[210:211], v150 offset:27168
    v_mfma_f32_16x16x32_bf16 v[16:19], a[228:231], a[36:39], v[16:19]
    ds_read_b64_tr_b16 a[212:213], v150 offset:29728
    ds_read_b64_tr_b16 a[214:215], v150 offset:32288
    buffer_load_dwordx4 v140, s[8:11], s35 offen offset:3072  lds
    s_add_u32 m0, s38, 28672
    s_nop 0
    v_mfma_f32_16x16x32_bf16 v[16:19], a[232:235], a[40:43], v[16:19]
    ds_read_b64_tr_b16 a[216:217], v150 offset:34848
    ds_read_b64_tr_b16 a[218:219], v150 offset:37408
    v_mfma_f32_16x16x32_bf16 v[16:19], a[236:239], a[44:47], v[16:19]
    ds_read_b64_tr_b16 a[220:221], v150 offset:39968
    ds_read_b64_tr_b16 a[222:223], v150 offset:42528
    buffer_load_dwordx4 v140, s[8:11], s43 offen offset:0  lds
    s_add_u32 s34, s34, 20480
    s_waitcnt lgkmcnt(8)
    v_mfma_f32_16x16x32_bf16 v[0:3], a[192:195], a[48:51], v[0:3]
    ds_read_b64_tr_b16 a[224:225], v150 offset:24640
    ds_read_b64_tr_b16 a[226:227], v150 offset:27200
    v_mfma_f32_16x16x32_bf16 v[0:3], a[196:199], a[52:55], v[0:3]
    ds_read_b64_tr_b16 a[228:229], v150 offset:29760
    ds_read_b64_tr_b16 a[230:231], v150 offset:32320
    buffer_load_dwordx4 a[16:19], v140, s[44:47], s42 offen offset:0 sc1
    v_mfma_f32_16x16x32_bf16 v[0:3], a[200:203], a[56:59], v[0:3]
    ds_read_b64_tr_b16 a[232:233], v150 offset:34880
    ds_read_b64_tr_b16 a[234:235], v150 offset:37440
    v_mfma_f32_16x16x32_bf16 v[0:3], a[204:207], a[60:63], v[0:3]
    ds_read_b64_tr_b16 a[236:237], v150 offset:40000
    ds_read_b64_tr_b16 a[238:239], v150 offset:42560
    buffer_load_dwordx4 a[20:23], v140, s[44:47], s42 offen offset:1024 sc1
    s_waitcnt lgkmcnt(8)
    v_mfma_f32_16x16x32_bf16 v[4:7], a[208:211], a[48:51], v[4:7]
    ds_read_b64_tr_b16 a[192:193], v150 offset:24672
    ds_read_b64_tr_b16 a[194:195], v150 offset:27232
    v_mfma_f32_16x16x32_bf16 v[4:7], a[212:215], a[52:55], v[4:7]
    ds_read_b64_tr_b16 a[196:197], v150 offset:29792
    ds_read_b64_tr_b16 a[198:199], v150 offset:32352
    buffer_load_dwordx4 a[24:27], v140, s[44:47], s42 offen offset:2048 sc1
    v_mfma_f32_16x16x32_bf16 v[4:7], a[216:219], a[56:59], v[4:7]
    ds_read_b64_tr_b16 a[200:201], v150 offset:34912
    ds_read_b64_tr_b16 a[202:203], v150 offset:37472
    v_mfma_f32_16x16x32_bf16 v[4:7], a[220:223], a[60:63], v[4:7]
    ds_read_b64_tr_b16 a[204:205], v150 offset:40032
    ds_read_b64_tr_b16 a[206:207], v150 offset:42592
    buffer_load_dwordx4 a[28:31], v140, s[44:47], s42 offen offset:3072 sc1
    s_add_u32 s42, s42, 4096
    s_waitcnt lgkmcnt(8)
    v_mfma_f32_16x16x32_bf16 v[8:11], a[224:227], a[48:51], v[8:11]
    ds_read_b64_tr_b16 a[208:209], v150 offset:24704
    ds_read_b64_tr_b16 a[210:211], v150 offset:27264
    v_mfma_f32_16x16x32_bf16 v[8:11], a[228:231], a[52:55], v[8:11]
    ds_read_b64_tr_b16 a[212:213], v150 offset:29824
    ds_read_b64_tr_b16 a[214:215], v150 offset:32384
    v_mfma_f32_16x16x32_bf16 v[8:11], a[232:235], a[56:59], v[8:11]
    ds_read_b64_tr_b16 a[216:217], v150 offset:34944
    ds_read_b64_tr_b16 a[218:219], v150 offset:37504
    v_mfma_f32_16x16x32_bf16 v[8:11], a[236:239], a[60:63], v[8:11]
    ds_read_b64_tr_b16 a[220:221], v150 offset:40064
    ds_read_b64_tr_b16 a[222:223], v150 offset:42624
    s_waitcnt vmcnt(9)
    s_barrier
    s_waitcnt lgkmcnt(8)
    v_mfma_f32_16x16x32_bf16 v[12:15], a[192:195], a[48:51], v[12:15]
    ds_read_b64_tr_b16 a[224:225], v148 offset:0
    ds_read_b64_tr_b16 a[226:227], v148 offset:2560
    s_add_u32 s35, s34, s38
    s_add_u32 s43, s35, 4096
    s_add_u32 m0, s38, 49152
    s_nop 0
    buffer_load_dwordx4 v140, s[8:11], s35 offen offset:0  lds
    v_mfma_f32_16x16x32_bf16 v[12:15], a[196:199], a[52:55], v[12:15]
    ds_read_b64_tr_b16 a[228:229], v148 offset:5120
    ds_read_b64_tr_b16 a[230:231], v148 offset:7680
    buffer_load_dwordx4 v140, s[8:11], s35 offen offset:1024  lds
    v_mfma_f32_16x16x32_bf16 v[12:15], a[200:203], a[56:59], v[12:15]
    ds_read_b64_tr_b16 a[232:233], v148 offset:10240
    ds_read_b64_tr_b16 a[234:235], v148 offset:12800
    v_mfma_f32_16x16x32_bf16 v[12:15], a[204:207], a[60:63], v[12:15]
    ds_read_b64_tr_b16 a[236:237], v148 offset:15360
    ds_read_b64_tr_b16 a[238:239], v148 offset:17920
    buffer_load_dwordx4 v140, s[8:11], s35 offen offset:2048  lds
    s_waitcnt lgkmcnt(8)
    v_mfma_f32_16x16x32_bf16 v[16:19], a[208:211], a[48:51], v[16:19]
    ds_read_b64_tr_b16 a[192:193], v148 offset:32
    ds_read_b64_tr_b16 a[194:195], v148 offset:2592
    v_mfma_f32_16x16x32_bf16 v[16:19], a[212:215], a[52:55], v[16:19]
    ds_read_b64_tr_b16 a[196:197], v148 offset:5152
    ds_read_b64_tr_b16 a[198:199], v148 offset:7712
    buffer_load_dwordx4 v140, s[8:11], s35 offen offset:3072  lds
    s_add_u32 m0, s38, 53248
    s_nop 0
    v_mfma_f32_16x16x32_bf16 v[16:19], a[216:219], a[56:59], v[16:19]
    ds_read_b64_tr_b16 a[200:201], v148 offset:10272
    ds_read_b64_tr_b16 a[202:203], v148 offset:12832
    v_mfma_f32_16x16x32_bf16 v[16:19], a[220:223], a[60:63], v[16:19]
    ds_read_b64_tr_b16 a[204:205], v148 offset:15392
    ds_read_b64_tr_b16 a[206:207], v148 offset:17952
    buffer_load_dwordx4 v140, s[8:11], s43 offen offset:0  lds
    s_add_u32 s34, s34, 20480
    s_waitcnt lgkmcnt(8)
    v_mfma_f32_16x16x32_bf16 v[0:3], a[224:227], a[0:3], v[0:3]
    ds_read_b64_tr_b16 a[208:209], v148 offset:64
    ds_read_b64_tr_b16 a[210:211], v148 offset:2624
    v_mfma_f32_16x16x32_bf16 v[0:3], a[228:231], a[4:7], v[0:3]
    ds_read_b64_tr_b16 a[212:213], v148 offset:5184
    ds_read_b64_tr_b16 a[214:215], v148 offset:7744
    buffer_load_dwordx4 a[32:35], v140, s[44:47], s42 offen offset:0 sc1
    v_mfma_f32_16x16x32_bf16 v[0:3], a[232:235], a[8:11], v[0:3]
    ds_read_b64_tr_b16 a[216:217], v148 offset:10304
    ds_read_b64_tr_b16 a[218:219], v148 offset:12864
    v_mfma_f32_16x16x32_bf16 v[0:3], a[236:239], a[12:15], v[0:3]
    ds_read_b64_tr_b16 a[220:221], v148 offset:15424
    ds_read_b64_tr_b16 a[222:223], v148 offset:17984
    buffer_load_dwordx4 a[36:39], v140, s[44:47], s42 offen offset:1024 sc1
    s_waitcnt lgkmcnt(8)
    v_mfma_f32_16x16x32_bf16 v[4:7], a[192:195], a[0:3], v[4:7]
    ds_read_b64_tr_b16 a[224:225], v148 offset:96
    ds_read_b64_tr_b16 a[226:227], v148 offset:2656
    v_mfma_f32_16x16x32_bf16 v[4:7], a[196:199], a[4:7], v[4:7]
    ds_read_b64_tr_b16 a[228:229], v148 offset:5216
    ds_read_b64_tr_b16 a[230:231], v148 offset:7776
    buffer_load_dwordx4 a[40:43], v140, s[44:47], s42 offen offset:2048 sc1
    v_mfma_f32_16x16x32_bf16 v[4:7], a[200:203], a[8:11], v[4:7]
    ds_read_b64_tr_b16 a[232:233], v148 offset:10336
    ds_read_b64_tr_b16 a[234:235], v148 offset:12896
    v_mfma_f32_16x16x32_bf16 v[4:7], a[204:207], a[12:15], v[4:7]
    ds_read_b64_tr_b16 a[236:237], v148 offset:15456
    ds_read_b64_tr_b16 a[238:239], v148 offset:18016
    buffer_load_dwordx4 a[44:47], v140, s[44:47], s42 offen offset:3072 sc1
    s_add_u32 s42, s42, 4096
    s_waitcnt lgkmcnt(8)
    v_mfma_f32_16x16x32_bf16 v[8:11], a[208:211], a[0:3], v[8:11]
    ds_read_b64_tr_b16 a[192:193], v148 offset:128
    ds_read_b64_tr_b16 a[194:195], v148 offset:2688
    v_mfma_f32_16x16x32_bf16 v[8:11], a[212:215], a[4:7], v[8:11]
    ds_read_b64_tr_b16 a[196:197], v148 offset:5248
    ds_read_b64_tr_b16 a[198:199], v148 offset:7808
    v_mfma_f32_16x16x32_bf16 v[8:11], a[216:219], a[8:11], v[8:11]
    ds_read_b64_tr_b16 a[200:201], v148 offset:10368
    ds_read_b64_tr_b16 a[202:203], v148 offset:12928
    v_mfma_f32_16x16x32_bf16 v[8:11], a[220:223], a[12:15], v[8:11]
    ds_read_b64_tr_b16 a[204:205], v148 offset:15488
    ds_read_b64_tr_b16 a[206:207], v148 offset:18048
    s_waitcnt vmcnt(9)
    s_barrier
    s_waitcnt lgkmcnt(8)
    v_mfma_f32_16x16x32_bf16 v[12:15], a[224:227], a[0:3], v[12:15]
    ds_read_b64_tr_b16 a[208:209], v148 offset:24576
    ds_read_b64_tr_b16 a[210:211], v148 offset:27136
    s_add_u32 s35, s34, s38
    s_add_u32 s43, s35, 4096
    s_add_u32 m0, s38, 73728
    s_nop 0
    buffer_load_dwordx4 v140, s[8:11], s35 offen offset:0  lds
    v_mfma_f32_16x16x32_bf16 v[12:15], a[228:231], a[4:7], v[12:15]
    ds_read_b64_tr_b16 a[212:213], v148 offset:29696
    ds_read_b64_tr_b16 a[214:215], v148 offset:32256
    buffer_load_dwordx4 v140, s[8:11], s35 offen offset:1024  lds
    v_mfma_f32_16x16x32_bf16 v[12:15], a[232:235], a[8:11], v[12:15]
    ds_read_b64_tr_b16 a[216:217], v148 offset:34816
    ds_read_b64_tr_b16 a[218:219], v148 offset:37376
    v_mfma_f32_16x16x32_bf16 v[12:15], a[236:239], a[12:15], v[12:15]
    ds_read_b64_tr_b16 a[220:221], v148 offset:39936
    ds_read_b64_tr_b16 a[222:223], v148 offset:42496
    buffer_load_dwordx4 v140, s[8:11], s35 offen offset:2048  lds
    s_waitcnt lgkmcnt(8)
    v_mfma_f32_16x16x32_bf16 v[16:19], a[192:195], a[0:3], v[16:19]
    ds_read_b64_tr_b16 a[224:225], v148 offset:24608
    ds_read_b64_tr_b16 a[226:227], v148 offset:27168
    v_mfma_f32_16x16x32_bf16 v[16:19], a[196:199], a[4:7], v[16:19]
    ds_read_b64_tr_b16 a[228:229], v148 offset:29728
    ds_read_b64_tr_b16 a[230:231], v148 offset:32288
    buffer_load_dwordx4 v140, s[8:11], s35 offen offset:3072  lds
    s_add_u32 m0, s38, 77824
    s_nop 0
    v_mfma_f32_16x16x32_bf16 v[16:19], a[200:203], a[8:11], v[16:19]
    ds_read_b64_tr_b16 a[232:233], v148 offset:34848
    ds_read_b64_tr_b16 a[234:235], v148 offset:37408
    v_mfma_f32_16x16x32_bf16 v[16:19], a[204:207], a[12:15], v[16:19]
    ds_read_b64_tr_b16 a[236:237], v148 offset:39968
    ds_read_b64_tr_b16 a[238:239], v148 offset:42528
    buffer_load_dwordx4 v140, s[8:11], s43 offen offset:0  lds
    s_add_u32 s34, s34, 20480
    s_waitcnt lgkmcnt(8)
    v_mfma_f32_16x16x32_bf16 v[0:3], a[208:211], a[16:19], v[0:3]
    ds_read_b64_tr_b16 a[192:193], v148 offset:24640
    ds_read_b64_tr_b16 a[194:195], v148 offset:27200
    v_mfma_f32_16x16x32_bf16 v[0:3], a[212:215], a[20:23], v[0:3]
    ds_read_b64_tr_b16 a[196:197], v148 offset:29760
    ds_read_b64_tr_b16 a[198:199], v148 offset:32320
    buffer_load_dwordx4 a[48:51], v140, s[44:47], s42 offen offset:0 sc1
    v_mfma_f32_16x16x32_bf16 v[0:3], a[216:219], a[24:27], v[0:3]
    ds_read_b64_tr_b16 a[200:201], v148 offset:34880
    ds_read_b64_tr_b16 a[202:203], v148 offset:37440
    v_mfma_f32_16x16x32_bf16 v[0:3], a[220:223], a[28:31], v[0:3]
    ds_read_b64_tr_b16 a[204:205], v148 offset:40000
    ds_read_b64_tr_b16 a[206:207], v148 offset:42560
    buffer_load_dwordx4 a[52:55], v140, s[44:47], s42 offen offset:1024 sc1
    s_waitcnt lgkmcnt(8)
    v_mfma_f32_16x16x32_bf16 v[4:7], a[224:227], a[16:19], v[4:7]
    ds_read_b64_tr_b16 a[208:209], v148 offset:24672
    ds_read_b64_tr_b16 a[210:211], v148 offset:27232
    v_mfma_f32_16x16x32_bf16 v[4:7], a[228:231], a[20:23], v[4:7]
    ds_read_b64_tr_b16 a[212:213], v148 offset:29792
    ds_read_b64_tr_b16 a[214:215], v148 offset:32352
    buffer_load_dwordx4 a[56:59], v140, s[44:47], s42 offen offset:2048 sc1
    v_mfma_f32_16x16x32_bf16 v[4:7], a[232:235], a[24:27], v[4:7]
    ds_read_b64_tr_b16 a[216:217], v148 offset:34912
    ds_read_b64_tr_b16 a[218:219], v148 offset:37472
    v_mfma_f32_16x16x32_bf16 v[4:7], a[236:239], a[28:31], v[4:7]
    ds_read_b64_tr_b16 a[220:221], v148 offset:40032
    ds_read_b64_tr_b16 a[222:223], v148 offset:42592
    buffer_load_dwordx4 a[60:63], v140, s[44:47], s42 offen offset:3072 sc1
    s_add_u32 s42, s42, 4096
    s_waitcnt lgkmcnt(8)
    v_mfma_f32_16x16x32_bf16 v[8:11], a[192:195], a[16:19], v[8:11]
    ds_read_b64_tr_b16 a[224:225], v148 offset:24704
    ds_read_b64_tr_b16 a[226:227], v148 offset:27264
    v_mfma_f32_16x16x32_bf16 v[8:11], a[196:199], a[20:23], v[8:11]
    ds_read_b64_tr_b16 a[228:229], v148 offset:29824
    ds_read_b64_tr_b16 a[230:231], v148 offset:32384
    v_mfma_f32_16x16x32_bf16 v[8:11], a[200:203], a[24:27], v[8:11]
    ds_read_b64_tr_b16 a[232:233], v148 offset:34944
    ds_read_b64_tr_b16 a[234:235], v148 offset:37504
    v_mfma_f32_16x16x32_bf16 v[8:11], a[204:207], a[28:31], v[8:11]
    ds_read_b64_tr_b16 a[236:237], v148 offset:40064
    ds_read_b64_tr_b16 a[238:239], v148 offset:42624
    s_waitcnt vmcnt(9)
    s_barrier
    s_waitcnt lgkmcnt(8)
    v_mfma_f32_16x16x32_bf16 v[12:15], a[208:211], a[16:19], v[12:15]
    ds_read_b64_tr_b16 a[192:193], v149 offset:0
    ds_read_b64_tr_b16 a[194:195], v149 offset:2560
    s_add_u32 s35, s34, s38
    s_add_u32 s43, s35, 4096
    s_add_u32 m0, s38, 98304
    s_nop 0
    buffer_load_dwordx4 v140, s[8:11], s35 offen offset:0  lds
    v_mfma_f32_16x16x32_bf16 v[12:15], a[212:215], a[20:23], v[12:15]
    ds_read_b64_tr_b16 a[196:197], v149 offset:5120
    ds_read_b64_tr_b16 a[198:199], v149 offset:7680
    buffer_load_dwordx4 v140, s[8:11], s35 offen offset:1024  lds
    v_mfma_f32_16x16x32_bf16 v[12:15], a[216:219], a[24:27], v[12:15]
    ds_read_b64_tr_b16 a[200:201], v149 offset:10240
    ds_read_b64_tr_b16 a[202:203], v149 offset:12800
    v_mfma_f32_16x16x32_bf16 v[12:15], a[220:223], a[28:31], v[12:15]
    ds_read_b64_tr_b16 a[204:205], v149 offset:15360
    ds_read_b64_tr_b16 a[206:207], v149 offset:17920
    buffer_load_dwordx4 v140, s[8:11], s35 offen offset:2048  lds
    s_waitcnt lgkmcnt(8)
    v_mfma_f32_16x16x32_bf16 v[16:19], a[224:227], a[16:19], v[16:19]
    ds_read_b64_tr_b16 a[208:209], v149 offset:32
    ds_read_b64_tr_b16 a[210:211], v149 offset:2592
    v_mfma_f32_16x16x32_bf16 v[16:19], a[228:231], a[20:23], v[16:19]
    ds_read_b64_tr_b16 a[212:213], v149 offset:5152
    ds_read_b64_tr_b16 a[214:215], v149 offset:7712
    buffer_load_dwordx4 v140, s[8:11], s35 offen offset:3072  lds
    s_add_u32 m0, s38, 102400
    s_nop 0
    v_mfma_f32_16x16x32_bf16 v[16:19], a[232:235], a[24:27], v[16:19]
    ds_read_b64_tr_b16 a[216:217], v149 offset:10272
    ds_read_b64_tr_b16 a[218:219], v149 offset:12832
    v_mfma_f32_16x16x32_bf16 v[16:19], a[236:239], a[28:31], v[16:19]
    ds_read_b64_tr_b16 a[220:221], v149 offset:15392
    ds_read_b64_tr_b16 a[222:223], v149 offset:17952
    buffer_load_dwordx4 v140, s[8:11], s43 offen offset:0  lds
    s_add_u32 s34, s34, 20480
    s_waitcnt lgkmcnt(8)
    v_mfma_f32_16x16x32_bf16 v[0:3], a[192:195], a[32:35], v[0:3]
    ds_read_b64_tr_b16 a[224:225], v149 offset:64
    ds_read_b64_tr_b16 a[226:227], v149 offset:2624
    v_mfma_f32_16x16x32_bf16 v[0:3], a[196:199], a[36:39], v[0:3]
    ds_read_b64_tr_b16 a[228:229], v149 offset:5184
    ds_read_b64_tr_b16 a[230:231], v149 offset:7744
    buffer_load_dwordx4 a[0:3], v140, s[44:47], s42 offen offset:0 sc1
    v_mfma_f32_16x16x32_bf16 v[0:3], a[200:203], a[40:43], v[0:3]
    ds_read_b64_tr_b16 a[232:233], v149 offset:10304
    ds_read_b64_tr_b16 a[234:235], v149 offset:12864
    v_mfma_f32_16x16x32_bf16 v[0:3], a[204:207], a[44:47], v[0:3]
    ds_read_b64_tr_b16 a[236:237], v149 offset:15424
    ds_read_b64_tr_b16 a[238:239], v149 offset:17984
    buffer_load_dwordx4 a[4:7], v140, s[44:47], s42 offen offset:1024 sc1
    s_waitcnt lgkmcnt(8)
    v_mfma_f32_16x16x32_bf16 v[4:7], a[208:211], a[32:35], v[4:7]
    ds_read_b64_tr_b16 a[192:193], v149 offset:96
    ds_read_b64_tr_b16 a[194:195], v149 offset:2656
    v_mfma_f32_16x16x32_bf16 v[4:7], a[212:215], a[36:39], v[4:7]
    ds_read_b64_tr_b16 a[196:197], v149 offset:5216
    ds_read_b64_tr_b16 a[198:199], v149 offset:7776
    buffer_load_dwordx4 a[8:11], v140, s[44:47], s42 offen offset:2048 sc1
    v_mfma_f32_16x16x32_bf16 v[4:7], a[216:219], a[40:43], v[4:7]
    ds_read_b64_tr_b16 a[200:201], v149 offset:10336
    ds_read_b64_tr_b16 a[202:203], v149 offset:12896
    v_mfma_f32_16x16x32_bf16 v[4:7], a[220:223], a[44:47], v[4:7]
    ds_read_b64_tr_b16 a[204:205], v149 offset:15456
    ds_read_b64_tr_b16 a[206:207], v149 offset:18016
    buffer_load_dwordx4 a[12:15], v140, s[44:47], s42 offen offset:3072 sc1
    s_add_u32 s42, s42, 4096
    s_waitcnt lgkmcnt(8)
    v_mfma_f32_16x16x32_bf16 v[8:11], a[224:227], a[32:35], v[8:11]
    ds_read_b64_tr_b16 a[208:209], v149 offset:128
    ds_read_b64_tr_b16 a[210:211], v149 offset:2688
    v_mfma_f32_16x16x32_bf16 v[8:11], a[228:231], a[36:39], v[8:11]
    ds_read_b64_tr_b16 a[212:213], v149 offset:5248
    ds_read_b64_tr_b16 a[214:215], v149 offset:7808
    v_mfma_f32_16x16x32_bf16 v[8:11], a[232:235], a[40:43], v[8:11]
    ds_read_b64_tr_b16 a[216:217], v149 offset:10368
    ds_read_b64_tr_b16 a[218:219], v149 offset:12928
    v_mfma_f32_16x16x32_bf16 v[8:11], a[236:239], a[44:47], v[8:11]
    ds_read_b64_tr_b16 a[220:221], v149 offset:15488
    ds_read_b64_tr_b16 a[222:223], v149 offset:18048
    s_waitcnt vmcnt(9)
    s_barrier
    s_waitcnt lgkmcnt(8)
    v_mfma_f32_16x16x32_bf16 v[12:15], a[192:195], a[32:35], v[12:15]
    ds_read_b64_tr_b16 a[224:225], v149 offset:24576
    ds_read_b64_tr_b16 a[226:227], v149 offset:27136
    s_add_u32 s35, s34, s38
    s_add_u32 s43, s35, 4096
    s_add_u32 m0, s38, 122880
    s_nop 0
    buffer_load_dwordx4 v140, s[8:11], s35 offen offset:0  lds
    v_mfma_f32_16x16x32_bf16 v[12:15], a[196:199], a[36:39], v[12:15]
    ds_read_b64_tr_b16 a[228:229], v149 offset:29696
    ds_read_b64_tr_b16 a[230:231], v149 offset:32256
    buffer_load_dwordx4 v140, s[8:11], s35 offen offset:1024  lds
    v_mfma_f32_16x16x32_bf16 v[12:15], a[200:203], a[40:43], v[12:15]
    ds_read_b64_tr_b16 a[232:233], v149 offset:34816
    ds_read_b64_tr_b16 a[234:235], v149 offset:37376
    v_mfma_f32_16x16x32_bf16 v[12:15], a[204:207], a[44:47], v[12:15]
    ds_read_b64_tr_b16 a[236:237], v149 offset:39936
    ds_read_b64_tr_b16 a[238:239], v149 offset:42496
    buffer_load_dwordx4 v140, s[8:11], s35 offen offset:2048  lds
    s_waitcnt lgkmcnt(8)
    v_mfma_f32_16x16x32_bf16 v[16:19], a[208:211], a[32:35], v[16:19]
    ds_read_b64_tr_b16 a[192:193], v149 offset:24608
    ds_read_b64_tr_b16 a[194:195], v149 offset:27168
    v_mfma_f32_16x16x32_bf16 v[16:19], a[212:215], a[36:39], v[16:19]
    ds_read_b64_tr_b16 a[196:197], v149 offset:29728
    ds_read_b64_tr_b16 a[198:199], v149 offset:32288
    buffer_load_dwordx4 v140, s[8:11], s35 offen offset:3072  lds
    s_add_u32 m0, s38, 126976
    s_nop 0
    v_mfma_f32_16x16x32_bf16 v[16:19], a[216:219], a[40:43], v[16:19]
    ds_read_b64_tr_b16 a[200:201], v149 offset:34848
    ds_read_b64_tr_b16 a[202:203], v149 offset:37408
    v_mfma_f32_16x16x32_bf16 v[16:19], a[220:223], a[44:47], v[16:19]
    ds_read_b64_tr_b16 a[204:205], v149 offset:39968
    ds_read_b64_tr_b16 a[206:207], v149 offset:42528
    buffer_load_dwordx4 v140, s[8:11], s43 offen offset:0  lds
    s_add_u32 s34, s34, 20480
    s_waitcnt lgkmcnt(8)
    v_mfma_f32_16x16x32_bf16 v[0:3], a[224:227], a[48:51], v[0:3]
    ds_read_b64_tr_b16 a[208:209], v149 offset:24640
    ds_read_b64_tr_b16 a[210:211], v149 offset:27200
    v_mfma_f32_16x16x32_bf16 v[0:3], a[228:231], a[52:55], v[0:3]
    ds_read_b64_tr_b16 a[212:213], v149 offset:29760
    ds_read_b64_tr_b16 a[214:215], v149 offset:32320
    buffer_load_dwordx4 a[16:19], v140, s[44:47], s42 offen offset:0 sc1
    v_mfma_f32_16x16x32_bf16 v[0:3], a[232:235], a[56:59], v[0:3]
    ds_read_b64_tr_b16 a[216:217], v149 offset:34880
    ds_read_b64_tr_b16 a[218:219], v149 offset:37440
    v_mfma_f32_16x16x32_bf16 v[0:3], a[236:239], a[60:63], v[0:3]
    ds_read_b64_tr_b16 a[220:221], v149 offset:40000
    ds_read_b64_tr_b16 a[222:223], v149 offset:42560
    buffer_load_dwordx4 a[20:23], v140, s[44:47], s42 offen offset:1024 sc1
    s_waitcnt lgkmcnt(8)
    v_mfma_f32_16x16x32_bf16 v[4:7], a[192:195], a[48:51], v[4:7]
    ds_read_b64_tr_b16 a[224:225], v149 offset:24672
    ds_read_b64_tr_b16 a[226:227], v149 offset:27232
    v_mfma_f32_16x16x32_bf16 v[4:7], a[196:199], a[52:55], v[4:7]
    ds_read_b64_tr_b16 a[228:229], v149 offset:29792
    ds_read_b64_tr_b16 a[230:231], v149 offset:32352
    buffer_load_dwordx4 a[24:27], v140, s[44:47], s42 offen offset:2048 sc1
    v_mfma_f32_16x16x32_bf16 v[4:7], a[200:203], a[56:59], v[4:7]
    ds_read_b64_tr_b16 a[232:233], v149 offset:34912
    ds_read_b64_tr_b16 a[234:235], v149 offset:37472
    v_mfma_f32_16x16x32_bf16 v[4:7], a[204:207], a[60:63], v[4:7]
    ds_read_b64_tr_b16 a[236:237], v149 offset:40032
    ds_read_b64_tr_b16 a[238:239], v149 offset:42592
    buffer_load_dwordx4 a[28:31], v140, s[44:47], s42 offen offset:3072 sc1
    s_add_u32 s42, s42, 4096
    s_waitcnt lgkmcnt(8)
    v_mfma_f32_16x16x32_bf16 v[8:11], a[208:211], a[48:51], v[8:11]
    ds_read_b64_tr_b16 a[192:193], v149 offset:24704
    ds_read_b64_tr_b16 a[194:195], v149 offset:27264
    v_mfma_f32_16x16x32_bf16 v[8:11], a[212:215], a[52:55], v[8:11]
    ds_read_b64_tr_b16 a[196:197], v149 offset:29824
    ds_read_b64_tr_b16 a[198:199], v149 offset:32384
    v_mfma_f32_16x16x32_bf16 v[8:11], a[216:219], a[56:59], v[8:11]
    ds_read_b64_tr_b16 a[200:201], v149 offset:34944
    ds_read_b64_tr_b16 a[202:203], v149 offset:37504
    v_mfma_f32_16x16x32_bf16 v[8:11], a[220:223], a[60:63], v[8:11]
    ds_read_b64_tr_b16 a[204:205], v149 offset:40064
    ds_read_b64_tr_b16 a[206:207], v149 offset:42624
    s_waitcnt vmcnt(9)
    s_barrier
    s_waitcnt lgkmcnt(8)
    v_mfma_f32_16x16x32_bf16 v[12:15], a[224:227], a[48:51], v[12:15]
    ds_read_b64_tr_b16 a[208:209], v150 offset:0
    ds_read_b64_tr_b16 a[210:211], v150 offset:2560
    s_add_u32 s35, s34, s38
    s_add_u32 s43, s35, 4096
    s_add_u32 m0, s38, 0
    s_nop 0
    buffer_load_dwordx4 v140, s[8:11], s35 offen offset:0  lds
    v_mfma_f32_16x16x32_bf16 v[12:15], a[228:231], a[52:55], v[12:15]
    ds_read_b64_tr_b16 a[212:213], v150 offset:5120
    ds_read_b64_tr_b16 a[214:215], v150 offset:7680
    buffer_load_dwordx4 v140, s[8:11], s35 offen offset:1024  lds
    v_mfma_f32_16x16x32_bf16 v[12:15], a[232:235], a[56:59], v[12:15]
    ds_read_b64_tr_b16 a[216:217], v150 offset:10240
    ds_read_b64_tr_b16 a[218:219], v150 offset:12800
    v_mfma_f32_16x16x32_bf16 v[12:15], a[236:239], a[60:63], v[12:15]
    ds_read_b64_tr_b16 a[220:221], v150 offset:15360
    ds_read_b64_tr_b16 a[222:223], v150 offset:17920
    buffer_load_dwordx4 v140, s[8:11], s35 offen offset:2048  lds
    s_waitcnt lgkmcnt(8)
    v_mfma_f32_16x16x32_bf16 v[16:19], a[192:195], a[48:51], v[16:19]
    ds_read_b64_tr_b16 a[224:225], v150 offset:32
    ds_read_b64_tr_b16 a[226:227], v150 offset:2592
    v_mfma_f32_16x16x32_bf16 v[16:19], a[196:199], a[52:55], v[16:19]
    ds_read_b64_tr_b16 a[228:229], v150 offset:5152
    ds_read_b64_tr_b16 a[230:231], v150 offset:7712
    buffer_load_dwordx4 v140, s[8:11], s35 offen offset:3072  lds
    s_add_u32 m0, s38, 4096
    s_nop 0
    v_mfma_f32_16x16x32_bf16 v[16:19], a[200:203], a[56:59], v[16:19]
    ds_read_b64_tr_b16 a[232:233], v150 offset:10272
    ds_read_b64_tr_b16 a[234:235], v150 offset:12832
    v_mfma_f32_16x16x32_bf16 v[16:19], a[204:207], a[60:63], v[16:19]
    ds_read_b64_tr_b16 a[236:237], v150 offset:15392
    ds_read_b64_tr_b16 a[238:239], v150 offset:17952
    buffer_load_dwordx4 v140, s[8:11], s43 offen offset:0  lds
    s_add_u32 s34, s34, 20480
    s_waitcnt lgkmcnt(8)
    v_mfma_f32_16x16x32_bf16 v[0:3], a[208:211], a[0:3], v[0:3]
    ds_read_b64_tr_b16 a[192:193], v150 offset:64
    ds_read_b64_tr_b16 a[194:195], v150 offset:2624
    v_mfma_f32_16x16x32_bf16 v[0:3], a[212:215], a[4:7], v[0:3]
    ds_read_b64_tr_b16 a[196:197], v150 offset:5184
    ds_read_b64_tr_b16 a[198:199], v150 offset:7744
    buffer_load_dwordx4 a[32:35], v140, s[44:47], s42 offen offset:0 sc1
    v_mfma_f32_16x16x32_bf16 v[0:3], a[216:219], a[8:11], v[0:3]
    ds_read_b64_tr_b16 a[200:201], v150 offset:10304
    ds_read_b64_tr_b16 a[202:203], v150 offset:12864
    v_mfma_f32_16x16x32_bf16 v[0:3], a[220:223], a[12:15], v[0:3]
    ds_read_b64_tr_b16 a[204:205], v150 offset:15424
    ds_read_b64_tr_b16 a[206:207], v150 offset:17984
    buffer_load_dwordx4 a[36:39], v140, s[44:47], s42 offen offset:1024 sc1
    s_waitcnt lgkmcnt(8)
    v_mfma_f32_16x16x32_bf16 v[4:7], a[224:227], a[0:3], v[4:7]
    ds_read_b64_tr_b16 a[208:209], v150 offset:96
    ds_read_b64_tr_b16 a[210:211], v150 offset:2656
    v_mfma_f32_16x16x32_bf16 v[4:7], a[228:231], a[4:7], v[4:7]
    ds_read_b64_tr_b16 a[212:213], v150 offset:5216
    ds_read_b64_tr_b16 a[214:215], v150 offset:7776
    buffer_load_dwordx4 a[40:43], v140, s[44:47], s42 offen offset:2048 sc1
    v_mfma_f32_16x16x32_bf16 v[4:7], a[232:235], a[8:11], v[4:7]
    ds_read_b64_tr_b16 a[216:217], v150 offset:10336
    ds_read_b64_tr_b16 a[218:219], v150 offset:12896
    v_mfma_f32_16x16x32_bf16 v[4:7], a[236:239], a[12:15], v[4:7]
    ds_read_b64_tr_b16 a[220:221], v150 offset:15456
    ds_read_b64_tr_b16 a[222:223], v150 offset:18016
    buffer_load_dwordx4 a[44:47], v140, s[44:47], s42 offen offset:3072 sc1
    s_add_u32 s42, s42, 4096
    s_waitcnt lgkmcnt(8)
    v_mfma_f32_16x16x32_bf16 v[8:11], a[192:195], a[0:3], v[8:11]
    ds_read_b64_tr_b16 a[224:225], v150 offset:128
    ds_read_b64_tr_b16 a[226:227], v150 offset:2688
    v_mfma_f32_16x16x32_bf16 v[8:11], a[196:199], a[4:7], v[8:11]
    ds_read_b64_tr_b16 a[228:229], v150 offset:5248
    ds_read_b64_tr_b16 a[230:231], v150 offset:7808
    v_mfma_f32_16x16x32_bf16 v[8:11], a[200:203], a[8:11], v[8:11]
    ds_read_b64_tr_b16 a[232:233], v150 offset:10368
    ds_read_b64_tr_b16 a[234:235], v150 offset:12928
    v_mfma_f32_16x16x32_bf16 v[8:11], a[204:207], a[12:15], v[8:11]
    ds_read_b64_tr_b16 a[236:237], v150 offset:15488
    ds_read_b64_tr_b16 a[238:239], v150 offset:18048
    s_waitcnt vmcnt(9)
    s_barrier
    s_waitcnt lgkmcnt(8)
    v_mfma_f32_16x16x32_bf16 v[12:15], a[208:211], a[0:3], v[12:15]
    ds_read_b64_tr_b16 a[192:193], v150 offset:24576
    ds_read_b64_tr_b16 a[194:195], v150 offset:27136
    s_add_u32 s35, s34, s38
    s_add_u32 s43, s35, 4096
    s_add_u32 m0, s38, 24576
    s_nop 0
    buffer_load_dwordx4 v140, s[8:11], s35 offen offset:0  lds
    v_mfma_f32_16x16x32_bf16 v[12:15], a[212:215], a[4:7], v[12:15]
    ds_read_b64_tr_b16 a[196:197], v150 offset:29696
    ds_read_b64_tr_b16 a[198:199], v150 offset:32256
    buffer_load_dwordx4 v140, s[8:11], s35 offen offset:1024  lds
    v_mfma_f32_16x16x32_bf16 v[12:15], a[216:219], a[8:11], v[12:15]
    ds_read_b64_tr_b16 a[200:201], v150 offset:34816
    ds_read_b64_tr_b16 a[202:203], v150 offset:37376
    v_mfma_f32_16x16x32_bf16 v[12:15], a[220:223], a[12:15], v[12:15]
    ds_read_b64_tr_b16 a[204:205], v150 offset:39936
    ds_read_b64_tr_b16 a[206:207], v150 offset:42496
    buffer_load_dwordx4 v140, s[8:11], s35 offen offset:2048  lds
    s_waitcnt lgkmcnt(8)
    v_mfma_f32_16x16x32_bf16 v[16:19], a[224:227], a[0:3], v[16:19]
    ds_read_b64_tr_b16 a[208:209], v150 offset:24608
    ds_read_b64_tr_b16 a[210:211], v150 offset:27168
    v_mfma_f32_16x16x32_bf16 v[16:19], a[228:231], a[4:7], v[16:19]
    ds_read_b64_tr_b16 a[212:213], v150 offset:29728
    ds_read_b64_tr_b16 a[214:215], v150 offset:32288
    buffer_load_dwordx4 v140, s[8:11], s35 offen offset:3072  lds
    s_add_u32 m0, s38, 28672
    s_nop 0
    v_mfma_f32_16x16x32_bf16 v[16:19], a[232:235], a[8:11], v[16:19]
    ds_read_b64_tr_b16 a[216:217], v150 offset:34848
    ds_read_b64_tr_b16 a[218:219], v150 offset:37408
    v_mfma_f32_16x16x32_bf16 v[16:19], a[236:239], a[12:15], v[16:19]
    ds_read_b64_tr_b16 a[220:221], v150 offset:39968
    ds_read_b64_tr_b16 a[222:223], v150 offset:42528
    buffer_load_dwordx4 v140, s[8:11], s43 offen offset:0  lds
    s_add_u32 s34, s34, 20480
    s_waitcnt lgkmcnt(8)
    v_mfma_f32_16x16x32_bf16 v[0:3], a[192:195], a[16:19], v[0:3]
    ds_read_b64_tr_b16 a[224:225], v150 offset:24640
    ds_read_b64_tr_b16 a[226:227], v150 offset:27200
    v_mfma_f32_16x16x32_bf16 v[0:3], a[196:199], a[20:23], v[0:3]
    ds_read_b64_tr_b16 a[228:229], v150 offset:29760
    ds_read_b64_tr_b16 a[230:231], v150 offset:32320
    buffer_load_dwordx4 a[48:51], v140, s[44:47], s42 offen offset:0 sc1
    v_mfma_f32_16x16x32_bf16 v[0:3], a[200:203], a[24:27], v[0:3]
    ds_read_b64_tr_b16 a[232:233], v150 offset:34880
    ds_read_b64_tr_b16 a[234:235], v150 offset:37440
    v_mfma_f32_16x16x32_bf16 v[0:3], a[204:207], a[28:31], v[0:3]
    ds_read_b64_tr_b16 a[236:237], v150 offset:40000
    ds_read_b64_tr_b16 a[238:239], v150 offset:42560
    buffer_load_dwordx4 a[52:55], v140, s[44:47], s42 offen offset:1024 sc1
    s_waitcnt lgkmcnt(8)
    v_mfma_f32_16x16x32_bf16 v[4:7], a[208:211], a[16:19], v[4:7]
    ds_read_b64_tr_b16 a[192:193], v150 offset:24672
    ds_read_b64_tr_b16 a[194:195], v150 offset:27232
    v_mfma_f32_16x16x32_bf16 v[4:7], a[212:215], a[20:23], v[4:7]
    ds_read_b64_tr_b16 a[196:197], v150 offset:29792
    ds_read_b64_tr_b16 a[198:199], v150 offset:32352
    buffer_load_dwordx4 a[56:59], v140, s[44:47], s42 offen offset:2048 sc1
    v_mfma_f32_16x16x32_bf16 v[4:7], a[216:219], a[24:27], v[4:7]
    ds_read_b64_tr_b16 a[200:201], v150 offset:34912
    ds_read_b64_tr_b16 a[202:203], v150 offset:37472
    v_mfma_f32_16x16x32_bf16 v[4:7], a[220:223], a[28:31], v[4:7]
    ds_read_b64_tr_b16 a[204:205], v150 offset:40032
    ds_read_b64_tr_b16 a[206:207], v150 offset:42592
    buffer_load_dwordx4 a[60:63], v140, s[44:47], s42 offen offset:3072 sc1
    s_add_u32 s42, s42, 4096
    s_waitcnt lgkmcnt(8)
    v_mfma_f32_16x16x32_bf16 v[8:11], a[224:227], a[16:19], v[8:11]
    ds_read_b64_tr_b16 a[208:209], v150 offset:24704
    ds_read_b64_tr_b16 a[210:211], v150 offset:27264
    v_mfma_f32_16x16x32_bf16 v[8:11], a[228:231], a[20:23], v[8:11]
    ds_read_b64_tr_b16 a[212:213], v150 offset:29824
    ds_read_b64_tr_b16 a[214:215], v150 offset:32384
    v_mfma_f32_16x16x32_bf16 v[8:11], a[232:235], a[24:27], v[8:11]
    ds_read_b64_tr_b16 a[216:217], v150 offset:34944
    ds_read_b64_tr_b16 a[218:219], v150 offset:37504
    v_mfma_f32_16x16x32_bf16 v[8:11], a[236:239], a[28:31], v[8:11]
    ds_read_b64_tr_b16 a[220:221], v150 offset:40064
    ds_read_b64_tr_b16 a[222:223], v150 offset:42624
    s_waitcnt vmcnt(9)
    s_barrier
    s_waitcnt lgkmcnt(8)
    v_mfma_f32_16x16x32_bf16 v[12:15], a[192:195], a[16:19], v[12:15]
    ds_read_b64_tr_b16 a[224:225], v148 offset:0
    ds_read_b64_tr_b16 a[226:227], v148 offset:2560
    buffer_load_dwordx4 v[48:51], v141, s[60:63], s0 offen offset:0 sc1
    v_mfma_f32_16x16x32_bf16 v[12:15], a[196:199], a[20:23], v[12:15]
    ds_read_b64_tr_b16 a[228:229], v148 offset:5120
    ds_read_b64_tr_b16 a[230:231], v148 offset:7680
    buffer_load_dwordx4 v[52:55], v141, s[60:63], s0 offen offset:1024 sc1
    v_mfma_f32_16x16x32_bf16 v[12:15], a[200:203], a[24:27], v[12:15]
    ds_read_b64_tr_b16 a[232:233], v148 offset:10240
    ds_read_b64_tr_b16 a[234:235], v148 offset:12800
    v_mfma_f32_16x16x32_bf16 v[12:15], a[204:207], a[28:31], v[12:15]
    ds_read_b64_tr_b16 a[236:237], v148 offset:15360
    ds_read_b64_tr_b16 a[238:239], v148 offset:17920
    buffer_load_dwordx2 v[56:57], v141, s[60:63], s0 offen offset:2048 sc1
    s_waitcnt lgkmcnt(8)
    v_mfma_f32_16x16x32_bf16 v[16:19], a[208:211], a[16:19], v[16:19]
    ds_read_b64_tr_b16 a[192:193], v148 offset:32
    ds_read_b64_tr_b16 a[194:195], v148 offset:2592
    buffer_load_dwordx2 v[58:59], v141, s[60:63], s1 offen offset:8 sc1
    v_mfma_f32_16x16x32_bf16 v[16:19], a[212:215], a[20:23], v[16:19]
    ds_read_b64_tr_b16 a[196:197], v148 offset:5152
    ds_read_b64_tr_b16 a[198:199], v148 offset:7712
    v_mfma_f32_16x16x32_bf16 v[16:19], a[216:219], a[24:27], v[16:19]
    ds_read_b64_tr_b16 a[200:201], v148 offset:10272
    ds_read_b64_tr_b16 a[202:203], v148 offset:12832
    buffer_load_dwordx4 v[60:63], v141, s[60:63], s1 offen offset:1024 sc1
    v_mfma_f32_16x16x32_bf16 v[16:19], a[220:223], a[28:31], v[16:19]
    ds_read_b64_tr_b16 a[204:205], v148 offset:15392
    ds_read_b64_tr_b16 a[206:207], v148 offset:17952
    s_waitcnt lgkmcnt(8)
    v_mfma_f32_16x16x32_bf16 v[0:3], a[224:227], a[32:35], v[0:3]
    ds_read_b64_tr_b16 a[208:209], v148 offset:64
    ds_read_b64_tr_b16 a[210:211], v148 offset:2624
    buffer_load_dwordx4 v[64:67], v141, s[60:63], s1 offen offset:2048 sc1
    v_mfma_f32_16x16x32_bf16 v[0:3], a[228:231], a[36:39], v[0:3]
    ds_read_b64_tr_b16 a[212:213], v148 offset:5184
    ds_read_b64_tr_b16 a[214:215], v148 offset:7744
    buffer_load_dwordx4 v[68:71], v166, s[28:31], s4 offen offset:0
    v_mfma_f32_16x16x32_bf16 v[0:3], a[232:235], a[40:43], v[0:3]
    ds_read_b64_tr_b16 a[216:217], v148 offset:10304
    ds_read_b64_tr_b16 a[218:219], v148 offset:12864
    v_mfma_f32_16x16x32_bf16 v[0:3], a[236:239], a[44:47], v[0:3]
    ds_read_b64_tr_b16 a[220:221], v148 offset:15424
    ds_read_b64_tr_b16 a[222:223], v148 offset:17984
    buffer_load_dwordx4 v[72:75], v166, s[28:31], s4 offen offset:64
    s_waitcnt lgkmcnt(8)
    v_mfma_f32_16x16x32_bf16 v[4:7], a[192:195], a[32:35], v[4:7]
    ds_read_b64_tr_b16 a[224:225], v148 offset:96
    ds_read_b64_tr_b16 a[226:227], v148 offset:2656
    v_mfma_f32_16x16x32_bf16 v[4:7], a[196:199], a[36:39], v[4:7]
    ds_read_b64_tr_b16 a[228:229], v148 offset:5216
    ds_read_b64_tr_b16 a[230:231], v148 offset:7776
    buffer_load_dwordx4 v[76:79], v166, s[28:31], s4 offen offset:128
    v_mfma_f32_16x16x32_bf16 v[4:7], a[200:203], a[40:43], v[4:7]
    ds_read_b64_tr_b16 a[232:233], v148 offset:10336
    ds_read_b64_tr_b16 a[234:235], v148 offset:12896
    buffer_load_dwordx4 v[80:83], v166, s[28:31], s4 offen offset:192
    v_mfma_f32_16x16x32_bf16 v[4:7], a[204:207], a[44:47], v[4:7]
    ds_read_b64_tr_b16 a[236:237], v148 offset:15456
    ds_read_b64_tr_b16 a[238:239], v148 offset:18016
    s_waitcnt lgkmcnt(8)
    v_mfma_f32_16x16x32_bf16 v[8:11], a[208:211], a[32:35], v[8:11]
    ds_read_b64_tr_b16 a[192:193], v148 offset:128
    ds_read_b64_tr_b16 a[194:195], v148 offset:2688
    buffer_load_dwordx4 v[84:87], v166, s[28:31], s4 offen offset:256
    v_mfma_f32_16x16x32_bf16 v[8:11], a[212:215], a[36:39], v[8:11]
    ds_read_b64_tr_b16 a[196:197], v148 offset:5248
    ds_read_b64_tr_b16 a[198:199], v148 offset:7808
    v_mfma_f32_16x16x32_bf16 v[8:11], a[216:219], a[40:43], v[8:11]
    ds_read_b64_tr_b16 a[200:201], v148 offset:10368
    ds_read_b64_tr_b16 a[202:203], v148 offset:12928
    v_mfma_f32_16x16x32_bf16 v[8:11], a[220:223], a[44:47], v[8:11]
    ds_read_b64_tr_b16 a[204:205], v148 offset:15488
    ds_read_b64_tr_b16 a[206:207], v148 offset:18048
    s_waitcnt vmcnt(11)
    s_barrier
    s_waitcnt lgkmcnt(8)
    v_mfma_f32_16x16x32_bf16 v[12:15], a[224:227], a[32:35], v[12:15]
    ds_read_b64_tr_b16 a[208:209], v148 offset:24576
    ds_read_b64_tr_b16 a[210:211], v148 offset:27136
    v_mfma_f32_16x16x32_bf16 v[12:15], a[228:231], a[36:39], v[12:15]
    ds_read_b64_tr_b16 a[212:213], v148 offset:29696
    ds_read_b64_tr_b16 a[214:215], v148 offset:32256
    v_mfma_f32_16x16x32_bf16 v[12:15], a[232:235], a[40:43], v[12:15]
    ds_read_b64_tr_b16 a[216:217], v148 offset:34816
    ds_read_b64_tr_b16 a[218:219], v148 offset:37376
    v_mfma_f32_16x16x32_bf16 v[12:15], a[236:239], a[44:47], v[12:15]
    ds_read_b64_tr_b16 a[220:221], v148 offset:39936
    ds_read_b64_tr_b16 a[222:223], v148 offset:42496
    s_waitcnt lgkmcnt(8)
    v_mfma_f32_16x16x32_bf16 v[16:19], a[192:195], a[32:35], v[16:19]
    ds_read_b64_tr_b16 a[224:225], v148 offset:24608
    ds_read_b64_tr_b16 a[226:227], v148 offset:27168
    v_mfma_f32_16x16x32_bf16 v[16:19], a[196:199], a[36:39], v[16:19]
    ds_read_b64_tr_b16 a[228:229], v148 offset:29728
    ds_read_b64_tr_b16 a[230:231], v148 offset:32288
    v_mfma_f32_16x16x32_bf16 v[16:19], a[200:203], a[40:43], v[16:19]
    ds_read_b64_tr_b16 a[232:233], v148 offset:34848
    ds_read_b64_tr_b16 a[234:235], v148 offset:37408
    v_mfma_f32_16x16x32_bf16 v[16:19], a[204:207], a[44:47], v[16:19]
    ds_read_b64_tr_b16 a[236:237], v148 offset:39968
    ds_read_b64_tr_b16 a[238:239], v148 offset:42528
    s_waitcnt lgkmcnt(8)
    v_mfma_f32_16x16x32_bf16 v[0:3], a[208:211], a[48:51], v[0:3]
    ds_read_b64_tr_b16 a[192:193], v148 offset:24640
    ds_read_b64_tr_b16 a[194:195], v148 offset:27200
    v_mfma_f32_16x16x32_bf16 v[0:3], a[212:215], a[52:55], v[0:3]
    ds_read_b64_tr_b16 a[196:197], v148 offset:29760
    ds_read_b64_tr_b16 a[198:199], v148 offset:32320
    v_mfma_f32_16x16x32_bf16 v[0:3], a[216:219], a[56:59], v[0:3]
    ds_read_b64_tr_b16 a[200:201], v148 offset:34880
    ds_read_b64_tr_b16 a[202:203], v148 offset:37440
    v_mfma_f32_16x16x32_bf16 v[0:3], a[220:223], a[60:63], v[0:3]
    ds_read_b64_tr_b16 a[204:205], v148 offset:40000
    ds_read_b64_tr_b16 a[206:207], v148 offset:42560
    s_waitcnt lgkmcnt(8)
    v_mfma_f32_16x16x32_bf16 v[4:7], a[224:227], a[48:51], v[4:7]
    ds_read_b64_tr_b16 a[208:209], v148 offset:24672
    ds_read_b64_tr_b16 a[210:211], v148 offset:27232
    v_mfma_f32_16x16x32_bf16 v[4:7], a[228:231], a[52:55], v[4:7]
    ds_read_b64_tr_b16 a[212:213], v148 offset:29792
    ds_read_b64_tr_b16 a[214:215], v148 offset:32352
    v_mfma_f32_16x16x32_bf16 v[4:7], a[232:235], a[56:59], v[4:7]
    ds_read_b64_tr_b16 a[216:217], v148 offset:34912
    ds_read_b64_tr_b16 a[218:219], v148 offset:37472
    v_mfma_f32_16x16x32_bf16 v[4:7], a[236:239], a[60:63], v[4:7]
    ds_read_b64_tr_b16 a[220:221], v148 offset:40032
    ds_read_b64_tr_b16 a[222:223], v148 offset:42592
    s_waitcnt lgkmcnt(8)
    v_mfma_f32_16x16x32_bf16 v[8:11], a[192:195], a[48:51], v[8:11]
    ds_read_b64_tr_b16 a[224:225], v148 offset:24704
    ds_read_b64_tr_b16 a[226:227], v148 offset:27264
    v_mfma_f32_16x16x32_bf16 v[8:11], a[196:199], a[52:55], v[8:11]
    ds_read_b64_tr_b16 a[228:229], v148 offset:29824
    ds_read_b64_tr_b16 a[230:231], v148 offset:32384
    v_mfma_f32_16x16x32_bf16 v[8:11], a[200:203], a[56:59], v[8:11]
    ds_read_b64_tr_b16 a[232:233], v148 offset:34944
    ds_read_b64_tr_b16 a[234:235], v148 offset:37504
    v_mfma_f32_16x16x32_bf16 v[8:11], a[204:207], a[60:63], v[8:11]
    ds_read_b64_tr_b16 a[236:237], v148 offset:40064
    ds_read_b64_tr_b16 a[238:239], v148 offset:42624
    s_waitcnt lgkmcnt(8)
    v_mfma_f32_16x16x32_bf16 v[12:15], a[208:211], a[48:51], v[12:15]
    v_mfma_f32_16x16x32_bf16 v[12:15], a[212:215], a[52:55], v[12:15]
    v_mfma_f32_16x16x32_bf16 v[12:15], a[216:219], a[56:59], v[12:15]
    v_mfma_f32_16x16x32_bf16 v[12:15], a[220:223], a[60:63], v[12:15]
    s_waitcnt lgkmcnt(0)
    v_mfma_f32_16x16x32_bf16 v[16:19], a[224:227], a[48:51], v[16:19]
    v_mfma_f32_16x16x32_bf16 v[16:19], a[228:231], a[52:55], v[16:19]
    v_mfma_f32_16x16x32_bf16 v[16:19], a[232:235], a[56:59], v[16:19]
    v_mfma_f32_16x16x32_bf16 v[16:19], a[236:239], a[60:63], v[16:19]
    s_waitcnt vmcnt(0)
    v_or_b32 v48, v48, v58
    v_or_b32 v49, v49, v59
    v_or_b32 v50, v50, v60
    v_or_b32 v51, v51, v61
    v_or_b32 v52, v52, v62
    v_or_b32 v53, v53, v63
    v_or_b32 v54, v54, v64
    v_or_b32 v55, v55, v65
    v_or_b32 v56, v56, v66
    v_or_b32 v57, v57, v67
    v_dot2c_f32_bf16 v0, v128, v190
    v_dot2c_f32_bf16 v1, v128, v191
    v_dot2c_f32_bf16 v2, v129, v190
    v_dot2c_f32_bf16 v3, v129, v191
    v_dot2c_f32_bf16 v4, v130, v190
    v_dot2c_f32_bf16 v5, v130, v191
    v_dot2c_f32_bf16 v6, v131, v190
    v_dot2c_f32_bf16 v7, v131, v191
    v_dot2c_f32_bf16 v8, v132, v190
    v_dot2c_f32_bf16 v9, v132, v191
    v_dot2c_f32_bf16 v10, v133, v190
    v_dot2c_f32_bf16 v11, v133, v191
    v_dot2c_f32_bf16 v12, v134, v190
    v_dot2c_f32_bf16 v13, v134, v191
    v_dot2c_f32_bf16 v14, v135, v190
    v_dot2c_f32_bf16 v15, v135, v191
    v_dot2c_f32_bf16 v16, v136, v190
    v_dot2c_f32_bf16 v17, v136, v191
    v_dot2c_f32_bf16 v18, v137, v190
    v_dot2c_f32_bf16 v19, v137, v191
    v_lshlrev_b32 v108, 16, v48
    v_and_b32 v109, 0xffff0000, v48
    v_lshlrev_b32 v110, 16, v49
    v_and_b32 v111, 0xffff0000, v49
    v_lshlrev_b32 v112, 16, v50
    v_and_b32 v113, 0xffff0000, v50
    v_lshlrev_b32 v114, 16, v51
    v_and_b32 v115, 0xffff0000, v51
    v_lshlrev_b32 v116, 16, v52
    v_and_b32 v117, 0xffff0000, v52
    v_lshlrev_b32 v118, 16, v53
    v_and_b32 v119, 0xffff0000, v53
    v_lshlrev_b32 v120, 16, v54
    v_and_b32 v121, 0xffff0000, v54
    v_lshlrev_b32 v122, 16, v55
    v_and_b32 v123, 0xffff0000, v55
    v_lshlrev_b32 v124, 16, v56
    v_and_b32 v125, 0xffff0000, v56
    v_lshlrev_b32 v126, 16, v57
    v_and_b32 v127, 0xffff0000, v57
    v_pk_fma_f32 v[0:1], v[0:1], v[68:69], v[108:109]
    v_pk_fma_f32 v[2:3], v[2:3], v[70:71], v[110:111]
    v_pk_fma_f32 v[4:5], v[4:5], v[72:73], v[112:113]
    v_pk_fma_f32 v[6:7], v[6:7], v[74:75], v[114:115]
    v_pk_fma_f32 v[8:9], v[8:9], v[76:77], v[116:117]
    v_pk_fma_f32 v[10:11], v[10:11], v[78:79], v[118:119]
    v_pk_fma_f32 v[12:13], v[12:13], v[80:81], v[120:121]
    v_pk_fma_f32 v[14:15], v[14:15], v[82:83], v[122:123]
    v_pk_fma_f32 v[16:17], v[16:17], v[84:85], v[124:125]
    v_pk_fma_f32 v[18:19], v[18:19], v[86:87], v[126:127]
    v_cvt_pk_bf16_f32 v88, v0, v1
    v_cvt_pk_bf16_f32 v89, v2, v3
    v_cvt_pk_bf16_f32 v90, v4, v5
    v_cvt_pk_bf16_f32 v91, v6, v7
    v_cvt_pk_bf16_f32 v92, v8, v9
    v_cvt_pk_bf16_f32 v93, v10, v11
    v_cvt_pk_bf16_f32 v94, v12, v13
    v_cvt_pk_bf16_f32 v95, v14, v15
    v_cvt_pk_bf16_f32 v96, v16, v17
    v_cvt_pk_bf16_f32 v97, v18, v19
    buffer_store_dwordx2 v[96:97], v167, s[84:87], s5 offen offset:128
    v_permlane16_swap_b32 v88, v90
    v_permlane16_swap_b32 v89, v91
    buffer_store_dwordx4 v[88:91], v169, s[84:87], s5 offen offset:0
    v_permlane16_swap_b32 v92, v94
    v_permlane16_swap_b32 v93, v95
    buffer_store_dwordx4 v[92:95], v169, s[84:87], s5 offen offset:64
    s_endpgm
L_attn_tailcode_end:
L_tail_aspin800:
    buffer_load_dword v173, v160, s[52:55], s36 offen sc1
    s_waitcnt vmcnt(0)
    v_cmp_ne_u32 vcc, 1, v173
    s_sub_u32 s37, s37, 1
    s_nop 3
    s_cbranch_vccz L_tail_aok800
    s_cmp_lg_u32 s37, 0
    s_cbranch_scc1 L_tail_aspin800
    s_branch L_tail_aok800
L_tail_aspin500:
    buffer_load_dword v173, v160, s[52:55], s36 offen sc1
    s_waitcnt vmcnt(0)
    v_cmp_ne_u32 vcc, 1, v173
    s_sub_u32 s37, s37, 1
    s_nop 3
    s_cbranch_vccz L_tail_aok500
    s_cmp_lg_u32 s37, 0
    s_cbranch_scc1 L_tail_aspin500
    s_branch L_tail_aok500
L_tail_w0_0:
    s_mov_b32 s34, 0
    s_add_u32 s8, s6, s17
    s_addc_u32 s9, s7, 0
    s_mov_b32 s10, 102400
    s_mov_b32 s11, 0x20000
    s_add_u32 s34, s34, 20480
    s_add_u32 s34, s34, 20480
    s_add_u32 s34, s34, 20480
    s_mov_b32 s37, 0x100000
L_tail_poll0:
    buffer_load_dword v172, v159, s[52:55], s36 offen sc1
    s_waitcnt vmcnt(0)
    v_cmp_ne_u32 vcc, 1, v172
    s_sub_u32 s37, s37, 1
    s_nop 3
    s_cbranch_vccz L_tail_got0
    s_cmp_eq_u32 s37, 0
    s_cbranch_scc1 L_tail_got0
    s_branch L_tail_poll0
L_tail_w0_1:
    s_add_u32 s34, s34, 20480
    s_mov_b32 s34, 0
    s_add_u32 s8, s6, s18
    s_addc_u32 s9, s7, 0
    s_mov_b32 s10, 102400
    s_mov_b32 s11, 0x20000
    s_add_u32 s34, s34, 20480
    s_mov_b32 s37, 0x100000
L_tail_poll1:
    buffer_load_dword v172, v143, s[52:55], s36 offen sc1
    s_waitcnt vmcnt(0)
    v_cmp_ne_u32 vcc, 1, v172
    s_sub_u32 s37, s37, 1
    s_nop 3
    s_cbranch_vccz L_tail_got1
    s_cmp_eq_u32 s37, 0
    s_cbranch_scc1 L_tail_got1
    s_branch L_tail_poll1
L_tail_w0_2:
    s_add_u32 s34, s34, 20480
    s_add_u32 s34, s34, 20480
    s_add_u32 s34, s34, 20480
    s_mov_b32 s37, 0x100000
L_tail_poll2:
    buffer_load_dword v172, v144, s[52:55], s36 offen sc1
    s_waitcnt vmcnt(0)
    v_cmp_ne_u32 vcc, 1, v172
    s_sub_u32 s37, s37, 1
    s_nop 3
    s_cbranch_vccz L_tail_got2
    s_cmp_eq_u32 s37, 0
    s_cbranch_scc1 L_tail_got2
    s_branch L_tail_poll2
L_tail_w0_3:
    s_add_u32 s34, s34, 24576
    s_add_u32 s34, s34, 24576
    s_add_u32 s34, s34, 24576
    s_mov_b32 s37, 0x100000
L_tail_poll3:
    buffer_load_dword v172, v145, s[52:55], s36 offen sc1
    s_waitcnt vmcnt(0)
    v_cmp_ne_u32 vcc, 1, v172
    s_sub_u32 s37, s37, 1
    s_nop 3
    s_cbranch_vccz L_tail_got3
    s_cmp_eq_u32 s37, 0
    s_cbranch_scc1 L_tail_got3
    s_branch L_tail_poll3
L_tail_w0_4:
    s_add_u32 s34, s34, 20480
    s_add_u32 s34, s34, 20480
    s_add_u32 s34, s34, 20480
    s_mov_b32 s37, 0x100000
L_tail_poll4:
    buffer_load_dword v172, v145, s[52:55], s36 offen sc1
    s_waitcnt vmcnt(0)
    v_cmp_ne_u32 vcc, 1, v172
    s_sub_u32 s37, s37, 1
    s_nop 3
    s_cbranch_vccz L_tail_got4
    s_cmp_eq_u32 s37, 0
    s_cbranch_scc1 L_tail_got4
    s_branch L_tail_poll4
L_attn_fallback:
    s_waitcnt vmcnt(0) lgkmcnt(0)
    s_barrier
    s_mov_b32 s29, 1
    s_mov_b32 s26, 0
    s_mov_b32 s28, 64
    v_mov_b32 v208, v214
    v_mov_b32 v209, v215
L_attn_fb_loop:
    s_add_u32 m0, s25, 0
    s_nop 0
    buffer_load_dwordx4 v220, s[4:7], s26 offen offset:0  lds
    buffer_load_dwordx4 v221, s[4:7], s26 offen offset:1024  lds
    buffer_load_dwordx4 v222, s[4:7], s26 offen offset:2048  lds
    s_add_u32 s26, s26, 12288
    s_waitcnt vmcnt(0)
    s_barrier
    ds_read_b128 a[192:195], v208 offset:0
    ds_read_b128 a[196:199], v209 offset:0
    ds_read_b128 a[200:203], v208 offset:128
    ds_read_b128 a[204:207], v209 offset:128
    ds_read_b128 a[208:211], v208 offset:256
    ds_read_b128 a[212:215], v209 offset:256
    s_waitcnt lgkmcnt(0)
    v_mfma_f32_16x16x32_bf16 v[96:99], a[192:195], v[0:3], 0
    v_mfma_f32_16x16x32_bf16 v[96:99], a[196:199], v[16:19], v[96:99]
    v_mfma_f32_16x16x32_bf16 v[96:99], a[200:203], v[32:35], v[96:99]
    v_mfma_f32_16x16x32_bf16 v[96:99], a[204:207], v[48:51], v[96:99]
    v_mfma_f32_16x16x32_bf16 v[96:99], a[208:211], v[64:67], v[96:99]
    v_mfma_f32_16x16x32_bf16 v[96:99], a[212:215], v[80:83], v[96:99]
    v_mfma_f32_16x16x32_bf16 v[100:103], a[192:195], v[4:7], 0
    v_mfma_f32_16x16x32_bf16 v[100:103], a[196:199], v[20:23], v[100:103]
    v_mfma_f32_16x16x32_bf16 v[100:103], a[200:203], v[36:39], v[100:103]
    v_mfma_f32_16x16x32_bf16 v[100:103], a[204:207], v[52:55], v[100:103]
    v_mfma_f32_16x16x32_bf16 v[100:103], a[208:211], v[68:71], v[100:103]
    v_mfma_f32_16x16x32_bf16 v[100:103], a[212:215], v[84:87], v[100:103]
    v_mfma_f32_16x16x32_bf16 v[104:107], a[192:195], v[8:11], 0
    v_mfma_f32_16x16x32_bf16 v[104:107], a[196:199], v[24:27], v[104:107]
    v_mfma_f32_16x16x32_bf16 v[104:107], a[200:203], v[40:43], v[104:107]
    v_mfma_f32_16x16x32_bf16 v[104:107], a[204:207], v[56:59], v[104:107]
    v_mfma_f32_16x16x32_bf16 v[104:107], a[208:211], v[72:75], v[104:107]
    v_mfma_f32_16x16x32_bf16 v[104:107], a[212:215], v[88:91], v[104:107]
    v_mfma_f32_16x16x32_bf16 v[108:111], a[192:195], v[12:15], 0
    v_mfma_f32_16x16x32_bf16 v[108:111], a[196:199], v[28:31], v[108:111]
    v_mfma_f32_16x16x32_bf16 v[108:111], a[200:203], v[44:47], v[108:111]
    v_mfma_f32_16x16x32_bf16 v[108:111], a[204:207], v[60:63], v[108:111]
    v_mfma_f32_16x16x32_bf16 v[108:111], a[208:211], v[76:79], v[108:111]
    v_mfma_f32_16x16x32_bf16 v[108:111], a[212:215], v[92:95], v[108:111]
    s_nop 7
    v_max3_f32 v230, v96, v97, v230
    v_max3_f32 v230, v98, v99, v230
    v_max3_f32 v231, v100, v101, v231
    v_max3_f32 v231, v102, v103, v231
    v_max3_f32 v232, v104, v105, v232
    v_max3_f32 v232, v106, v107, v232
    v_max3_f32 v233, v108, v109, v233
    v_max3_f32 v233, v110, v111, v233
    ds_read_b128 a[192:195], v208 offset:6144
    ds_read_b128 a[196:199], v209 offset:6144
    ds_read_b128 a[200:203], v208 offset:6272
    ds_read_b128 a[204:207], v209 offset:6272
    ds_read_b128 a[208:211], v208 offset:6400
    ds_read_b128 a[212:215], v209 offset:6400
    s_waitcnt lgkmcnt(0)
    v_mfma_f32_16x16x32_bf16 v[96:99], a[192:195], v[0:3], 0
    v_mfma_f32_16x16x32_bf16 v[96:99], a[196:199], v[16:19], v[96:99]
    v_mfma_f32_16x16x32_bf16 v[96:99], a[200:203], v[32:35], v[96:99]
    v_mfma_f32_16x16x32_bf16 v[96:99], a[204:207], v[48:51], v[96:99]
    v_mfma_f32_16x16x32_bf16 v[96:99], a[208:211], v[64:67], v[96:99]
    v_mfma_f32_16x16x32_bf16 v[96:99], a[212:215], v[80:83], v[96:99]
    v_mfma_f32_16x16x32_bf16 v[100:103], a[192:195], v[4:7], 0
    v_mfma_f32_16x16x32_bf16 v[100:103], a[196:199], v[20:23], v[100:103]
    v_mfma_f32_16x16x32_bf16 v[100:103], a[200:203], v[36:39], v[100:103]
    v_mfma_f32_16x16x32_bf16 v[100:103], a[204:207], v[52:55], v[100:103]
    v_mfma_f32_16x16x32_bf16 v[100:103], a[208:211], v[68:71], v[100:103]
    v_mfma_f32_16x16x32_bf16 v[100:103], a[212:215], v[84:87], v[100:103]
    v_mfma_f32_16x16x32_bf16 v[104:107], a[192:195], v[8:11], 0
    v_mfma_f32_16x16x32_bf16 v[104:107], a[196:199], v[24:27], v[104:107]
    v_mfma_f32_16x16x32_bf16 v[104:107], a[200:203], v[40:43], v[104:107]
    v_mfma_f32_16x16x32_bf16 v[104:107], a[204:207], v[56:59], v[104:107]
    v_mfma_f32_16x16x32_bf16 v[104:107], a[208:211], v[72:75], v[104:107]
    v_mfma_f32_16x16x32_bf16 v[104:107], a[212:215], v[88:91], v[104:107]
    v_mfma_f32_16x16x32_bf16 v[108:111], a[192:195], v[12:15], 0
    v_mfma_f32_16x16x32_bf16 v[108:111], a[196:199], v[28:31], v[108:111]
    v_mfma_f32_16x16x32_bf16 v[108:111], a[200:203], v[44:47], v[108:111]
    v_mfma_f32_16x16x32_bf16 v[108:111], a[204:207], v[60:63], v[108:111]
    v_mfma_f32_16x16x32_bf16 v[108:111], a[208:211], v[76:79], v[108:111]
    v_mfma_f32_16x16x32_bf16 v[108:111], a[212:215], v[92:95], v[108:111]
    s_nop 7
    v_max3_f32 v230, v96, v97, v230
    v_max3_f32 v230, v98, v99, v230
    v_max3_f32 v231, v100, v101, v231
    v_max3_f32 v231, v102, v103, v231
    v_max3_f32 v232, v104, v105, v232
    v_max3_f32 v232, v106, v107, v232
    v_max3_f32 v233, v108, v109, v233
    v_max3_f32 v233, v110, v111, v233
    s_barrier
    s_sub_u32 s28, s28, 1
    s_cmp_lg_u32 s28, 0
    s_cbranch_scc1 L_attn_fb_loop
    s_mov_b32 s26, 0
    s_mov_b32 s27, 0
    s_add_u32 m0, s25, 0
    s_nop 0
    buffer_load_dwordx4 v220, s[4:7], s26 offen offset:0  lds
    buffer_load_dwordx4 v221, s[4:7], s26 offen offset:1024  lds
    buffer_load_dwordx4 v222, s[4:7], s26 offen offset:2048  lds
    s_add_u32 s26, s26, 12288
    s_add_u32 m0, s25, 12288
    s_nop 0
    buffer_load_dwordx4 v220, s[4:7], s26 offen offset:0  lds
    buffer_load_dwordx4 v221, s[4:7], s26 offen offset:1024  lds
    buffer_load_dwordx4 v222, s[4:7], s26 offen offset:2048  lds
    s_add_u32 s26, s26, 12288
    s_add_u32 m0, s25, 24576
    s_nop 0
    buffer_load_dwordx4 v220, s[4:7], s26 offen offset:0  lds
    buffer_load_dwordx4 v221, s[4:7], s26 offen offset:1024  lds
    buffer_load_dwordx4 v222, s[4:7], s26 offen offset:2048  lds
    s_add_u32 s26, s26, 12288
    s_add_u32 m0, s25, 36864
    s_nop 0
    buffer_load_dwordx4 v220, s[4:7], s26 offen offset:0  lds
    buffer_load_dwordx4 v221, s[4:7], s26 offen offset:1024  lds
    buffer_load_dwordx4 v222, s[4:7], s26 offen offset:2048  lds
    s_add_u32 s26, s26, 12288
    s_add_u32 m0, s25, 73728
    s_nop 0
    buffer_load_dwordx4 v223, s[8:11], s27 offen offset:0  lds
    buffer_load_dwordx4 v224, s[8:11], s27 offen offset:1024  lds
    buffer_load_dwordx4 v225, s[8:11], s27 offen offset:2048  lds
    s_add_u32 s27, s27, 12288
    s_add_u32 m0, s25, 86016
    s_nop 0
    buffer_load_dwordx4 v223, s[8:11], s27 offen offset:0  lds
    buffer_load_dwordx4 v224, s[8:11], s27 offen offset:1024  lds
    buffer_load_dwordx4 v225, s[8:11], s27 offen offset:2048  lds
    s_add_u32 s27, s27, 12288
    s_add_u32 m0, s25, 49152
    s_nop 0
    buffer_load_dwordx4 v220, s[4:7], s26 offen offset:0  lds
    buffer_load_dwordx4 v221, s[4:7], s26 offen offset:1024  lds
    buffer_load_dwordx4 v222, s[4:7], s26 offen offset:2048  lds
    s_add_u32 s26, s26, 12288
    s_add_u32 m0, s25, 61440
    s_nop 0
    buffer_load_dwordx4 v220, s[4:7], s26 offen offset:0  lds
    buffer_load_dwordx4 v221, s[4:7], s26 offen offset:1024  lds
    buffer_load_dwordx4 v222, s[4:7], s26 offen offset:2048  lds
    s_add_u32 s26, s26, 12288
    s_add_u32 m0, s25, 98304
    s_nop 0
    buffer_load_dwordx4 v223, s[8:11], s27 offen offset:0  lds
    buffer_load_dwordx4 v224, s[8:11], s27 offen offset:1024  lds
    buffer_load_dwordx4 v225, s[8:11], s27 offen offset:2048  lds
    s_add_u32 s27, s27, 12288
    s_add_u32 m0, s25, 110592
    s_nop 0
    buffer_load_dwordx4 v223, s[8:11], s27 offen offset:0  lds
    buffer_load_dwordx4 v224, s[8:11], s27 offen offset:1024  lds
    buffer_load_dwordx4 v225, s[8:11], s27 offen offset:2048  lds
    s_add_u32 s27, s27, 12288
    s_waitcnt vmcnt(0)
    s_barrier
    s_branch L_attn_restart
L_attn_end:
    s_endpgm
.section .rodata,"a"
.p2align 6
.amdhsa_kernel mod_kernel
  .amdhsa_next_free_vgpr 64
  .amdhsa_next_free_sgpr 96
  .amdhsa_accum_offset 64
  .amdhsa_group_segment_fixed_size 0
  .amdhsa_kernarg_size 120
  .amdhsa_user_sgpr_count 2
  .amdhsa_user_sgpr_kernarg_segment_ptr 1
  .amdhsa_system_sgpr_workgroup_id_x 1
.end_amdhsa_kernel
.p2align 6
.amdhsa_kernel attn_kernel
  .amdhsa_next_free_vgpr 512
  .amdhsa_next_free_sgpr 102
  .amdhsa_accum_offset 256
  .amdhsa_group_segment_fixed_size 0
  .amdhsa_kernarg_size 120
  .amdhsa_user_sgpr_count 2
  .amdhsa_user_sgpr_kernarg_segment_ptr 1
  .amdhsa_system_sgpr_workgroup_id_x 1
.end_amdhsa_kernel
```
